```python
import torch

def _softmax(x, axis=-1):
    return torch.softmax(x, dim=axis)
def _gelu(x):
    return torch.nn.functional.gelu(x, approximate="tanh")
def _silu(x):
    return torch.nn.functional.silu(x)
def _sigmoid(x):
    return torch.sigmoid(x)
def _layernorm(x, axis=-1, eps=1e-5):
    m = x.mean(dim=axis, keepdim=True)
    v = x.var(dim=axis, keepdim=True, unbiased=False)
    return (x - m) / torch.sqrt(v + eps)
def _scatter_add(tgt, idx, src, axis=0):
    return tgt.clone().index_add_(axis, idx, src)
def _segment_sum(src, seg, n):
    out = torch.zeros((n,) + src.shape[1:], dtype=src.dtype)
    return out.index_add_(0, seg, src)
def _pad(x, pw):
    flat = tuple(v for pair in reversed(pw) for v in pair)
    return torch.nn.functional.pad(x, flat)

kernel_name = 'recurrent_scan__spectral_gfnet__glu_gated_geglu__prompt'

def setup_inputs():

    _w = (lambda a: (lambda t: t.to(torch.bfloat16) if t.is_floating_point() else t)(torch.as_tensor(a)))
    def _A_setup():
        B, S, D = 1, 2048, 1024
        Df = D // 2 + 1
        return {
            "x": _w((lambda *s: torch.randn(*s, dtype=torch.bfloat16) * 0.2)(B, S, D)),
            "w_r": _w((lambda *s: torch.randn(*s, dtype=torch.bfloat16) * 1.6)(S, Df) * 0.02),
            "w_i": _w((lambda *s: torch.randn(*s, dtype=torch.bfloat16) * 1.6)(S, Df) * 0.02),
        }
    _A_in = _A_setup()

    def _B_setup():
        B, S, Dm, Df = 1, 2048, 1024, 3584
        return {
            "x": _w((lambda *s: torch.randn(*s, dtype=torch.bfloat16) * 0.2)(B, S, Dm)),
            "w_gate": _w((lambda *s: torch.randn(*s, dtype=torch.bfloat16) * 0.8)(Dm, Df) * (Dm ** -0.5)),
            "w_up": _w((lambda *s: torch.randn(*s, dtype=torch.bfloat16) * 0.8)(Dm, Df) * (Dm ** -0.5)),
            "w_down": _w((lambda *s: torch.randn(*s, dtype=torch.bfloat16) * 0.8)(Df, Dm) * (Df ** -0.5)),
        }
    _B_in = _B_setup()

    return {
        "A_x": _A_in["x"],
        "A_w_r": _A_in["w_r"],
        "A_w_i": _A_in["w_i"],
        "B_x": _B_in["x"],
        "B_w_gate": _B_in["w_gate"],
        "B_w_up": _B_in["w_up"],
        "B_w_down": _B_in["w_down"],
    }

def reference(A_x, A_w_r, A_w_i, B_x, B_w_gate, B_w_up, B_w_down):
    def _A_ref(x, w_r, w_i):
        B, S, D = x.shape
        X = (lambda x, axes=(-2,-1): torch.fft.rfft2(x.float(), dim=axes))(x, axes=(-2, -1))
        W = w_r + 1j * w_i
        X = X * W
        y = (lambda x, s, axes=(-2,-1): torch.fft.irfft2(x, s=s, dim=axes).to(torch.bfloat16))(X, (S, D), axes=(-2, -1))
        return y

    def _B_ref(x, w_gate, w_up, w_down):
        g = torch.einsum("bsd,df->bsf", x, w_gate)
        u = torch.einsum("bsd,df->bsf", x, w_up)
        h = _gelu(g) * u
        return torch.einsum("bsf,fd->bsd", h, w_down)

    x = A_x
    xn = _layernorm(x, axis=-1)
    s = _A_ref(xn, A_w_r, A_w_i)
    g = _silu(_B_ref(xn, B_w_gate, B_w_up, B_w_down))
    return x + s * g
```

```asm
; @launch kernel=k1_rowfft_kernel grid=(544,1,1) block=(256,1,1) lds=34816
; @launch kernel=k2_colfft_kernel grid=(513,1,1) block=(128,1,1) lds=34816
; @launch kernel=k3_irfft_kernel grid=(256,1,1) block=(256,1,1) lds=34816
; @launch kernel=k2_gemm1_kernel grid=(256,1,1) block=(512,1,1) lds=135168
; @launch kernel=k4_gemm2_kernel grid=(256,1,1) block=(512,1,1) lds=147456
.amdgcn_target "amdgcn-amd-amdhsa--gfx950"
.text
.globl k1_rowfft_kernel
.p2align 8
.type k1_rowfft_kernel,@function
k1_rowfft_kernel:
    s_cmp_ge_u32 s2, 256
    s_cbranch_scc1 K1_WT
    s_load_dwordx2 s[4:5], s[0:1], 0
    s_load_dwordx2 s[6:7], s[0:1], 72
    s_mov_b32 s16, 0x3f6c835e
    s_mov_b32 s17, 0xbf6c835e
    s_mov_b32 s18, 0x3ec3ef15
    s_mov_b32 s19, 0xbec3ef15
    s_mov_b32 s20, 0x3f3504f3
    s_mov_b32 s21, 0xbf3504f3
    s_getpc_b64 s[26:27]
    s_add_u32 s26, s26, T1024_tw1A@rel32@lo+4
    s_addc_u32 s27, s27, T1024_tw1A@rel32@hi+12
    v_and_b32 v1, 63, v0
    v_lshrrev_b32 v2, 6, v0
    s_nop 0
    v_readfirstlane_b32 s23, v2
    s_waitcnt lgkmcnt(0)
    s_mov_b32 s8, s4
    s_mov_b32 s9, s5
    s_mov_b32 s10, 4194304
    s_mov_b32 s11, 0x00020000
    s_mov_b32 s12, s6
    s_mov_b32 s13, s7
    s_mov_b32 s14, 268435456
    s_mov_b32 s15, 0x00020000
    s_lshl_b32 s24, s2, 2
    s_add_u32 s23, s24, s23
    s_lshl_b32 s24, s23, 12
    v_lshlrev_b32 v3, 4, v1
    buffer_load_dwordx4 v[4:7], v3, s[8:11], s24 offen offset:0
    buffer_load_dwordx4 v[8:11], v3, s[8:11], s24 offen offset:1024
    buffer_load_dwordx4 v[12:15], v3, s[8:11], s24 offen offset:2048
    buffer_load_dwordx4 v[16:19], v3, s[8:11], s24 offen offset:3072
    v_lshlrev_b32 v20, 3, v1
    global_load_dwordx2 v[22:23], v20, s[26:27] offset:512
    global_load_dwordx2 v[24:25], v20, s[26:27] offset:1024
    global_load_dwordx2 v[26:27], v20, s[26:27] offset:1536
    global_load_dwordx2 v[28:29], v20, s[26:27] offset:2048
    global_load_dwordx2 v[30:31], v20, s[26:27] offset:2560
    global_load_dwordx2 v[32:33], v20, s[26:27] offset:3072
    global_load_dwordx2 v[34:35], v20, s[26:27] offset:3584
    v_add_u32 v20, 4096, v20
    global_load_dwordx2 v[36:37], v20, s[26:27] offset:0
    global_load_dwordx2 v[38:39], v20, s[26:27] offset:512
    global_load_dwordx2 v[40:41], v20, s[26:27] offset:1024
    global_load_dwordx2 v[42:43], v20, s[26:27] offset:1536
    global_load_dwordx2 v[44:45], v20, s[26:27] offset:2048
    global_load_dwordx2 v[46:47], v20, s[26:27] offset:2560
    global_load_dwordx2 v[48:49], v20, s[26:27] offset:3072
    global_load_dwordx2 v[50:51], v20, s[26:27] offset:3584
    v_add_u32 v20, 4096, v20
    global_load_dwordx2 v[52:53], v20, s[26:27] offset:512
    global_load_dwordx2 v[54:55], v20, s[26:27] offset:1024
    global_load_dwordx2 v[56:57], v20, s[26:27] offset:1536
    global_load_dwordx2 v[58:59], v20, s[26:27] offset:2048
    global_load_dwordx2 v[60:61], v20, s[26:27] offset:2560
    global_load_dwordx2 v[62:63], v20, s[26:27] offset:3072
    global_load_dwordx2 v[64:65], v20, s[26:27] offset:3584
    v_add_u32 v20, 4096, v20
    global_load_dwordx2 v[66:67], v20, s[26:27] offset:0
    global_load_dwordx2 v[68:69], v20, s[26:27] offset:512
    global_load_dwordx2 v[70:71], v20, s[26:27] offset:1024
    global_load_dwordx2 v[72:73], v20, s[26:27] offset:1536
    global_load_dwordx2 v[74:75], v20, s[26:27] offset:2048
    global_load_dwordx2 v[76:77], v20, s[26:27] offset:2560
    global_load_dwordx2 v[78:79], v20, s[26:27] offset:3072
    global_load_dwordx2 v[80:81], v20, s[26:27] offset:3584
    s_mov_b32 s25, 8704
    v_mul_lo_u32 v21, v2, s25
    v_lshl_add_u32 v84, v1, 3, v21
    v_lshrrev_b32 v82, 2, v1
    v_and_b32 v83, 3, v1
    s_mov_b32 s22, 544
    v_mul_lo_u32 v85, v82, s22
    v_lshl_add_u32 v85, v83, 3, v85
    v_add_u32 v85, v85, v21
    v_lshrrev_b32 v87, 3, v82
    v_mul_u32_u24 v87, 8, v87
    v_lshl_add_u32 v86, v1, 3, v87
    v_add_u32 v86, v86, v21
    s_mov_b32 s22, 528
    v_mul_lo_u32 v88, v82, s22
    v_lshl_add_u32 v88, v83, 7, v88
    v_mul_u32_u24 v87, 4, v83
    v_lshrrev_b32 v87, 3, v87
    v_mul_u32_u24 v87, 8, v87
    v_add_u32 v88, v88, v87
    v_add_u32 v88, v88, v21
    s_waitcnt vmcnt(30)
    v_lshlrev_b32 v92, 16, v4
    v_and_b32 v93, 0xffff0000, v4
    v_lshlrev_b32 v94, 16, v5
    v_and_b32 v95, 0xffff0000, v5
    v_lshlrev_b32 v96, 16, v6
    v_and_b32 v97, 0xffff0000, v6
    v_lshlrev_b32 v98, 16, v7
    v_and_b32 v99, 0xffff0000, v7
    v_lshlrev_b32 v100, 16, v8
    v_and_b32 v101, 0xffff0000, v8
    v_lshlrev_b32 v102, 16, v9
    v_and_b32 v103, 0xffff0000, v9
    v_lshlrev_b32 v104, 16, v10
    v_and_b32 v105, 0xffff0000, v10
    v_lshlrev_b32 v106, 16, v11
    v_and_b32 v107, 0xffff0000, v11
    v_lshlrev_b32 v108, 16, v12
    v_and_b32 v109, 0xffff0000, v12
    v_lshlrev_b32 v110, 16, v13
    v_and_b32 v111, 0xffff0000, v13
    v_lshlrev_b32 v112, 16, v14
    v_and_b32 v113, 0xffff0000, v14
    v_lshlrev_b32 v114, 16, v15
    v_and_b32 v115, 0xffff0000, v15
    v_lshlrev_b32 v116, 16, v16
    v_and_b32 v117, 0xffff0000, v16
    v_lshlrev_b32 v118, 16, v17
    v_and_b32 v119, 0xffff0000, v17
    v_lshlrev_b32 v120, 16, v18
    v_and_b32 v121, 0xffff0000, v18
    v_lshlrev_b32 v122, 16, v19
    v_and_b32 v123, 0xffff0000, v19
    v_add_f32 v4, v92, v93
    v_add_f32 v5, v108, v109
    v_add_f32 v4, v4, v94
    v_add_f32 v5, v5, v110
    v_add_f32 v4, v4, v95
    v_add_f32 v5, v5, v111
    v_add_f32 v4, v4, v96
    v_add_f32 v5, v5, v112
    v_add_f32 v4, v4, v97
    v_add_f32 v5, v5, v113
    v_add_f32 v4, v4, v98
    v_add_f32 v5, v5, v114
    v_add_f32 v4, v4, v99
    v_add_f32 v5, v5, v115
    v_add_f32 v4, v4, v100
    v_add_f32 v5, v5, v116
    v_add_f32 v4, v4, v101
    v_add_f32 v5, v5, v117
    v_add_f32 v4, v4, v102
    v_add_f32 v5, v5, v118
    v_add_f32 v4, v4, v103
    v_add_f32 v5, v5, v119
    v_add_f32 v4, v4, v104
    v_add_f32 v5, v5, v120
    v_add_f32 v4, v4, v105
    v_add_f32 v5, v5, v121
    v_add_f32 v4, v4, v106
    v_add_f32 v5, v5, v122
    v_add_f32 v4, v4, v107
    v_add_f32 v5, v5, v123
    s_nop 1
    v_add_f32_dpp v4, v4, v4 quad_perm:[1,0,3,2] row_mask:0xf bank_mask:0xf
    v_add_f32_dpp v5, v5, v5 quad_perm:[1,0,3,2] row_mask:0xf bank_mask:0xf
    s_nop 1
    v_add_f32_dpp v4, v4, v4 quad_perm:[2,3,0,1] row_mask:0xf bank_mask:0xf
    v_add_f32_dpp v5, v5, v5 quad_perm:[2,3,0,1] row_mask:0xf bank_mask:0xf
    s_nop 1
    v_add_f32_dpp v4, v4, v4 row_ror:4 row_mask:0xf bank_mask:0xf
    v_add_f32_dpp v5, v5, v5 row_ror:4 row_mask:0xf bank_mask:0xf
    s_nop 1
    v_add_f32_dpp v4, v4, v4 row_ror:8 row_mask:0xf bank_mask:0xf
    v_add_f32_dpp v5, v5, v5 row_ror:8 row_mask:0xf bank_mask:0xf
    s_nop 1
    v_readlane_b32 s28, v4, 0
    v_readlane_b32 s32, v5, 0
    v_readlane_b32 s29, v4, 16
    v_readlane_b32 s33, v5, 16
    v_readlane_b32 s30, v4, 32
    v_readlane_b32 s34, v5, 32
    v_readlane_b32 s31, v4, 48
    v_readlane_b32 s35, v5, 48
    s_nop 1
    v_mov_b32 v4, s28
    v_mov_b32 v5, s32
    v_add_f32 v4, s29, v4
    v_add_f32 v5, s33, v5
    v_add_f32 v4, s30, v4
    v_add_f32 v5, s34, v5
    v_add_f32 v4, s31, v4
    v_add_f32 v5, s35, v5
    v_mul_f32 v4, 0x3a800000, v4
    v_mul_f32 v5, 0x3a800000, v5
    v_mov_b32 v6, 0
    v_mov_b32 v7, 0
    v_sub_f32 v8, v92, v4
    v_fma_f32 v6, v8, v8, v6
    v_sub_f32 v8, v93, v4
    v_fma_f32 v6, v8, v8, v6
    v_sub_f32 v8, v94, v4
    v_fma_f32 v6, v8, v8, v6
    v_sub_f32 v8, v95, v4
    v_fma_f32 v6, v8, v8, v6
    v_sub_f32 v8, v96, v4
    v_fma_f32 v6, v8, v8, v6
    v_sub_f32 v8, v97, v4
    v_fma_f32 v6, v8, v8, v6
    v_sub_f32 v8, v98, v4
    v_fma_f32 v6, v8, v8, v6
    v_sub_f32 v8, v99, v4
    v_fma_f32 v6, v8, v8, v6
    v_sub_f32 v8, v100, v4
    v_fma_f32 v6, v8, v8, v6
    v_sub_f32 v8, v101, v4
    v_fma_f32 v6, v8, v8, v6
    v_sub_f32 v8, v102, v4
    v_fma_f32 v6, v8, v8, v6
    v_sub_f32 v8, v103, v4
    v_fma_f32 v6, v8, v8, v6
    v_sub_f32 v8, v104, v4
    v_fma_f32 v6, v8, v8, v6
    v_sub_f32 v8, v105, v4
    v_fma_f32 v6, v8, v8, v6
    v_sub_f32 v8, v106, v4
    v_fma_f32 v6, v8, v8, v6
    v_sub_f32 v8, v107, v4
    v_fma_f32 v6, v8, v8, v6
    v_sub_f32 v8, v108, v5
    v_fma_f32 v7, v8, v8, v7
    v_sub_f32 v8, v109, v5
    v_fma_f32 v7, v8, v8, v7
    v_sub_f32 v8, v110, v5
    v_fma_f32 v7, v8, v8, v7
    v_sub_f32 v8, v111, v5
    v_fma_f32 v7, v8, v8, v7
    v_sub_f32 v8, v112, v5
    v_fma_f32 v7, v8, v8, v7
    v_sub_f32 v8, v113, v5
    v_fma_f32 v7, v8, v8, v7
    v_sub_f32 v8, v114, v5
    v_fma_f32 v7, v8, v8, v7
    v_sub_f32 v8, v115, v5
    v_fma_f32 v7, v8, v8, v7
    v_sub_f32 v8, v116, v5
    v_fma_f32 v7, v8, v8, v7
    v_sub_f32 v8, v117, v5
    v_fma_f32 v7, v8, v8, v7
    v_sub_f32 v8, v118, v5
    v_fma_f32 v7, v8, v8, v7
    v_sub_f32 v8, v119, v5
    v_fma_f32 v7, v8, v8, v7
    v_sub_f32 v8, v120, v5
    v_fma_f32 v7, v8, v8, v7
    v_sub_f32 v8, v121, v5
    v_fma_f32 v7, v8, v8, v7
    v_sub_f32 v8, v122, v5
    v_fma_f32 v7, v8, v8, v7
    v_sub_f32 v8, v123, v5
    v_fma_f32 v7, v8, v8, v7
    s_nop 1
    v_add_f32_dpp v6, v6, v6 quad_perm:[1,0,3,2] row_mask:0xf bank_mask:0xf
    v_add_f32_dpp v7, v7, v7 quad_perm:[1,0,3,2] row_mask:0xf bank_mask:0xf
    s_nop 1
    v_add_f32_dpp v6, v6, v6 quad_perm:[2,3,0,1] row_mask:0xf bank_mask:0xf
    v_add_f32_dpp v7, v7, v7 quad_perm:[2,3,0,1] row_mask:0xf bank_mask:0xf
    s_nop 1
    v_add_f32_dpp v6, v6, v6 row_ror:4 row_mask:0xf bank_mask:0xf
    v_add_f32_dpp v7, v7, v7 row_ror:4 row_mask:0xf bank_mask:0xf
    s_nop 1
    v_add_f32_dpp v6, v6, v6 row_ror:8 row_mask:0xf bank_mask:0xf
    v_add_f32_dpp v7, v7, v7 row_ror:8 row_mask:0xf bank_mask:0xf
    s_nop 1
    v_readlane_b32 s28, v6, 0
    v_readlane_b32 s32, v7, 0
    v_readlane_b32 s29, v6, 16
    v_readlane_b32 s33, v7, 16
    v_readlane_b32 s30, v6, 32
    v_readlane_b32 s34, v7, 32
    v_readlane_b32 s31, v6, 48
    v_readlane_b32 s35, v7, 48
    s_nop 1
    v_mov_b32 v6, s28
    v_mov_b32 v7, s32
    v_add_f32 v6, s29, v6
    v_add_f32 v7, s33, v7
    v_add_f32 v6, s30, v6
    v_add_f32 v7, s34, v7
    v_add_f32 v6, s31, v6
    v_add_f32 v7, s35, v7
    v_mul_f32 v6, 0x3a800000, v6
    v_mul_f32 v7, 0x3a800000, v7
    v_cvt_pk_bf16_f32 v9, v4, v5
    v_lshlrev_b32 v4, 16, v9
    v_and_b32 v5, 0xffff0000, v9
    v_cvt_pk_bf16_f32 v9, v6, v7
    v_lshlrev_b32 v6, 16, v9
    v_and_b32 v7, 0xffff0000, v9
    v_add_f32 v6, 0x3727c5ac, v6
    v_add_f32 v7, 0x3727c5ac, v7
    v_cvt_pk_bf16_f32 v9, v6, v7
    v_lshlrev_b32 v6, 16, v9
    v_and_b32 v7, 0xffff0000, v9
    v_sqrt_f32 v10, v6
    s_nop 0
    v_rcp_f32 v12, v10
    v_fma_f32 v8, -v10, v10, v6
    v_mul_f32 v12, 0.5, v12
    v_fma_f32 v10, v8, v12, v10
    v_sqrt_f32 v11, v7
    s_nop 0
    v_rcp_f32 v13, v11
    v_fma_f32 v8, -v11, v11, v7
    v_mul_f32 v13, 0.5, v13
    v_fma_f32 v11, v8, v13, v11
    v_cvt_pk_bf16_f32 v9, v10, v11
    v_lshlrev_b32 v10, 16, v9
    v_and_b32 v11, 0xffff0000, v9
    v_rcp_f32 v12, v10
    s_nop 0
    v_fma_f32 v8, -v10, v12, 1.0
    v_fma_f32 v12, v8, v12, v12
    v_rcp_f32 v13, v11
    s_nop 0
    v_fma_f32 v8, -v11, v13, 1.0
    v_fma_f32 v13, v8, v13, v13
    v_sub_f32 v92, v92, v4
    v_sub_f32 v93, v93, v4
    v_cvt_pk_bf16_f32 v9, v92, v93
    v_lshlrev_b32 v92, 16, v9
    v_and_b32 v93, 0xffff0000, v9
    v_mul_f32 v8, v92, v12
    v_fma_f32 v14, -v8, v10, v92
    v_fma_f32 v92, v14, v12, v8
    v_mul_f32 v8, v93, v12
    v_fma_f32 v14, -v8, v10, v93
    v_fma_f32 v93, v14, v12, v8
    v_cvt_pk_bf16_f32 v16, v92, v93
    v_lshlrev_b32 v92, 16, v16
    v_and_b32 v93, 0xffff0000, v16
    v_sub_f32 v94, v94, v4
    v_sub_f32 v95, v95, v4
    v_cvt_pk_bf16_f32 v9, v94, v95
    v_lshlrev_b32 v94, 16, v9
    v_and_b32 v95, 0xffff0000, v9
    v_mul_f32 v8, v94, v12
    v_fma_f32 v14, -v8, v10, v94
    v_fma_f32 v94, v14, v12, v8
    v_mul_f32 v8, v95, v12
    v_fma_f32 v14, -v8, v10, v95
    v_fma_f32 v95, v14, v12, v8
    v_cvt_pk_bf16_f32 v17, v94, v95
    v_lshlrev_b32 v94, 16, v17
    v_and_b32 v95, 0xffff0000, v17
    v_sub_f32 v96, v96, v4
    v_sub_f32 v97, v97, v4
    v_cvt_pk_bf16_f32 v9, v96, v97
    v_lshlrev_b32 v96, 16, v9
    v_and_b32 v97, 0xffff0000, v9
    v_mul_f32 v8, v96, v12
    v_fma_f32 v14, -v8, v10, v96
    v_fma_f32 v96, v14, v12, v8
    v_mul_f32 v8, v97, v12
    v_fma_f32 v14, -v8, v10, v97
    v_fma_f32 v97, v14, v12, v8
    v_cvt_pk_bf16_f32 v18, v96, v97
    v_lshlrev_b32 v96, 16, v18
    v_and_b32 v97, 0xffff0000, v18
    v_sub_f32 v98, v98, v4
    v_sub_f32 v99, v99, v4
    v_cvt_pk_bf16_f32 v9, v98, v99
    v_lshlrev_b32 v98, 16, v9
    v_and_b32 v99, 0xffff0000, v9
    v_mul_f32 v8, v98, v12
    v_fma_f32 v14, -v8, v10, v98
    v_fma_f32 v98, v14, v12, v8
    v_mul_f32 v8, v99, v12
    v_fma_f32 v14, -v8, v10, v99
    v_fma_f32 v99, v14, v12, v8
    v_cvt_pk_bf16_f32 v19, v98, v99
    v_lshlrev_b32 v98, 16, v19
    v_and_b32 v99, 0xffff0000, v19
    v_sub_f32 v100, v100, v4
    v_sub_f32 v101, v101, v4
    v_cvt_pk_bf16_f32 v9, v100, v101
    v_lshlrev_b32 v100, 16, v9
    v_and_b32 v101, 0xffff0000, v9
    v_mul_f32 v8, v100, v12
    v_fma_f32 v14, -v8, v10, v100
    v_fma_f32 v100, v14, v12, v8
    v_mul_f32 v8, v101, v12
    v_fma_f32 v14, -v8, v10, v101
    v_fma_f32 v101, v14, v12, v8
    v_cvt_pk_bf16_f32 v124, v100, v101
    v_lshlrev_b32 v100, 16, v124
    v_and_b32 v101, 0xffff0000, v124
    v_sub_f32 v102, v102, v4
    v_sub_f32 v103, v103, v4
    v_cvt_pk_bf16_f32 v9, v102, v103
    v_lshlrev_b32 v102, 16, v9
    v_and_b32 v103, 0xffff0000, v9
    v_mul_f32 v8, v102, v12
    v_fma_f32 v14, -v8, v10, v102
    v_fma_f32 v102, v14, v12, v8
    v_mul_f32 v8, v103, v12
    v_fma_f32 v14, -v8, v10, v103
    v_fma_f32 v103, v14, v12, v8
    v_cvt_pk_bf16_f32 v125, v102, v103
    v_lshlrev_b32 v102, 16, v125
    v_and_b32 v103, 0xffff0000, v125
    v_sub_f32 v104, v104, v4
    v_sub_f32 v105, v105, v4
    v_cvt_pk_bf16_f32 v9, v104, v105
    v_lshlrev_b32 v104, 16, v9
    v_and_b32 v105, 0xffff0000, v9
    v_mul_f32 v8, v104, v12
    v_fma_f32 v14, -v8, v10, v104
    v_fma_f32 v104, v14, v12, v8
    v_mul_f32 v8, v105, v12
    v_fma_f32 v14, -v8, v10, v105
    v_fma_f32 v105, v14, v12, v8
    v_cvt_pk_bf16_f32 v126, v104, v105
    v_lshlrev_b32 v104, 16, v126
    v_and_b32 v105, 0xffff0000, v126
    v_sub_f32 v106, v106, v4
    v_sub_f32 v107, v107, v4
    v_cvt_pk_bf16_f32 v9, v106, v107
    v_lshlrev_b32 v106, 16, v9
    v_and_b32 v107, 0xffff0000, v9
    v_mul_f32 v8, v106, v12
    v_fma_f32 v14, -v8, v10, v106
    v_fma_f32 v106, v14, v12, v8
    v_mul_f32 v8, v107, v12
    v_fma_f32 v14, -v8, v10, v107
    v_fma_f32 v107, v14, v12, v8
    v_cvt_pk_bf16_f32 v127, v106, v107
    v_lshlrev_b32 v106, 16, v127
    v_and_b32 v107, 0xffff0000, v127
    v_sub_f32 v108, v108, v5
    v_sub_f32 v109, v109, v5
    v_cvt_pk_bf16_f32 v9, v108, v109
    v_lshlrev_b32 v108, 16, v9
    v_and_b32 v109, 0xffff0000, v9
    v_mul_f32 v8, v108, v13
    v_fma_f32 v14, -v8, v11, v108
    v_fma_f32 v108, v14, v13, v8
    v_mul_f32 v8, v109, v13
    v_fma_f32 v14, -v8, v11, v109
    v_fma_f32 v109, v14, v13, v8
    v_cvt_pk_bf16_f32 v128, v108, v109
    v_lshlrev_b32 v108, 16, v128
    v_and_b32 v109, 0xffff0000, v128
    v_sub_f32 v110, v110, v5
    v_sub_f32 v111, v111, v5
    v_cvt_pk_bf16_f32 v9, v110, v111
    v_lshlrev_b32 v110, 16, v9
    v_and_b32 v111, 0xffff0000, v9
    v_mul_f32 v8, v110, v13
    v_fma_f32 v14, -v8, v11, v110
    v_fma_f32 v110, v14, v13, v8
    v_mul_f32 v8, v111, v13
    v_fma_f32 v14, -v8, v11, v111
    v_fma_f32 v111, v14, v13, v8
    v_cvt_pk_bf16_f32 v129, v110, v111
    v_lshlrev_b32 v110, 16, v129
    v_and_b32 v111, 0xffff0000, v129
    v_sub_f32 v112, v112, v5
    v_sub_f32 v113, v113, v5
    v_cvt_pk_bf16_f32 v9, v112, v113
    v_lshlrev_b32 v112, 16, v9
    v_and_b32 v113, 0xffff0000, v9
    v_mul_f32 v8, v112, v13
    v_fma_f32 v14, -v8, v11, v112
    v_fma_f32 v112, v14, v13, v8
    v_mul_f32 v8, v113, v13
    v_fma_f32 v14, -v8, v11, v113
    v_fma_f32 v113, v14, v13, v8
    v_cvt_pk_bf16_f32 v130, v112, v113
    v_lshlrev_b32 v112, 16, v130
    v_and_b32 v113, 0xffff0000, v130
    v_sub_f32 v114, v114, v5
    v_sub_f32 v115, v115, v5
    v_cvt_pk_bf16_f32 v9, v114, v115
    v_lshlrev_b32 v114, 16, v9
    v_and_b32 v115, 0xffff0000, v9
    v_mul_f32 v8, v114, v13
    v_fma_f32 v14, -v8, v11, v114
    v_fma_f32 v114, v14, v13, v8
    v_mul_f32 v8, v115, v13
    v_fma_f32 v14, -v8, v11, v115
    v_fma_f32 v115, v14, v13, v8
    v_cvt_pk_bf16_f32 v131, v114, v115
    v_lshlrev_b32 v114, 16, v131
    v_and_b32 v115, 0xffff0000, v131
    v_sub_f32 v116, v116, v5
    v_sub_f32 v117, v117, v5
    v_cvt_pk_bf16_f32 v9, v116, v117
    v_lshlrev_b32 v116, 16, v9
    v_and_b32 v117, 0xffff0000, v9
    v_mul_f32 v8, v116, v13
    v_fma_f32 v14, -v8, v11, v116
    v_fma_f32 v116, v14, v13, v8
    v_mul_f32 v8, v117, v13
    v_fma_f32 v14, -v8, v11, v117
    v_fma_f32 v117, v14, v13, v8
    v_cvt_pk_bf16_f32 v132, v116, v117
    v_lshlrev_b32 v116, 16, v132
    v_and_b32 v117, 0xffff0000, v132
    v_sub_f32 v118, v118, v5
    v_sub_f32 v119, v119, v5
    v_cvt_pk_bf16_f32 v9, v118, v119
    v_lshlrev_b32 v118, 16, v9
    v_and_b32 v119, 0xffff0000, v9
    v_mul_f32 v8, v118, v13
    v_fma_f32 v14, -v8, v11, v118
    v_fma_f32 v118, v14, v13, v8
    v_mul_f32 v8, v119, v13
    v_fma_f32 v14, -v8, v11, v119
    v_fma_f32 v119, v14, v13, v8
    v_cvt_pk_bf16_f32 v133, v118, v119
    v_lshlrev_b32 v118, 16, v133
    v_and_b32 v119, 0xffff0000, v133
    v_sub_f32 v120, v120, v5
    v_sub_f32 v121, v121, v5
    v_cvt_pk_bf16_f32 v9, v120, v121
    v_lshlrev_b32 v120, 16, v9
    v_and_b32 v121, 0xffff0000, v9
    v_mul_f32 v8, v120, v13
    v_fma_f32 v14, -v8, v11, v120
    v_fma_f32 v120, v14, v13, v8
    v_mul_f32 v8, v121, v13
    v_fma_f32 v14, -v8, v11, v121
    v_fma_f32 v121, v14, v13, v8
    v_cvt_pk_bf16_f32 v134, v120, v121
    v_lshlrev_b32 v120, 16, v134
    v_and_b32 v121, 0xffff0000, v134
    v_sub_f32 v122, v122, v5
    v_sub_f32 v123, v123, v5
    v_cvt_pk_bf16_f32 v9, v122, v123
    v_lshlrev_b32 v122, 16, v9
    v_and_b32 v123, 0xffff0000, v9
    v_mul_f32 v8, v122, v13
    v_fma_f32 v14, -v8, v11, v122
    v_fma_f32 v122, v14, v13, v8
    v_mul_f32 v8, v123, v13
    v_fma_f32 v14, -v8, v11, v123
    v_fma_f32 v123, v14, v13, v8
    v_cvt_pk_bf16_f32 v135, v122, v123
    v_lshlrev_b32 v122, 16, v135
    v_and_b32 v123, 0xffff0000, v135
    s_add_u32 s25, s24, 0
    buffer_store_dwordx4 v[16:19], v3, s[12:15], s25 offen offset:0
    buffer_store_dwordx4 v[124:127], v3, s[12:15], s25 offen offset:1024
    buffer_store_dwordx4 v[128:131], v3, s[12:15], s25 offen offset:2048
    buffer_store_dwordx4 v[132:135], v3, s[12:15], s25 offen offset:3072
    v_lshl_add_u32 v4, v1, 5, v21
    ds_write_b128 v4, v[92:95] offset:0
    ds_write_b128 v4, v[96:99] offset:16
    ds_write_b128 v4, v[100:103] offset:2048
    ds_write_b128 v4, v[104:107] offset:2064
    ds_write_b128 v4, v[108:111] offset:4096
    ds_write_b128 v4, v[112:115] offset:4112
    ds_write_b128 v4, v[116:119] offset:6144
    ds_write_b128 v4, v[120:123] offset:6160
    v_lshl_add_u32 v4, v1, 2, v21
    ds_read2st64_b32 v[6:7], v4 offset0:0 offset1:16
    ds_read2st64_b32 v[8:9], v4 offset0:1 offset1:17
    ds_read2st64_b32 v[10:11], v4 offset0:2 offset1:18
    ds_read2st64_b32 v[12:13], v4 offset0:3 offset1:19
    ds_read2st64_b32 v[14:15], v4 offset0:4 offset1:20
    ds_read2st64_b32 v[82:83], v4 offset0:5 offset1:21
    ds_read2st64_b32 v[90:91], v4 offset0:6 offset1:22
    ds_read2st64_b32 v[136:137], v4 offset0:7 offset1:23
    ds_read2st64_b32 v[138:139], v4 offset0:8 offset1:24
    ds_read2st64_b32 v[140:141], v4 offset0:9 offset1:25
    ds_read2st64_b32 v[142:143], v4 offset0:10 offset1:26
    ds_read2st64_b32 v[144:145], v4 offset0:11 offset1:27
    ds_read2st64_b32 v[146:147], v4 offset0:12 offset1:28
    ds_read2st64_b32 v[148:149], v4 offset0:13 offset1:29
    ds_read2st64_b32 v[150:151], v4 offset0:14 offset1:30
    ds_read2st64_b32 v[152:153], v4 offset0:15 offset1:31
    s_waitcnt lgkmcnt(0)
    s_waitcnt vmcnt(4)
    v_add_f32 v16, v6, v138
    v_add_f32 v17, v7, v139
    v_sub_f32 v18, v6, v138
    v_sub_f32 v19, v7, v139
    v_add_f32 v6, v14, v146
    v_add_f32 v7, v15, v147
    v_sub_f32 v92, v14, v146
    v_sub_f32 v93, v15, v147
    v_add_f32 v14, v16, v6
    v_add_f32 v15, v17, v7
    v_sub_f32 v94, v16, v6
    v_sub_f32 v95, v17, v7
    v_add_f32 v6, v18, v93
    v_sub_f32 v7, v19, v92
    v_sub_f32 v16, v18, v93
    v_add_f32 v17, v19, v92
    v_add_f32 v18, v8, v140
    v_add_f32 v19, v9, v141
    v_sub_f32 v92, v8, v140
    v_sub_f32 v93, v9, v141
    v_add_f32 v8, v82, v148
    v_add_f32 v9, v83, v149
    v_sub_f32 v96, v82, v148
    v_sub_f32 v97, v83, v149
    v_add_f32 v82, v18, v8
    v_add_f32 v83, v19, v9
    v_sub_f32 v98, v18, v8
    v_sub_f32 v99, v19, v9
    v_add_f32 v8, v92, v97
    v_sub_f32 v9, v93, v96
    v_sub_f32 v18, v92, v97
    v_add_f32 v19, v93, v96
    v_add_f32 v92, v10, v142
    v_add_f32 v93, v11, v143
    v_sub_f32 v96, v10, v142
    v_sub_f32 v97, v11, v143
    v_add_f32 v10, v90, v150
    v_add_f32 v11, v91, v151
    v_sub_f32 v100, v90, v150
    v_sub_f32 v101, v91, v151
    v_add_f32 v90, v92, v10
    v_add_f32 v91, v93, v11
    v_sub_f32 v102, v92, v10
    v_sub_f32 v103, v93, v11
    v_add_f32 v10, v96, v101
    v_sub_f32 v11, v97, v100
    v_sub_f32 v92, v96, v101
    v_add_f32 v93, v97, v100
    v_add_f32 v96, v12, v144
    v_add_f32 v97, v13, v145
    v_sub_f32 v100, v12, v144
    v_sub_f32 v101, v13, v145
    v_add_f32 v12, v136, v152
    v_add_f32 v13, v137, v153
    v_sub_f32 v104, v136, v152
    v_sub_f32 v105, v137, v153
    v_add_f32 v106, v96, v12
    v_add_f32 v107, v97, v13
    v_sub_f32 v108, v96, v12
    v_sub_f32 v109, v97, v13
    v_add_f32 v12, v100, v105
    v_sub_f32 v13, v101, v104
    v_sub_f32 v96, v100, v105
    v_add_f32 v97, v101, v104
    v_mul_f32 v100, s16, v8
    v_fma_f32 v100, v9, s18, v100
    v_mul_f32 v101, s19, v8
    v_fma_f32 v101, v9, s16, v101
    v_mul_f32 v8, s20, v98
    v_fma_f32 v8, v99, s20, v8
    v_mul_f32 v9, s21, v98
    v_fma_f32 v9, v99, s20, v9
    v_mul_f32 v98, s18, v18
    v_fma_f32 v98, v19, s16, v98
    v_mul_f32 v99, s17, v18
    v_fma_f32 v99, v19, s18, v99
    v_mul_f32 v18, s20, v10
    v_fma_f32 v18, v11, s20, v18
    v_mul_f32 v19, s21, v10
    v_fma_f32 v19, v11, s20, v19
    v_mov_b32 v10, v103
    v_sub_f32 v11, 0, v102
    v_mul_f32 v102, s21, v92
    v_fma_f32 v102, v93, s20, v102
    v_mul_f32 v103, s21, v92
    v_fma_f32 v103, v93, s21, v103
    v_mul_f32 v92, s18, v12
    v_fma_f32 v92, v13, s16, v92
    v_mul_f32 v93, s17, v12
    v_fma_f32 v93, v13, s18, v93
    v_mul_f32 v12, s21, v108
    v_fma_f32 v12, v109, s20, v12
    v_mul_f32 v13, s21, v108
    v_fma_f32 v13, v109, s21, v13
    v_mul_f32 v104, s17, v96
    v_fma_f32 v104, v97, s19, v104
    v_mul_f32 v105, s18, v96
    v_fma_f32 v105, v97, s17, v105
    v_add_f32 v96, v14, v90
    v_add_f32 v97, v15, v91
    v_sub_f32 v108, v14, v90
    v_sub_f32 v109, v15, v91
    v_add_f32 v14, v82, v106
    v_add_f32 v15, v83, v107
    v_sub_f32 v90, v82, v106
    v_sub_f32 v91, v83, v107
    v_add_f32 v82, v96, v14
    v_add_f32 v83, v97, v15
    v_sub_f32 v106, v96, v14
    v_sub_f32 v107, v97, v15
    v_add_f32 v14, v108, v91
    v_sub_f32 v15, v109, v90
    v_sub_f32 v96, v108, v91
    v_add_f32 v97, v109, v90
    v_add_f32 v90, v6, v18
    v_add_f32 v91, v7, v19
    v_sub_f32 v108, v6, v18
    v_sub_f32 v109, v7, v19
    v_add_f32 v6, v100, v92
    v_add_f32 v7, v101, v93
    v_sub_f32 v18, v100, v92
    v_sub_f32 v19, v101, v93
    v_add_f32 v92, v90, v6
    v_add_f32 v93, v91, v7
    v_sub_f32 v100, v90, v6
    v_sub_f32 v101, v91, v7
    v_add_f32 v6, v108, v19
    v_sub_f32 v7, v109, v18
    v_sub_f32 v90, v108, v19
    v_add_f32 v91, v109, v18
    v_add_f32 v18, v94, v10
    v_add_f32 v19, v95, v11
    v_sub_f32 v108, v94, v10
    v_sub_f32 v109, v95, v11
    v_add_f32 v10, v8, v12
    v_add_f32 v11, v9, v13
    v_sub_f32 v94, v8, v12
    v_sub_f32 v95, v9, v13
    v_add_f32 v8, v18, v10
    v_add_f32 v9, v19, v11
    v_sub_f32 v12, v18, v10
    v_sub_f32 v13, v19, v11
    v_add_f32 v10, v108, v95
    v_sub_f32 v11, v109, v94
    v_sub_f32 v18, v108, v95
    v_add_f32 v19, v109, v94
    v_add_f32 v94, v16, v102
    v_add_f32 v95, v17, v103
    v_sub_f32 v108, v16, v102
    v_sub_f32 v109, v17, v103
    v_add_f32 v16, v98, v104
    v_add_f32 v17, v99, v105
    v_sub_f32 v102, v98, v104
    v_sub_f32 v103, v99, v105
    v_add_f32 v98, v94, v16
    v_add_f32 v99, v95, v17
    v_sub_f32 v104, v94, v16
    v_sub_f32 v105, v95, v17
    v_add_f32 v16, v108, v103
    v_sub_f32 v17, v109, v102
    v_sub_f32 v94, v108, v103
    v_add_f32 v95, v109, v102
    v_mul_f32 v102, v92, v22
    v_fma_f32 v102, -v93, v23, v102
    v_mul_f32 v103, v93, v22
    v_fma_f32 v103, v92, v23, v103
    v_mul_f32 v92, v8, v24
    v_fma_f32 v92, -v9, v25, v92
    v_mul_f32 v93, v9, v24
    v_fma_f32 v93, v8, v25, v93
    v_mul_f32 v8, v98, v26
    v_fma_f32 v8, -v99, v27, v8
    v_mul_f32 v9, v99, v26
    v_fma_f32 v9, v98, v27, v9
    v_mul_f32 v98, v14, v28
    v_fma_f32 v98, -v15, v29, v98
    v_mul_f32 v99, v15, v28
    v_fma_f32 v99, v14, v29, v99
    v_mul_f32 v14, v6, v30
    v_fma_f32 v14, -v7, v31, v14
    v_mul_f32 v15, v7, v30
    v_fma_f32 v15, v6, v31, v15
    v_mul_f32 v6, v10, v32
    v_fma_f32 v6, -v11, v33, v6
    v_mul_f32 v7, v11, v32
    v_fma_f32 v7, v10, v33, v7
    v_mul_f32 v10, v16, v34
    v_fma_f32 v10, -v17, v35, v10
    v_mul_f32 v11, v17, v34
    v_fma_f32 v11, v16, v35, v11
    v_mul_f32 v16, v106, v36
    v_fma_f32 v16, -v107, v37, v16
    v_mul_f32 v17, v107, v36
    v_fma_f32 v17, v106, v37, v17
    v_mul_f32 v106, v100, v38
    v_fma_f32 v106, -v101, v39, v106
    v_mul_f32 v107, v101, v38
    v_fma_f32 v107, v100, v39, v107
    v_mul_f32 v100, v12, v40
    v_fma_f32 v100, -v13, v41, v100
    v_mul_f32 v101, v13, v40
    v_fma_f32 v101, v12, v41, v101
    v_mul_f32 v12, v104, v42
    v_fma_f32 v12, -v105, v43, v12
    v_mul_f32 v13, v105, v42
    v_fma_f32 v13, v104, v43, v13
    v_mul_f32 v104, v96, v44
    v_fma_f32 v104, -v97, v45, v104
    v_mul_f32 v105, v97, v44
    v_fma_f32 v105, v96, v45, v105
    v_mul_f32 v96, v90, v46
    v_fma_f32 v96, -v91, v47, v96
    v_mul_f32 v97, v91, v46
    v_fma_f32 v97, v90, v47, v97
    v_mul_f32 v90, v18, v48
    v_fma_f32 v90, -v19, v49, v90
    v_mul_f32 v91, v19, v48
    v_fma_f32 v91, v18, v49, v91
    v_mul_f32 v18, v94, v50
    v_fma_f32 v18, -v95, v51, v18
    v_mul_f32 v19, v95, v50
    v_fma_f32 v19, v94, v51, v19
    ds_write_b64 v84, v[82:83] offset:0
    ds_write_b64 v84, v[102:103] offset:544
    ds_write_b64 v84, v[92:93] offset:1088
    ds_write_b64 v84, v[8:9] offset:1632
    ds_write_b64 v84, v[98:99] offset:2176
    ds_write_b64 v84, v[14:15] offset:2720
    ds_write_b64 v84, v[6:7] offset:3264
    ds_write_b64 v84, v[10:11] offset:3808
    ds_write_b64 v84, v[16:17] offset:4352
    ds_write_b64 v84, v[106:107] offset:4896
    ds_write_b64 v84, v[100:101] offset:5440
    ds_write_b64 v84, v[12:13] offset:5984
    ds_write_b64 v84, v[104:105] offset:6528
    ds_write_b64 v84, v[96:97] offset:7072
    ds_write_b64 v84, v[90:91] offset:7616
    ds_write_b64 v84, v[18:19] offset:8160
    ds_read_b64 v[6:7], v85 offset:0
    ds_read_b64 v[8:9], v85 offset:32
    ds_read_b64 v[10:11], v85 offset:64
    ds_read_b64 v[12:13], v85 offset:96
    ds_read_b64 v[14:15], v85 offset:128
    ds_read_b64 v[16:17], v85 offset:160
    ds_read_b64 v[18:19], v85 offset:192
    ds_read_b64 v[82:83], v85 offset:224
    ds_read_b64 v[90:91], v85 offset:256
    ds_read_b64 v[92:93], v85 offset:288
    ds_read_b64 v[94:95], v85 offset:320
    ds_read_b64 v[96:97], v85 offset:352
    ds_read_b64 v[98:99], v85 offset:384
    ds_read_b64 v[100:101], v85 offset:416
    ds_read_b64 v[102:103], v85 offset:448
    ds_read_b64 v[104:105], v85 offset:480
    s_waitcnt lgkmcnt(0)
    v_add_f32 v106, v6, v90
    v_add_f32 v107, v7, v91
    v_sub_f32 v108, v6, v90
    v_sub_f32 v109, v7, v91
    v_add_f32 v6, v14, v98
    v_add_f32 v7, v15, v99
    v_sub_f32 v90, v14, v98
    v_sub_f32 v91, v15, v99
    v_add_f32 v14, v106, v6
    v_add_f32 v15, v107, v7
    v_sub_f32 v98, v106, v6
    v_sub_f32 v99, v107, v7
    v_add_f32 v6, v108, v91
    v_sub_f32 v7, v109, v90
    v_sub_f32 v106, v108, v91
    v_add_f32 v107, v109, v90
    v_add_f32 v90, v8, v92
    v_add_f32 v91, v9, v93
    v_sub_f32 v108, v8, v92
    v_sub_f32 v109, v9, v93
    v_add_f32 v8, v16, v100
    v_add_f32 v9, v17, v101
    v_sub_f32 v92, v16, v100
    v_sub_f32 v93, v17, v101
    v_add_f32 v16, v90, v8
    v_add_f32 v17, v91, v9
    v_sub_f32 v100, v90, v8
    v_sub_f32 v101, v91, v9
    v_add_f32 v8, v108, v93
    v_sub_f32 v9, v109, v92
    v_sub_f32 v90, v108, v93
    v_add_f32 v91, v109, v92
    v_add_f32 v92, v10, v94
    v_add_f32 v93, v11, v95
    v_sub_f32 v108, v10, v94
    v_sub_f32 v109, v11, v95
    v_add_f32 v10, v18, v102
    v_add_f32 v11, v19, v103
    v_sub_f32 v94, v18, v102
    v_sub_f32 v95, v19, v103
    v_add_f32 v18, v92, v10
    v_add_f32 v19, v93, v11
    v_sub_f32 v102, v92, v10
    v_sub_f32 v103, v93, v11
    v_add_f32 v10, v108, v95
    v_sub_f32 v11, v109, v94
    v_sub_f32 v92, v108, v95
    v_add_f32 v93, v109, v94
    v_add_f32 v94, v12, v96
    v_add_f32 v95, v13, v97
    v_sub_f32 v108, v12, v96
    v_sub_f32 v109, v13, v97
    v_add_f32 v12, v82, v104
    v_add_f32 v13, v83, v105
    v_sub_f32 v96, v82, v104
    v_sub_f32 v97, v83, v105
    v_add_f32 v82, v94, v12
    v_add_f32 v83, v95, v13
    v_sub_f32 v104, v94, v12
    v_sub_f32 v105, v95, v13
    v_add_f32 v12, v108, v97
    v_sub_f32 v13, v109, v96
    v_sub_f32 v94, v108, v97
    v_add_f32 v95, v109, v96
    v_mul_f32 v96, s16, v8
    v_fma_f32 v96, v9, s18, v96
    v_mul_f32 v97, s19, v8
    v_fma_f32 v97, v9, s16, v97
    v_mul_f32 v8, s20, v100
    v_fma_f32 v8, v101, s20, v8
    v_mul_f32 v9, s21, v100
    v_fma_f32 v9, v101, s20, v9
    v_mul_f32 v100, s18, v90
    v_fma_f32 v100, v91, s16, v100
    v_mul_f32 v101, s17, v90
    v_fma_f32 v101, v91, s18, v101
    v_mul_f32 v90, s20, v10
    v_fma_f32 v90, v11, s20, v90
    v_mul_f32 v91, s21, v10
    v_fma_f32 v91, v11, s20, v91
    v_mov_b32 v10, v103
    v_sub_f32 v11, 0, v102
    v_mul_f32 v102, s21, v92
    v_fma_f32 v102, v93, s20, v102
    v_mul_f32 v103, s21, v92
    v_fma_f32 v103, v93, s21, v103
    v_mul_f32 v92, s18, v12
    v_fma_f32 v92, v13, s16, v92
    v_mul_f32 v93, s17, v12
    v_fma_f32 v93, v13, s18, v93
    v_mul_f32 v12, s21, v104
    v_fma_f32 v12, v105, s20, v12
    v_mul_f32 v13, s21, v104
    v_fma_f32 v13, v105, s21, v13
    v_mul_f32 v104, s17, v94
    v_fma_f32 v104, v95, s19, v104
    v_mul_f32 v105, s18, v94
    v_fma_f32 v105, v95, s17, v105
    v_add_f32 v94, v14, v18
    v_add_f32 v95, v15, v19
    v_sub_f32 v108, v14, v18
    v_sub_f32 v109, v15, v19
    v_add_f32 v14, v16, v82
    v_add_f32 v15, v17, v83
    v_sub_f32 v18, v16, v82
    v_sub_f32 v19, v17, v83
    v_add_f32 v16, v94, v14
    v_add_f32 v17, v95, v15
    v_sub_f32 v82, v94, v14
    v_sub_f32 v83, v95, v15
    v_add_f32 v14, v108, v19
    v_sub_f32 v15, v109, v18
    v_sub_f32 v94, v108, v19
    v_add_f32 v95, v109, v18
    v_add_f32 v18, v6, v90
    v_add_f32 v19, v7, v91
    v_sub_f32 v108, v6, v90
    v_sub_f32 v109, v7, v91
    v_add_f32 v6, v96, v92
    v_add_f32 v7, v97, v93
    v_sub_f32 v90, v96, v92
    v_sub_f32 v91, v97, v93
    v_add_f32 v92, v18, v6
    v_add_f32 v93, v19, v7
    v_sub_f32 v96, v18, v6
    v_sub_f32 v97, v19, v7
    v_add_f32 v6, v108, v91
    v_sub_f32 v7, v109, v90
    v_sub_f32 v18, v108, v91
    v_add_f32 v19, v109, v90
    v_add_f32 v90, v98, v10
    v_add_f32 v91, v99, v11
    v_sub_f32 v108, v98, v10
    v_sub_f32 v109, v99, v11
    v_add_f32 v10, v8, v12
    v_add_f32 v11, v9, v13
    v_sub_f32 v98, v8, v12
    v_sub_f32 v99, v9, v13
    v_add_f32 v8, v90, v10
    v_add_f32 v9, v91, v11
    v_sub_f32 v12, v90, v10
    v_sub_f32 v13, v91, v11
    v_add_f32 v10, v108, v99
    v_sub_f32 v11, v109, v98
    v_sub_f32 v90, v108, v99
    v_add_f32 v91, v109, v98
    v_add_f32 v98, v106, v102
    v_add_f32 v99, v107, v103
    v_sub_f32 v108, v106, v102
    v_sub_f32 v109, v107, v103
    v_add_f32 v102, v100, v104
    v_add_f32 v103, v101, v105
    v_sub_f32 v106, v100, v104
    v_sub_f32 v107, v101, v105
    v_add_f32 v100, v98, v102
    v_add_f32 v101, v99, v103
    v_sub_f32 v104, v98, v102
    v_sub_f32 v105, v99, v103
    v_add_f32 v98, v108, v107
    v_sub_f32 v99, v109, v106
    v_sub_f32 v102, v108, v107
    v_add_f32 v103, v109, v106
    v_mul_f32 v106, v92, v52
    v_fma_f32 v106, -v93, v53, v106
    v_mul_f32 v107, v93, v52
    v_fma_f32 v107, v92, v53, v107
    v_mul_f32 v92, v8, v54
    v_fma_f32 v92, -v9, v55, v92
    v_mul_f32 v93, v9, v54
    v_fma_f32 v93, v8, v55, v93
    v_mul_f32 v8, v100, v56
    v_fma_f32 v8, -v101, v57, v8
    v_mul_f32 v9, v101, v56
    v_fma_f32 v9, v100, v57, v9
    v_mul_f32 v100, v14, v58
    v_fma_f32 v100, -v15, v59, v100
    v_mul_f32 v101, v15, v58
    v_fma_f32 v101, v14, v59, v101
    v_mul_f32 v14, v6, v60
    v_fma_f32 v14, -v7, v61, v14
    v_mul_f32 v15, v7, v60
    v_fma_f32 v15, v6, v61, v15
    v_mul_f32 v6, v10, v62
    v_fma_f32 v6, -v11, v63, v6
    v_mul_f32 v7, v11, v62
    v_fma_f32 v7, v10, v63, v7
    v_mul_f32 v10, v98, v64
    v_fma_f32 v10, -v99, v65, v10
    v_mul_f32 v11, v99, v64
    v_fma_f32 v11, v98, v65, v11
    v_mul_f32 v98, v82, v66
    v_fma_f32 v98, -v83, v67, v98
    v_mul_f32 v99, v83, v66
    v_fma_f32 v99, v82, v67, v99
    v_mul_f32 v82, v96, v68
    v_fma_f32 v82, -v97, v69, v82
    v_mul_f32 v83, v97, v68
    v_fma_f32 v83, v96, v69, v83
    v_mul_f32 v96, v12, v70
    v_fma_f32 v96, -v13, v71, v96
    v_mul_f32 v97, v13, v70
    v_fma_f32 v97, v12, v71, v97
    v_mul_f32 v12, v104, v72
    v_fma_f32 v12, -v105, v73, v12
    v_mul_f32 v13, v105, v72
    v_fma_f32 v13, v104, v73, v13
    v_mul_f32 v104, v94, v74
    v_fma_f32 v104, -v95, v75, v104
    v_mul_f32 v105, v95, v74
    v_fma_f32 v105, v94, v75, v105
    v_mul_f32 v94, v18, v76
    v_fma_f32 v94, -v19, v77, v94
    v_mul_f32 v95, v19, v76
    v_fma_f32 v95, v18, v77, v95
    v_mul_f32 v18, v90, v78
    v_fma_f32 v18, -v91, v79, v18
    v_mul_f32 v19, v91, v78
    v_fma_f32 v19, v90, v79, v19
    v_mul_f32 v90, v102, v80
    v_fma_f32 v90, -v103, v81, v90
    v_mul_f32 v91, v103, v80
    v_fma_f32 v91, v102, v81, v91
    ds_write_b64 v86, v[16:17] offset:0
    ds_write_b64 v86, v[106:107] offset:528
    ds_write_b64 v86, v[92:93] offset:1056
    ds_write_b64 v86, v[8:9] offset:1584
    ds_write_b64 v86, v[100:101] offset:2112
    ds_write_b64 v86, v[14:15] offset:2640
    ds_write_b64 v86, v[6:7] offset:3168
    ds_write_b64 v86, v[10:11] offset:3696
    ds_write_b64 v86, v[98:99] offset:4224
    ds_write_b64 v86, v[82:83] offset:4752
    ds_write_b64 v86, v[96:97] offset:5280
    ds_write_b64 v86, v[12:13] offset:5808
    ds_write_b64 v86, v[104:105] offset:6336
    ds_write_b64 v86, v[94:95] offset:6864
    ds_write_b64 v86, v[18:19] offset:7392
    ds_write_b64 v86, v[90:91] offset:7920
    ds_read_b64 v[6:7], v88 offset:0
    ds_read_b64 v[8:9], v88 offset:8
    ds_read_b64 v[10:11], v88 offset:16
    ds_read_b64 v[12:13], v88 offset:24
    ds_read_b64 v[14:15], v88 offset:32
    ds_read_b64 v[16:17], v88 offset:40
    ds_read_b64 v[18:19], v88 offset:48
    ds_read_b64 v[82:83], v88 offset:56
    ds_read_b64 v[90:91], v88 offset:64
    ds_read_b64 v[92:93], v88 offset:72
    ds_read_b64 v[94:95], v88 offset:80
    ds_read_b64 v[96:97], v88 offset:88
    ds_read_b64 v[98:99], v88 offset:96
    ds_read_b64 v[100:101], v88 offset:104
    ds_read_b64 v[102:103], v88 offset:112
    ds_read_b64 v[104:105], v88 offset:120
    s_waitcnt lgkmcnt(0)
    v_add_f32 v106, v6, v10
    v_add_f32 v107, v7, v11
    v_sub_f32 v108, v6, v10
    v_sub_f32 v109, v7, v11
    v_add_f32 v6, v8, v12
    v_add_f32 v7, v9, v13
    v_sub_f32 v10, v8, v12
    v_sub_f32 v11, v9, v13
    v_add_f32 v8, v106, v6
    v_add_f32 v9, v107, v7
    v_sub_f32 v12, v106, v6
    v_sub_f32 v13, v107, v7
    v_add_f32 v6, v108, v11
    v_sub_f32 v7, v109, v10
    v_sub_f32 v106, v108, v11
    v_add_f32 v107, v109, v10
    v_add_f32 v10, v14, v18
    v_add_f32 v11, v15, v19
    v_sub_f32 v108, v14, v18
    v_sub_f32 v109, v15, v19
    v_add_f32 v14, v16, v82
    v_add_f32 v15, v17, v83
    v_sub_f32 v18, v16, v82
    v_sub_f32 v19, v17, v83
    v_add_f32 v16, v10, v14
    v_add_f32 v17, v11, v15
    v_sub_f32 v82, v10, v14
    v_sub_f32 v83, v11, v15
    v_add_f32 v10, v108, v19
    v_sub_f32 v11, v109, v18
    v_sub_f32 v14, v108, v19
    v_add_f32 v15, v109, v18
    v_add_f32 v18, v90, v94
    v_add_f32 v19, v91, v95
    v_sub_f32 v108, v90, v94
    v_sub_f32 v109, v91, v95
    v_add_f32 v90, v92, v96
    v_add_f32 v91, v93, v97
    v_sub_f32 v94, v92, v96
    v_sub_f32 v95, v93, v97
    v_add_f32 v92, v18, v90
    v_add_f32 v93, v19, v91
    v_sub_f32 v96, v18, v90
    v_sub_f32 v97, v19, v91
    v_add_f32 v18, v108, v95
    v_sub_f32 v19, v109, v94
    v_sub_f32 v90, v108, v95
    v_add_f32 v91, v109, v94
    v_add_f32 v94, v98, v102
    v_add_f32 v95, v99, v103
    v_sub_f32 v108, v98, v102
    v_sub_f32 v109, v99, v103
    v_add_f32 v98, v100, v104
    v_add_f32 v99, v101, v105
    v_sub_f32 v102, v100, v104
    v_sub_f32 v103, v101, v105
    v_add_f32 v100, v94, v98
    v_add_f32 v101, v95, v99
    v_sub_f32 v104, v94, v98
    v_sub_f32 v105, v95, v99
    v_add_f32 v94, v108, v103
    v_sub_f32 v95, v109, v102
    v_sub_f32 v98, v108, v103
    v_add_f32 v99, v109, v102
    v_lshl_add_u32 v4, v1, 5, v21
    ds_write_b64 v4, v[8:9] offset:0
    ds_write_b64 v4, v[6:7] offset:2048
    ds_write_b64 v4, v[12:13] offset:4096
    ds_write_b64 v4, v[106:107] offset:6144
    ds_write_b64 v4, v[16:17] offset:8
    ds_write_b64 v4, v[10:11] offset:2056
    ds_write_b64 v4, v[82:83] offset:4104
    ds_write_b64 v4, v[14:15] offset:6152
    ds_write_b64 v4, v[92:93] offset:16
    ds_write_b64 v4, v[18:19] offset:2064
    ds_write_b64 v4, v[96:97] offset:4112
    ds_write_b64 v4, v[90:91] offset:6160
    ds_write_b64 v4, v[100:101] offset:24
    ds_write_b64 v4, v[94:95] offset:2072
    ds_write_b64 v4, v[104:105] offset:4120
    ds_write_b64 v4, v[98:99] offset:6168
    v_cmp_eq_u32 vcc, 0, v1
    v_mov_b32 v5, 8200
    s_nop 1
    v_cndmask_b32 v5, v5, v4, vcc
    v_add_u32 v5, v5, v21
    v_sub_u32 v5, v5, v21
    v_mov_b32 v5, 8200
    v_mov_b32 v4, 8192
    s_nop 1
    v_cndmask_b32 v5, v5, v4, vcc
    v_add_u32 v5, v5, v21
    ds_write_b64 v5, v[8:9]
    v_lshl_add_u32 v6, v1, 3, v21
    v_sub_u32 v7, 4608, v3
    v_lshlrev_b32 v7, 3, v1
    v_sub_u32 v7, 4608, v7
    v_add_u32 v7, v7, v21
    ds_read_b64 v[8:9], v6 offset:0
    ds_read_b64 v[10:11], v7 offset:3584
    ds_read_b64 v[12:13], v6 offset:512
    ds_read_b64 v[14:15], v7 offset:3072
    ds_read_b64 v[16:17], v6 offset:1024
    ds_read_b64 v[18:19], v7 offset:2560
    ds_read_b64 v[22:23], v6 offset:1536
    ds_read_b64 v[24:25], v7 offset:2048
    ds_read_b64 v[26:27], v6 offset:2048
    ds_read_b64 v[28:29], v7 offset:1536
    ds_read_b64 v[30:31], v6 offset:2560
    ds_read_b64 v[32:33], v7 offset:1024
    ds_read_b64 v[34:35], v6 offset:3072
    ds_read_b64 v[36:37], v7 offset:512
    ds_read_b64 v[38:39], v6 offset:3584
    ds_read_b64 v[40:41], v7 offset:0
    ds_read_b64 v[42:43], v21 offset:4096
    s_waitcnt lgkmcnt(0)
    v_lshlrev_b32 v44, 14, v1
    s_lshl_b32 s25, s23, 4
    s_add_u32 s25, s25, 4194304
    v_add_f32 v48, v8, v10
    v_sub_f32 v49, v9, v11
    v_add_f32 v50, v9, v11
    v_sub_f32 v51, v10, v8
    v_mul_f32 v48, 0.5, v48
    v_mul_f32 v49, 0.5, v49
    v_mul_f32 v50, 0.5, v50
    v_mul_f32 v51, 0.5, v51
    buffer_store_dwordx4 v[48:51], v44, s[12:15], s25 offen
    s_add_u32 s25, s25, 1048576
    v_add_f32 v8, v12, v14
    v_sub_f32 v9, v13, v15
    v_add_f32 v10, v13, v15
    v_sub_f32 v11, v14, v12
    v_mul_f32 v8, 0.5, v8
    v_mul_f32 v9, 0.5, v9
    v_mul_f32 v10, 0.5, v10
    v_mul_f32 v11, 0.5, v11
    buffer_store_dwordx4 v[8:11], v44, s[12:15], s25 offen
    s_add_u32 s25, s25, 1048576
    v_add_f32 v8, v16, v18
    v_sub_f32 v9, v17, v19
    v_add_f32 v10, v17, v19
    v_sub_f32 v11, v18, v16
    v_mul_f32 v8, 0.5, v8
    v_mul_f32 v9, 0.5, v9
    v_mul_f32 v10, 0.5, v10
    v_mul_f32 v11, 0.5, v11
    buffer_store_dwordx4 v[8:11], v44, s[12:15], s25 offen
    s_add_u32 s25, s25, 1048576
    v_add_f32 v8, v22, v24
    v_sub_f32 v9, v23, v25
    v_add_f32 v10, v23, v25
    v_sub_f32 v11, v24, v22
    v_mul_f32 v8, 0.5, v8
    v_mul_f32 v9, 0.5, v9
    v_mul_f32 v10, 0.5, v10
    v_mul_f32 v11, 0.5, v11
    buffer_store_dwordx4 v[8:11], v44, s[12:15], s25 offen
    s_add_u32 s25, s25, 1048576
    v_add_f32 v8, v26, v28
    v_sub_f32 v9, v27, v29
    v_add_f32 v10, v27, v29
    v_sub_f32 v11, v28, v26
    v_mul_f32 v8, 0.5, v8
    v_mul_f32 v9, 0.5, v9
    v_mul_f32 v10, 0.5, v10
    v_mul_f32 v11, 0.5, v11
    buffer_store_dwordx4 v[8:11], v44, s[12:15], s25 offen
    s_add_u32 s25, s25, 1048576
    v_add_f32 v8, v30, v32
    v_sub_f32 v9, v31, v33
    v_add_f32 v10, v31, v33
    v_sub_f32 v11, v32, v30
    v_mul_f32 v8, 0.5, v8
    v_mul_f32 v9, 0.5, v9
    v_mul_f32 v10, 0.5, v10
    v_mul_f32 v11, 0.5, v11
    buffer_store_dwordx4 v[8:11], v44, s[12:15], s25 offen
    s_add_u32 s25, s25, 1048576
    v_add_f32 v8, v34, v36
    v_sub_f32 v9, v35, v37
    v_add_f32 v10, v35, v37
    v_sub_f32 v11, v36, v34
    v_mul_f32 v8, 0.5, v8
    v_mul_f32 v9, 0.5, v9
    v_mul_f32 v10, 0.5, v10
    v_mul_f32 v11, 0.5, v11
    buffer_store_dwordx4 v[8:11], v44, s[12:15], s25 offen
    s_add_u32 s25, s25, 1048576
    v_add_f32 v8, v38, v40
    v_sub_f32 v9, v39, v41
    v_add_f32 v10, v39, v41
    v_sub_f32 v11, v40, v38
    v_mul_f32 v8, 0.5, v8
    v_mul_f32 v9, 0.5, v9
    v_mul_f32 v10, 0.5, v10
    v_mul_f32 v11, 0.5, v11
    buffer_store_dwordx4 v[8:11], v44, s[12:15], s25 offen
    s_add_u32 s25, s25, 1048576
    v_mov_b32 v8, v42
    v_mov_b32 v9, 0
    v_mov_b32 v10, v43
    v_mov_b32 v11, 0
    s_mov_b64 exec, 1
    buffer_store_dwordx4 v[8:11], v44, s[12:15], s25 offen
    s_mov_b64 exec, -1
    s_waitcnt vmcnt(0)
    s_branch K1_END
K1_WT:
    s_cmp_ge_u32 s2, 544
    s_cbranch_scc1 K1_END
    s_load_dwordx4 s[32:35], s[0:1], 8
    s_load_dwordx2 s[6:7], s[0:1], 72
    s_sub_u32 s3, s2, 256
    s_mul_hi_u32 s4, s3, 0x1c71c71d
    s_mul_i32 s5, s4, 9
    s_sub_u32 s5, s3, s5
    s_waitcnt lgkmcnt(0)
    s_mov_b32 s36, s32
    s_mov_b32 s37, s33
    s_mov_b32 s38, 2101248
    s_mov_b32 s39, 0x00020000
    s_mov_b32 s40, s34
    s_mov_b32 s41, s35
    s_mov_b32 s42, 2101248
    s_mov_b32 s43, 0x00020000
    s_mov_b32 s12, s6
    s_mov_b32 s13, s7
    s_mov_b32 s14, 268435456
    s_mov_b32 s15, 0x00020000
    v_lshrrev_b32 v1, 2, v0
    v_and_b32 v2, 3, v0
    s_lshl_b32 s8, s4, 6
    v_add_u32 v1, s8, v1
    s_mov_b32 s9, 1026
    v_mul_lo_u32 v3, v1, s9
    v_lshl_add_u32 v3, v2, 5, v3
    s_lshl_b32 s9, s5, 7
    buffer_load_dwordx4 v[4:7], v3, s[36:39], s9 offen offset:0
    buffer_load_dwordx4 v[12:15], v3, s[40:43], s9 offen offset:0
    buffer_load_dwordx4 v[8:11], v3, s[36:39], s9 offen offset:16
    buffer_load_dwordx4 v[16:19], v3, s[40:43], s9 offen offset:16
    buffer_load_ushort v20, v3, s[36:39], s9 offen
    buffer_load_ushort v21, v3, s[40:43], s9 offen
    s_waitcnt vmcnt(0)
    v_and_b32 v22, 0xffff, v4
    v_lshl_or_b32 v22, v12, 16, v22
    v_lshl_or_b32 v22, v21, 16, v20
    v_lshrrev_b32 v23, 16, v4
    v_and_b32 v91, 0xffff0000, v12
    v_or_b32 v23, v23, v91
    v_and_b32 v24, 0xffff, v5
    v_lshl_or_b32 v24, v13, 16, v24
    v_lshrrev_b32 v25, 16, v5
    v_and_b32 v91, 0xffff0000, v13
    v_or_b32 v25, v25, v91
    v_and_b32 v26, 0xffff, v6
    v_lshl_or_b32 v26, v14, 16, v26
    v_lshrrev_b32 v27, 16, v6
    v_and_b32 v91, 0xffff0000, v14
    v_or_b32 v27, v27, v91
    v_and_b32 v28, 0xffff, v7
    v_lshl_or_b32 v28, v15, 16, v28
    v_lshrrev_b32 v29, 16, v7
    v_and_b32 v91, 0xffff0000, v15
    v_or_b32 v29, v29, v91
    v_and_b32 v30, 0xffff, v8
    v_lshl_or_b32 v30, v16, 16, v30
    v_lshrrev_b32 v31, 16, v8
    v_and_b32 v91, 0xffff0000, v16
    v_or_b32 v31, v31, v91
    v_and_b32 v32, 0xffff, v9
    v_lshl_or_b32 v32, v17, 16, v32
    v_lshrrev_b32 v33, 16, v9
    v_and_b32 v91, 0xffff0000, v17
    v_or_b32 v33, v33, v91
    v_and_b32 v34, 0xffff, v10
    v_lshl_or_b32 v34, v18, 16, v34
    v_lshrrev_b32 v35, 16, v10
    v_and_b32 v91, 0xffff0000, v18
    v_or_b32 v35, v35, v91
    v_and_b32 v36, 0xffff, v11
    v_lshl_or_b32 v36, v19, 16, v36
    v_lshrrev_b32 v37, 16, v11
    v_and_b32 v91, 0xffff0000, v19
    v_or_b32 v37, v37, v91
    v_lshrrev_b32 v39, 2, v0
    v_lshlrev_b32 v38, 2, v39
    s_mov_b32 s9, 4160
    v_mul_lo_u32 v39, v2, s9
    v_add_u32 v38, v38, v39
    ds_write_b32 v38, v22 offset:0
    ds_write_b32 v38, v23 offset:260
    ds_write_b32 v38, v24 offset:520
    ds_write_b32 v38, v25 offset:780
    ds_write_b32 v38, v26 offset:1040
    ds_write_b32 v38, v27 offset:1300
    ds_write_b32 v38, v28 offset:1560
    ds_write_b32 v38, v29 offset:1820
    ds_write_b32 v38, v30 offset:2080
    ds_write_b32 v38, v31 offset:2340
    ds_write_b32 v38, v32 offset:2600
    ds_write_b32 v38, v33 offset:2860
    ds_write_b32 v38, v34 offset:3120
    ds_write_b32 v38, v35 offset:3380
    ds_write_b32 v38, v36 offset:3640
    ds_write_b32 v38, v37 offset:3900
    s_waitcnt lgkmcnt(0)
    s_barrier
    v_lshrrev_b32 v39, 2, v0
    s_mov_b32 s9, 260
    v_mul_lo_u32 v38, v39, s9
    v_lshl_add_u32 v38, v2, 6, v38
    ds_read_b32 v40, v38 offset:0
    ds_read_b32 v41, v38 offset:4
    ds_read_b32 v42, v38 offset:8
    ds_read_b32 v43, v38 offset:12
    ds_read_b32 v44, v38 offset:16
    ds_read_b32 v45, v38 offset:20
    ds_read_b32 v46, v38 offset:24
    ds_read_b32 v47, v38 offset:28
    ds_read_b32 v48, v38 offset:32
    ds_read_b32 v49, v38 offset:36
    ds_read_b32 v50, v38 offset:40
    ds_read_b32 v51, v38 offset:44
    ds_read_b32 v52, v38 offset:48
    ds_read_b32 v53, v38 offset:52
    ds_read_b32 v54, v38 offset:56
    ds_read_b32 v55, v38 offset:60
    s_waitcnt lgkmcnt(0)
    s_lshl_b32 s9, s5, 6
    v_add_u32 v39, s9, v39
    v_lshlrev_b32 v38, 13, v39
    v_lshl_add_u32 v38, v2, 6, v38
    s_lshl_b32 s9, s4, 8
    s_add_u32 s9, s9, 37748736
    v_cmp_gt_u32 vcc, 513, v39
    s_and_saveexec_b64 s[10:11], vcc
    buffer_store_dwordx4 v[40:43], v38, s[12:15], s9 offen offset:0
    buffer_store_dwordx4 v[44:47], v38, s[12:15], s9 offen offset:16
    buffer_store_dwordx4 v[48:51], v38, s[12:15], s9 offen offset:32
    buffer_store_dwordx4 v[52:55], v38, s[12:15], s9 offen offset:48
    s_or_b64 exec, exec, s[10:11]
    s_waitcnt vmcnt(0)
K1_END:
    s_endpgm
.globl k2_colfft_kernel
.p2align 8
.type k2_colfft_kernel,@function
k2_colfft_kernel:
    s_cmp_ge_u32 s2, 513
    s_cbranch_scc1 K2C_END
    s_load_dwordx2 s[6:7], s[0:1], 72
    s_load_dwordx4 s[32:35], s[0:1], 8
    s_mov_b32 s16, 0x3f6c835e
    s_mov_b32 s17, 0xbf6c835e
    s_mov_b32 s18, 0x3ec3ef15
    s_mov_b32 s19, 0xbec3ef15
    s_mov_b32 s20, 0x3f3504f3
    s_mov_b32 s21, 0xbf3504f3
    s_getpc_b64 s[26:27]
    s_add_u32 s26, s26, T2048_tw1A@rel32@lo+4
    s_addc_u32 s27, s27, T2048_tw1A@rel32@hi+12
    s_waitcnt lgkmcnt(0)
    s_mov_b32 s12, s6
    s_mov_b32 s13, s7
    s_mov_b32 s14, 268435456
    s_mov_b32 s15, 0x00020000
    s_mov_b32 s36, s32
    s_mov_b32 s37, s33
    s_mov_b32 s38, 2101248
    s_mov_b32 s39, 0x00020000
    s_mov_b32 s40, s34
    s_mov_b32 s41, s35
    s_mov_b32 s42, 2101248
    s_mov_b32 s43, 0x00020000
    s_lshl_b32 s24, s2, 14
    s_add_u32 s24, s24, 4194304
    v_lshlrev_b32 v1, 3, v0
    v_mov_b32 v2, v1
    buffer_load_dwordx2 v[4:5], v2, s[12:15], s24 offen offset:0
    buffer_load_dwordx2 v[6:7], v2, s[12:15], s24 offen offset:1024
    buffer_load_dwordx2 v[8:9], v2, s[12:15], s24 offen offset:2048
    buffer_load_dwordx2 v[10:11], v2, s[12:15], s24 offen offset:3072
    v_add_u32 v2, 4096, v2
    buffer_load_dwordx2 v[12:13], v2, s[12:15], s24 offen offset:0
    buffer_load_dwordx2 v[14:15], v2, s[12:15], s24 offen offset:1024
    buffer_load_dwordx2 v[16:17], v2, s[12:15], s24 offen offset:2048
    buffer_load_dwordx2 v[18:19], v2, s[12:15], s24 offen offset:3072
    v_add_u32 v2, 4096, v2
    buffer_load_dwordx2 v[20:21], v2, s[12:15], s24 offen offset:0
    buffer_load_dwordx2 v[22:23], v2, s[12:15], s24 offen offset:1024
    buffer_load_dwordx2 v[24:25], v2, s[12:15], s24 offen offset:2048
    buffer_load_dwordx2 v[26:27], v2, s[12:15], s24 offen offset:3072
    v_add_u32 v2, 4096, v2
    buffer_load_dwordx2 v[28:29], v2, s[12:15], s24 offen offset:0
    buffer_load_dwordx2 v[30:31], v2, s[12:15], s24 offen offset:1024
    buffer_load_dwordx2 v[32:33], v2, s[12:15], s24 offen offset:2048
    buffer_load_dwordx2 v[34:35], v2, s[12:15], s24 offen offset:3072
    v_mov_b32 v3, v1
    global_load_dwordx2 v[36:37], v3, s[26:27] offset:1024
    global_load_dwordx2 v[38:39], v3, s[26:27] offset:2048
    global_load_dwordx2 v[40:41], v3, s[26:27] offset:3072
    v_add_u32 v3, 4096, v3
    global_load_dwordx2 v[42:43], v3, s[26:27] offset:0
    global_load_dwordx2 v[44:45], v3, s[26:27] offset:1024
    global_load_dwordx2 v[46:47], v3, s[26:27] offset:2048
    global_load_dwordx2 v[48:49], v3, s[26:27] offset:3072
    v_add_u32 v3, 4096, v3
    global_load_dwordx2 v[50:51], v3, s[26:27] offset:0
    global_load_dwordx2 v[52:53], v3, s[26:27] offset:1024
    global_load_dwordx2 v[54:55], v3, s[26:27] offset:2048
    global_load_dwordx2 v[56:57], v3, s[26:27] offset:3072
    v_add_u32 v3, 4096, v3
    global_load_dwordx2 v[58:59], v3, s[26:27] offset:0
    global_load_dwordx2 v[60:61], v3, s[26:27] offset:1024
    global_load_dwordx2 v[62:63], v3, s[26:27] offset:2048
    global_load_dwordx2 v[64:65], v3, s[26:27] offset:3072
    v_add_u32 v3, 4096, v3
    global_load_dwordx2 v[66:67], v3, s[26:27] offset:1024
    global_load_dwordx2 v[68:69], v3, s[26:27] offset:2048
    global_load_dwordx2 v[70:71], v3, s[26:27] offset:3072
    v_add_u32 v3, 4096, v3
    global_load_dwordx2 v[72:73], v3, s[26:27] offset:0
    global_load_dwordx2 v[74:75], v3, s[26:27] offset:1024
    global_load_dwordx2 v[76:77], v3, s[26:27] offset:2048
    global_load_dwordx2 v[78:79], v3, s[26:27] offset:3072
    v_add_u32 v3, 4096, v3
    global_load_dwordx2 v[80:81], v3, s[26:27] offset:0
    global_load_dwordx2 v[82:83], v3, s[26:27] offset:1024
    global_load_dwordx2 v[84:85], v3, s[26:27] offset:2048
    global_load_dwordx2 v[86:87], v3, s[26:27] offset:3072
    v_add_u32 v3, 4096, v3
    global_load_dwordx2 v[88:89], v3, s[26:27] offset:0
    global_load_dwordx2 v[90:91], v3, s[26:27] offset:1024
    global_load_dwordx2 v[92:93], v3, s[26:27] offset:2048
    global_load_dwordx2 v[94:95], v3, s[26:27] offset:3072
    v_add_u32 v3, 4096, v3
    global_load_dwordx2 v[96:97], v3, s[26:27] offset:1024
    global_load_dwordx2 v[98:99], v3, s[26:27] offset:2048
    global_load_dwordx2 v[100:101], v3, s[26:27] offset:3072
    v_add_u32 v3, 4096, v3
    global_load_dwordx2 v[102:103], v3, s[26:27] offset:0
    global_load_dwordx2 v[104:105], v3, s[26:27] offset:1024
    global_load_dwordx2 v[106:107], v3, s[26:27] offset:2048
    global_load_dwordx2 v[108:109], v3, s[26:27] offset:3072
    v_add_u32 v3, 4096, v3
    global_load_dwordx2 v[110:111], v3, s[26:27] offset:0
    global_load_dwordx2 v[112:113], v3, s[26:27] offset:1024
    global_load_dwordx2 v[114:115], v3, s[26:27] offset:2048
    global_load_dwordx2 v[116:117], v3, s[26:27] offset:3072
    v_add_u32 v3, 4096, v3
    global_load_dwordx2 v[118:119], v3, s[26:27] offset:0
    global_load_dwordx2 v[120:121], v3, s[26:27] offset:1024
    global_load_dwordx2 v[122:123], v3, s[26:27] offset:2048
    global_load_dwordx2 v[124:125], v3, s[26:27] offset:3072
    v_add_u32 v3, 4096, v3
    global_load_dwordx2 v[126:127], v3, s[26:27] offset:0
    global_load_dwordx2 v[128:129], v3, s[26:27] offset:1024
    global_load_dwordx2 v[130:131], v3, s[26:27] offset:2048
    global_load_dwordx2 v[132:133], v3, s[26:27] offset:3072
    v_add_u32 v3, 4096, v3
    global_load_dwordx2 v[134:135], v3, s[26:27] offset:0
    global_load_dwordx2 v[136:137], v3, s[26:27] offset:1024
    global_load_dwordx2 v[138:139], v3, s[26:27] offset:2048
    global_load_dwordx2 v[140:141], v3, s[26:27] offset:3072
    v_add_u32 v3, 4096, v3
    v_lshlrev_b32 v142, 3, v0
    s_lshl_b32 s25, s2, 13
    s_add_u32 s25, s25, 37748736
    buffer_load_dwordx2 v[144:145], v142, s[12:15], s25 offen offset:0
    buffer_load_dwordx2 v[146:147], v142, s[12:15], s25 offen offset:1024
    buffer_load_dwordx2 v[148:149], v142, s[12:15], s25 offen offset:2048
    buffer_load_dwordx2 v[150:151], v142, s[12:15], s25 offen offset:3072
    v_add_u32 v142, 4096, v142
    buffer_load_dwordx2 v[152:153], v142, s[12:15], s25 offen offset:0
    buffer_load_dwordx2 v[154:155], v142, s[12:15], s25 offen offset:1024
    buffer_load_dwordx2 v[156:157], v142, s[12:15], s25 offen offset:2048
    buffer_load_dwordx2 v[158:159], v142, s[12:15], s25 offen offset:3072
    v_mov_b32 v143, 0
    v_lshl_add_u32 v162, v0, 3, v143
    v_lshrrev_b32 v160, 3, v0
    v_and_b32 v161, 7, v0
    s_mov_b32 s22, 1088
    v_mul_lo_u32 v163, v160, s22
    v_lshl_add_u32 v163, v161, 3, v163
    v_add_u32 v163, v163, v143
    v_lshrrev_b32 v165, 2, v160
    v_mul_u32_u24 v165, 8, v165
    v_lshl_add_u32 v164, v0, 3, v165
    v_add_u32 v164, v164, v143
    s_mov_b32 s22, 1056
    v_mul_lo_u32 v166, v160, s22
    v_lshl_add_u32 v166, v161, 7, v166
    v_mul_u32_u24 v165, 2, v161
    v_lshrrev_b32 v165, 2, v165
    v_mul_u32_u24 v165, 8, v165
    v_add_u32 v166, v166, v165
    v_add_u32 v166, v166, v143
    s_waitcnt vmcnt(8)
    v_add_f32 v160, v4, v20
    v_add_f32 v161, v5, v21
    v_sub_f32 v168, v4, v20
    v_sub_f32 v169, v5, v21
    v_add_f32 v4, v12, v28
    v_add_f32 v5, v13, v29
    v_sub_f32 v20, v12, v28
    v_sub_f32 v21, v13, v29
    v_add_f32 v12, v160, v4
    v_add_f32 v13, v161, v5
    v_sub_f32 v28, v160, v4
    v_sub_f32 v29, v161, v5
    v_add_f32 v4, v168, v21
    v_sub_f32 v5, v169, v20
    v_sub_f32 v160, v168, v21
    v_add_f32 v161, v169, v20
    v_add_f32 v20, v6, v22
    v_add_f32 v21, v7, v23
    v_sub_f32 v168, v6, v22
    v_sub_f32 v169, v7, v23
    v_add_f32 v6, v14, v30
    v_add_f32 v7, v15, v31
    v_sub_f32 v22, v14, v30
    v_sub_f32 v23, v15, v31
    v_add_f32 v14, v20, v6
    v_add_f32 v15, v21, v7
    v_sub_f32 v30, v20, v6
    v_sub_f32 v31, v21, v7
    v_add_f32 v6, v168, v23
    v_sub_f32 v7, v169, v22
    v_sub_f32 v20, v168, v23
    v_add_f32 v21, v169, v22
    v_add_f32 v22, v8, v24
    v_add_f32 v23, v9, v25
    v_sub_f32 v168, v8, v24
    v_sub_f32 v169, v9, v25
    v_add_f32 v8, v16, v32
    v_add_f32 v9, v17, v33
    v_sub_f32 v24, v16, v32
    v_sub_f32 v25, v17, v33
    v_add_f32 v16, v22, v8
    v_add_f32 v17, v23, v9
    v_sub_f32 v32, v22, v8
    v_sub_f32 v33, v23, v9
    v_add_f32 v8, v168, v25
    v_sub_f32 v9, v169, v24
    v_sub_f32 v22, v168, v25
    v_add_f32 v23, v169, v24
    v_add_f32 v24, v10, v26
    v_add_f32 v25, v11, v27
    v_sub_f32 v168, v10, v26
    v_sub_f32 v169, v11, v27
    v_add_f32 v10, v18, v34
    v_add_f32 v11, v19, v35
    v_sub_f32 v26, v18, v34
    v_sub_f32 v27, v19, v35
    v_add_f32 v18, v24, v10
    v_add_f32 v19, v25, v11
    v_sub_f32 v34, v24, v10
    v_sub_f32 v35, v25, v11
    v_add_f32 v10, v168, v27
    v_sub_f32 v11, v169, v26
    v_sub_f32 v24, v168, v27
    v_add_f32 v25, v169, v26
    v_mul_f32 v26, s16, v6
    v_fma_f32 v26, v7, s18, v26
    v_mul_f32 v27, s19, v6
    v_fma_f32 v27, v7, s16, v27
    v_mul_f32 v6, s20, v30
    v_fma_f32 v6, v31, s20, v6
    v_mul_f32 v7, s21, v30
    v_fma_f32 v7, v31, s20, v7
    v_mul_f32 v30, s18, v20
    v_fma_f32 v30, v21, s16, v30
    v_mul_f32 v31, s17, v20
    v_fma_f32 v31, v21, s18, v31
    v_mul_f32 v20, s20, v8
    v_fma_f32 v20, v9, s20, v20
    v_mul_f32 v21, s21, v8
    v_fma_f32 v21, v9, s20, v21
    v_mov_b32 v8, v33
    v_sub_f32 v9, 0, v32
    v_mul_f32 v32, s21, v22
    v_fma_f32 v32, v23, s20, v32
    v_mul_f32 v33, s21, v22
    v_fma_f32 v33, v23, s21, v33
    v_mul_f32 v22, s18, v10
    v_fma_f32 v22, v11, s16, v22
    v_mul_f32 v23, s17, v10
    v_fma_f32 v23, v11, s18, v23
    v_mul_f32 v10, s21, v34
    v_fma_f32 v10, v35, s20, v10
    v_mul_f32 v11, s21, v34
    v_fma_f32 v11, v35, s21, v11
    v_mul_f32 v34, s17, v24
    v_fma_f32 v34, v25, s19, v34
    v_mul_f32 v35, s18, v24
    v_fma_f32 v35, v25, s17, v35
    v_add_f32 v24, v12, v16
    v_add_f32 v25, v13, v17
    v_sub_f32 v168, v12, v16
    v_sub_f32 v169, v13, v17
    v_add_f32 v12, v14, v18
    v_add_f32 v13, v15, v19
    v_sub_f32 v16, v14, v18
    v_sub_f32 v17, v15, v19
    v_add_f32 v14, v24, v12
    v_add_f32 v15, v25, v13
    v_sub_f32 v18, v24, v12
    v_sub_f32 v19, v25, v13
    v_add_f32 v12, v168, v17
    v_sub_f32 v13, v169, v16
    v_sub_f32 v24, v168, v17
    v_add_f32 v25, v169, v16
    v_add_f32 v16, v4, v20
    v_add_f32 v17, v5, v21
    v_sub_f32 v168, v4, v20
    v_sub_f32 v169, v5, v21
    v_add_f32 v4, v26, v22
    v_add_f32 v5, v27, v23
    v_sub_f32 v20, v26, v22
    v_sub_f32 v21, v27, v23
    v_add_f32 v22, v16, v4
    v_add_f32 v23, v17, v5
    v_sub_f32 v26, v16, v4
    v_sub_f32 v27, v17, v5
    v_add_f32 v4, v168, v21
    v_sub_f32 v5, v169, v20
    v_sub_f32 v16, v168, v21
    v_add_f32 v17, v169, v20
    v_add_f32 v20, v28, v8
    v_add_f32 v21, v29, v9
    v_sub_f32 v168, v28, v8
    v_sub_f32 v169, v29, v9
    v_add_f32 v8, v6, v10
    v_add_f32 v9, v7, v11
    v_sub_f32 v28, v6, v10
    v_sub_f32 v29, v7, v11
    v_add_f32 v6, v20, v8
    v_add_f32 v7, v21, v9
    v_sub_f32 v10, v20, v8
    v_sub_f32 v11, v21, v9
    v_add_f32 v8, v168, v29
    v_sub_f32 v9, v169, v28
    v_sub_f32 v20, v168, v29
    v_add_f32 v21, v169, v28
    v_add_f32 v28, v160, v32
    v_add_f32 v29, v161, v33
    v_sub_f32 v168, v160, v32
    v_sub_f32 v169, v161, v33
    v_add_f32 v32, v30, v34
    v_add_f32 v33, v31, v35
    v_sub_f32 v160, v30, v34
    v_sub_f32 v161, v31, v35
    v_add_f32 v30, v28, v32
    v_add_f32 v31, v29, v33
    v_sub_f32 v34, v28, v32
    v_sub_f32 v35, v29, v33
    v_add_f32 v28, v168, v161
    v_sub_f32 v29, v169, v160
    v_sub_f32 v32, v168, v161
    v_add_f32 v33, v169, v160
    v_mul_f32 v160, v22, v36
    v_fma_f32 v160, -v23, v37, v160
    v_mul_f32 v161, v23, v36
    v_fma_f32 v161, v22, v37, v161
    v_mul_f32 v22, v6, v38
    v_fma_f32 v22, -v7, v39, v22
    v_mul_f32 v23, v7, v38
    v_fma_f32 v23, v6, v39, v23
    v_mul_f32 v6, v30, v40
    v_fma_f32 v6, -v31, v41, v6
    v_mul_f32 v7, v31, v40
    v_fma_f32 v7, v30, v41, v7
    v_mul_f32 v30, v12, v42
    v_fma_f32 v30, -v13, v43, v30
    v_mul_f32 v31, v13, v42
    v_fma_f32 v31, v12, v43, v31
    v_mul_f32 v12, v4, v44
    v_fma_f32 v12, -v5, v45, v12
    v_mul_f32 v13, v5, v44
    v_fma_f32 v13, v4, v45, v13
    v_mul_f32 v4, v8, v46
    v_fma_f32 v4, -v9, v47, v4
    v_mul_f32 v5, v9, v46
    v_fma_f32 v5, v8, v47, v5
    v_mul_f32 v8, v28, v48
    v_fma_f32 v8, -v29, v49, v8
    v_mul_f32 v9, v29, v48
    v_fma_f32 v9, v28, v49, v9
    v_mul_f32 v28, v18, v50
    v_fma_f32 v28, -v19, v51, v28
    v_mul_f32 v29, v19, v50
    v_fma_f32 v29, v18, v51, v29
    v_mul_f32 v18, v26, v52
    v_fma_f32 v18, -v27, v53, v18
    v_mul_f32 v19, v27, v52
    v_fma_f32 v19, v26, v53, v19
    v_mul_f32 v26, v10, v54
    v_fma_f32 v26, -v11, v55, v26
    v_mul_f32 v27, v11, v54
    v_fma_f32 v27, v10, v55, v27
    v_mul_f32 v10, v34, v56
    v_fma_f32 v10, -v35, v57, v10
    v_mul_f32 v11, v35, v56
    v_fma_f32 v11, v34, v57, v11
    v_mul_f32 v34, v24, v58
    v_fma_f32 v34, -v25, v59, v34
    v_mul_f32 v35, v25, v58
    v_fma_f32 v35, v24, v59, v35
    v_mul_f32 v24, v16, v60
    v_fma_f32 v24, -v17, v61, v24
    v_mul_f32 v25, v17, v60
    v_fma_f32 v25, v16, v61, v25
    v_mul_f32 v16, v20, v62
    v_fma_f32 v16, -v21, v63, v16
    v_mul_f32 v17, v21, v62
    v_fma_f32 v17, v20, v63, v17
    v_mul_f32 v20, v32, v64
    v_fma_f32 v20, -v33, v65, v20
    v_mul_f32 v21, v33, v64
    v_fma_f32 v21, v32, v65, v21
    ds_write_b64 v162, v[14:15] offset:0
    ds_write_b64 v162, v[160:161] offset:1088
    ds_write_b64 v162, v[22:23] offset:2176
    ds_write_b64 v162, v[6:7] offset:3264
    ds_write_b64 v162, v[30:31] offset:4352
    ds_write_b64 v162, v[12:13] offset:5440
    ds_write_b64 v162, v[4:5] offset:6528
    ds_write_b64 v162, v[8:9] offset:7616
    ds_write_b64 v162, v[28:29] offset:8704
    ds_write_b64 v162, v[18:19] offset:9792
    ds_write_b64 v162, v[26:27] offset:10880
    ds_write_b64 v162, v[10:11] offset:11968
    ds_write_b64 v162, v[34:35] offset:13056
    ds_write_b64 v162, v[24:25] offset:14144
    ds_write_b64 v162, v[16:17] offset:15232
    ds_write_b64 v162, v[20:21] offset:16320
    s_waitcnt lgkmcnt(0)
    s_barrier
    ds_read_b64 v[4:5], v163 offset:0
    ds_read_b64 v[6:7], v163 offset:64
    ds_read_b64 v[8:9], v163 offset:128
    ds_read_b64 v[10:11], v163 offset:192
    ds_read_b64 v[12:13], v163 offset:256
    ds_read_b64 v[14:15], v163 offset:320
    ds_read_b64 v[16:17], v163 offset:384
    ds_read_b64 v[18:19], v163 offset:448
    ds_read_b64 v[20:21], v163 offset:512
    ds_read_b64 v[22:23], v163 offset:576
    ds_read_b64 v[24:25], v163 offset:640
    ds_read_b64 v[26:27], v163 offset:704
    ds_read_b64 v[28:29], v163 offset:768
    ds_read_b64 v[30:31], v163 offset:832
    ds_read_b64 v[32:33], v163 offset:896
    ds_read_b64 v[34:35], v163 offset:960
    s_waitcnt lgkmcnt(0)
    v_add_f32 v160, v4, v20
    v_add_f32 v161, v5, v21
    v_sub_f32 v168, v4, v20
    v_sub_f32 v169, v5, v21
    v_add_f32 v4, v12, v28
    v_add_f32 v5, v13, v29
    v_sub_f32 v20, v12, v28
    v_sub_f32 v21, v13, v29
    v_add_f32 v12, v160, v4
    v_add_f32 v13, v161, v5
    v_sub_f32 v28, v160, v4
    v_sub_f32 v29, v161, v5
    v_add_f32 v4, v168, v21
    v_sub_f32 v5, v169, v20
    v_sub_f32 v160, v168, v21
    v_add_f32 v161, v169, v20
    v_add_f32 v20, v6, v22
    v_add_f32 v21, v7, v23
    v_sub_f32 v168, v6, v22
    v_sub_f32 v169, v7, v23
    v_add_f32 v6, v14, v30
    v_add_f32 v7, v15, v31
    v_sub_f32 v22, v14, v30
    v_sub_f32 v23, v15, v31
    v_add_f32 v14, v20, v6
    v_add_f32 v15, v21, v7
    v_sub_f32 v30, v20, v6
    v_sub_f32 v31, v21, v7
    v_add_f32 v6, v168, v23
    v_sub_f32 v7, v169, v22
    v_sub_f32 v20, v168, v23
    v_add_f32 v21, v169, v22
    v_add_f32 v22, v8, v24
    v_add_f32 v23, v9, v25
    v_sub_f32 v168, v8, v24
    v_sub_f32 v169, v9, v25
    v_add_f32 v8, v16, v32
    v_add_f32 v9, v17, v33
    v_sub_f32 v24, v16, v32
    v_sub_f32 v25, v17, v33
    v_add_f32 v16, v22, v8
    v_add_f32 v17, v23, v9
    v_sub_f32 v32, v22, v8
    v_sub_f32 v33, v23, v9
    v_add_f32 v8, v168, v25
    v_sub_f32 v9, v169, v24
    v_sub_f32 v22, v168, v25
    v_add_f32 v23, v169, v24
    v_add_f32 v24, v10, v26
    v_add_f32 v25, v11, v27
    v_sub_f32 v168, v10, v26
    v_sub_f32 v169, v11, v27
    v_add_f32 v10, v18, v34
    v_add_f32 v11, v19, v35
    v_sub_f32 v26, v18, v34
    v_sub_f32 v27, v19, v35
    v_add_f32 v18, v24, v10
    v_add_f32 v19, v25, v11
    v_sub_f32 v34, v24, v10
    v_sub_f32 v35, v25, v11
    v_add_f32 v10, v168, v27
    v_sub_f32 v11, v169, v26
    v_sub_f32 v24, v168, v27
    v_add_f32 v25, v169, v26
    v_mul_f32 v26, s16, v6
    v_fma_f32 v26, v7, s18, v26
    v_mul_f32 v27, s19, v6
    v_fma_f32 v27, v7, s16, v27
    v_mul_f32 v6, s20, v30
    v_fma_f32 v6, v31, s20, v6
    v_mul_f32 v7, s21, v30
    v_fma_f32 v7, v31, s20, v7
    v_mul_f32 v30, s18, v20
    v_fma_f32 v30, v21, s16, v30
    v_mul_f32 v31, s17, v20
    v_fma_f32 v31, v21, s18, v31
    v_mul_f32 v20, s20, v8
    v_fma_f32 v20, v9, s20, v20
    v_mul_f32 v21, s21, v8
    v_fma_f32 v21, v9, s20, v21
    v_mov_b32 v8, v33
    v_sub_f32 v9, 0, v32
    v_mul_f32 v32, s21, v22
    v_fma_f32 v32, v23, s20, v32
    v_mul_f32 v33, s21, v22
    v_fma_f32 v33, v23, s21, v33
    v_mul_f32 v22, s18, v10
    v_fma_f32 v22, v11, s16, v22
    v_mul_f32 v23, s17, v10
    v_fma_f32 v23, v11, s18, v23
    v_mul_f32 v10, s21, v34
    v_fma_f32 v10, v35, s20, v10
    v_mul_f32 v11, s21, v34
    v_fma_f32 v11, v35, s21, v11
    v_mul_f32 v34, s17, v24
    v_fma_f32 v34, v25, s19, v34
    v_mul_f32 v35, s18, v24
    v_fma_f32 v35, v25, s17, v35
    v_add_f32 v24, v12, v16
    v_add_f32 v25, v13, v17
    v_sub_f32 v168, v12, v16
    v_sub_f32 v169, v13, v17
    v_add_f32 v12, v14, v18
    v_add_f32 v13, v15, v19
    v_sub_f32 v16, v14, v18
    v_sub_f32 v17, v15, v19
    v_add_f32 v14, v24, v12
    v_add_f32 v15, v25, v13
    v_sub_f32 v18, v24, v12
    v_sub_f32 v19, v25, v13
    v_add_f32 v12, v168, v17
    v_sub_f32 v13, v169, v16
    v_sub_f32 v24, v168, v17
    v_add_f32 v25, v169, v16
    v_add_f32 v16, v4, v20
    v_add_f32 v17, v5, v21
    v_sub_f32 v168, v4, v20
    v_sub_f32 v169, v5, v21
    v_add_f32 v4, v26, v22
    v_add_f32 v5, v27, v23
    v_sub_f32 v20, v26, v22
    v_sub_f32 v21, v27, v23
    v_add_f32 v22, v16, v4
    v_add_f32 v23, v17, v5
    v_sub_f32 v26, v16, v4
    v_sub_f32 v27, v17, v5
    v_add_f32 v4, v168, v21
    v_sub_f32 v5, v169, v20
    v_sub_f32 v16, v168, v21
    v_add_f32 v17, v169, v20
    v_add_f32 v20, v28, v8
    v_add_f32 v21, v29, v9
    v_sub_f32 v168, v28, v8
    v_sub_f32 v169, v29, v9
    v_add_f32 v8, v6, v10
    v_add_f32 v9, v7, v11
    v_sub_f32 v28, v6, v10
    v_sub_f32 v29, v7, v11
    v_add_f32 v6, v20, v8
    v_add_f32 v7, v21, v9
    v_sub_f32 v10, v20, v8
    v_sub_f32 v11, v21, v9
    v_add_f32 v8, v168, v29
    v_sub_f32 v9, v169, v28
    v_sub_f32 v20, v168, v29
    v_add_f32 v21, v169, v28
    v_add_f32 v28, v160, v32
    v_add_f32 v29, v161, v33
    v_sub_f32 v168, v160, v32
    v_sub_f32 v169, v161, v33
    v_add_f32 v32, v30, v34
    v_add_f32 v33, v31, v35
    v_sub_f32 v160, v30, v34
    v_sub_f32 v161, v31, v35
    v_add_f32 v30, v28, v32
    v_add_f32 v31, v29, v33
    v_sub_f32 v34, v28, v32
    v_sub_f32 v35, v29, v33
    v_add_f32 v28, v168, v161
    v_sub_f32 v29, v169, v160
    v_sub_f32 v32, v168, v161
    v_add_f32 v33, v169, v160
    v_mul_f32 v160, v22, v66
    v_fma_f32 v160, -v23, v67, v160
    v_mul_f32 v161, v23, v66
    v_fma_f32 v161, v22, v67, v161
    v_mul_f32 v22, v6, v68
    v_fma_f32 v22, -v7, v69, v22
    v_mul_f32 v23, v7, v68
    v_fma_f32 v23, v6, v69, v23
    v_mul_f32 v6, v30, v70
    v_fma_f32 v6, -v31, v71, v6
    v_mul_f32 v7, v31, v70
    v_fma_f32 v7, v30, v71, v7
    v_mul_f32 v30, v12, v72
    v_fma_f32 v30, -v13, v73, v30
    v_mul_f32 v31, v13, v72
    v_fma_f32 v31, v12, v73, v31
    v_mul_f32 v12, v4, v74
    v_fma_f32 v12, -v5, v75, v12
    v_mul_f32 v13, v5, v74
    v_fma_f32 v13, v4, v75, v13
    v_mul_f32 v4, v8, v76
    v_fma_f32 v4, -v9, v77, v4
    v_mul_f32 v5, v9, v76
    v_fma_f32 v5, v8, v77, v5
    v_mul_f32 v8, v28, v78
    v_fma_f32 v8, -v29, v79, v8
    v_mul_f32 v9, v29, v78
    v_fma_f32 v9, v28, v79, v9
    v_mul_f32 v28, v18, v80
    v_fma_f32 v28, -v19, v81, v28
    v_mul_f32 v29, v19, v80
    v_fma_f32 v29, v18, v81, v29
    v_mul_f32 v18, v26, v82
    v_fma_f32 v18, -v27, v83, v18
    v_mul_f32 v19, v27, v82
    v_fma_f32 v19, v26, v83, v19
    v_mul_f32 v26, v10, v84
    v_fma_f32 v26, -v11, v85, v26
    v_mul_f32 v27, v11, v84
    v_fma_f32 v27, v10, v85, v27
    v_mul_f32 v10, v34, v86
    v_fma_f32 v10, -v35, v87, v10
    v_mul_f32 v11, v35, v86
    v_fma_f32 v11, v34, v87, v11
    v_mul_f32 v34, v24, v88
    v_fma_f32 v34, -v25, v89, v34
    v_mul_f32 v35, v25, v88
    v_fma_f32 v35, v24, v89, v35
    v_mul_f32 v24, v16, v90
    v_fma_f32 v24, -v17, v91, v24
    v_mul_f32 v25, v17, v90
    v_fma_f32 v25, v16, v91, v25
    v_mul_f32 v16, v20, v92
    v_fma_f32 v16, -v21, v93, v16
    v_mul_f32 v17, v21, v92
    v_fma_f32 v17, v20, v93, v17
    v_mul_f32 v20, v32, v94
    v_fma_f32 v20, -v33, v95, v20
    v_mul_f32 v21, v33, v94
    v_fma_f32 v21, v32, v95, v21
    ds_write_b64 v164, v[14:15] offset:17408
    ds_write_b64 v164, v[160:161] offset:18464
    ds_write_b64 v164, v[22:23] offset:19520
    ds_write_b64 v164, v[6:7] offset:20576
    ds_write_b64 v164, v[30:31] offset:21632
    ds_write_b64 v164, v[12:13] offset:22688
    ds_write_b64 v164, v[4:5] offset:23744
    ds_write_b64 v164, v[8:9] offset:24800
    ds_write_b64 v164, v[28:29] offset:25856
    ds_write_b64 v164, v[18:19] offset:26912
    ds_write_b64 v164, v[26:27] offset:27968
    ds_write_b64 v164, v[10:11] offset:29024
    ds_write_b64 v164, v[34:35] offset:30080
    ds_write_b64 v164, v[24:25] offset:31136
    ds_write_b64 v164, v[16:17] offset:32192
    ds_write_b64 v164, v[20:21] offset:33248
    s_waitcnt lgkmcnt(0)
    s_barrier
    ds_read_b64 v[4:5], v166 offset:17408
    ds_read_b64 v[6:7], v166 offset:17416
    ds_read_b64 v[8:9], v166 offset:17424
    ds_read_b64 v[10:11], v166 offset:17432
    ds_read_b64 v[12:13], v166 offset:17440
    ds_read_b64 v[14:15], v166 offset:17448
    ds_read_b64 v[16:17], v166 offset:17456
    ds_read_b64 v[18:19], v166 offset:17464
    ds_read_b64 v[20:21], v166 offset:17472
    ds_read_b64 v[22:23], v166 offset:17480
    ds_read_b64 v[24:25], v166 offset:17488
    ds_read_b64 v[26:27], v166 offset:17496
    ds_read_b64 v[28:29], v166 offset:17504
    ds_read_b64 v[30:31], v166 offset:17512
    ds_read_b64 v[32:33], v166 offset:17520
    ds_read_b64 v[34:35], v166 offset:17528
    s_waitcnt lgkmcnt(0)
    v_add_f32 v160, v4, v12
    v_add_f32 v161, v5, v13
    v_sub_f32 v168, v4, v12
    v_sub_f32 v169, v5, v13
    v_add_f32 v4, v8, v16
    v_add_f32 v5, v9, v17
    v_sub_f32 v12, v8, v16
    v_sub_f32 v13, v9, v17
    v_add_f32 v8, v160, v4
    v_add_f32 v9, v161, v5
    v_sub_f32 v16, v160, v4
    v_sub_f32 v17, v161, v5
    v_add_f32 v4, v168, v13
    v_sub_f32 v5, v169, v12
    v_sub_f32 v160, v168, v13
    v_add_f32 v161, v169, v12
    v_add_f32 v12, v6, v14
    v_add_f32 v13, v7, v15
    v_sub_f32 v168, v6, v14
    v_sub_f32 v169, v7, v15
    v_add_f32 v6, v10, v18
    v_add_f32 v7, v11, v19
    v_sub_f32 v14, v10, v18
    v_sub_f32 v15, v11, v19
    v_add_f32 v10, v12, v6
    v_add_f32 v11, v13, v7
    v_sub_f32 v18, v12, v6
    v_sub_f32 v19, v13, v7
    v_add_f32 v6, v168, v15
    v_sub_f32 v7, v169, v14
    v_sub_f32 v12, v168, v15
    v_add_f32 v13, v169, v14
    v_mul_f32 v14, s20, v6
    v_fma_f32 v14, v7, s20, v14
    v_mul_f32 v15, s21, v6
    v_fma_f32 v15, v7, s20, v15
    v_mov_b32 v6, v19
    v_sub_f32 v7, 0, v18
    v_mul_f32 v18, s21, v12
    v_fma_f32 v18, v13, s20, v18
    v_mul_f32 v19, s21, v12
    v_fma_f32 v19, v13, s21, v19
    v_add_f32 v12, v8, v10
    v_add_f32 v13, v9, v11
    v_sub_f32 v168, v8, v10
    v_sub_f32 v169, v9, v11
    v_add_f32 v8, v4, v14
    v_add_f32 v9, v5, v15
    v_sub_f32 v10, v4, v14
    v_sub_f32 v11, v5, v15
    v_add_f32 v4, v16, v6
    v_add_f32 v5, v17, v7
    v_sub_f32 v14, v16, v6
    v_sub_f32 v15, v17, v7
    v_add_f32 v6, v160, v18
    v_add_f32 v7, v161, v19
    v_sub_f32 v16, v160, v18
    v_sub_f32 v17, v161, v19
    v_add_f32 v18, v20, v28
    v_add_f32 v19, v21, v29
    v_sub_f32 v160, v20, v28
    v_sub_f32 v161, v21, v29
    v_add_f32 v20, v24, v32
    v_add_f32 v21, v25, v33
    v_sub_f32 v28, v24, v32
    v_sub_f32 v29, v25, v33
    v_add_f32 v24, v18, v20
    v_add_f32 v25, v19, v21
    v_sub_f32 v32, v18, v20
    v_sub_f32 v33, v19, v21
    v_add_f32 v18, v160, v29
    v_sub_f32 v19, v161, v28
    v_sub_f32 v20, v160, v29
    v_add_f32 v21, v161, v28
    v_add_f32 v28, v22, v30
    v_add_f32 v29, v23, v31
    v_sub_f32 v160, v22, v30
    v_sub_f32 v161, v23, v31
    v_add_f32 v22, v26, v34
    v_add_f32 v23, v27, v35
    v_sub_f32 v30, v26, v34
    v_sub_f32 v31, v27, v35
    v_add_f32 v26, v28, v22
    v_add_f32 v27, v29, v23
    v_sub_f32 v34, v28, v22
    v_sub_f32 v35, v29, v23
    v_add_f32 v22, v160, v31
    v_sub_f32 v23, v161, v30
    v_sub_f32 v28, v160, v31
    v_add_f32 v29, v161, v30
    v_mul_f32 v30, s20, v22
    v_fma_f32 v30, v23, s20, v30
    v_mul_f32 v31, s21, v22
    v_fma_f32 v31, v23, s20, v31
    v_mov_b32 v22, v35
    v_sub_f32 v23, 0, v34
    v_mul_f32 v34, s21, v28
    v_fma_f32 v34, v29, s20, v34
    v_mul_f32 v35, s21, v28
    v_fma_f32 v35, v29, s21, v35
    v_add_f32 v28, v24, v26
    v_add_f32 v29, v25, v27
    v_sub_f32 v160, v24, v26
    v_sub_f32 v161, v25, v27
    v_add_f32 v24, v18, v30
    v_add_f32 v25, v19, v31
    v_sub_f32 v26, v18, v30
    v_sub_f32 v27, v19, v31
    v_add_f32 v18, v32, v22
    v_add_f32 v19, v33, v23
    v_sub_f32 v30, v32, v22
    v_sub_f32 v31, v33, v23
    v_add_f32 v22, v20, v34
    v_add_f32 v23, v21, v35
    v_sub_f32 v32, v20, v34
    v_sub_f32 v33, v21, v35
    s_waitcnt vmcnt(0)
    v_lshlrev_b32 v20, 16, v144
    v_and_b32 v21, 0xffff0000, v144
    v_mul_f32 v34, v12, v20
    v_fma_f32 v34, -v13, v21, v34
    v_mul_f32 v35, v13, v20
    v_fma_f32 v35, v12, v21, v35
    v_lshlrev_b32 v20, 16, v146
    v_and_b32 v21, 0xffff0000, v146
    v_mul_f32 v12, v8, v20
    v_fma_f32 v12, -v9, v21, v12
    v_mul_f32 v13, v9, v20
    v_fma_f32 v13, v8, v21, v13
    v_lshlrev_b32 v20, 16, v148
    v_and_b32 v21, 0xffff0000, v148
    v_mul_f32 v8, v4, v20
    v_fma_f32 v8, -v5, v21, v8
    v_mul_f32 v9, v5, v20
    v_fma_f32 v9, v4, v21, v9
    v_lshlrev_b32 v20, 16, v150
    v_and_b32 v21, 0xffff0000, v150
    v_mul_f32 v4, v6, v20
    v_fma_f32 v4, -v7, v21, v4
    v_mul_f32 v5, v7, v20
    v_fma_f32 v5, v6, v21, v5
    v_lshlrev_b32 v20, 16, v152
    v_and_b32 v21, 0xffff0000, v152
    v_mul_f32 v6, v168, v20
    v_fma_f32 v6, -v169, v21, v6
    v_mul_f32 v7, v169, v20
    v_fma_f32 v7, v168, v21, v7
    v_lshlrev_b32 v20, 16, v154
    v_and_b32 v21, 0xffff0000, v154
    v_mul_f32 v36, v10, v20
    v_fma_f32 v36, -v11, v21, v36
    v_mul_f32 v37, v11, v20
    v_fma_f32 v37, v10, v21, v37
    v_lshlrev_b32 v20, 16, v156
    v_and_b32 v21, 0xffff0000, v156
    v_mul_f32 v10, v14, v20
    v_fma_f32 v10, -v15, v21, v10
    v_mul_f32 v11, v15, v20
    v_fma_f32 v11, v14, v21, v11
    v_lshlrev_b32 v20, 16, v158
    v_and_b32 v21, 0xffff0000, v158
    v_mul_f32 v14, v16, v20
    v_fma_f32 v14, -v17, v21, v14
    v_mul_f32 v15, v17, v20
    v_fma_f32 v15, v16, v21, v15
    v_lshlrev_b32 v20, 16, v145
    v_and_b32 v21, 0xffff0000, v145
    v_mul_f32 v16, v28, v20
    v_fma_f32 v16, -v29, v21, v16
    v_mul_f32 v17, v29, v20
    v_fma_f32 v17, v28, v21, v17
    v_lshlrev_b32 v20, 16, v147
    v_and_b32 v21, 0xffff0000, v147
    v_mul_f32 v28, v24, v20
    v_fma_f32 v28, -v25, v21, v28
    v_mul_f32 v29, v25, v20
    v_fma_f32 v29, v24, v21, v29
    v_lshlrev_b32 v20, 16, v149
    v_and_b32 v21, 0xffff0000, v149
    v_mul_f32 v24, v18, v20
    v_fma_f32 v24, -v19, v21, v24
    v_mul_f32 v25, v19, v20
    v_fma_f32 v25, v18, v21, v25
    v_lshlrev_b32 v20, 16, v151
    v_and_b32 v21, 0xffff0000, v151
    v_mul_f32 v18, v22, v20
    v_fma_f32 v18, -v23, v21, v18
    v_mul_f32 v19, v23, v20
    v_fma_f32 v19, v22, v21, v19
    v_lshlrev_b32 v20, 16, v153
    v_and_b32 v21, 0xffff0000, v153
    v_mul_f32 v22, v160, v20
    v_fma_f32 v22, -v161, v21, v22
    v_mul_f32 v23, v161, v20
    v_fma_f32 v23, v160, v21, v23
    v_lshlrev_b32 v20, 16, v155
    v_and_b32 v21, 0xffff0000, v155
    v_mul_f32 v38, v26, v20
    v_fma_f32 v38, -v27, v21, v38
    v_mul_f32 v39, v27, v20
    v_fma_f32 v39, v26, v21, v39
    v_lshlrev_b32 v20, 16, v157
    v_and_b32 v21, 0xffff0000, v157
    v_mul_f32 v26, v30, v20
    v_fma_f32 v26, -v31, v21, v26
    v_mul_f32 v27, v31, v20
    v_fma_f32 v27, v30, v21, v27
    v_lshlrev_b32 v20, 16, v159
    v_and_b32 v21, 0xffff0000, v159
    v_mul_f32 v30, v32, v20
    v_fma_f32 v30, -v33, v21, v30
    v_mul_f32 v31, v33, v20
    v_fma_f32 v31, v32, v21, v31
    v_add_f32 v32, v34, v6
    v_add_f32 v33, v35, v7
    v_sub_f32 v40, v34, v6
    v_sub_f32 v41, v35, v7
    v_add_f32 v6, v8, v10
    v_add_f32 v7, v9, v11
    v_sub_f32 v34, v8, v10
    v_sub_f32 v35, v9, v11
    v_add_f32 v8, v32, v6
    v_add_f32 v9, v33, v7
    v_sub_f32 v10, v32, v6
    v_sub_f32 v11, v33, v7
    v_sub_f32 v6, v40, v35
    v_add_f32 v7, v41, v34
    v_add_f32 v32, v40, v35
    v_sub_f32 v33, v41, v34
    v_add_f32 v34, v12, v36
    v_add_f32 v35, v13, v37
    v_sub_f32 v40, v12, v36
    v_sub_f32 v41, v13, v37
    v_add_f32 v12, v4, v14
    v_add_f32 v13, v5, v15
    v_sub_f32 v36, v4, v14
    v_sub_f32 v37, v5, v15
    v_add_f32 v4, v34, v12
    v_add_f32 v5, v35, v13
    v_sub_f32 v14, v34, v12
    v_sub_f32 v15, v35, v13
    v_sub_f32 v12, v40, v37
    v_add_f32 v13, v41, v36
    v_add_f32 v34, v40, v37
    v_sub_f32 v35, v41, v36
    v_mul_f32 v36, s20, v12
    v_fma_f32 v36, v13, s21, v36
    v_mul_f32 v37, s20, v12
    v_fma_f32 v37, v13, s20, v37
    v_sub_f32 v12, 0, v15
    v_mov_b32 v13, v14
    v_mul_f32 v14, s21, v34
    v_fma_f32 v14, v35, s21, v14
    v_mul_f32 v15, s20, v34
    v_fma_f32 v15, v35, s21, v15
    v_add_f32 v34, v8, v4
    v_add_f32 v35, v9, v5
    v_sub_f32 v40, v8, v4
    v_sub_f32 v41, v9, v5
    v_add_f32 v4, v6, v36
    v_add_f32 v5, v7, v37
    v_sub_f32 v8, v6, v36
    v_sub_f32 v9, v7, v37
    v_add_f32 v6, v10, v12
    v_add_f32 v7, v11, v13
    v_sub_f32 v36, v10, v12
    v_sub_f32 v37, v11, v13
    v_add_f32 v10, v32, v14
    v_add_f32 v11, v33, v15
    v_sub_f32 v12, v32, v14
    v_sub_f32 v13, v33, v15
    v_mul_f32 v14, v4, v96
    v_fma_f32 v14, v5, v97, v14
    v_mul_f32 v15, v5, v96
    v_fma_f32 v15, -v4, v97, v15
    v_mul_f32 v4, v6, v98
    v_fma_f32 v4, v7, v99, v4
    v_mul_f32 v5, v7, v98
    v_fma_f32 v5, -v6, v99, v5
    v_mul_f32 v6, v10, v100
    v_fma_f32 v6, v11, v101, v6
    v_mul_f32 v7, v11, v100
    v_fma_f32 v7, -v10, v101, v7
    v_mul_f32 v10, v40, v102
    v_fma_f32 v10, v41, v103, v10
    v_mul_f32 v11, v41, v102
    v_fma_f32 v11, -v40, v103, v11
    v_mul_f32 v32, v8, v104
    v_fma_f32 v32, v9, v105, v32
    v_mul_f32 v33, v9, v104
    v_fma_f32 v33, -v8, v105, v33
    v_mul_f32 v8, v36, v106
    v_fma_f32 v8, v37, v107, v8
    v_mul_f32 v9, v37, v106
    v_fma_f32 v9, -v36, v107, v9
    v_mul_f32 v36, v12, v108
    v_fma_f32 v36, v13, v109, v36
    v_mul_f32 v37, v13, v108
    v_fma_f32 v37, -v12, v109, v37
    v_add_f32 v12, v16, v22
    v_add_f32 v13, v17, v23
    v_sub_f32 v40, v16, v22
    v_sub_f32 v41, v17, v23
    v_add_f32 v16, v24, v26
    v_add_f32 v17, v25, v27
    v_sub_f32 v22, v24, v26
    v_sub_f32 v23, v25, v27
    v_add_f32 v24, v12, v16
    v_add_f32 v25, v13, v17
    v_sub_f32 v26, v12, v16
    v_sub_f32 v27, v13, v17
    v_sub_f32 v12, v40, v23
    v_add_f32 v13, v41, v22
    v_add_f32 v16, v40, v23
    v_sub_f32 v17, v41, v22
    v_add_f32 v22, v28, v38
    v_add_f32 v23, v29, v39
    v_sub_f32 v40, v28, v38
    v_sub_f32 v41, v29, v39
    v_add_f32 v28, v18, v30
    v_add_f32 v29, v19, v31
    v_sub_f32 v38, v18, v30
    v_sub_f32 v39, v19, v31
    v_add_f32 v18, v22, v28
    v_add_f32 v19, v23, v29
    v_sub_f32 v30, v22, v28
    v_sub_f32 v31, v23, v29
    v_sub_f32 v22, v40, v39
    v_add_f32 v23, v41, v38
    v_add_f32 v28, v40, v39
    v_sub_f32 v29, v41, v38
    v_mul_f32 v38, s20, v22
    v_fma_f32 v38, v23, s21, v38
    v_mul_f32 v39, s20, v22
    v_fma_f32 v39, v23, s20, v39
    v_sub_f32 v22, 0, v31
    v_mov_b32 v23, v30
    v_mul_f32 v30, s21, v28
    v_fma_f32 v30, v29, s21, v30
    v_mul_f32 v31, s20, v28
    v_fma_f32 v31, v29, s21, v31
    v_add_f32 v28, v24, v18
    v_add_f32 v29, v25, v19
    v_sub_f32 v40, v24, v18
    v_sub_f32 v41, v25, v19
    v_add_f32 v18, v12, v38
    v_add_f32 v19, v13, v39
    v_sub_f32 v24, v12, v38
    v_sub_f32 v25, v13, v39
    v_add_f32 v12, v26, v22
    v_add_f32 v13, v27, v23
    v_sub_f32 v38, v26, v22
    v_sub_f32 v39, v27, v23
    v_add_f32 v22, v16, v30
    v_add_f32 v23, v17, v31
    v_sub_f32 v26, v16, v30
    v_sub_f32 v27, v17, v31
    v_mul_f32 v16, v18, v96
    v_fma_f32 v16, v19, v97, v16
    v_mul_f32 v17, v19, v96
    v_fma_f32 v17, -v18, v97, v17
    v_mul_f32 v18, v12, v98
    v_fma_f32 v18, v13, v99, v18
    v_mul_f32 v19, v13, v98
    v_fma_f32 v19, -v12, v99, v19
    v_mul_f32 v12, v22, v100
    v_fma_f32 v12, v23, v101, v12
    v_mul_f32 v13, v23, v100
    v_fma_f32 v13, -v22, v101, v13
    v_mul_f32 v22, v40, v102
    v_fma_f32 v22, v41, v103, v22
    v_mul_f32 v23, v41, v102
    v_fma_f32 v23, -v40, v103, v23
    v_mul_f32 v30, v24, v104
    v_fma_f32 v30, v25, v105, v30
    v_mul_f32 v31, v25, v104
    v_fma_f32 v31, -v24, v105, v31
    v_mul_f32 v24, v38, v106
    v_fma_f32 v24, v39, v107, v24
    v_mul_f32 v25, v39, v106
    v_fma_f32 v25, -v38, v107, v25
    v_mul_f32 v38, v26, v108
    v_fma_f32 v38, v27, v109, v38
    v_mul_f32 v39, v27, v108
    v_fma_f32 v39, -v26, v109, v39
    ds_write_b64 v166, v[34:35] offset:0
    ds_write_b64 v166, v[14:15] offset:8
    ds_write_b64 v166, v[4:5] offset:16
    ds_write_b64 v166, v[6:7] offset:24
    ds_write_b64 v166, v[10:11] offset:32
    ds_write_b64 v166, v[32:33] offset:40
    ds_write_b64 v166, v[8:9] offset:48
    ds_write_b64 v166, v[36:37] offset:56
    ds_write_b64 v166, v[28:29] offset:64
    ds_write_b64 v166, v[16:17] offset:72
    ds_write_b64 v166, v[18:19] offset:80
    ds_write_b64 v166, v[12:13] offset:88
    ds_write_b64 v166, v[22:23] offset:96
    ds_write_b64 v166, v[30:31] offset:104
    ds_write_b64 v166, v[24:25] offset:112
    ds_write_b64 v166, v[38:39] offset:120
    s_waitcnt lgkmcnt(0)
    s_barrier
    ds_read_b64 v[4:5], v164 offset:0
    ds_read_b64 v[6:7], v164 offset:1056
    ds_read_b64 v[8:9], v164 offset:2112
    ds_read_b64 v[10:11], v164 offset:3168
    ds_read_b64 v[12:13], v164 offset:4224
    ds_read_b64 v[14:15], v164 offset:5280
    ds_read_b64 v[16:17], v164 offset:6336
    ds_read_b64 v[18:19], v164 offset:7392
    ds_read_b64 v[22:23], v164 offset:8448
    ds_read_b64 v[24:25], v164 offset:9504
    ds_read_b64 v[26:27], v164 offset:10560
    ds_read_b64 v[28:29], v164 offset:11616
    ds_read_b64 v[30:31], v164 offset:12672
    ds_read_b64 v[32:33], v164 offset:13728
    ds_read_b64 v[34:35], v164 offset:14784
    ds_read_b64 v[36:37], v164 offset:15840
    s_waitcnt lgkmcnt(0)
    v_add_f32 v38, v4, v22
    v_add_f32 v39, v5, v23
    v_sub_f32 v40, v4, v22
    v_sub_f32 v41, v5, v23
    v_add_f32 v4, v12, v30
    v_add_f32 v5, v13, v31
    v_sub_f32 v22, v12, v30
    v_sub_f32 v23, v13, v31
    v_add_f32 v12, v38, v4
    v_add_f32 v13, v39, v5
    v_sub_f32 v30, v38, v4
    v_sub_f32 v31, v39, v5
    v_sub_f32 v4, v40, v23
    v_add_f32 v5, v41, v22
    v_add_f32 v38, v40, v23
    v_sub_f32 v39, v41, v22
    v_add_f32 v22, v6, v24
    v_add_f32 v23, v7, v25
    v_sub_f32 v40, v6, v24
    v_sub_f32 v41, v7, v25
    v_add_f32 v6, v14, v32
    v_add_f32 v7, v15, v33
    v_sub_f32 v24, v14, v32
    v_sub_f32 v25, v15, v33
    v_add_f32 v14, v22, v6
    v_add_f32 v15, v23, v7
    v_sub_f32 v32, v22, v6
    v_sub_f32 v33, v23, v7
    v_sub_f32 v6, v40, v25
    v_add_f32 v7, v41, v24
    v_add_f32 v22, v40, v25
    v_sub_f32 v23, v41, v24
    v_add_f32 v24, v8, v26
    v_add_f32 v25, v9, v27
    v_sub_f32 v40, v8, v26
    v_sub_f32 v41, v9, v27
    v_add_f32 v8, v16, v34
    v_add_f32 v9, v17, v35
    v_sub_f32 v26, v16, v34
    v_sub_f32 v27, v17, v35
    v_add_f32 v16, v24, v8
    v_add_f32 v17, v25, v9
    v_sub_f32 v34, v24, v8
    v_sub_f32 v35, v25, v9
    v_sub_f32 v8, v40, v27
    v_add_f32 v9, v41, v26
    v_add_f32 v24, v40, v27
    v_sub_f32 v25, v41, v26
    v_add_f32 v26, v10, v28
    v_add_f32 v27, v11, v29
    v_sub_f32 v40, v10, v28
    v_sub_f32 v41, v11, v29
    v_add_f32 v10, v18, v36
    v_add_f32 v11, v19, v37
    v_sub_f32 v28, v18, v36
    v_sub_f32 v29, v19, v37
    v_add_f32 v18, v26, v10
    v_add_f32 v19, v27, v11
    v_sub_f32 v36, v26, v10
    v_sub_f32 v37, v27, v11
    v_sub_f32 v10, v40, v29
    v_add_f32 v11, v41, v28
    v_add_f32 v26, v40, v29
    v_sub_f32 v27, v41, v28
    v_mul_f32 v28, s16, v6
    v_fma_f32 v28, v7, s19, v28
    v_mul_f32 v29, s18, v6
    v_fma_f32 v29, v7, s16, v29
    v_mul_f32 v6, s20, v32
    v_fma_f32 v6, v33, s21, v6
    v_mul_f32 v7, s20, v32
    v_fma_f32 v7, v33, s20, v7
    v_mul_f32 v32, s18, v22
    v_fma_f32 v32, v23, s17, v32
    v_mul_f32 v33, s16, v22
    v_fma_f32 v33, v23, s18, v33
    v_mul_f32 v22, s20, v8
    v_fma_f32 v22, v9, s21, v22
    v_mul_f32 v23, s20, v8
    v_fma_f32 v23, v9, s20, v23
    v_sub_f32 v8, 0, v35
    v_mov_b32 v9, v34
    v_mul_f32 v34, s21, v24
    v_fma_f32 v34, v25, s21, v34
    v_mul_f32 v35, s20, v24
    v_fma_f32 v35, v25, s21, v35
    v_mul_f32 v24, s18, v10
    v_fma_f32 v24, v11, s17, v24
    v_mul_f32 v25, s16, v10
    v_fma_f32 v25, v11, s18, v25
    v_mul_f32 v10, s21, v36
    v_fma_f32 v10, v37, s21, v10
    v_mul_f32 v11, s20, v36
    v_fma_f32 v11, v37, s21, v11
    v_mul_f32 v36, s17, v26
    v_fma_f32 v36, v27, s18, v36
    v_mul_f32 v37, s19, v26
    v_fma_f32 v37, v27, s17, v37
    v_add_f32 v26, v12, v16
    v_add_f32 v27, v13, v17
    v_sub_f32 v40, v12, v16
    v_sub_f32 v41, v13, v17
    v_add_f32 v12, v14, v18
    v_add_f32 v13, v15, v19
    v_sub_f32 v16, v14, v18
    v_sub_f32 v17, v15, v19
    v_add_f32 v14, v26, v12
    v_add_f32 v15, v27, v13
    v_sub_f32 v18, v26, v12
    v_sub_f32 v19, v27, v13
    v_sub_f32 v12, v40, v17
    v_add_f32 v13, v41, v16
    v_add_f32 v26, v40, v17
    v_sub_f32 v27, v41, v16
    v_add_f32 v16, v4, v22
    v_add_f32 v17, v5, v23
    v_sub_f32 v40, v4, v22
    v_sub_f32 v41, v5, v23
    v_add_f32 v4, v28, v24
    v_add_f32 v5, v29, v25
    v_sub_f32 v22, v28, v24
    v_sub_f32 v23, v29, v25
    v_add_f32 v24, v16, v4
    v_add_f32 v25, v17, v5
    v_sub_f32 v28, v16, v4
    v_sub_f32 v29, v17, v5
    v_sub_f32 v4, v40, v23
    v_add_f32 v5, v41, v22
    v_add_f32 v16, v40, v23
    v_sub_f32 v17, v41, v22
    v_add_f32 v22, v30, v8
    v_add_f32 v23, v31, v9
    v_sub_f32 v40, v30, v8
    v_sub_f32 v41, v31, v9
    v_add_f32 v8, v6, v10
    v_add_f32 v9, v7, v11
    v_sub_f32 v30, v6, v10
    v_sub_f32 v31, v7, v11
    v_add_f32 v6, v22, v8
    v_add_f32 v7, v23, v9
    v_sub_f32 v10, v22, v8
    v_sub_f32 v11, v23, v9
    v_sub_f32 v8, v40, v31
    v_add_f32 v9, v41, v30
    v_add_f32 v22, v40, v31
    v_sub_f32 v23, v41, v30
    v_add_f32 v30, v38, v34
    v_add_f32 v31, v39, v35
    v_sub_f32 v40, v38, v34
    v_sub_f32 v41, v39, v35
    v_add_f32 v34, v32, v36
    v_add_f32 v35, v33, v37
    v_sub_f32 v38, v32, v36
    v_sub_f32 v39, v33, v37
    v_add_f32 v32, v30, v34
    v_add_f32 v33, v31, v35
    v_sub_f32 v36, v30, v34
    v_sub_f32 v37, v31, v35
    v_sub_f32 v30, v40, v39
    v_add_f32 v31, v41, v38
    v_add_f32 v34, v40, v39
    v_sub_f32 v35, v41, v38
    v_mul_f32 v38, v14, v110
    v_fma_f32 v38, v15, v111, v38
    v_mul_f32 v39, v15, v110
    v_fma_f32 v39, -v14, v111, v39
    v_mul_f32 v14, v24, v112
    v_fma_f32 v14, v25, v113, v14
    v_mul_f32 v15, v25, v112
    v_fma_f32 v15, -v24, v113, v15
    v_mul_f32 v24, v6, v114
    v_fma_f32 v24, v7, v115, v24
    v_mul_f32 v25, v7, v114
    v_fma_f32 v25, -v6, v115, v25
    v_mul_f32 v6, v32, v116
    v_fma_f32 v6, v33, v117, v6
    v_mul_f32 v7, v33, v116
    v_fma_f32 v7, -v32, v117, v7
    v_mul_f32 v32, v12, v118
    v_fma_f32 v32, v13, v119, v32
    v_mul_f32 v33, v13, v118
    v_fma_f32 v33, -v12, v119, v33
    v_mul_f32 v12, v4, v120
    v_fma_f32 v12, v5, v121, v12
    v_mul_f32 v13, v5, v120
    v_fma_f32 v13, -v4, v121, v13
    v_mul_f32 v4, v8, v122
    v_fma_f32 v4, v9, v123, v4
    v_mul_f32 v5, v9, v122
    v_fma_f32 v5, -v8, v123, v5
    v_mul_f32 v8, v30, v124
    v_fma_f32 v8, v31, v125, v8
    v_mul_f32 v9, v31, v124
    v_fma_f32 v9, -v30, v125, v9
    v_mul_f32 v30, v18, v126
    v_fma_f32 v30, v19, v127, v30
    v_mul_f32 v31, v19, v126
    v_fma_f32 v31, -v18, v127, v31
    v_mul_f32 v18, v28, v128
    v_fma_f32 v18, v29, v129, v18
    v_mul_f32 v19, v29, v128
    v_fma_f32 v19, -v28, v129, v19
    v_mul_f32 v28, v10, v130
    v_fma_f32 v28, v11, v131, v28
    v_mul_f32 v29, v11, v130
    v_fma_f32 v29, -v10, v131, v29
    v_mul_f32 v10, v36, v132
    v_fma_f32 v10, v37, v133, v10
    v_mul_f32 v11, v37, v132
    v_fma_f32 v11, -v36, v133, v11
    v_mul_f32 v36, v26, v134
    v_fma_f32 v36, v27, v135, v36
    v_mul_f32 v37, v27, v134
    v_fma_f32 v37, -v26, v135, v37
    v_mul_f32 v26, v16, v136
    v_fma_f32 v26, v17, v137, v26
    v_mul_f32 v27, v17, v136
    v_fma_f32 v27, -v16, v137, v27
    v_mul_f32 v16, v22, v138
    v_fma_f32 v16, v23, v139, v16
    v_mul_f32 v17, v23, v138
    v_fma_f32 v17, -v22, v139, v17
    v_mul_f32 v22, v34, v140
    v_fma_f32 v22, v35, v141, v22
    v_mul_f32 v23, v35, v140
    v_fma_f32 v23, -v34, v141, v23
    ds_write_b64 v163, v[38:39] offset:17408
    ds_write_b64 v163, v[14:15] offset:17472
    ds_write_b64 v163, v[24:25] offset:17536
    ds_write_b64 v163, v[6:7] offset:17600
    ds_write_b64 v163, v[32:33] offset:17664
    ds_write_b64 v163, v[12:13] offset:17728
    ds_write_b64 v163, v[4:5] offset:17792
    ds_write_b64 v163, v[8:9] offset:17856
    ds_write_b64 v163, v[30:31] offset:17920
    ds_write_b64 v163, v[18:19] offset:17984
    ds_write_b64 v163, v[28:29] offset:18048
    ds_write_b64 v163, v[10:11] offset:18112
    ds_write_b64 v163, v[36:37] offset:18176
    ds_write_b64 v163, v[26:27] offset:18240
    ds_write_b64 v163, v[16:17] offset:18304
    ds_write_b64 v163, v[22:23] offset:18368
    s_waitcnt lgkmcnt(0)
    s_barrier
    ds_read_b64 v[4:5], v162 offset:17408
    ds_read_b64 v[6:7], v162 offset:18496
    ds_read_b64 v[8:9], v162 offset:19584
    ds_read_b64 v[10:11], v162 offset:20672
    ds_read_b64 v[12:13], v162 offset:21760
    ds_read_b64 v[14:15], v162 offset:22848
    ds_read_b64 v[16:17], v162 offset:23936
    ds_read_b64 v[18:19], v162 offset:25024
    ds_read_b64 v[22:23], v162 offset:26112
    ds_read_b64 v[24:25], v162 offset:27200
    ds_read_b64 v[26:27], v162 offset:28288
    ds_read_b64 v[28:29], v162 offset:29376
    ds_read_b64 v[30:31], v162 offset:30464
    ds_read_b64 v[32:33], v162 offset:31552
    ds_read_b64 v[34:35], v162 offset:32640
    ds_read_b64 v[36:37], v162 offset:33728
    s_waitcnt lgkmcnt(0)
    v_add_f32 v38, v4, v22
    v_add_f32 v39, v5, v23
    v_sub_f32 v40, v4, v22
    v_sub_f32 v41, v5, v23
    v_add_f32 v4, v12, v30
    v_add_f32 v5, v13, v31
    v_sub_f32 v22, v12, v30
    v_sub_f32 v23, v13, v31
    v_add_f32 v12, v38, v4
    v_add_f32 v13, v39, v5
    v_sub_f32 v30, v38, v4
    v_sub_f32 v31, v39, v5
    v_sub_f32 v4, v40, v23
    v_add_f32 v5, v41, v22
    v_add_f32 v38, v40, v23
    v_sub_f32 v39, v41, v22
    v_add_f32 v22, v6, v24
    v_add_f32 v23, v7, v25
    v_sub_f32 v40, v6, v24
    v_sub_f32 v41, v7, v25
    v_add_f32 v6, v14, v32
    v_add_f32 v7, v15, v33
    v_sub_f32 v24, v14, v32
    v_sub_f32 v25, v15, v33
    v_add_f32 v14, v22, v6
    v_add_f32 v15, v23, v7
    v_sub_f32 v32, v22, v6
    v_sub_f32 v33, v23, v7
    v_sub_f32 v6, v40, v25
    v_add_f32 v7, v41, v24
    v_add_f32 v22, v40, v25
    v_sub_f32 v23, v41, v24
    v_add_f32 v24, v8, v26
    v_add_f32 v25, v9, v27
    v_sub_f32 v40, v8, v26
    v_sub_f32 v41, v9, v27
    v_add_f32 v8, v16, v34
    v_add_f32 v9, v17, v35
    v_sub_f32 v26, v16, v34
    v_sub_f32 v27, v17, v35
    v_add_f32 v16, v24, v8
    v_add_f32 v17, v25, v9
    v_sub_f32 v34, v24, v8
    v_sub_f32 v35, v25, v9
    v_sub_f32 v8, v40, v27
    v_add_f32 v9, v41, v26
    v_add_f32 v24, v40, v27
    v_sub_f32 v25, v41, v26
    v_add_f32 v26, v10, v28
    v_add_f32 v27, v11, v29
    v_sub_f32 v40, v10, v28
    v_sub_f32 v41, v11, v29
    v_add_f32 v10, v18, v36
    v_add_f32 v11, v19, v37
    v_sub_f32 v28, v18, v36
    v_sub_f32 v29, v19, v37
    v_add_f32 v18, v26, v10
    v_add_f32 v19, v27, v11
    v_sub_f32 v36, v26, v10
    v_sub_f32 v37, v27, v11
    v_sub_f32 v10, v40, v29
    v_add_f32 v11, v41, v28
    v_add_f32 v26, v40, v29
    v_sub_f32 v27, v41, v28
    v_mul_f32 v28, s16, v6
    v_fma_f32 v28, v7, s19, v28
    v_mul_f32 v29, s18, v6
    v_fma_f32 v29, v7, s16, v29
    v_mul_f32 v6, s20, v32
    v_fma_f32 v6, v33, s21, v6
    v_mul_f32 v7, s20, v32
    v_fma_f32 v7, v33, s20, v7
    v_mul_f32 v32, s18, v22
    v_fma_f32 v32, v23, s17, v32
    v_mul_f32 v33, s16, v22
    v_fma_f32 v33, v23, s18, v33
    v_mul_f32 v22, s20, v8
    v_fma_f32 v22, v9, s21, v22
    v_mul_f32 v23, s20, v8
    v_fma_f32 v23, v9, s20, v23
    v_sub_f32 v8, 0, v35
    v_mov_b32 v9, v34
    v_mul_f32 v34, s21, v24
    v_fma_f32 v34, v25, s21, v34
    v_mul_f32 v35, s20, v24
    v_fma_f32 v35, v25, s21, v35
    v_mul_f32 v24, s18, v10
    v_fma_f32 v24, v11, s17, v24
    v_mul_f32 v25, s16, v10
    v_fma_f32 v25, v11, s18, v25
    v_mul_f32 v10, s21, v36
    v_fma_f32 v10, v37, s21, v10
    v_mul_f32 v11, s20, v36
    v_fma_f32 v11, v37, s21, v11
    v_mul_f32 v36, s17, v26
    v_fma_f32 v36, v27, s18, v36
    v_mul_f32 v37, s19, v26
    v_fma_f32 v37, v27, s17, v37
    v_add_f32 v26, v12, v16
    v_add_f32 v27, v13, v17
    v_sub_f32 v40, v12, v16
    v_sub_f32 v41, v13, v17
    v_add_f32 v12, v14, v18
    v_add_f32 v13, v15, v19
    v_sub_f32 v16, v14, v18
    v_sub_f32 v17, v15, v19
    v_add_f32 v14, v26, v12
    v_add_f32 v15, v27, v13
    v_sub_f32 v18, v26, v12
    v_sub_f32 v19, v27, v13
    v_sub_f32 v12, v40, v17
    v_add_f32 v13, v41, v16
    v_add_f32 v26, v40, v17
    v_sub_f32 v27, v41, v16
    v_add_f32 v16, v4, v22
    v_add_f32 v17, v5, v23
    v_sub_f32 v40, v4, v22
    v_sub_f32 v41, v5, v23
    v_add_f32 v4, v28, v24
    v_add_f32 v5, v29, v25
    v_sub_f32 v22, v28, v24
    v_sub_f32 v23, v29, v25
    v_add_f32 v24, v16, v4
    v_add_f32 v25, v17, v5
    v_sub_f32 v28, v16, v4
    v_sub_f32 v29, v17, v5
    v_sub_f32 v4, v40, v23
    v_add_f32 v5, v41, v22
    v_add_f32 v16, v40, v23
    v_sub_f32 v17, v41, v22
    v_add_f32 v22, v30, v8
    v_add_f32 v23, v31, v9
    v_sub_f32 v40, v30, v8
    v_sub_f32 v41, v31, v9
    v_add_f32 v8, v6, v10
    v_add_f32 v9, v7, v11
    v_sub_f32 v30, v6, v10
    v_sub_f32 v31, v7, v11
    v_add_f32 v6, v22, v8
    v_add_f32 v7, v23, v9
    v_sub_f32 v10, v22, v8
    v_sub_f32 v11, v23, v9
    v_sub_f32 v8, v40, v31
    v_add_f32 v9, v41, v30
    v_add_f32 v22, v40, v31
    v_sub_f32 v23, v41, v30
    v_add_f32 v30, v38, v34
    v_add_f32 v31, v39, v35
    v_sub_f32 v40, v38, v34
    v_sub_f32 v41, v39, v35
    v_add_f32 v34, v32, v36
    v_add_f32 v35, v33, v37
    v_sub_f32 v38, v32, v36
    v_sub_f32 v39, v33, v37
    v_add_f32 v32, v30, v34
    v_add_f32 v33, v31, v35
    v_sub_f32 v36, v30, v34
    v_sub_f32 v37, v31, v35
    v_sub_f32 v30, v40, v39
    v_add_f32 v31, v41, v38
    v_add_f32 v34, v40, v39
    v_sub_f32 v35, v41, v38
    s_lshl_b32 s24, s2, 14
    s_add_u32 s24, s24, 20971520
    v_mov_b32 v2, v1
    buffer_store_dwordx2 v[14:15], v2, s[12:15], s24 offen offset:0
    buffer_store_dwordx2 v[24:25], v2, s[12:15], s24 offen offset:1024
    buffer_store_dwordx2 v[6:7], v2, s[12:15], s24 offen offset:2048
    buffer_store_dwordx2 v[32:33], v2, s[12:15], s24 offen offset:3072
    v_add_u32 v2, 4096, v2
    buffer_store_dwordx2 v[12:13], v2, s[12:15], s24 offen offset:0
    buffer_store_dwordx2 v[4:5], v2, s[12:15], s24 offen offset:1024
    buffer_store_dwordx2 v[8:9], v2, s[12:15], s24 offen offset:2048
    buffer_store_dwordx2 v[30:31], v2, s[12:15], s24 offen offset:3072
    v_add_u32 v2, 4096, v2
    buffer_store_dwordx2 v[18:19], v2, s[12:15], s24 offen offset:0
    buffer_store_dwordx2 v[28:29], v2, s[12:15], s24 offen offset:1024
    buffer_store_dwordx2 v[10:11], v2, s[12:15], s24 offen offset:2048
    buffer_store_dwordx2 v[36:37], v2, s[12:15], s24 offen offset:3072
    v_add_u32 v2, 4096, v2
    buffer_store_dwordx2 v[26:27], v2, s[12:15], s24 offen offset:0
    buffer_store_dwordx2 v[16:17], v2, s[12:15], s24 offen offset:1024
    buffer_store_dwordx2 v[22:23], v2, s[12:15], s24 offen offset:2048
    buffer_store_dwordx2 v[34:35], v2, s[12:15], s24 offen offset:3072
    s_waitcnt vmcnt(0)
K2C_END:
    s_endpgm
.globl k3_irfft_kernel
.p2align 8
.type k3_irfft_kernel,@function
k3_irfft_kernel:
    s_cmp_ge_u32 s2, 256
    s_cbranch_scc1 K3_END
    s_load_dwordx2 s[6:7], s[0:1], 72
    s_mov_b32 s16, 0x3f6c835e
    s_mov_b32 s17, 0xbf6c835e
    s_mov_b32 s18, 0x3ec3ef15
    s_mov_b32 s19, 0xbec3ef15
    s_mov_b32 s20, 0x3f3504f3
    s_mov_b32 s21, 0xbf3504f3
    s_getpc_b64 s[26:27]
    s_add_u32 s26, s26, T1024_tw1A@rel32@lo+4
    s_addc_u32 s27, s27, T1024_tw1A@rel32@hi+12
    v_and_b32 v1, 63, v0
    v_lshrrev_b32 v2, 6, v0
    s_nop 0
    v_readfirstlane_b32 s23, v2
    s_waitcnt lgkmcnt(0)
    s_mov_b32 s12, s6
    s_mov_b32 s13, s7
    s_mov_b32 s14, 268435456
    s_mov_b32 s15, 0x00020000
    s_lshl_b32 s24, s2, 2
    s_add_u32 s23, s24, s23
    s_lshl_b32 s24, s23, 4
    s_add_u32 s24, s24, 20971520
    v_lshlrev_b32 v3, 14, v1
    v_sub_u32 v4, 8388608, v3
    buffer_load_dwordx4 v[8:11], v3, s[12:15], s24 offen
    v_add_u32 v3, 1048576, v3
    buffer_load_dwordx4 v[12:15], v3, s[12:15], s24 offen
    v_add_u32 v3, 1048576, v3
    buffer_load_dwordx4 v[16:19], v3, s[12:15], s24 offen
    v_add_u32 v3, 1048576, v3
    buffer_load_dwordx4 v[20:23], v3, s[12:15], s24 offen
    v_add_u32 v3, 1048576, v3
    buffer_load_dwordx4 v[24:27], v3, s[12:15], s24 offen
    v_add_u32 v3, 1048576, v3
    buffer_load_dwordx4 v[28:31], v3, s[12:15], s24 offen
    v_add_u32 v3, 1048576, v3
    buffer_load_dwordx4 v[32:35], v3, s[12:15], s24 offen
    v_add_u32 v3, 1048576, v3
    buffer_load_dwordx4 v[36:39], v3, s[12:15], s24 offen
    buffer_load_dwordx4 v[40:43], v4, s[12:15], s24 offen
    v_subrev_u32 v4, 1048576, v4
    buffer_load_dwordx4 v[44:47], v4, s[12:15], s24 offen
    v_subrev_u32 v4, 1048576, v4
    buffer_load_dwordx4 v[48:51], v4, s[12:15], s24 offen
    v_subrev_u32 v4, 1048576, v4
    buffer_load_dwordx4 v[52:55], v4, s[12:15], s24 offen
    v_subrev_u32 v4, 1048576, v4
    buffer_load_dwordx4 v[56:59], v4, s[12:15], s24 offen
    v_subrev_u32 v4, 1048576, v4
    buffer_load_dwordx4 v[60:63], v4, s[12:15], s24 offen
    v_subrev_u32 v4, 1048576, v4
    buffer_load_dwordx4 v[64:67], v4, s[12:15], s24 offen
    v_subrev_u32 v4, 1048576, v4
    buffer_load_dwordx4 v[68:71], v4, s[12:15], s24 offen
    v_lshlrev_b32 v5, 3, v1
    global_load_dwordx2 v[6:7], v5, s[26:27] offset:512
    global_load_dwordx2 v[72:73], v5, s[26:27] offset:1024
    global_load_dwordx2 v[74:75], v5, s[26:27] offset:1536
    global_load_dwordx2 v[76:77], v5, s[26:27] offset:2048
    global_load_dwordx2 v[78:79], v5, s[26:27] offset:2560
    global_load_dwordx2 v[80:81], v5, s[26:27] offset:3072
    global_load_dwordx2 v[82:83], v5, s[26:27] offset:3584
    v_add_u32 v5, 4096, v5
    global_load_dwordx2 v[84:85], v5, s[26:27] offset:0
    global_load_dwordx2 v[86:87], v5, s[26:27] offset:512
    global_load_dwordx2 v[88:89], v5, s[26:27] offset:1024
    global_load_dwordx2 v[90:91], v5, s[26:27] offset:1536
    global_load_dwordx2 v[92:93], v5, s[26:27] offset:2048
    global_load_dwordx2 v[94:95], v5, s[26:27] offset:2560
    global_load_dwordx2 v[96:97], v5, s[26:27] offset:3072
    global_load_dwordx2 v[98:99], v5, s[26:27] offset:3584
    v_add_u32 v5, 4096, v5
    global_load_dwordx2 v[100:101], v5, s[26:27] offset:512
    global_load_dwordx2 v[102:103], v5, s[26:27] offset:1024
    global_load_dwordx2 v[104:105], v5, s[26:27] offset:1536
    global_load_dwordx2 v[106:107], v5, s[26:27] offset:2048
    global_load_dwordx2 v[108:109], v5, s[26:27] offset:2560
    global_load_dwordx2 v[110:111], v5, s[26:27] offset:3072
    global_load_dwordx2 v[112:113], v5, s[26:27] offset:3584
    v_add_u32 v5, 4096, v5
    global_load_dwordx2 v[114:115], v5, s[26:27] offset:0
    global_load_dwordx2 v[116:117], v5, s[26:27] offset:512
    global_load_dwordx2 v[118:119], v5, s[26:27] offset:1024
    global_load_dwordx2 v[120:121], v5, s[26:27] offset:1536
    global_load_dwordx2 v[122:123], v5, s[26:27] offset:2048
    global_load_dwordx2 v[124:125], v5, s[26:27] offset:2560
    global_load_dwordx2 v[126:127], v5, s[26:27] offset:3072
    global_load_dwordx2 v[128:129], v5, s[26:27] offset:3584
    s_mov_b32 s25, 8704
    v_mul_lo_u32 v130, v2, s25
    v_lshl_add_u32 v133, v1, 3, v130
    v_lshrrev_b32 v131, 2, v1
    v_and_b32 v132, 3, v1
    s_mov_b32 s22, 544
    v_mul_lo_u32 v134, v131, s22
    v_lshl_add_u32 v134, v132, 3, v134
    v_add_u32 v134, v134, v130
    v_lshrrev_b32 v136, 3, v131
    v_mul_u32_u24 v136, 8, v136
    v_lshl_add_u32 v135, v1, 3, v136
    v_add_u32 v135, v135, v130
    s_mov_b32 s22, 528
    v_mul_lo_u32 v137, v131, s22
    v_lshl_add_u32 v137, v132, 7, v137
    v_mul_u32_u24 v136, 4, v132
    v_lshrrev_b32 v136, 3, v136
    v_mul_u32_u24 v136, 8, v136
    v_add_u32 v137, v137, v136
    v_add_u32 v137, v137, v130
    s_waitcnt vmcnt(30)
    v_cmp_eq_u32 vcc, 0, v1
    s_nop 1
    v_cndmask_b32 v9, v9, 0, vcc
    v_cndmask_b32 v11, v11, 0, vcc
    v_cndmask_b32 v41, v41, 0, vcc
    v_cndmask_b32 v43, v43, 0, vcc
    v_sub_f32 v138, v8, v11
    v_add_f32 v139, v9, v10
    v_sub_f32 v8, v12, v15
    v_add_f32 v9, v13, v14
    v_sub_f32 v10, v16, v19
    v_add_f32 v11, v17, v18
    v_sub_f32 v12, v20, v23
    v_add_f32 v13, v21, v22
    v_sub_f32 v14, v24, v27
    v_add_f32 v15, v25, v26
    v_sub_f32 v16, v28, v31
    v_add_f32 v17, v29, v30
    v_sub_f32 v18, v32, v35
    v_add_f32 v19, v33, v34
    v_sub_f32 v20, v36, v39
    v_add_f32 v21, v37, v38
    v_add_f32 v22, v40, v43
    v_sub_f32 v23, v42, v41
    v_add_f32 v24, v44, v47
    v_sub_f32 v25, v46, v45
    v_add_f32 v26, v48, v51
    v_sub_f32 v27, v50, v49
    v_add_f32 v28, v52, v55
    v_sub_f32 v29, v54, v53
    v_add_f32 v30, v56, v59
    v_sub_f32 v31, v58, v57
    v_add_f32 v32, v60, v63
    v_sub_f32 v33, v62, v61
    v_add_f32 v34, v64, v67
    v_sub_f32 v35, v66, v65
    v_add_f32 v36, v68, v71
    v_sub_f32 v37, v70, v69
    s_waitcnt vmcnt(0)
    v_add_f32 v38, v138, v22
    v_add_f32 v39, v139, v23
    v_sub_f32 v40, v138, v22
    v_sub_f32 v41, v139, v23
    v_add_f32 v22, v14, v30
    v_add_f32 v23, v15, v31
    v_sub_f32 v42, v14, v30
    v_sub_f32 v43, v15, v31
    v_add_f32 v14, v38, v22
    v_add_f32 v15, v39, v23
    v_sub_f32 v30, v38, v22
    v_sub_f32 v31, v39, v23
    v_sub_f32 v22, v40, v43
    v_add_f32 v23, v41, v42
    v_add_f32 v38, v40, v43
    v_sub_f32 v39, v41, v42
    v_add_f32 v40, v8, v24
    v_add_f32 v41, v9, v25
    v_sub_f32 v42, v8, v24
    v_sub_f32 v43, v9, v25
    v_add_f32 v8, v16, v32
    v_add_f32 v9, v17, v33
    v_sub_f32 v24, v16, v32
    v_sub_f32 v25, v17, v33
    v_add_f32 v16, v40, v8
    v_add_f32 v17, v41, v9
    v_sub_f32 v32, v40, v8
    v_sub_f32 v33, v41, v9
    v_sub_f32 v8, v42, v25
    v_add_f32 v9, v43, v24
    v_add_f32 v40, v42, v25
    v_sub_f32 v41, v43, v24
    v_add_f32 v24, v10, v26
    v_add_f32 v25, v11, v27
    v_sub_f32 v42, v10, v26
    v_sub_f32 v43, v11, v27
    v_add_f32 v10, v18, v34
    v_add_f32 v11, v19, v35
    v_sub_f32 v26, v18, v34
    v_sub_f32 v27, v19, v35
    v_add_f32 v18, v24, v10
    v_add_f32 v19, v25, v11
    v_sub_f32 v34, v24, v10
    v_sub_f32 v35, v25, v11
    v_sub_f32 v10, v42, v27
    v_add_f32 v11, v43, v26
    v_add_f32 v24, v42, v27
    v_sub_f32 v25, v43, v26
    v_add_f32 v26, v12, v28
    v_add_f32 v27, v13, v29
    v_sub_f32 v42, v12, v28
    v_sub_f32 v43, v13, v29
    v_add_f32 v12, v20, v36
    v_add_f32 v13, v21, v37
    v_sub_f32 v28, v20, v36
    v_sub_f32 v29, v21, v37
    v_add_f32 v20, v26, v12
    v_add_f32 v21, v27, v13
    v_sub_f32 v36, v26, v12
    v_sub_f32 v37, v27, v13
    v_sub_f32 v12, v42, v29
    v_add_f32 v13, v43, v28
    v_add_f32 v26, v42, v29
    v_sub_f32 v27, v43, v28
    v_mul_f32 v28, s16, v8
    v_fma_f32 v28, v9, s19, v28
    v_mul_f32 v29, s18, v8
    v_fma_f32 v29, v9, s16, v29
    v_mul_f32 v8, s20, v32
    v_fma_f32 v8, v33, s21, v8
    v_mul_f32 v9, s20, v32
    v_fma_f32 v9, v33, s20, v9
    v_mul_f32 v32, s18, v40
    v_fma_f32 v32, v41, s17, v32
    v_mul_f32 v33, s16, v40
    v_fma_f32 v33, v41, s18, v33
    v_mul_f32 v40, s20, v10
    v_fma_f32 v40, v11, s21, v40
    v_mul_f32 v41, s20, v10
    v_fma_f32 v41, v11, s20, v41
    v_sub_f32 v10, 0, v35
    v_mov_b32 v11, v34
    v_mul_f32 v34, s21, v24
    v_fma_f32 v34, v25, s21, v34
    v_mul_f32 v35, s20, v24
    v_fma_f32 v35, v25, s21, v35
    v_mul_f32 v24, s18, v12
    v_fma_f32 v24, v13, s17, v24
    v_mul_f32 v25, s16, v12
    v_fma_f32 v25, v13, s18, v25
    v_mul_f32 v12, s21, v36
    v_fma_f32 v12, v37, s21, v12
    v_mul_f32 v13, s20, v36
    v_fma_f32 v13, v37, s21, v13
    v_mul_f32 v36, s17, v26
    v_fma_f32 v36, v27, s18, v36
    v_mul_f32 v37, s19, v26
    v_fma_f32 v37, v27, s17, v37
    v_add_f32 v26, v14, v18
    v_add_f32 v27, v15, v19
    v_sub_f32 v42, v14, v18
    v_sub_f32 v43, v15, v19
    v_add_f32 v14, v16, v20
    v_add_f32 v15, v17, v21
    v_sub_f32 v18, v16, v20
    v_sub_f32 v19, v17, v21
    v_add_f32 v16, v26, v14
    v_add_f32 v17, v27, v15
    v_sub_f32 v20, v26, v14
    v_sub_f32 v21, v27, v15
    v_sub_f32 v14, v42, v19
    v_add_f32 v15, v43, v18
    v_add_f32 v26, v42, v19
    v_sub_f32 v27, v43, v18
    v_add_f32 v18, v22, v40
    v_add_f32 v19, v23, v41
    v_sub_f32 v42, v22, v40
    v_sub_f32 v43, v23, v41
    v_add_f32 v22, v28, v24
    v_add_f32 v23, v29, v25
    v_sub_f32 v40, v28, v24
    v_sub_f32 v41, v29, v25
    v_add_f32 v24, v18, v22
    v_add_f32 v25, v19, v23
    v_sub_f32 v28, v18, v22
    v_sub_f32 v29, v19, v23
    v_sub_f32 v18, v42, v41
    v_add_f32 v19, v43, v40
    v_add_f32 v22, v42, v41
    v_sub_f32 v23, v43, v40
    v_add_f32 v40, v30, v10
    v_add_f32 v41, v31, v11
    v_sub_f32 v42, v30, v10
    v_sub_f32 v43, v31, v11
    v_add_f32 v10, v8, v12
    v_add_f32 v11, v9, v13
    v_sub_f32 v30, v8, v12
    v_sub_f32 v31, v9, v13
    v_add_f32 v8, v40, v10
    v_add_f32 v9, v41, v11
    v_sub_f32 v12, v40, v10
    v_sub_f32 v13, v41, v11
    v_sub_f32 v10, v42, v31
    v_add_f32 v11, v43, v30
    v_add_f32 v40, v42, v31
    v_sub_f32 v41, v43, v30
    v_add_f32 v30, v38, v34
    v_add_f32 v31, v39, v35
    v_sub_f32 v42, v38, v34
    v_sub_f32 v43, v39, v35
    v_add_f32 v34, v32, v36
    v_add_f32 v35, v33, v37
    v_sub_f32 v38, v32, v36
    v_sub_f32 v39, v33, v37
    v_add_f32 v32, v30, v34
    v_add_f32 v33, v31, v35
    v_sub_f32 v36, v30, v34
    v_sub_f32 v37, v31, v35
    v_sub_f32 v30, v42, v39
    v_add_f32 v31, v43, v38
    v_add_f32 v34, v42, v39
    v_sub_f32 v35, v43, v38
    v_mul_f32 v38, v24, v6
    v_fma_f32 v38, v25, v7, v38
    v_mul_f32 v39, v25, v6
    v_fma_f32 v39, -v24, v7, v39
    v_mul_f32 v24, v8, v72
    v_fma_f32 v24, v9, v73, v24
    v_mul_f32 v25, v9, v72
    v_fma_f32 v25, -v8, v73, v25
    v_mul_f32 v8, v32, v74
    v_fma_f32 v8, v33, v75, v8
    v_mul_f32 v9, v33, v74
    v_fma_f32 v9, -v32, v75, v9
    v_mul_f32 v32, v14, v76
    v_fma_f32 v32, v15, v77, v32
    v_mul_f32 v33, v15, v76
    v_fma_f32 v33, -v14, v77, v33
    v_mul_f32 v14, v18, v78
    v_fma_f32 v14, v19, v79, v14
    v_mul_f32 v15, v19, v78
    v_fma_f32 v15, -v18, v79, v15
    v_mul_f32 v18, v10, v80
    v_fma_f32 v18, v11, v81, v18
    v_mul_f32 v19, v11, v80
    v_fma_f32 v19, -v10, v81, v19
    v_mul_f32 v10, v30, v82
    v_fma_f32 v10, v31, v83, v10
    v_mul_f32 v11, v31, v82
    v_fma_f32 v11, -v30, v83, v11
    v_mul_f32 v30, v20, v84
    v_fma_f32 v30, v21, v85, v30
    v_mul_f32 v31, v21, v84
    v_fma_f32 v31, -v20, v85, v31
    v_mul_f32 v20, v28, v86
    v_fma_f32 v20, v29, v87, v20
    v_mul_f32 v21, v29, v86
    v_fma_f32 v21, -v28, v87, v21
    v_mul_f32 v28, v12, v88
    v_fma_f32 v28, v13, v89, v28
    v_mul_f32 v29, v13, v88
    v_fma_f32 v29, -v12, v89, v29
    v_mul_f32 v12, v36, v90
    v_fma_f32 v12, v37, v91, v12
    v_mul_f32 v13, v37, v90
    v_fma_f32 v13, -v36, v91, v13
    v_mul_f32 v36, v26, v92
    v_fma_f32 v36, v27, v93, v36
    v_mul_f32 v37, v27, v92
    v_fma_f32 v37, -v26, v93, v37
    v_mul_f32 v26, v22, v94
    v_fma_f32 v26, v23, v95, v26
    v_mul_f32 v27, v23, v94
    v_fma_f32 v27, -v22, v95, v27
    v_mul_f32 v22, v40, v96
    v_fma_f32 v22, v41, v97, v22
    v_mul_f32 v23, v41, v96
    v_fma_f32 v23, -v40, v97, v23
    v_mul_f32 v40, v34, v98
    v_fma_f32 v40, v35, v99, v40
    v_mul_f32 v41, v35, v98
    v_fma_f32 v41, -v34, v99, v41
    ds_write_b64 v133, v[16:17] offset:0
    ds_write_b64 v133, v[38:39] offset:544
    ds_write_b64 v133, v[24:25] offset:1088
    ds_write_b64 v133, v[8:9] offset:1632
    ds_write_b64 v133, v[32:33] offset:2176
    ds_write_b64 v133, v[14:15] offset:2720
    ds_write_b64 v133, v[18:19] offset:3264
    ds_write_b64 v133, v[10:11] offset:3808
    ds_write_b64 v133, v[30:31] offset:4352
    ds_write_b64 v133, v[20:21] offset:4896
    ds_write_b64 v133, v[28:29] offset:5440
    ds_write_b64 v133, v[12:13] offset:5984
    ds_write_b64 v133, v[36:37] offset:6528
    ds_write_b64 v133, v[26:27] offset:7072
    ds_write_b64 v133, v[22:23] offset:7616
    ds_write_b64 v133, v[40:41] offset:8160
    ds_read_b64 v[8:9], v134 offset:0
    ds_read_b64 v[10:11], v134 offset:32
    ds_read_b64 v[12:13], v134 offset:64
    ds_read_b64 v[14:15], v134 offset:96
    ds_read_b64 v[16:17], v134 offset:128
    ds_read_b64 v[18:19], v134 offset:160
    ds_read_b64 v[20:21], v134 offset:192
    ds_read_b64 v[22:23], v134 offset:224
    ds_read_b64 v[24:25], v134 offset:256
    ds_read_b64 v[26:27], v134 offset:288
    ds_read_b64 v[28:29], v134 offset:320
    ds_read_b64 v[30:31], v134 offset:352
    ds_read_b64 v[32:33], v134 offset:384
    ds_read_b64 v[34:35], v134 offset:416
    ds_read_b64 v[36:37], v134 offset:448
    ds_read_b64 v[38:39], v134 offset:480
    s_waitcnt lgkmcnt(0)
    v_add_f32 v40, v8, v24
    v_add_f32 v41, v9, v25
    v_sub_f32 v42, v8, v24
    v_sub_f32 v43, v9, v25
    v_add_f32 v8, v16, v32
    v_add_f32 v9, v17, v33
    v_sub_f32 v24, v16, v32
    v_sub_f32 v25, v17, v33
    v_add_f32 v16, v40, v8
    v_add_f32 v17, v41, v9
    v_sub_f32 v32, v40, v8
    v_sub_f32 v33, v41, v9
    v_sub_f32 v8, v42, v25
    v_add_f32 v9, v43, v24
    v_add_f32 v40, v42, v25
    v_sub_f32 v41, v43, v24
    v_add_f32 v24, v10, v26
    v_add_f32 v25, v11, v27
    v_sub_f32 v42, v10, v26
    v_sub_f32 v43, v11, v27
    v_add_f32 v10, v18, v34
    v_add_f32 v11, v19, v35
    v_sub_f32 v26, v18, v34
    v_sub_f32 v27, v19, v35
    v_add_f32 v18, v24, v10
    v_add_f32 v19, v25, v11
    v_sub_f32 v34, v24, v10
    v_sub_f32 v35, v25, v11
    v_sub_f32 v10, v42, v27
    v_add_f32 v11, v43, v26
    v_add_f32 v24, v42, v27
    v_sub_f32 v25, v43, v26
    v_add_f32 v26, v12, v28
    v_add_f32 v27, v13, v29
    v_sub_f32 v42, v12, v28
    v_sub_f32 v43, v13, v29
    v_add_f32 v12, v20, v36
    v_add_f32 v13, v21, v37
    v_sub_f32 v28, v20, v36
    v_sub_f32 v29, v21, v37
    v_add_f32 v20, v26, v12
    v_add_f32 v21, v27, v13
    v_sub_f32 v36, v26, v12
    v_sub_f32 v37, v27, v13
    v_sub_f32 v12, v42, v29
    v_add_f32 v13, v43, v28
    v_add_f32 v26, v42, v29
    v_sub_f32 v27, v43, v28
    v_add_f32 v28, v14, v30
    v_add_f32 v29, v15, v31
    v_sub_f32 v42, v14, v30
    v_sub_f32 v43, v15, v31
    v_add_f32 v14, v22, v38
    v_add_f32 v15, v23, v39
    v_sub_f32 v30, v22, v38
    v_sub_f32 v31, v23, v39
    v_add_f32 v22, v28, v14
    v_add_f32 v23, v29, v15
    v_sub_f32 v38, v28, v14
    v_sub_f32 v39, v29, v15
    v_sub_f32 v14, v42, v31
    v_add_f32 v15, v43, v30
    v_add_f32 v28, v42, v31
    v_sub_f32 v29, v43, v30
    v_mul_f32 v30, s16, v10
    v_fma_f32 v30, v11, s19, v30
    v_mul_f32 v31, s18, v10
    v_fma_f32 v31, v11, s16, v31
    v_mul_f32 v10, s20, v34
    v_fma_f32 v10, v35, s21, v10
    v_mul_f32 v11, s20, v34
    v_fma_f32 v11, v35, s20, v11
    v_mul_f32 v34, s18, v24
    v_fma_f32 v34, v25, s17, v34
    v_mul_f32 v35, s16, v24
    v_fma_f32 v35, v25, s18, v35
    v_mul_f32 v24, s20, v12
    v_fma_f32 v24, v13, s21, v24
    v_mul_f32 v25, s20, v12
    v_fma_f32 v25, v13, s20, v25
    v_sub_f32 v12, 0, v37
    v_mov_b32 v13, v36
    v_mul_f32 v36, s21, v26
    v_fma_f32 v36, v27, s21, v36
    v_mul_f32 v37, s20, v26
    v_fma_f32 v37, v27, s21, v37
    v_mul_f32 v26, s18, v14
    v_fma_f32 v26, v15, s17, v26
    v_mul_f32 v27, s16, v14
    v_fma_f32 v27, v15, s18, v27
    v_mul_f32 v14, s21, v38
    v_fma_f32 v14, v39, s21, v14
    v_mul_f32 v15, s20, v38
    v_fma_f32 v15, v39, s21, v15
    v_mul_f32 v38, s17, v28
    v_fma_f32 v38, v29, s18, v38
    v_mul_f32 v39, s19, v28
    v_fma_f32 v39, v29, s17, v39
    v_add_f32 v28, v16, v20
    v_add_f32 v29, v17, v21
    v_sub_f32 v42, v16, v20
    v_sub_f32 v43, v17, v21
    v_add_f32 v16, v18, v22
    v_add_f32 v17, v19, v23
    v_sub_f32 v20, v18, v22
    v_sub_f32 v21, v19, v23
    v_add_f32 v18, v28, v16
    v_add_f32 v19, v29, v17
    v_sub_f32 v22, v28, v16
    v_sub_f32 v23, v29, v17
    v_sub_f32 v16, v42, v21
    v_add_f32 v17, v43, v20
    v_add_f32 v28, v42, v21
    v_sub_f32 v29, v43, v20
    v_add_f32 v20, v8, v24
    v_add_f32 v21, v9, v25
    v_sub_f32 v42, v8, v24
    v_sub_f32 v43, v9, v25
    v_add_f32 v8, v30, v26
    v_add_f32 v9, v31, v27
    v_sub_f32 v24, v30, v26
    v_sub_f32 v25, v31, v27
    v_add_f32 v26, v20, v8
    v_add_f32 v27, v21, v9
    v_sub_f32 v30, v20, v8
    v_sub_f32 v31, v21, v9
    v_sub_f32 v8, v42, v25
    v_add_f32 v9, v43, v24
    v_add_f32 v20, v42, v25
    v_sub_f32 v21, v43, v24
    v_add_f32 v24, v32, v12
    v_add_f32 v25, v33, v13
    v_sub_f32 v42, v32, v12
    v_sub_f32 v43, v33, v13
    v_add_f32 v12, v10, v14
    v_add_f32 v13, v11, v15
    v_sub_f32 v32, v10, v14
    v_sub_f32 v33, v11, v15
    v_add_f32 v10, v24, v12
    v_add_f32 v11, v25, v13
    v_sub_f32 v14, v24, v12
    v_sub_f32 v15, v25, v13
    v_sub_f32 v12, v42, v33
    v_add_f32 v13, v43, v32
    v_add_f32 v24, v42, v33
    v_sub_f32 v25, v43, v32
    v_add_f32 v32, v40, v36
    v_add_f32 v33, v41, v37
    v_sub_f32 v42, v40, v36
    v_sub_f32 v43, v41, v37
    v_add_f32 v36, v34, v38
    v_add_f32 v37, v35, v39
    v_sub_f32 v40, v34, v38
    v_sub_f32 v41, v35, v39
    v_add_f32 v34, v32, v36
    v_add_f32 v35, v33, v37
    v_sub_f32 v38, v32, v36
    v_sub_f32 v39, v33, v37
    v_sub_f32 v32, v42, v41
    v_add_f32 v33, v43, v40
    v_add_f32 v36, v42, v41
    v_sub_f32 v37, v43, v40
    v_mul_f32 v40, v26, v100
    v_fma_f32 v40, v27, v101, v40
    v_mul_f32 v41, v27, v100
    v_fma_f32 v41, -v26, v101, v41
    v_mul_f32 v26, v10, v102
    v_fma_f32 v26, v11, v103, v26
    v_mul_f32 v27, v11, v102
    v_fma_f32 v27, -v10, v103, v27
    v_mul_f32 v10, v34, v104
    v_fma_f32 v10, v35, v105, v10
    v_mul_f32 v11, v35, v104
    v_fma_f32 v11, -v34, v105, v11
    v_mul_f32 v34, v16, v106
    v_fma_f32 v34, v17, v107, v34
    v_mul_f32 v35, v17, v106
    v_fma_f32 v35, -v16, v107, v35
    v_mul_f32 v16, v8, v108
    v_fma_f32 v16, v9, v109, v16
    v_mul_f32 v17, v9, v108
    v_fma_f32 v17, -v8, v109, v17
    v_mul_f32 v8, v12, v110
    v_fma_f32 v8, v13, v111, v8
    v_mul_f32 v9, v13, v110
    v_fma_f32 v9, -v12, v111, v9
    v_mul_f32 v12, v32, v112
    v_fma_f32 v12, v33, v113, v12
    v_mul_f32 v13, v33, v112
    v_fma_f32 v13, -v32, v113, v13
    v_mul_f32 v32, v22, v114
    v_fma_f32 v32, v23, v115, v32
    v_mul_f32 v33, v23, v114
    v_fma_f32 v33, -v22, v115, v33
    v_mul_f32 v22, v30, v116
    v_fma_f32 v22, v31, v117, v22
    v_mul_f32 v23, v31, v116
    v_fma_f32 v23, -v30, v117, v23
    v_mul_f32 v30, v14, v118
    v_fma_f32 v30, v15, v119, v30
    v_mul_f32 v31, v15, v118
    v_fma_f32 v31, -v14, v119, v31
    v_mul_f32 v14, v38, v120
    v_fma_f32 v14, v39, v121, v14
    v_mul_f32 v15, v39, v120
    v_fma_f32 v15, -v38, v121, v15
    v_mul_f32 v38, v28, v122
    v_fma_f32 v38, v29, v123, v38
    v_mul_f32 v39, v29, v122
    v_fma_f32 v39, -v28, v123, v39
    v_mul_f32 v28, v20, v124
    v_fma_f32 v28, v21, v125, v28
    v_mul_f32 v29, v21, v124
    v_fma_f32 v29, -v20, v125, v29
    v_mul_f32 v20, v24, v126
    v_fma_f32 v20, v25, v127, v20
    v_mul_f32 v21, v25, v126
    v_fma_f32 v21, -v24, v127, v21
    v_mul_f32 v24, v36, v128
    v_fma_f32 v24, v37, v129, v24
    v_mul_f32 v25, v37, v128
    v_fma_f32 v25, -v36, v129, v25
    ds_write_b64 v135, v[18:19] offset:0
    ds_write_b64 v135, v[40:41] offset:528
    ds_write_b64 v135, v[26:27] offset:1056
    ds_write_b64 v135, v[10:11] offset:1584
    ds_write_b64 v135, v[34:35] offset:2112
    ds_write_b64 v135, v[16:17] offset:2640
    ds_write_b64 v135, v[8:9] offset:3168
    ds_write_b64 v135, v[12:13] offset:3696
    ds_write_b64 v135, v[32:33] offset:4224
    ds_write_b64 v135, v[22:23] offset:4752
    ds_write_b64 v135, v[30:31] offset:5280
    ds_write_b64 v135, v[14:15] offset:5808
    ds_write_b64 v135, v[38:39] offset:6336
    ds_write_b64 v135, v[28:29] offset:6864
    ds_write_b64 v135, v[20:21] offset:7392
    ds_write_b64 v135, v[24:25] offset:7920
    ds_read_b64 v[8:9], v137 offset:0
    ds_read_b64 v[10:11], v137 offset:8
    ds_read_b64 v[12:13], v137 offset:16
    ds_read_b64 v[14:15], v137 offset:24
    ds_read_b64 v[16:17], v137 offset:32
    ds_read_b64 v[18:19], v137 offset:40
    ds_read_b64 v[20:21], v137 offset:48
    ds_read_b64 v[22:23], v137 offset:56
    ds_read_b64 v[24:25], v137 offset:64
    ds_read_b64 v[26:27], v137 offset:72
    ds_read_b64 v[28:29], v137 offset:80
    ds_read_b64 v[30:31], v137 offset:88
    ds_read_b64 v[32:33], v137 offset:96
    ds_read_b64 v[34:35], v137 offset:104
    ds_read_b64 v[36:37], v137 offset:112
    ds_read_b64 v[38:39], v137 offset:120
    s_waitcnt lgkmcnt(0)
    v_add_f32 v40, v8, v12
    v_add_f32 v41, v9, v13
    v_sub_f32 v42, v8, v12
    v_sub_f32 v43, v9, v13
    v_add_f32 v8, v10, v14
    v_add_f32 v9, v11, v15
    v_sub_f32 v12, v10, v14
    v_sub_f32 v13, v11, v15
    v_add_f32 v10, v40, v8
    v_add_f32 v11, v41, v9
    v_sub_f32 v14, v40, v8
    v_sub_f32 v15, v41, v9
    v_sub_f32 v8, v42, v13
    v_add_f32 v9, v43, v12
    v_add_f32 v40, v42, v13
    v_sub_f32 v41, v43, v12
    v_add_f32 v12, v16, v20
    v_add_f32 v13, v17, v21
    v_sub_f32 v42, v16, v20
    v_sub_f32 v43, v17, v21
    v_add_f32 v16, v18, v22
    v_add_f32 v17, v19, v23
    v_sub_f32 v20, v18, v22
    v_sub_f32 v21, v19, v23
    v_add_f32 v18, v12, v16
    v_add_f32 v19, v13, v17
    v_sub_f32 v22, v12, v16
    v_sub_f32 v23, v13, v17
    v_sub_f32 v12, v42, v21
    v_add_f32 v13, v43, v20
    v_add_f32 v16, v42, v21
    v_sub_f32 v17, v43, v20
    v_add_f32 v20, v24, v28
    v_add_f32 v21, v25, v29
    v_sub_f32 v42, v24, v28
    v_sub_f32 v43, v25, v29
    v_add_f32 v24, v26, v30
    v_add_f32 v25, v27, v31
    v_sub_f32 v28, v26, v30
    v_sub_f32 v29, v27, v31
    v_add_f32 v26, v20, v24
    v_add_f32 v27, v21, v25
    v_sub_f32 v30, v20, v24
    v_sub_f32 v31, v21, v25
    v_sub_f32 v20, v42, v29
    v_add_f32 v21, v43, v28
    v_add_f32 v24, v42, v29
    v_sub_f32 v25, v43, v28
    v_add_f32 v28, v32, v36
    v_add_f32 v29, v33, v37
    v_sub_f32 v42, v32, v36
    v_sub_f32 v43, v33, v37
    v_add_f32 v32, v34, v38
    v_add_f32 v33, v35, v39
    v_sub_f32 v36, v34, v38
    v_sub_f32 v37, v35, v39
    v_add_f32 v34, v28, v32
    v_add_f32 v35, v29, v33
    v_sub_f32 v38, v28, v32
    v_sub_f32 v39, v29, v33
    v_sub_f32 v28, v42, v37
    v_add_f32 v29, v43, v36
    v_add_f32 v32, v42, v37
    v_sub_f32 v33, v43, v36
    v_lshlrev_b32 v36, 3, v1
    s_lshl_b32 s24, s23, 12
    s_add_u32 s24, s24, 50331648
    v_mul_f32 v10, 0x35000000, v10
    v_mul_f32 v11, 0x35000000, v11
    v_mul_f32 v18, 0x35000000, v18
    v_mul_f32 v19, 0x35000000, v19
    v_mul_f32 v26, 0x35000000, v26
    v_mul_f32 v27, 0x35000000, v27
    v_mul_f32 v34, 0x35000000, v34
    v_mul_f32 v35, 0x35000000, v35
    v_cvt_pk_bf16_f32 v42, v10, v18
    v_cvt_pk_bf16_f32 v43, v26, v34
    v_cvt_pk_bf16_f32 v44, v11, v19
    v_cvt_pk_bf16_f32 v45, v27, v35
    buffer_store_dwordx2 v[42:43], v36, s[12:15], s24 offen offset:0
    buffer_store_dwordx2 v[44:45], v36, s[12:15], s24 offen offset:2048
    v_mul_f32 v8, 0x35000000, v8
    v_mul_f32 v9, 0x35000000, v9
    v_mul_f32 v12, 0x35000000, v12
    v_mul_f32 v13, 0x35000000, v13
    v_mul_f32 v20, 0x35000000, v20
    v_mul_f32 v21, 0x35000000, v21
    v_mul_f32 v28, 0x35000000, v28
    v_mul_f32 v29, 0x35000000, v29
    v_cvt_pk_bf16_f32 v46, v8, v12
    v_cvt_pk_bf16_f32 v47, v20, v28
    v_cvt_pk_bf16_f32 v48, v9, v13
    v_cvt_pk_bf16_f32 v49, v21, v29
    buffer_store_dwordx2 v[46:47], v36, s[12:15], s24 offen offset:512
    buffer_store_dwordx2 v[48:49], v36, s[12:15], s24 offen offset:2560
    v_mul_f32 v14, 0x35000000, v14
    v_mul_f32 v15, 0x35000000, v15
    v_mul_f32 v22, 0x35000000, v22
    v_mul_f32 v23, 0x35000000, v23
    v_mul_f32 v30, 0x35000000, v30
    v_mul_f32 v31, 0x35000000, v31
    v_mul_f32 v38, 0x35000000, v38
    v_mul_f32 v39, 0x35000000, v39
    v_cvt_pk_bf16_f32 v50, v14, v22
    v_cvt_pk_bf16_f32 v51, v30, v38
    v_cvt_pk_bf16_f32 v52, v15, v23
    v_cvt_pk_bf16_f32 v53, v31, v39
    buffer_store_dwordx2 v[50:51], v36, s[12:15], s24 offen offset:1024
    buffer_store_dwordx2 v[52:53], v36, s[12:15], s24 offen offset:3072
    v_mul_f32 v40, 0x35000000, v40
    v_mul_f32 v41, 0x35000000, v41
    v_mul_f32 v16, 0x35000000, v16
    v_mul_f32 v17, 0x35000000, v17
    v_mul_f32 v24, 0x35000000, v24
    v_mul_f32 v25, 0x35000000, v25
    v_mul_f32 v32, 0x35000000, v32
    v_mul_f32 v33, 0x35000000, v33
    v_cvt_pk_bf16_f32 v54, v40, v16
    v_cvt_pk_bf16_f32 v55, v24, v32
    v_cvt_pk_bf16_f32 v56, v41, v17
    v_cvt_pk_bf16_f32 v57, v25, v33
    buffer_store_dwordx2 v[54:55], v36, s[12:15], s24 offen offset:1536
    buffer_store_dwordx2 v[56:57], v36, s[12:15], s24 offen offset:3584
    s_waitcnt vmcnt(0)
K3_END:
    s_endpgm
.globl k2_gemm1_kernel
.p2align 8
.type k2_gemm1_kernel,@function
k2_gemm1_kernel:
    s_cmp_ge_u32 s2, 256
    s_cbranch_scc1 G1_END
    s_load_dwordx2 s[4:5], s[0:1], 72
    s_load_dwordx4 s[8:11], s[0:1], 32
    v_and_b32 v1, 63, v0
    v_lshrrev_b32 v2, 6, v0
    s_nop 0
    v_readfirstlane_b32 s20, v2
    s_lshr_b32 s21, s2, 5
    s_and_b32 s22, s2, 31
    s_lshr_b32 s23, s20, 2
    s_and_b32 s24, s20, 3
    s_waitcnt lgkmcnt(0)
    s_add_u32 s12, s4, 0
    s_addc_u32 s13, s5, 0
    s_mov_b32 s14, 4194304
    s_mov_b32 s15, 0x00020000
    s_cmp_eq_u32 s23, 0
    s_cselect_b32 s16, s8, s10
    s_cselect_b32 s17, s9, s11
    s_mov_b32 s18, 7340032
    s_mov_b32 s19, 0x00020000
    s_add_u32 s28, s4, 67108864
    s_addc_u32 s29, s5, 0
    s_mov_b32 s30, 14680064
    s_mov_b32 s31, 0x00020000
    s_lshl_b32 s25, s21, 8
    v_lshrrev_b32 v3, 3, v1
    v_and_b32 v5, 7, v1
    v_and_b32 v4, 7, v3
    v_xor_b32 v5, v5, v4
    v_lshl_add_u32 v3, v2, 5, v3
    v_add_u32 v3, s25, v3
    v_lshlrev_b32 v6, 11, v3
    v_lshl_add_u32 v6, v5, 4, v6
    v_add_u32 v7, 16384, v6
    v_add_u32 v8, 32768, v6
    v_add_u32 v9, 49152, v6
    v_mul_u32_u24 v3, 4682, v1
    v_lshrrev_b32 v3, 16, v3
    v_mul_u32_u24 v4, 14, v3
    v_sub_u32 v4, v1, v4
    s_lshl_b32 s26, s24, 4
    v_add_u32 v3, s26, v3
    s_mov_b32 s27, 7168
    v_mul_lo_u32 v10, v3, s27
    v_lshl_add_u32 v10, v4, 4, v10
    s_mul_i32 s27, s22, 224
    v_add_u32 v10, s27, v10
    v_add_u32 v11, 28672, v10
    v_add_u32 v12, 57344, v10
    v_add_u32 v13, 86016, v10
    v_and_b32 v3, 15, v1
    v_and_b32 v4, 7, v1
    v_lshrrev_b32 v5, 4, v1
    v_xor_b32 v5, v5, v4
    s_lshl_b32 s26, s24, 6
    v_add_u32 v3, s26, v3
    v_lshlrev_b32 v14, 7, v3
    v_lshl_add_u32 v14, v5, 4, v14
    v_xor_b32 v15, 64, v14
    v_lshrrev_b32 v3, 4, v1
    v_mul_u32_u24 v16, 2176, v3
    v_lshrrev_b32 v3, 2, v1
    v_and_b32 v3, 3, v3
    v_mul_u32_u24 v3, 224, v3
    v_add_u32 v16, v16, v3
    v_and_b32 v3, 3, v1
    v_lshl_add_u32 v16, v3, 3, v16
    s_mul_i32 s26, s23, 17408
    s_add_u32 s26, s26, 32768
    v_add_u32 v16, s26, v16
    v_add_u32 v17, 8704, v16
    s_lshl_b32 s32, s20, 12
    s_mul_i32 s33, s24, 4352
    s_add_u32 s33, s33, s26
    s_mov_b32 s34, 0
    s_mov_b32 s35, 0
    v_mov_b32 v20, 0
    v_mov_b32 v21, 0
    v_mov_b32 v22, 0
    v_mov_b32 v23, 0
    v_mov_b32 v24, 0
    v_mov_b32 v25, 0
    v_mov_b32 v26, 0
    v_mov_b32 v27, 0
    v_mov_b32 v28, 0
    v_mov_b32 v29, 0
    v_mov_b32 v30, 0
    v_mov_b32 v31, 0
    v_mov_b32 v32, 0
    v_mov_b32 v33, 0
    v_mov_b32 v34, 0
    v_mov_b32 v35, 0
    v_mov_b32 v36, 0
    v_mov_b32 v37, 0
    v_mov_b32 v38, 0
    v_mov_b32 v39, 0
    v_mov_b32 v40, 0
    v_mov_b32 v41, 0
    v_mov_b32 v42, 0
    v_mov_b32 v43, 0
    v_mov_b32 v44, 0
    v_mov_b32 v45, 0
    v_mov_b32 v46, 0
    v_mov_b32 v47, 0
    v_mov_b32 v48, 0
    v_mov_b32 v49, 0
    v_mov_b32 v50, 0
    v_mov_b32 v51, 0
    v_mov_b32 v52, 0
    v_mov_b32 v53, 0
    v_mov_b32 v54, 0
    v_mov_b32 v55, 0
    v_mov_b32 v56, 0
    v_mov_b32 v57, 0
    v_mov_b32 v58, 0
    v_mov_b32 v59, 0
    v_mov_b32 v60, 0
    v_mov_b32 v61, 0
    v_mov_b32 v62, 0
    v_mov_b32 v63, 0
    v_mov_b32 v64, 0
    v_mov_b32 v65, 0
    v_mov_b32 v66, 0
    v_mov_b32 v67, 0
    v_mov_b32 v68, 0
    v_mov_b32 v69, 0
    v_mov_b32 v70, 0
    v_mov_b32 v71, 0
    v_mov_b32 v72, 0
    v_mov_b32 v73, 0
    v_mov_b32 v74, 0
    v_mov_b32 v75, 0
    v_mov_b32 v76, 0
    v_mov_b32 v77, 0
    v_mov_b32 v78, 0
    v_mov_b32 v79, 0
    v_mov_b32 v80, 0
    v_mov_b32 v81, 0
    v_mov_b32 v82, 0
    v_mov_b32 v83, 0
    v_mov_b32 v84, 0
    v_mov_b32 v85, 0
    v_mov_b32 v86, 0
    v_mov_b32 v87, 0
    v_mov_b32 v88, 0
    v_mov_b32 v89, 0
    v_mov_b32 v90, 0
    v_mov_b32 v91, 0
    v_mov_b32 v92, 0
    v_mov_b32 v93, 0
    v_mov_b32 v94, 0
    v_mov_b32 v95, 0
    v_mov_b32 v96, 0
    v_mov_b32 v97, 0
    v_mov_b32 v98, 0
    v_mov_b32 v99, 0
    v_mov_b32 v100, 0
    v_mov_b32 v101, 0
    v_mov_b32 v102, 0
    v_mov_b32 v103, 0
    v_mov_b32 v104, 0
    v_mov_b32 v105, 0
    v_mov_b32 v106, 0
    v_mov_b32 v107, 0
    v_mov_b32 v108, 0
    v_mov_b32 v109, 0
    v_mov_b32 v110, 0
    v_mov_b32 v111, 0
    v_mov_b32 v112, 0
    v_mov_b32 v113, 0
    v_mov_b32 v114, 0
    v_mov_b32 v115, 0
    v_mov_b32 v116, 0
    v_mov_b32 v117, 0
    v_mov_b32 v118, 0
    v_mov_b32 v119, 0
    v_mov_b32 v120, 0
    v_mov_b32 v121, 0
    v_mov_b32 v122, 0
    v_mov_b32 v123, 0
    v_mov_b32 v124, 0
    v_mov_b32 v125, 0
    v_mov_b32 v126, 0
    v_mov_b32 v127, 0
    v_mov_b32 v128, 0
    v_mov_b32 v129, 0
    v_mov_b32 v130, 0
    v_mov_b32 v131, 0
    s_add_u32 m0, s32, 0
    s_nop 0
    buffer_load_dwordx4 v6, s[12:15], s34 offen lds
    s_add_u32 m0, s32, 1024
    s_nop 0
    buffer_load_dwordx4 v7, s[12:15], s34 offen lds
    s_add_u32 m0, s32, 2048
    s_nop 0
    buffer_load_dwordx4 v8, s[12:15], s34 offen lds
    s_add_u32 m0, s32, 3072
    s_nop 0
    buffer_load_dwordx4 v9, s[12:15], s34 offen lds
    s_add_u32 m0, s33, 0
    s_nop 0
    buffer_load_dwordx4 v10, s[16:19], s35 offen lds
    s_add_u32 m0, s33, 1088
    s_nop 0
    buffer_load_dwordx4 v11, s[16:19], s35 offen lds
    s_add_u32 m0, s33, 2176
    s_nop 0
    buffer_load_dwordx4 v12, s[16:19], s35 offen lds
    s_add_u32 m0, s33, 3264
    s_nop 0
    buffer_load_dwordx4 v13, s[16:19], s35 offen lds
    s_add_u32 s34, s34, 128
    s_add_u32 s35, s35, 458752
    s_waitcnt vmcnt(0)
    s_barrier
    s_mov_b32 s36, 0
G1_LOOP:
    s_add_u32 m0, s32, 67584
    s_nop 0
    buffer_load_dwordx4 v6, s[12:15], s34 offen lds
    s_add_u32 m0, s32, 68608
    s_nop 0
    buffer_load_dwordx4 v7, s[12:15], s34 offen lds
    s_add_u32 m0, s32, 69632
    s_nop 0
    buffer_load_dwordx4 v8, s[12:15], s34 offen lds
    s_add_u32 m0, s32, 70656
    s_nop 0
    buffer_load_dwordx4 v9, s[12:15], s34 offen lds
    s_add_u32 m0, s33, 67584
    s_nop 0
    buffer_load_dwordx4 v10, s[16:19], s35 offen lds
    s_add_u32 m0, s33, 68672
    s_nop 0
    buffer_load_dwordx4 v11, s[16:19], s35 offen lds
    s_add_u32 m0, s33, 69760
    s_nop 0
    buffer_load_dwordx4 v12, s[16:19], s35 offen lds
    s_add_u32 m0, s33, 70848
    s_nop 0
    buffer_load_dwordx4 v13, s[16:19], s35 offen lds
    s_add_u32 s34, s34, 128
    s_add_u32 s35, s35, 458752
    ds_read_b128 v[132:135], v14 offset:0
    ds_read_b128 v[136:139], v14 offset:2048
    ds_read_b128 v[140:143], v14 offset:4096
    ds_read_b128 v[144:147], v14 offset:6144
    ds_read_b64_tr_b16 v[164:165], v16 offset:0
    ds_read_b64_tr_b16 v[166:167], v16 offset:1088
    ds_read_b64_tr_b16 v[168:169], v16 offset:32
    ds_read_b64_tr_b16 v[170:171], v16 offset:1120
    ds_read_b64_tr_b16 v[172:173], v16 offset:64
    ds_read_b64_tr_b16 v[174:175], v16 offset:1152
    ds_read_b64_tr_b16 v[176:177], v16 offset:96
    ds_read_b64_tr_b16 v[178:179], v16 offset:1184
    ds_read_b64_tr_b16 v[180:181], v16 offset:128
    ds_read_b64_tr_b16 v[182:183], v16 offset:1216
    ds_read_b64_tr_b16 v[184:185], v16 offset:160
    ds_read_b64_tr_b16 v[186:187], v16 offset:1248
    ds_read_b64_tr_b16 v[188:189], v16 offset:192
    ds_read_b64_tr_b16 v[190:191], v16 offset:1280
    s_waitcnt lgkmcnt(0)
    v_mfma_f32_16x16x32_bf16 v[20:23], v[164:167], v[132:135], v[20:23]
    ds_read_b128 v[148:151], v15 offset:0
    v_mfma_f32_16x16x32_bf16 v[24:27], v[168:171], v[132:135], v[24:27]
    ds_read_b128 v[152:155], v15 offset:2048
    v_mfma_f32_16x16x32_bf16 v[28:31], v[172:175], v[132:135], v[28:31]
    ds_read_b128 v[156:159], v15 offset:4096
    v_mfma_f32_16x16x32_bf16 v[32:35], v[176:179], v[132:135], v[32:35]
    ds_read_b128 v[160:163], v15 offset:6144
    v_mfma_f32_16x16x32_bf16 v[36:39], v[180:183], v[132:135], v[36:39]
    ds_read_b64_tr_b16 v[192:193], v17 offset:0
    v_mfma_f32_16x16x32_bf16 v[40:43], v[184:187], v[132:135], v[40:43]
    ds_read_b64_tr_b16 v[194:195], v17 offset:1088
    v_mfma_f32_16x16x32_bf16 v[44:47], v[188:191], v[132:135], v[44:47]
    ds_read_b64_tr_b16 v[196:197], v17 offset:32
    v_mfma_f32_16x16x32_bf16 v[48:51], v[164:167], v[136:139], v[48:51]
    ds_read_b64_tr_b16 v[198:199], v17 offset:1120
    v_mfma_f32_16x16x32_bf16 v[52:55], v[168:171], v[136:139], v[52:55]
    ds_read_b64_tr_b16 v[200:201], v17 offset:64
    v_mfma_f32_16x16x32_bf16 v[56:59], v[172:175], v[136:139], v[56:59]
    ds_read_b64_tr_b16 v[202:203], v17 offset:1152
    v_mfma_f32_16x16x32_bf16 v[60:63], v[176:179], v[136:139], v[60:63]
    ds_read_b64_tr_b16 v[204:205], v17 offset:96
    v_mfma_f32_16x16x32_bf16 v[64:67], v[180:183], v[136:139], v[64:67]
    ds_read_b64_tr_b16 v[206:207], v17 offset:1184
    v_mfma_f32_16x16x32_bf16 v[68:71], v[184:187], v[136:139], v[68:71]
    ds_read_b64_tr_b16 v[208:209], v17 offset:128
    v_mfma_f32_16x16x32_bf16 v[72:75], v[188:191], v[136:139], v[72:75]
    ds_read_b64_tr_b16 v[210:211], v17 offset:1216
    v_mfma_f32_16x16x32_bf16 v[76:79], v[164:167], v[140:143], v[76:79]
    ds_read_b64_tr_b16 v[212:213], v17 offset:160
    v_mfma_f32_16x16x32_bf16 v[80:83], v[168:171], v[140:143], v[80:83]
    ds_read_b64_tr_b16 v[214:215], v17 offset:1248
    v_mfma_f32_16x16x32_bf16 v[84:87], v[172:175], v[140:143], v[84:87]
    ds_read_b64_tr_b16 v[216:217], v17 offset:192
    v_mfma_f32_16x16x32_bf16 v[88:91], v[176:179], v[140:143], v[88:91]
    ds_read_b64_tr_b16 v[218:219], v17 offset:1280
    v_mfma_f32_16x16x32_bf16 v[92:95], v[180:183], v[140:143], v[92:95]
    v_mfma_f32_16x16x32_bf16 v[96:99], v[184:187], v[140:143], v[96:99]
    v_mfma_f32_16x16x32_bf16 v[100:103], v[188:191], v[140:143], v[100:103]
    v_mfma_f32_16x16x32_bf16 v[104:107], v[164:167], v[144:147], v[104:107]
    v_mfma_f32_16x16x32_bf16 v[108:111], v[168:171], v[144:147], v[108:111]
    v_mfma_f32_16x16x32_bf16 v[112:115], v[172:175], v[144:147], v[112:115]
    v_mfma_f32_16x16x32_bf16 v[116:119], v[176:179], v[144:147], v[116:119]
    v_mfma_f32_16x16x32_bf16 v[120:123], v[180:183], v[144:147], v[120:123]
    v_mfma_f32_16x16x32_bf16 v[124:127], v[184:187], v[144:147], v[124:127]
    v_mfma_f32_16x16x32_bf16 v[128:131], v[188:191], v[144:147], v[128:131]
    s_waitcnt lgkmcnt(0)
    v_mfma_f32_16x16x32_bf16 v[20:23], v[192:195], v[148:151], v[20:23]
    v_mfma_f32_16x16x32_bf16 v[24:27], v[196:199], v[148:151], v[24:27]
    v_mfma_f32_16x16x32_bf16 v[28:31], v[200:203], v[148:151], v[28:31]
    v_mfma_f32_16x16x32_bf16 v[32:35], v[204:207], v[148:151], v[32:35]
    v_mfma_f32_16x16x32_bf16 v[36:39], v[208:211], v[148:151], v[36:39]
    v_mfma_f32_16x16x32_bf16 v[40:43], v[212:215], v[148:151], v[40:43]
    v_mfma_f32_16x16x32_bf16 v[44:47], v[216:219], v[148:151], v[44:47]
    v_mfma_f32_16x16x32_bf16 v[48:51], v[192:195], v[152:155], v[48:51]
    v_mfma_f32_16x16x32_bf16 v[52:55], v[196:199], v[152:155], v[52:55]
    v_mfma_f32_16x16x32_bf16 v[56:59], v[200:203], v[152:155], v[56:59]
    v_mfma_f32_16x16x32_bf16 v[60:63], v[204:207], v[152:155], v[60:63]
    v_mfma_f32_16x16x32_bf16 v[64:67], v[208:211], v[152:155], v[64:67]
    v_mfma_f32_16x16x32_bf16 v[68:71], v[212:215], v[152:155], v[68:71]
    v_mfma_f32_16x16x32_bf16 v[72:75], v[216:219], v[152:155], v[72:75]
    v_mfma_f32_16x16x32_bf16 v[76:79], v[192:195], v[156:159], v[76:79]
    v_mfma_f32_16x16x32_bf16 v[80:83], v[196:199], v[156:159], v[80:83]
    v_mfma_f32_16x16x32_bf16 v[84:87], v[200:203], v[156:159], v[84:87]
    v_mfma_f32_16x16x32_bf16 v[88:91], v[204:207], v[156:159], v[88:91]
    v_mfma_f32_16x16x32_bf16 v[92:95], v[208:211], v[156:159], v[92:95]
    v_mfma_f32_16x16x32_bf16 v[96:99], v[212:215], v[156:159], v[96:99]
    v_mfma_f32_16x16x32_bf16 v[100:103], v[216:219], v[156:159], v[100:103]
    v_mfma_f32_16x16x32_bf16 v[104:107], v[192:195], v[160:163], v[104:107]
    v_mfma_f32_16x16x32_bf16 v[108:111], v[196:199], v[160:163], v[108:111]
    v_mfma_f32_16x16x32_bf16 v[112:115], v[200:203], v[160:163], v[112:115]
    v_mfma_f32_16x16x32_bf16 v[116:119], v[204:207], v[160:163], v[116:119]
    v_mfma_f32_16x16x32_bf16 v[120:123], v[208:211], v[160:163], v[120:123]
    v_mfma_f32_16x16x32_bf16 v[124:127], v[212:215], v[160:163], v[124:127]
    v_mfma_f32_16x16x32_bf16 v[128:131], v[216:219], v[160:163], v[128:131]
    s_waitcnt vmcnt(0)
    s_barrier
    v_add_u32 v14, 67584, v14
    v_add_u32 v15, 67584, v15
    v_add_u32 v16, 67584, v16
    v_add_u32 v17, 67584, v17
    s_add_u32 m0, s32, 0
    s_nop 0
    buffer_load_dwordx4 v6, s[12:15], s34 offen lds
    s_add_u32 m0, s32, 1024
    s_nop 0
    buffer_load_dwordx4 v7, s[12:15], s34 offen lds
    s_add_u32 m0, s32, 2048
    s_nop 0
    buffer_load_dwordx4 v8, s[12:15], s34 offen lds
    s_add_u32 m0, s32, 3072
    s_nop 0
    buffer_load_dwordx4 v9, s[12:15], s34 offen lds
    s_add_u32 m0, s33, 0
    s_nop 0
    buffer_load_dwordx4 v10, s[16:19], s35 offen lds
    s_add_u32 m0, s33, 1088
    s_nop 0
    buffer_load_dwordx4 v11, s[16:19], s35 offen lds
    s_add_u32 m0, s33, 2176
    s_nop 0
    buffer_load_dwordx4 v12, s[16:19], s35 offen lds
    s_add_u32 m0, s33, 3264
    s_nop 0
    buffer_load_dwordx4 v13, s[16:19], s35 offen lds
    s_add_u32 s34, s34, 128
    s_add_u32 s35, s35, 458752
    ds_read_b128 v[132:135], v14 offset:0
    ds_read_b128 v[136:139], v14 offset:2048
    ds_read_b128 v[140:143], v14 offset:4096
    ds_read_b128 v[144:147], v14 offset:6144
    ds_read_b64_tr_b16 v[164:165], v16 offset:0
    ds_read_b64_tr_b16 v[166:167], v16 offset:1088
    ds_read_b64_tr_b16 v[168:169], v16 offset:32
    ds_read_b64_tr_b16 v[170:171], v16 offset:1120
    ds_read_b64_tr_b16 v[172:173], v16 offset:64
    ds_read_b64_tr_b16 v[174:175], v16 offset:1152
    ds_read_b64_tr_b16 v[176:177], v16 offset:96
    ds_read_b64_tr_b16 v[178:179], v16 offset:1184
    ds_read_b64_tr_b16 v[180:181], v16 offset:128
    ds_read_b64_tr_b16 v[182:183], v16 offset:1216
    ds_read_b64_tr_b16 v[184:185], v16 offset:160
    ds_read_b64_tr_b16 v[186:187], v16 offset:1248
    ds_read_b64_tr_b16 v[188:189], v16 offset:192
    ds_read_b64_tr_b16 v[190:191], v16 offset:1280
    s_waitcnt lgkmcnt(0)
    v_mfma_f32_16x16x32_bf16 v[20:23], v[164:167], v[132:135], v[20:23]
    ds_read_b128 v[148:151], v15 offset:0
    v_mfma_f32_16x16x32_bf16 v[24:27], v[168:171], v[132:135], v[24:27]
    ds_read_b128 v[152:155], v15 offset:2048
    v_mfma_f32_16x16x32_bf16 v[28:31], v[172:175], v[132:135], v[28:31]
    ds_read_b128 v[156:159], v15 offset:4096
    v_mfma_f32_16x16x32_bf16 v[32:35], v[176:179], v[132:135], v[32:35]
    ds_read_b128 v[160:163], v15 offset:6144
    v_mfma_f32_16x16x32_bf16 v[36:39], v[180:183], v[132:135], v[36:39]
    ds_read_b64_tr_b16 v[192:193], v17 offset:0
    v_mfma_f32_16x16x32_bf16 v[40:43], v[184:187], v[132:135], v[40:43]
    ds_read_b64_tr_b16 v[194:195], v17 offset:1088
    v_mfma_f32_16x16x32_bf16 v[44:47], v[188:191], v[132:135], v[44:47]
    ds_read_b64_tr_b16 v[196:197], v17 offset:32
    v_mfma_f32_16x16x32_bf16 v[48:51], v[164:167], v[136:139], v[48:51]
    ds_read_b64_tr_b16 v[198:199], v17 offset:1120
    v_mfma_f32_16x16x32_bf16 v[52:55], v[168:171], v[136:139], v[52:55]
    ds_read_b64_tr_b16 v[200:201], v17 offset:64
    v_mfma_f32_16x16x32_bf16 v[56:59], v[172:175], v[136:139], v[56:59]
    ds_read_b64_tr_b16 v[202:203], v17 offset:1152
    v_mfma_f32_16x16x32_bf16 v[60:63], v[176:179], v[136:139], v[60:63]
    ds_read_b64_tr_b16 v[204:205], v17 offset:96
    v_mfma_f32_16x16x32_bf16 v[64:67], v[180:183], v[136:139], v[64:67]
    ds_read_b64_tr_b16 v[206:207], v17 offset:1184
    v_mfma_f32_16x16x32_bf16 v[68:71], v[184:187], v[136:139], v[68:71]
    ds_read_b64_tr_b16 v[208:209], v17 offset:128
    v_mfma_f32_16x16x32_bf16 v[72:75], v[188:191], v[136:139], v[72:75]
    ds_read_b64_tr_b16 v[210:211], v17 offset:1216
    v_mfma_f32_16x16x32_bf16 v[76:79], v[164:167], v[140:143], v[76:79]
    ds_read_b64_tr_b16 v[212:213], v17 offset:160
    v_mfma_f32_16x16x32_bf16 v[80:83], v[168:171], v[140:143], v[80:83]
    ds_read_b64_tr_b16 v[214:215], v17 offset:1248
    v_mfma_f32_16x16x32_bf16 v[84:87], v[172:175], v[140:143], v[84:87]
    ds_read_b64_tr_b16 v[216:217], v17 offset:192
    v_mfma_f32_16x16x32_bf16 v[88:91], v[176:179], v[140:143], v[88:91]
    ds_read_b64_tr_b16 v[218:219], v17 offset:1280
    v_mfma_f32_16x16x32_bf16 v[92:95], v[180:183], v[140:143], v[92:95]
    v_mfma_f32_16x16x32_bf16 v[96:99], v[184:187], v[140:143], v[96:99]
    v_mfma_f32_16x16x32_bf16 v[100:103], v[188:191], v[140:143], v[100:103]
    v_mfma_f32_16x16x32_bf16 v[104:107], v[164:167], v[144:147], v[104:107]
    v_mfma_f32_16x16x32_bf16 v[108:111], v[168:171], v[144:147], v[108:111]
    v_mfma_f32_16x16x32_bf16 v[112:115], v[172:175], v[144:147], v[112:115]
    v_mfma_f32_16x16x32_bf16 v[116:119], v[176:179], v[144:147], v[116:119]
    v_mfma_f32_16x16x32_bf16 v[120:123], v[180:183], v[144:147], v[120:123]
    v_mfma_f32_16x16x32_bf16 v[124:127], v[184:187], v[144:147], v[124:127]
    v_mfma_f32_16x16x32_bf16 v[128:131], v[188:191], v[144:147], v[128:131]
    s_waitcnt lgkmcnt(0)
    v_mfma_f32_16x16x32_bf16 v[20:23], v[192:195], v[148:151], v[20:23]
    v_mfma_f32_16x16x32_bf16 v[24:27], v[196:199], v[148:151], v[24:27]
    v_mfma_f32_16x16x32_bf16 v[28:31], v[200:203], v[148:151], v[28:31]
    v_mfma_f32_16x16x32_bf16 v[32:35], v[204:207], v[148:151], v[32:35]
    v_mfma_f32_16x16x32_bf16 v[36:39], v[208:211], v[148:151], v[36:39]
    v_mfma_f32_16x16x32_bf16 v[40:43], v[212:215], v[148:151], v[40:43]
    v_mfma_f32_16x16x32_bf16 v[44:47], v[216:219], v[148:151], v[44:47]
    v_mfma_f32_16x16x32_bf16 v[48:51], v[192:195], v[152:155], v[48:51]
    v_mfma_f32_16x16x32_bf16 v[52:55], v[196:199], v[152:155], v[52:55]
    v_mfma_f32_16x16x32_bf16 v[56:59], v[200:203], v[152:155], v[56:59]
    v_mfma_f32_16x16x32_bf16 v[60:63], v[204:207], v[152:155], v[60:63]
    v_mfma_f32_16x16x32_bf16 v[64:67], v[208:211], v[152:155], v[64:67]
    v_mfma_f32_16x16x32_bf16 v[68:71], v[212:215], v[152:155], v[68:71]
    v_mfma_f32_16x16x32_bf16 v[72:75], v[216:219], v[152:155], v[72:75]
    v_mfma_f32_16x16x32_bf16 v[76:79], v[192:195], v[156:159], v[76:79]
    v_mfma_f32_16x16x32_bf16 v[80:83], v[196:199], v[156:159], v[80:83]
    v_mfma_f32_16x16x32_bf16 v[84:87], v[200:203], v[156:159], v[84:87]
    v_mfma_f32_16x16x32_bf16 v[88:91], v[204:207], v[156:159], v[88:91]
    v_mfma_f32_16x16x32_bf16 v[92:95], v[208:211], v[156:159], v[92:95]
    v_mfma_f32_16x16x32_bf16 v[96:99], v[212:215], v[156:159], v[96:99]
    v_mfma_f32_16x16x32_bf16 v[100:103], v[216:219], v[156:159], v[100:103]
    v_mfma_f32_16x16x32_bf16 v[104:107], v[192:195], v[160:163], v[104:107]
    v_mfma_f32_16x16x32_bf16 v[108:111], v[196:199], v[160:163], v[108:111]
    v_mfma_f32_16x16x32_bf16 v[112:115], v[200:203], v[160:163], v[112:115]
    v_mfma_f32_16x16x32_bf16 v[116:119], v[204:207], v[160:163], v[116:119]
    v_mfma_f32_16x16x32_bf16 v[120:123], v[208:211], v[160:163], v[120:123]
    v_mfma_f32_16x16x32_bf16 v[124:127], v[212:215], v[160:163], v[124:127]
    v_mfma_f32_16x16x32_bf16 v[128:131], v[216:219], v[160:163], v[128:131]
    s_waitcnt vmcnt(0)
    s_barrier
    v_add_u32 v14, 4294899712, v14
    v_add_u32 v15, 4294899712, v15
    v_add_u32 v16, 4294899712, v16
    v_add_u32 v17, 4294899712, v17
    s_add_u32 s36, s36, 1
    s_cmp_lt_u32 s36, 7
    s_cbranch_scc1 G1_LOOP
    s_add_u32 m0, s32, 67584
    s_nop 0
    buffer_load_dwordx4 v6, s[12:15], s34 offen lds
    s_add_u32 m0, s32, 68608
    s_nop 0
    buffer_load_dwordx4 v7, s[12:15], s34 offen lds
    s_add_u32 m0, s32, 69632
    s_nop 0
    buffer_load_dwordx4 v8, s[12:15], s34 offen lds
    s_add_u32 m0, s32, 70656
    s_nop 0
    buffer_load_dwordx4 v9, s[12:15], s34 offen lds
    s_add_u32 m0, s33, 67584
    s_nop 0
    buffer_load_dwordx4 v10, s[16:19], s35 offen lds
    s_add_u32 m0, s33, 68672
    s_nop 0
    buffer_load_dwordx4 v11, s[16:19], s35 offen lds
    s_add_u32 m0, s33, 69760
    s_nop 0
    buffer_load_dwordx4 v12, s[16:19], s35 offen lds
    s_add_u32 m0, s33, 70848
    s_nop 0
    buffer_load_dwordx4 v13, s[16:19], s35 offen lds
    s_add_u32 s34, s34, 128
    s_add_u32 s35, s35, 458752
    ds_read_b128 v[132:135], v14 offset:0
    ds_read_b128 v[136:139], v14 offset:2048
    ds_read_b128 v[140:143], v14 offset:4096
    ds_read_b128 v[144:147], v14 offset:6144
    ds_read_b64_tr_b16 v[164:165], v16 offset:0
    ds_read_b64_tr_b16 v[166:167], v16 offset:1088
    ds_read_b64_tr_b16 v[168:169], v16 offset:32
    ds_read_b64_tr_b16 v[170:171], v16 offset:1120
    ds_read_b64_tr_b16 v[172:173], v16 offset:64
    ds_read_b64_tr_b16 v[174:175], v16 offset:1152
    ds_read_b64_tr_b16 v[176:177], v16 offset:96
    ds_read_b64_tr_b16 v[178:179], v16 offset:1184
    ds_read_b64_tr_b16 v[180:181], v16 offset:128
    ds_read_b64_tr_b16 v[182:183], v16 offset:1216
    ds_read_b64_tr_b16 v[184:185], v16 offset:160
    ds_read_b64_tr_b16 v[186:187], v16 offset:1248
    ds_read_b64_tr_b16 v[188:189], v16 offset:192
    ds_read_b64_tr_b16 v[190:191], v16 offset:1280
    s_waitcnt lgkmcnt(0)
    v_mfma_f32_16x16x32_bf16 v[20:23], v[164:167], v[132:135], v[20:23]
    ds_read_b128 v[148:151], v15 offset:0
    v_mfma_f32_16x16x32_bf16 v[24:27], v[168:171], v[132:135], v[24:27]
    ds_read_b128 v[152:155], v15 offset:2048
    v_mfma_f32_16x16x32_bf16 v[28:31], v[172:175], v[132:135], v[28:31]
    ds_read_b128 v[156:159], v15 offset:4096
    v_mfma_f32_16x16x32_bf16 v[32:35], v[176:179], v[132:135], v[32:35]
    ds_read_b128 v[160:163], v15 offset:6144
    v_mfma_f32_16x16x32_bf16 v[36:39], v[180:183], v[132:135], v[36:39]
    ds_read_b64_tr_b16 v[192:193], v17 offset:0
    v_mfma_f32_16x16x32_bf16 v[40:43], v[184:187], v[132:135], v[40:43]
    ds_read_b64_tr_b16 v[194:195], v17 offset:1088
    v_mfma_f32_16x16x32_bf16 v[44:47], v[188:191], v[132:135], v[44:47]
    ds_read_b64_tr_b16 v[196:197], v17 offset:32
    v_mfma_f32_16x16x32_bf16 v[48:51], v[164:167], v[136:139], v[48:51]
    ds_read_b64_tr_b16 v[198:199], v17 offset:1120
    v_mfma_f32_16x16x32_bf16 v[52:55], v[168:171], v[136:139], v[52:55]
    ds_read_b64_tr_b16 v[200:201], v17 offset:64
    v_mfma_f32_16x16x32_bf16 v[56:59], v[172:175], v[136:139], v[56:59]
    ds_read_b64_tr_b16 v[202:203], v17 offset:1152
    v_mfma_f32_16x16x32_bf16 v[60:63], v[176:179], v[136:139], v[60:63]
    ds_read_b64_tr_b16 v[204:205], v17 offset:96
    v_mfma_f32_16x16x32_bf16 v[64:67], v[180:183], v[136:139], v[64:67]
    ds_read_b64_tr_b16 v[206:207], v17 offset:1184
    v_mfma_f32_16x16x32_bf16 v[68:71], v[184:187], v[136:139], v[68:71]
    ds_read_b64_tr_b16 v[208:209], v17 offset:128
    v_mfma_f32_16x16x32_bf16 v[72:75], v[188:191], v[136:139], v[72:75]
    ds_read_b64_tr_b16 v[210:211], v17 offset:1216
    v_mfma_f32_16x16x32_bf16 v[76:79], v[164:167], v[140:143], v[76:79]
    ds_read_b64_tr_b16 v[212:213], v17 offset:160
    v_mfma_f32_16x16x32_bf16 v[80:83], v[168:171], v[140:143], v[80:83]
    ds_read_b64_tr_b16 v[214:215], v17 offset:1248
    v_mfma_f32_16x16x32_bf16 v[84:87], v[172:175], v[140:143], v[84:87]
    ds_read_b64_tr_b16 v[216:217], v17 offset:192
    v_mfma_f32_16x16x32_bf16 v[88:91], v[176:179], v[140:143], v[88:91]
    ds_read_b64_tr_b16 v[218:219], v17 offset:1280
    v_mfma_f32_16x16x32_bf16 v[92:95], v[180:183], v[140:143], v[92:95]
    v_mfma_f32_16x16x32_bf16 v[96:99], v[184:187], v[140:143], v[96:99]
    v_mfma_f32_16x16x32_bf16 v[100:103], v[188:191], v[140:143], v[100:103]
    v_mfma_f32_16x16x32_bf16 v[104:107], v[164:167], v[144:147], v[104:107]
    v_mfma_f32_16x16x32_bf16 v[108:111], v[168:171], v[144:147], v[108:111]
    v_mfma_f32_16x16x32_bf16 v[112:115], v[172:175], v[144:147], v[112:115]
    v_mfma_f32_16x16x32_bf16 v[116:119], v[176:179], v[144:147], v[116:119]
    v_mfma_f32_16x16x32_bf16 v[120:123], v[180:183], v[144:147], v[120:123]
    v_mfma_f32_16x16x32_bf16 v[124:127], v[184:187], v[144:147], v[124:127]
    v_mfma_f32_16x16x32_bf16 v[128:131], v[188:191], v[144:147], v[128:131]
    s_waitcnt lgkmcnt(0)
    v_mfma_f32_16x16x32_bf16 v[20:23], v[192:195], v[148:151], v[20:23]
    v_mfma_f32_16x16x32_bf16 v[24:27], v[196:199], v[148:151], v[24:27]
    v_mfma_f32_16x16x32_bf16 v[28:31], v[200:203], v[148:151], v[28:31]
    v_mfma_f32_16x16x32_bf16 v[32:35], v[204:207], v[148:151], v[32:35]
    v_mfma_f32_16x16x32_bf16 v[36:39], v[208:211], v[148:151], v[36:39]
    v_mfma_f32_16x16x32_bf16 v[40:43], v[212:215], v[148:151], v[40:43]
    v_mfma_f32_16x16x32_bf16 v[44:47], v[216:219], v[148:151], v[44:47]
    v_mfma_f32_16x16x32_bf16 v[48:51], v[192:195], v[152:155], v[48:51]
    v_mfma_f32_16x16x32_bf16 v[52:55], v[196:199], v[152:155], v[52:55]
    v_mfma_f32_16x16x32_bf16 v[56:59], v[200:203], v[152:155], v[56:59]
    v_mfma_f32_16x16x32_bf16 v[60:63], v[204:207], v[152:155], v[60:63]
    v_mfma_f32_16x16x32_bf16 v[64:67], v[208:211], v[152:155], v[64:67]
    v_mfma_f32_16x16x32_bf16 v[68:71], v[212:215], v[152:155], v[68:71]
    v_mfma_f32_16x16x32_bf16 v[72:75], v[216:219], v[152:155], v[72:75]
    v_mfma_f32_16x16x32_bf16 v[76:79], v[192:195], v[156:159], v[76:79]
    v_mfma_f32_16x16x32_bf16 v[80:83], v[196:199], v[156:159], v[80:83]
    v_mfma_f32_16x16x32_bf16 v[84:87], v[200:203], v[156:159], v[84:87]
    v_mfma_f32_16x16x32_bf16 v[88:91], v[204:207], v[156:159], v[88:91]
    v_mfma_f32_16x16x32_bf16 v[92:95], v[208:211], v[156:159], v[92:95]
    v_mfma_f32_16x16x32_bf16 v[96:99], v[212:215], v[156:159], v[96:99]
    v_mfma_f32_16x16x32_bf16 v[100:103], v[216:219], v[156:159], v[100:103]
    v_mfma_f32_16x16x32_bf16 v[104:107], v[192:195], v[160:163], v[104:107]
    v_mfma_f32_16x16x32_bf16 v[108:111], v[196:199], v[160:163], v[108:111]
    v_mfma_f32_16x16x32_bf16 v[112:115], v[200:203], v[160:163], v[112:115]
    v_mfma_f32_16x16x32_bf16 v[116:119], v[204:207], v[160:163], v[116:119]
    v_mfma_f32_16x16x32_bf16 v[120:123], v[208:211], v[160:163], v[120:123]
    v_mfma_f32_16x16x32_bf16 v[124:127], v[212:215], v[160:163], v[124:127]
    v_mfma_f32_16x16x32_bf16 v[128:131], v[216:219], v[160:163], v[128:131]
    s_waitcnt vmcnt(0)
    s_barrier
    v_add_u32 v14, 67584, v14
    v_add_u32 v15, 67584, v15
    v_add_u32 v16, 67584, v16
    v_add_u32 v17, 67584, v17
    ds_read_b128 v[132:135], v14 offset:0
    ds_read_b128 v[136:139], v14 offset:2048
    ds_read_b128 v[140:143], v14 offset:4096
    ds_read_b128 v[144:147], v14 offset:6144
    ds_read_b64_tr_b16 v[164:165], v16 offset:0
    ds_read_b64_tr_b16 v[166:167], v16 offset:1088
    ds_read_b64_tr_b16 v[168:169], v16 offset:32
    ds_read_b64_tr_b16 v[170:171], v16 offset:1120
    ds_read_b64_tr_b16 v[172:173], v16 offset:64
    ds_read_b64_tr_b16 v[174:175], v16 offset:1152
    ds_read_b64_tr_b16 v[176:177], v16 offset:96
    ds_read_b64_tr_b16 v[178:179], v16 offset:1184
    ds_read_b64_tr_b16 v[180:181], v16 offset:128
    ds_read_b64_tr_b16 v[182:183], v16 offset:1216
    ds_read_b64_tr_b16 v[184:185], v16 offset:160
    ds_read_b64_tr_b16 v[186:187], v16 offset:1248
    ds_read_b64_tr_b16 v[188:189], v16 offset:192
    ds_read_b64_tr_b16 v[190:191], v16 offset:1280
    s_waitcnt lgkmcnt(0)
    v_mfma_f32_16x16x32_bf16 v[20:23], v[164:167], v[132:135], v[20:23]
    ds_read_b128 v[148:151], v15 offset:0
    v_mfma_f32_16x16x32_bf16 v[24:27], v[168:171], v[132:135], v[24:27]
    ds_read_b128 v[152:155], v15 offset:2048
    v_mfma_f32_16x16x32_bf16 v[28:31], v[172:175], v[132:135], v[28:31]
    ds_read_b128 v[156:159], v15 offset:4096
    v_mfma_f32_16x16x32_bf16 v[32:35], v[176:179], v[132:135], v[32:35]
    ds_read_b128 v[160:163], v15 offset:6144
    v_mfma_f32_16x16x32_bf16 v[36:39], v[180:183], v[132:135], v[36:39]
    ds_read_b64_tr_b16 v[192:193], v17 offset:0
    v_mfma_f32_16x16x32_bf16 v[40:43], v[184:187], v[132:135], v[40:43]
    ds_read_b64_tr_b16 v[194:195], v17 offset:1088
    v_mfma_f32_16x16x32_bf16 v[44:47], v[188:191], v[132:135], v[44:47]
    ds_read_b64_tr_b16 v[196:197], v17 offset:32
    v_mfma_f32_16x16x32_bf16 v[48:51], v[164:167], v[136:139], v[48:51]
    ds_read_b64_tr_b16 v[198:199], v17 offset:1120
    v_mfma_f32_16x16x32_bf16 v[52:55], v[168:171], v[136:139], v[52:55]
    ds_read_b64_tr_b16 v[200:201], v17 offset:64
    v_mfma_f32_16x16x32_bf16 v[56:59], v[172:175], v[136:139], v[56:59]
    ds_read_b64_tr_b16 v[202:203], v17 offset:1152
    v_mfma_f32_16x16x32_bf16 v[60:63], v[176:179], v[136:139], v[60:63]
    ds_read_b64_tr_b16 v[204:205], v17 offset:96
    v_mfma_f32_16x16x32_bf16 v[64:67], v[180:183], v[136:139], v[64:67]
    ds_read_b64_tr_b16 v[206:207], v17 offset:1184
    v_mfma_f32_16x16x32_bf16 v[68:71], v[184:187], v[136:139], v[68:71]
    ds_read_b64_tr_b16 v[208:209], v17 offset:128
    v_mfma_f32_16x16x32_bf16 v[72:75], v[188:191], v[136:139], v[72:75]
    ds_read_b64_tr_b16 v[210:211], v17 offset:1216
    v_mfma_f32_16x16x32_bf16 v[76:79], v[164:167], v[140:143], v[76:79]
    ds_read_b64_tr_b16 v[212:213], v17 offset:160
    v_mfma_f32_16x16x32_bf16 v[80:83], v[168:171], v[140:143], v[80:83]
    ds_read_b64_tr_b16 v[214:215], v17 offset:1248
    v_mfma_f32_16x16x32_bf16 v[84:87], v[172:175], v[140:143], v[84:87]
    ds_read_b64_tr_b16 v[216:217], v17 offset:192
    v_mfma_f32_16x16x32_bf16 v[88:91], v[176:179], v[140:143], v[88:91]
    ds_read_b64_tr_b16 v[218:219], v17 offset:1280
    v_mfma_f32_16x16x32_bf16 v[92:95], v[180:183], v[140:143], v[92:95]
    v_mfma_f32_16x16x32_bf16 v[96:99], v[184:187], v[140:143], v[96:99]
    v_mfma_f32_16x16x32_bf16 v[100:103], v[188:191], v[140:143], v[100:103]
    v_mfma_f32_16x16x32_bf16 v[104:107], v[164:167], v[144:147], v[104:107]
    v_mfma_f32_16x16x32_bf16 v[108:111], v[168:171], v[144:147], v[108:111]
    v_mfma_f32_16x16x32_bf16 v[112:115], v[172:175], v[144:147], v[112:115]
    v_mfma_f32_16x16x32_bf16 v[116:119], v[176:179], v[144:147], v[116:119]
    v_mfma_f32_16x16x32_bf16 v[120:123], v[180:183], v[144:147], v[120:123]
    v_mfma_f32_16x16x32_bf16 v[124:127], v[184:187], v[144:147], v[124:127]
    v_mfma_f32_16x16x32_bf16 v[128:131], v[188:191], v[144:147], v[128:131]
    s_waitcnt lgkmcnt(0)
    v_mfma_f32_16x16x32_bf16 v[20:23], v[192:195], v[148:151], v[20:23]
    v_mfma_f32_16x16x32_bf16 v[24:27], v[196:199], v[148:151], v[24:27]
    v_mfma_f32_16x16x32_bf16 v[28:31], v[200:203], v[148:151], v[28:31]
    v_mfma_f32_16x16x32_bf16 v[32:35], v[204:207], v[148:151], v[32:35]
    v_mfma_f32_16x16x32_bf16 v[36:39], v[208:211], v[148:151], v[36:39]
    v_mfma_f32_16x16x32_bf16 v[40:43], v[212:215], v[148:151], v[40:43]
    v_mfma_f32_16x16x32_bf16 v[44:47], v[216:219], v[148:151], v[44:47]
    v_mfma_f32_16x16x32_bf16 v[48:51], v[192:195], v[152:155], v[48:51]
    v_mfma_f32_16x16x32_bf16 v[52:55], v[196:199], v[152:155], v[52:55]
    v_mfma_f32_16x16x32_bf16 v[56:59], v[200:203], v[152:155], v[56:59]
    v_mfma_f32_16x16x32_bf16 v[60:63], v[204:207], v[152:155], v[60:63]
    v_mfma_f32_16x16x32_bf16 v[64:67], v[208:211], v[152:155], v[64:67]
    v_mfma_f32_16x16x32_bf16 v[68:71], v[212:215], v[152:155], v[68:71]
    v_mfma_f32_16x16x32_bf16 v[72:75], v[216:219], v[152:155], v[72:75]
    v_mfma_f32_16x16x32_bf16 v[76:79], v[192:195], v[156:159], v[76:79]
    v_mfma_f32_16x16x32_bf16 v[80:83], v[196:199], v[156:159], v[80:83]
    v_mfma_f32_16x16x32_bf16 v[84:87], v[200:203], v[156:159], v[84:87]
    v_mfma_f32_16x16x32_bf16 v[88:91], v[204:207], v[156:159], v[88:91]
    v_mfma_f32_16x16x32_bf16 v[92:95], v[208:211], v[156:159], v[92:95]
    v_mfma_f32_16x16x32_bf16 v[96:99], v[212:215], v[156:159], v[96:99]
    v_mfma_f32_16x16x32_bf16 v[100:103], v[216:219], v[156:159], v[100:103]
    v_mfma_f32_16x16x32_bf16 v[104:107], v[192:195], v[160:163], v[104:107]
    v_mfma_f32_16x16x32_bf16 v[108:111], v[196:199], v[160:163], v[108:111]
    v_mfma_f32_16x16x32_bf16 v[112:115], v[200:203], v[160:163], v[112:115]
    v_mfma_f32_16x16x32_bf16 v[116:119], v[204:207], v[160:163], v[116:119]
    v_mfma_f32_16x16x32_bf16 v[120:123], v[208:211], v[160:163], v[120:123]
    v_mfma_f32_16x16x32_bf16 v[124:127], v[212:215], v[160:163], v[124:127]
    v_mfma_f32_16x16x32_bf16 v[128:131], v[216:219], v[160:163], v[128:131]
    s_waitcnt vmcnt(0)
    s_barrier
    v_add_u32 v14, 4294899712, v14
    v_add_u32 v15, 4294899712, v15
    v_add_u32 v16, 4294899712, v16
    v_add_u32 v17, 4294899712, v17
    v_lshlrev_b32 v3, 3, v1
    s_mul_i32 s26, s24, 14336
    v_add_u32 v3, s26, v3
    s_cmp_eq_u32 s23, 0
    s_cbranch_scc0 G1_EXU
    v_cvt_pk_bf16_f32 v4, v76, v77
    v_cvt_pk_bf16_f32 v5, v78, v79
    ds_write_b64 v3, v[4:5] offset:7168
    v_cvt_pk_bf16_f32 v6, v80, v81
    v_cvt_pk_bf16_f32 v7, v82, v83
    ds_write_b64 v3, v[6:7] offset:7680
    v_cvt_pk_bf16_f32 v4, v84, v85
    v_cvt_pk_bf16_f32 v5, v86, v87
    ds_write_b64 v3, v[4:5] offset:8192
    v_cvt_pk_bf16_f32 v6, v88, v89
    v_cvt_pk_bf16_f32 v7, v90, v91
    ds_write_b64 v3, v[6:7] offset:8704
    v_cvt_pk_bf16_f32 v4, v92, v93
    v_cvt_pk_bf16_f32 v5, v94, v95
    ds_write_b64 v3, v[4:5] offset:9216
    v_cvt_pk_bf16_f32 v6, v96, v97
    v_cvt_pk_bf16_f32 v7, v98, v99
    ds_write_b64 v3, v[6:7] offset:9728
    v_cvt_pk_bf16_f32 v4, v100, v101
    v_cvt_pk_bf16_f32 v5, v102, v103
    ds_write_b64 v3, v[4:5] offset:10240
    v_cvt_pk_bf16_f32 v6, v104, v105
    v_cvt_pk_bf16_f32 v7, v106, v107
    ds_write_b64 v3, v[6:7] offset:10752
    v_cvt_pk_bf16_f32 v4, v108, v109
    v_cvt_pk_bf16_f32 v5, v110, v111
    ds_write_b64 v3, v[4:5] offset:11264
    v_cvt_pk_bf16_f32 v6, v112, v113
    v_cvt_pk_bf16_f32 v7, v114, v115
    ds_write_b64 v3, v[6:7] offset:11776
    v_cvt_pk_bf16_f32 v4, v116, v117
    v_cvt_pk_bf16_f32 v5, v118, v119
    ds_write_b64 v3, v[4:5] offset:12288
    v_cvt_pk_bf16_f32 v6, v120, v121
    v_cvt_pk_bf16_f32 v7, v122, v123
    ds_write_b64 v3, v[6:7] offset:12800
    v_cvt_pk_bf16_f32 v4, v124, v125
    v_cvt_pk_bf16_f32 v5, v126, v127
    ds_write_b64 v3, v[4:5] offset:13312
    v_cvt_pk_bf16_f32 v6, v128, v129
    v_cvt_pk_bf16_f32 v7, v130, v131
    ds_write_b64 v3, v[6:7] offset:13824
    s_branch G1_EXD
G1_EXU:
    v_cvt_pk_bf16_f32 v4, v20, v21
    v_cvt_pk_bf16_f32 v5, v22, v23
    ds_write_b64 v3, v[4:5] offset:0
    v_cvt_pk_bf16_f32 v6, v24, v25
    v_cvt_pk_bf16_f32 v7, v26, v27
    ds_write_b64 v3, v[6:7] offset:512
    v_cvt_pk_bf16_f32 v4, v28, v29
    v_cvt_pk_bf16_f32 v5, v30, v31
    ds_write_b64 v3, v[4:5] offset:1024
    v_cvt_pk_bf16_f32 v6, v32, v33
    v_cvt_pk_bf16_f32 v7, v34, v35
    ds_write_b64 v3, v[6:7] offset:1536
    v_cvt_pk_bf16_f32 v4, v36, v37
    v_cvt_pk_bf16_f32 v5, v38, v39
    ds_write_b64 v3, v[4:5] offset:2048
    v_cvt_pk_bf16_f32 v6, v40, v41
    v_cvt_pk_bf16_f32 v7, v42, v43
    ds_write_b64 v3, v[6:7] offset:2560
    v_cvt_pk_bf16_f32 v4, v44, v45
    v_cvt_pk_bf16_f32 v5, v46, v47
    ds_write_b64 v3, v[4:5] offset:3072
    v_cvt_pk_bf16_f32 v6, v48, v49
    v_cvt_pk_bf16_f32 v7, v50, v51
    ds_write_b64 v3, v[6:7] offset:3584
    v_cvt_pk_bf16_f32 v4, v52, v53
    v_cvt_pk_bf16_f32 v5, v54, v55
    ds_write_b64 v3, v[4:5] offset:4096
    v_cvt_pk_bf16_f32 v6, v56, v57
    v_cvt_pk_bf16_f32 v7, v58, v59
    ds_write_b64 v3, v[6:7] offset:4608
    v_cvt_pk_bf16_f32 v4, v60, v61
    v_cvt_pk_bf16_f32 v5, v62, v63
    ds_write_b64 v3, v[4:5] offset:5120
    v_cvt_pk_bf16_f32 v6, v64, v65
    v_cvt_pk_bf16_f32 v7, v66, v67
    ds_write_b64 v3, v[6:7] offset:5632
    v_cvt_pk_bf16_f32 v4, v68, v69
    v_cvt_pk_bf16_f32 v5, v70, v71
    ds_write_b64 v3, v[4:5] offset:6144
    v_cvt_pk_bf16_f32 v6, v72, v73
    v_cvt_pk_bf16_f32 v7, v74, v75
    ds_write_b64 v3, v[6:7] offset:6656
G1_EXD:
    s_waitcnt lgkmcnt(0)
    s_barrier
    v_and_b32 v8, 15, v1
    s_lshl_b32 s26, s24, 6
    v_add_u32 v8, s26, v8
    s_mov_b32 s27, 7168
    v_mul_lo_u32 v10, v8, s27
    v_lshrrev_b32 v9, 4, v1
    v_lshl_add_u32 v10, v9, 3, v10
    s_mul_i32 s26, s25, 7168
    s_mul_i32 s27, s22, 224
    s_add_u32 s26, s26, s27
    s_mov_b32 s37, 0xc0135761
    s_mov_b32 s38, 0xbdd2d3e8
    s_cmp_eq_u32 s23, 0
    s_cbranch_scc0 G1_FU
    ds_read_b64 v[12:13], v3 offset:0
    ds_read_b64 v[14:15], v3 offset:512
    ds_read_b64 v[16:17], v3 offset:1024
    ds_read_b64 v[18:19], v3 offset:1536
    ds_read_b64 v[132:133], v3 offset:2048
    ds_read_b64 v[134:135], v3 offset:2560
    ds_read_b64 v[136:137], v3 offset:3072
    ds_read_b64 v[138:139], v3 offset:3584
    ds_read_b64 v[140:141], v3 offset:4096
    ds_read_b64 v[142:143], v3 offset:4608
    ds_read_b64 v[144:145], v3 offset:5120
    ds_read_b64 v[146:147], v3 offset:5632
    ds_read_b64 v[148:149], v3 offset:6144
    ds_read_b64 v[150:151], v3 offset:6656
    s_waitcnt lgkmcnt(0)
    v_cvt_pk_bf16_f32 v11, v20, v21
    v_cvt_pk_bf16_f32 v153, v22, v23
    v_and_b32 v152, 0xffff0000, v11
    v_lshlrev_b32 v11, 16, v11
    v_and_b32 v154, 0xffff0000, v153
    v_lshlrev_b32 v153, 16, v153
    v_lshlrev_b32 v155, 16, v12
    v_and_b32 v156, 0xffff0000, v12
    v_lshlrev_b32 v157, 16, v13
    v_and_b32 v158, 0xffff0000, v13
    v_mov_b32 v9, s37
    v_mul_f32 v159, v11, v11
    v_mul_f32 v160, v152, v152
    v_mul_f32 v161, v153, v153
    v_mul_f32 v162, v154, v154
    v_fma_f32 v159, v159, s38, v9
    v_fma_f32 v160, v160, s38, v9
    v_fma_f32 v161, v161, s38, v9
    v_fma_f32 v162, v162, s38, v9
    v_mul_f32 v159, v159, v11
    v_mul_f32 v160, v160, v152
    v_mul_f32 v161, v161, v153
    v_mul_f32 v162, v162, v154
    v_exp_f32 v159, v159
    v_exp_f32 v160, v160
    v_exp_f32 v161, v161
    v_exp_f32 v162, v162
    v_add_f32 v159, 1.0, v159
    v_add_f32 v160, 1.0, v160
    v_add_f32 v161, 1.0, v161
    v_add_f32 v162, 1.0, v162
    v_rcp_f32 v159, v159
    v_rcp_f32 v160, v160
    v_rcp_f32 v161, v161
    v_rcp_f32 v162, v162
    v_mul_f32 v159, v159, v11
    v_mul_f32 v160, v160, v152
    v_mul_f32 v161, v161, v153
    v_mul_f32 v162, v162, v154
    v_cvt_pk_bf16_f32 v8, v159, v160
    v_cvt_pk_bf16_f32 v9, v161, v162
    v_lshlrev_b32 v159, 16, v8
    v_and_b32 v160, 0xffff0000, v8
    v_lshlrev_b32 v161, 16, v9
    v_and_b32 v162, 0xffff0000, v9
    v_mul_f32 v159, v159, v155
    v_mul_f32 v160, v160, v156
    v_mul_f32 v161, v161, v157
    v_mul_f32 v162, v162, v158
    v_cvt_pk_bf16_f32 v164, v159, v160
    v_cvt_pk_bf16_f32 v165, v161, v162
    v_add_u32 v163, 0, v10
    buffer_store_dwordx2 v[164:165], v163, s[28:31], s26 offen offset:0
    v_cvt_pk_bf16_f32 v11, v24, v25
    v_cvt_pk_bf16_f32 v13, v26, v27
    v_and_b32 v12, 0xffff0000, v11
    v_lshlrev_b32 v11, 16, v11
    v_and_b32 v152, 0xffff0000, v13
    v_lshlrev_b32 v13, 16, v13
    v_lshlrev_b32 v153, 16, v14
    v_and_b32 v154, 0xffff0000, v14
    v_lshlrev_b32 v155, 16, v15
    v_and_b32 v156, 0xffff0000, v15
    v_mov_b32 v9, s37
    v_mul_f32 v157, v11, v11
    v_mul_f32 v158, v12, v12
    v_mul_f32 v159, v13, v13
    v_mul_f32 v160, v152, v152
    v_fma_f32 v157, v157, s38, v9
    v_fma_f32 v158, v158, s38, v9
    v_fma_f32 v159, v159, s38, v9
    v_fma_f32 v160, v160, s38, v9
    v_mul_f32 v157, v157, v11
    v_mul_f32 v158, v158, v12
    v_mul_f32 v159, v159, v13
    v_mul_f32 v160, v160, v152
    v_exp_f32 v157, v157
    v_exp_f32 v158, v158
    v_exp_f32 v159, v159
    v_exp_f32 v160, v160
    v_add_f32 v157, 1.0, v157
    v_add_f32 v158, 1.0, v158
    v_add_f32 v159, 1.0, v159
    v_add_f32 v160, 1.0, v160
    v_rcp_f32 v157, v157
    v_rcp_f32 v158, v158
    v_rcp_f32 v159, v159
    v_rcp_f32 v160, v160
    v_mul_f32 v157, v157, v11
    v_mul_f32 v158, v158, v12
    v_mul_f32 v159, v159, v13
    v_mul_f32 v160, v160, v152
    v_cvt_pk_bf16_f32 v8, v157, v158
    v_cvt_pk_bf16_f32 v9, v159, v160
    v_lshlrev_b32 v157, 16, v8
    v_and_b32 v158, 0xffff0000, v8
    v_lshlrev_b32 v159, 16, v9
    v_and_b32 v160, 0xffff0000, v9
    v_mul_f32 v157, v157, v153
    v_mul_f32 v158, v158, v154
    v_mul_f32 v159, v159, v155
    v_mul_f32 v160, v160, v156
    v_cvt_pk_bf16_f32 v162, v157, v158
    v_cvt_pk_bf16_f32 v163, v159, v160
    v_add_u32 v161, 0, v10
    buffer_store_dwordx2 v[162:163], v161, s[28:31], s26 offen offset:32
    v_cvt_pk_bf16_f32 v11, v28, v29
    v_cvt_pk_bf16_f32 v13, v30, v31
    v_and_b32 v12, 0xffff0000, v11
    v_lshlrev_b32 v11, 16, v11
    v_and_b32 v14, 0xffff0000, v13
    v_lshlrev_b32 v13, 16, v13
    v_lshlrev_b32 v15, 16, v16
    v_and_b32 v152, 0xffff0000, v16
    v_lshlrev_b32 v153, 16, v17
    v_and_b32 v154, 0xffff0000, v17
    v_mov_b32 v9, s37
    v_mul_f32 v155, v11, v11
    v_mul_f32 v156, v12, v12
    v_mul_f32 v157, v13, v13
    v_mul_f32 v158, v14, v14
    v_fma_f32 v155, v155, s38, v9
    v_fma_f32 v156, v156, s38, v9
    v_fma_f32 v157, v157, s38, v9
    v_fma_f32 v158, v158, s38, v9
    v_mul_f32 v155, v155, v11
    v_mul_f32 v156, v156, v12
    v_mul_f32 v157, v157, v13
    v_mul_f32 v158, v158, v14
    v_exp_f32 v155, v155
    v_exp_f32 v156, v156
    v_exp_f32 v157, v157
    v_exp_f32 v158, v158
    v_add_f32 v155, 1.0, v155
    v_add_f32 v156, 1.0, v156
    v_add_f32 v157, 1.0, v157
    v_add_f32 v158, 1.0, v158
    v_rcp_f32 v155, v155
    v_rcp_f32 v156, v156
    v_rcp_f32 v157, v157
    v_rcp_f32 v158, v158
    v_mul_f32 v155, v155, v11
    v_mul_f32 v156, v156, v12
    v_mul_f32 v157, v157, v13
    v_mul_f32 v158, v158, v14
    v_cvt_pk_bf16_f32 v8, v155, v156
    v_cvt_pk_bf16_f32 v9, v157, v158
    v_lshlrev_b32 v155, 16, v8
    v_and_b32 v156, 0xffff0000, v8
    v_lshlrev_b32 v157, 16, v9
    v_and_b32 v158, 0xffff0000, v9
    v_mul_f32 v155, v155, v15
    v_mul_f32 v156, v156, v152
    v_mul_f32 v157, v157, v153
    v_mul_f32 v158, v158, v154
    v_cvt_pk_bf16_f32 v160, v155, v156
    v_cvt_pk_bf16_f32 v161, v157, v158
    v_add_u32 v159, 0, v10
    buffer_store_dwordx2 v[160:161], v159, s[28:31], s26 offen offset:64
    v_cvt_pk_bf16_f32 v11, v32, v33
    v_cvt_pk_bf16_f32 v13, v34, v35
    v_and_b32 v12, 0xffff0000, v11
    v_lshlrev_b32 v11, 16, v11
    v_and_b32 v14, 0xffff0000, v13
    v_lshlrev_b32 v13, 16, v13
    v_lshlrev_b32 v15, 16, v18
    v_and_b32 v16, 0xffff0000, v18
    v_lshlrev_b32 v17, 16, v19
    v_and_b32 v152, 0xffff0000, v19
    v_mov_b32 v9, s37
    v_mul_f32 v153, v11, v11
    v_mul_f32 v154, v12, v12
    v_mul_f32 v155, v13, v13
    v_mul_f32 v156, v14, v14
    v_fma_f32 v153, v153, s38, v9
    v_fma_f32 v154, v154, s38, v9
    v_fma_f32 v155, v155, s38, v9
    v_fma_f32 v156, v156, s38, v9
    v_mul_f32 v153, v153, v11
    v_mul_f32 v154, v154, v12
    v_mul_f32 v155, v155, v13
    v_mul_f32 v156, v156, v14
    v_exp_f32 v153, v153
    v_exp_f32 v154, v154
    v_exp_f32 v155, v155
    v_exp_f32 v156, v156
    v_add_f32 v153, 1.0, v153
    v_add_f32 v154, 1.0, v154
    v_add_f32 v155, 1.0, v155
    v_add_f32 v156, 1.0, v156
    v_rcp_f32 v153, v153
    v_rcp_f32 v154, v154
    v_rcp_f32 v155, v155
    v_rcp_f32 v156, v156
    v_mul_f32 v153, v153, v11
    v_mul_f32 v154, v154, v12
    v_mul_f32 v155, v155, v13
    v_mul_f32 v156, v156, v14
    v_cvt_pk_bf16_f32 v8, v153, v154
    v_cvt_pk_bf16_f32 v9, v155, v156
    v_lshlrev_b32 v153, 16, v8
    v_and_b32 v154, 0xffff0000, v8
    v_lshlrev_b32 v155, 16, v9
    v_and_b32 v156, 0xffff0000, v9
    v_mul_f32 v153, v153, v15
    v_mul_f32 v154, v154, v16
    v_mul_f32 v155, v155, v17
    v_mul_f32 v156, v156, v152
    v_cvt_pk_bf16_f32 v158, v153, v154
    v_cvt_pk_bf16_f32 v159, v155, v156
    v_add_u32 v157, 0, v10
    buffer_store_dwordx2 v[158:159], v157, s[28:31], s26 offen offset:96
    v_cvt_pk_bf16_f32 v11, v36, v37
    v_cvt_pk_bf16_f32 v13, v38, v39
    v_and_b32 v12, 0xffff0000, v11
    v_lshlrev_b32 v11, 16, v11
    v_and_b32 v14, 0xffff0000, v13
    v_lshlrev_b32 v13, 16, v13
    v_lshlrev_b32 v15, 16, v132
    v_and_b32 v16, 0xffff0000, v132
    v_lshlrev_b32 v17, 16, v133
    v_and_b32 v18, 0xffff0000, v133
    v_mov_b32 v9, s37
    v_mul_f32 v19, v11, v11
    v_mul_f32 v152, v12, v12
    v_mul_f32 v153, v13, v13
    v_mul_f32 v154, v14, v14
    v_fma_f32 v19, v19, s38, v9
    v_fma_f32 v152, v152, s38, v9
    v_fma_f32 v153, v153, s38, v9
    v_fma_f32 v154, v154, s38, v9
    v_mul_f32 v19, v19, v11
    v_mul_f32 v152, v152, v12
    v_mul_f32 v153, v153, v13
    v_mul_f32 v154, v154, v14
    v_exp_f32 v19, v19
    v_exp_f32 v152, v152
    v_exp_f32 v153, v153
    v_exp_f32 v154, v154
    v_add_f32 v19, 1.0, v19
    v_add_f32 v152, 1.0, v152
    v_add_f32 v153, 1.0, v153
    v_add_f32 v154, 1.0, v154
    v_rcp_f32 v19, v19
    v_rcp_f32 v152, v152
    v_rcp_f32 v153, v153
    v_rcp_f32 v154, v154
    v_mul_f32 v19, v19, v11
    v_mul_f32 v152, v152, v12
    v_mul_f32 v153, v153, v13
    v_mul_f32 v154, v154, v14
    v_cvt_pk_bf16_f32 v8, v19, v152
    v_cvt_pk_bf16_f32 v9, v153, v154
    v_lshlrev_b32 v19, 16, v8
    v_and_b32 v152, 0xffff0000, v8
    v_lshlrev_b32 v153, 16, v9
    v_and_b32 v154, 0xffff0000, v9
    v_mul_f32 v19, v19, v15
    v_mul_f32 v152, v152, v16
    v_mul_f32 v153, v153, v17
    v_mul_f32 v154, v154, v18
    v_cvt_pk_bf16_f32 v156, v19, v152
    v_cvt_pk_bf16_f32 v157, v153, v154
    v_add_u32 v155, 0, v10
    buffer_store_dwordx2 v[156:157], v155, s[28:31], s26 offen offset:128
    v_cvt_pk_bf16_f32 v11, v40, v41
    v_cvt_pk_bf16_f32 v13, v42, v43
    v_and_b32 v12, 0xffff0000, v11
    v_lshlrev_b32 v11, 16, v11
    v_and_b32 v14, 0xffff0000, v13
    v_lshlrev_b32 v13, 16, v13
    v_lshlrev_b32 v15, 16, v134
    v_and_b32 v16, 0xffff0000, v134
    v_lshlrev_b32 v17, 16, v135
    v_and_b32 v18, 0xffff0000, v135
    v_mov_b32 v9, s37
    v_mul_f32 v19, v11, v11
    v_mul_f32 v132, v12, v12
    v_mul_f32 v133, v13, v13
    v_mul_f32 v152, v14, v14
    v_fma_f32 v19, v19, s38, v9
    v_fma_f32 v132, v132, s38, v9
    v_fma_f32 v133, v133, s38, v9
    v_fma_f32 v152, v152, s38, v9
    v_mul_f32 v19, v19, v11
    v_mul_f32 v132, v132, v12
    v_mul_f32 v133, v133, v13
    v_mul_f32 v152, v152, v14
    v_exp_f32 v19, v19
    v_exp_f32 v132, v132
    v_exp_f32 v133, v133
    v_exp_f32 v152, v152
    v_add_f32 v19, 1.0, v19
    v_add_f32 v132, 1.0, v132
    v_add_f32 v133, 1.0, v133
    v_add_f32 v152, 1.0, v152
    v_rcp_f32 v19, v19
    v_rcp_f32 v132, v132
    v_rcp_f32 v133, v133
    v_rcp_f32 v152, v152
    v_mul_f32 v19, v19, v11
    v_mul_f32 v132, v132, v12
    v_mul_f32 v133, v133, v13
    v_mul_f32 v152, v152, v14
    v_cvt_pk_bf16_f32 v8, v19, v132
    v_cvt_pk_bf16_f32 v9, v133, v152
    v_lshlrev_b32 v19, 16, v8
    v_and_b32 v132, 0xffff0000, v8
    v_lshlrev_b32 v133, 16, v9
    v_and_b32 v152, 0xffff0000, v9
    v_mul_f32 v19, v19, v15
    v_mul_f32 v132, v132, v16
    v_mul_f32 v133, v133, v17
    v_mul_f32 v152, v152, v18
    v_cvt_pk_bf16_f32 v154, v19, v132
    v_cvt_pk_bf16_f32 v155, v133, v152
    v_add_u32 v153, 0, v10
    buffer_store_dwordx2 v[154:155], v153, s[28:31], s26 offen offset:160
    v_cvt_pk_bf16_f32 v11, v44, v45
    v_cvt_pk_bf16_f32 v13, v46, v47
    v_and_b32 v12, 0xffff0000, v11
    v_lshlrev_b32 v11, 16, v11
    v_and_b32 v14, 0xffff0000, v13
    v_lshlrev_b32 v13, 16, v13
    v_lshlrev_b32 v15, 16, v136
    v_and_b32 v16, 0xffff0000, v136
    v_lshlrev_b32 v17, 16, v137
    v_and_b32 v18, 0xffff0000, v137
    v_mov_b32 v9, s37
    v_mul_f32 v19, v11, v11
    v_mul_f32 v132, v12, v12
    v_mul_f32 v133, v13, v13
    v_mul_f32 v134, v14, v14
    v_fma_f32 v19, v19, s38, v9
    v_fma_f32 v132, v132, s38, v9
    v_fma_f32 v133, v133, s38, v9
    v_fma_f32 v134, v134, s38, v9
    v_mul_f32 v19, v19, v11
    v_mul_f32 v132, v132, v12
    v_mul_f32 v133, v133, v13
    v_mul_f32 v134, v134, v14
    v_exp_f32 v19, v19
    v_exp_f32 v132, v132
    v_exp_f32 v133, v133
    v_exp_f32 v134, v134
    v_add_f32 v19, 1.0, v19
    v_add_f32 v132, 1.0, v132
    v_add_f32 v133, 1.0, v133
    v_add_f32 v134, 1.0, v134
    v_rcp_f32 v19, v19
    v_rcp_f32 v132, v132
    v_rcp_f32 v133, v133
    v_rcp_f32 v134, v134
    v_mul_f32 v19, v19, v11
    v_mul_f32 v132, v132, v12
    v_mul_f32 v133, v133, v13
    v_mul_f32 v134, v134, v14
    v_cvt_pk_bf16_f32 v8, v19, v132
    v_cvt_pk_bf16_f32 v9, v133, v134
    v_lshlrev_b32 v19, 16, v8
    v_and_b32 v132, 0xffff0000, v8
    v_lshlrev_b32 v133, 16, v9
    v_and_b32 v134, 0xffff0000, v9
    v_mul_f32 v19, v19, v15
    v_mul_f32 v132, v132, v16
    v_mul_f32 v133, v133, v17
    v_mul_f32 v134, v134, v18
    v_cvt_pk_bf16_f32 v152, v19, v132
    v_cvt_pk_bf16_f32 v153, v133, v134
    v_add_u32 v135, 0, v10
    buffer_store_dwordx2 v[152:153], v135, s[28:31], s26 offen offset:192
    v_cvt_pk_bf16_f32 v11, v48, v49
    v_cvt_pk_bf16_f32 v13, v50, v51
    v_and_b32 v12, 0xffff0000, v11
    v_lshlrev_b32 v11, 16, v11
    v_and_b32 v14, 0xffff0000, v13
    v_lshlrev_b32 v13, 16, v13
    v_lshlrev_b32 v15, 16, v138
    v_and_b32 v16, 0xffff0000, v138
    v_lshlrev_b32 v17, 16, v139
    v_and_b32 v18, 0xffff0000, v139
    v_mov_b32 v9, s37
    v_mul_f32 v19, v11, v11
    v_mul_f32 v132, v12, v12
    v_mul_f32 v133, v13, v13
    v_mul_f32 v134, v14, v14
    v_fma_f32 v19, v19, s38, v9
    v_fma_f32 v132, v132, s38, v9
    v_fma_f32 v133, v133, s38, v9
    v_fma_f32 v134, v134, s38, v9
    v_mul_f32 v19, v19, v11
    v_mul_f32 v132, v132, v12
    v_mul_f32 v133, v133, v13
    v_mul_f32 v134, v134, v14
    v_exp_f32 v19, v19
    v_exp_f32 v132, v132
    v_exp_f32 v133, v133
    v_exp_f32 v134, v134
    v_add_f32 v19, 1.0, v19
    v_add_f32 v132, 1.0, v132
    v_add_f32 v133, 1.0, v133
    v_add_f32 v134, 1.0, v134
    v_rcp_f32 v19, v19
    v_rcp_f32 v132, v132
    v_rcp_f32 v133, v133
    v_rcp_f32 v134, v134
    v_mul_f32 v19, v19, v11
    v_mul_f32 v132, v132, v12
    v_mul_f32 v133, v133, v13
    v_mul_f32 v134, v134, v14
    v_cvt_pk_bf16_f32 v8, v19, v132
    v_cvt_pk_bf16_f32 v9, v133, v134
    v_lshlrev_b32 v19, 16, v8
    v_and_b32 v132, 0xffff0000, v8
    v_lshlrev_b32 v133, 16, v9
    v_and_b32 v134, 0xffff0000, v9
    v_mul_f32 v19, v19, v15
    v_mul_f32 v132, v132, v16
    v_mul_f32 v133, v133, v17
    v_mul_f32 v134, v134, v18
    v_cvt_pk_bf16_f32 v136, v19, v132
    v_cvt_pk_bf16_f32 v137, v133, v134
    v_add_u32 v135, 114688, v10
    buffer_store_dwordx2 v[136:137], v135, s[28:31], s26 offen offset:0
    v_cvt_pk_bf16_f32 v11, v52, v53
    v_cvt_pk_bf16_f32 v13, v54, v55
    v_and_b32 v12, 0xffff0000, v11
    v_lshlrev_b32 v11, 16, v11
    v_and_b32 v14, 0xffff0000, v13
    v_lshlrev_b32 v13, 16, v13
    v_lshlrev_b32 v15, 16, v140
    v_and_b32 v16, 0xffff0000, v140
    v_lshlrev_b32 v17, 16, v141
    v_and_b32 v18, 0xffff0000, v141
    v_mov_b32 v9, s37
    v_mul_f32 v19, v11, v11
    v_mul_f32 v132, v12, v12
    v_mul_f32 v133, v13, v13
    v_mul_f32 v134, v14, v14
    v_fma_f32 v19, v19, s38, v9
    v_fma_f32 v132, v132, s38, v9
    v_fma_f32 v133, v133, s38, v9
    v_fma_f32 v134, v134, s38, v9
    v_mul_f32 v19, v19, v11
    v_mul_f32 v132, v132, v12
    v_mul_f32 v133, v133, v13
    v_mul_f32 v134, v134, v14
    v_exp_f32 v19, v19
    v_exp_f32 v132, v132
    v_exp_f32 v133, v133
    v_exp_f32 v134, v134
    v_add_f32 v19, 1.0, v19
    v_add_f32 v132, 1.0, v132
    v_add_f32 v133, 1.0, v133
    v_add_f32 v134, 1.0, v134
    v_rcp_f32 v19, v19
    v_rcp_f32 v132, v132
    v_rcp_f32 v133, v133
    v_rcp_f32 v134, v134
    v_mul_f32 v19, v19, v11
    v_mul_f32 v132, v132, v12
    v_mul_f32 v133, v133, v13
    v_mul_f32 v134, v134, v14
    v_cvt_pk_bf16_f32 v8, v19, v132
    v_cvt_pk_bf16_f32 v9, v133, v134
    v_lshlrev_b32 v19, 16, v8
    v_and_b32 v132, 0xffff0000, v8
    v_lshlrev_b32 v133, 16, v9
    v_and_b32 v134, 0xffff0000, v9
    v_mul_f32 v19, v19, v15
    v_mul_f32 v132, v132, v16
    v_mul_f32 v133, v133, v17
    v_mul_f32 v134, v134, v18
    v_cvt_pk_bf16_f32 v136, v19, v132
    v_cvt_pk_bf16_f32 v137, v133, v134
    v_add_u32 v135, 114688, v10
    buffer_store_dwordx2 v[136:137], v135, s[28:31], s26 offen offset:32
    v_cvt_pk_bf16_f32 v11, v56, v57
    v_cvt_pk_bf16_f32 v13, v58, v59
    v_and_b32 v12, 0xffff0000, v11
    v_lshlrev_b32 v11, 16, v11
    v_and_b32 v14, 0xffff0000, v13
    v_lshlrev_b32 v13, 16, v13
    v_lshlrev_b32 v15, 16, v142
    v_and_b32 v16, 0xffff0000, v142
    v_lshlrev_b32 v17, 16, v143
    v_and_b32 v18, 0xffff0000, v143
    v_mov_b32 v9, s37
    v_mul_f32 v19, v11, v11
    v_mul_f32 v132, v12, v12
    v_mul_f32 v133, v13, v13
    v_mul_f32 v134, v14, v14
    v_fma_f32 v19, v19, s38, v9
    v_fma_f32 v132, v132, s38, v9
    v_fma_f32 v133, v133, s38, v9
    v_fma_f32 v134, v134, s38, v9
    v_mul_f32 v19, v19, v11
    v_mul_f32 v132, v132, v12
    v_mul_f32 v133, v133, v13
    v_mul_f32 v134, v134, v14
    v_exp_f32 v19, v19
    v_exp_f32 v132, v132
    v_exp_f32 v133, v133
    v_exp_f32 v134, v134
    v_add_f32 v19, 1.0, v19
    v_add_f32 v132, 1.0, v132
    v_add_f32 v133, 1.0, v133
    v_add_f32 v134, 1.0, v134
    v_rcp_f32 v19, v19
    v_rcp_f32 v132, v132
    v_rcp_f32 v133, v133
    v_rcp_f32 v134, v134
    v_mul_f32 v19, v19, v11
    v_mul_f32 v132, v132, v12
    v_mul_f32 v133, v133, v13
    v_mul_f32 v134, v134, v14
    v_cvt_pk_bf16_f32 v8, v19, v132
    v_cvt_pk_bf16_f32 v9, v133, v134
    v_lshlrev_b32 v19, 16, v8
    v_and_b32 v132, 0xffff0000, v8
    v_lshlrev_b32 v133, 16, v9
    v_and_b32 v134, 0xffff0000, v9
    v_mul_f32 v19, v19, v15
    v_mul_f32 v132, v132, v16
    v_mul_f32 v133, v133, v17
    v_mul_f32 v134, v134, v18
    v_cvt_pk_bf16_f32 v136, v19, v132
    v_cvt_pk_bf16_f32 v137, v133, v134
    v_add_u32 v135, 114688, v10
    buffer_store_dwordx2 v[136:137], v135, s[28:31], s26 offen offset:64
    v_cvt_pk_bf16_f32 v11, v60, v61
    v_cvt_pk_bf16_f32 v13, v62, v63
    v_and_b32 v12, 0xffff0000, v11
    v_lshlrev_b32 v11, 16, v11
    v_and_b32 v14, 0xffff0000, v13
    v_lshlrev_b32 v13, 16, v13
    v_lshlrev_b32 v15, 16, v144
    v_and_b32 v16, 0xffff0000, v144
    v_lshlrev_b32 v17, 16, v145
    v_and_b32 v18, 0xffff0000, v145
    v_mov_b32 v9, s37
    v_mul_f32 v19, v11, v11
    v_mul_f32 v132, v12, v12
    v_mul_f32 v133, v13, v13
    v_mul_f32 v134, v14, v14
    v_fma_f32 v19, v19, s38, v9
    v_fma_f32 v132, v132, s38, v9
    v_fma_f32 v133, v133, s38, v9
    v_fma_f32 v134, v134, s38, v9
    v_mul_f32 v19, v19, v11
    v_mul_f32 v132, v132, v12
    v_mul_f32 v133, v133, v13
    v_mul_f32 v134, v134, v14
    v_exp_f32 v19, v19
    v_exp_f32 v132, v132
    v_exp_f32 v133, v133
    v_exp_f32 v134, v134
    v_add_f32 v19, 1.0, v19
    v_add_f32 v132, 1.0, v132
    v_add_f32 v133, 1.0, v133
    v_add_f32 v134, 1.0, v134
    v_rcp_f32 v19, v19
    v_rcp_f32 v132, v132
    v_rcp_f32 v133, v133
    v_rcp_f32 v134, v134
    v_mul_f32 v19, v19, v11
    v_mul_f32 v132, v132, v12
    v_mul_f32 v133, v133, v13
    v_mul_f32 v134, v134, v14
    v_cvt_pk_bf16_f32 v8, v19, v132
    v_cvt_pk_bf16_f32 v9, v133, v134
    v_lshlrev_b32 v19, 16, v8
    v_and_b32 v132, 0xffff0000, v8
    v_lshlrev_b32 v133, 16, v9
    v_and_b32 v134, 0xffff0000, v9
    v_mul_f32 v19, v19, v15
    v_mul_f32 v132, v132, v16
    v_mul_f32 v133, v133, v17
    v_mul_f32 v134, v134, v18
    v_cvt_pk_bf16_f32 v136, v19, v132
    v_cvt_pk_bf16_f32 v137, v133, v134
    v_add_u32 v135, 114688, v10
    buffer_store_dwordx2 v[136:137], v135, s[28:31], s26 offen offset:96
    v_cvt_pk_bf16_f32 v11, v64, v65
    v_cvt_pk_bf16_f32 v13, v66, v67
    v_and_b32 v12, 0xffff0000, v11
    v_lshlrev_b32 v11, 16, v11
    v_and_b32 v14, 0xffff0000, v13
    v_lshlrev_b32 v13, 16, v13
    v_lshlrev_b32 v15, 16, v146
    v_and_b32 v16, 0xffff0000, v146
    v_lshlrev_b32 v17, 16, v147
    v_and_b32 v18, 0xffff0000, v147
    v_mov_b32 v9, s37
    v_mul_f32 v19, v11, v11
    v_mul_f32 v132, v12, v12
    v_mul_f32 v133, v13, v13
    v_mul_f32 v134, v14, v14
    v_fma_f32 v19, v19, s38, v9
    v_fma_f32 v132, v132, s38, v9
    v_fma_f32 v133, v133, s38, v9
    v_fma_f32 v134, v134, s38, v9
    v_mul_f32 v19, v19, v11
    v_mul_f32 v132, v132, v12
    v_mul_f32 v133, v133, v13
    v_mul_f32 v134, v134, v14
    v_exp_f32 v19, v19
    v_exp_f32 v132, v132
    v_exp_f32 v133, v133
    v_exp_f32 v134, v134
    v_add_f32 v19, 1.0, v19
    v_add_f32 v132, 1.0, v132
    v_add_f32 v133, 1.0, v133
    v_add_f32 v134, 1.0, v134
    v_rcp_f32 v19, v19
    v_rcp_f32 v132, v132
    v_rcp_f32 v133, v133
    v_rcp_f32 v134, v134
    v_mul_f32 v19, v19, v11
    v_mul_f32 v132, v132, v12
    v_mul_f32 v133, v133, v13
    v_mul_f32 v134, v134, v14
    v_cvt_pk_bf16_f32 v8, v19, v132
    v_cvt_pk_bf16_f32 v9, v133, v134
    v_lshlrev_b32 v19, 16, v8
    v_and_b32 v132, 0xffff0000, v8
    v_lshlrev_b32 v133, 16, v9
    v_and_b32 v134, 0xffff0000, v9
    v_mul_f32 v19, v19, v15
    v_mul_f32 v132, v132, v16
    v_mul_f32 v133, v133, v17
    v_mul_f32 v134, v134, v18
    v_cvt_pk_bf16_f32 v136, v19, v132
    v_cvt_pk_bf16_f32 v137, v133, v134
    v_add_u32 v135, 114688, v10
    buffer_store_dwordx2 v[136:137], v135, s[28:31], s26 offen offset:128
    v_cvt_pk_bf16_f32 v11, v68, v69
    v_cvt_pk_bf16_f32 v13, v70, v71
    v_and_b32 v12, 0xffff0000, v11
    v_lshlrev_b32 v11, 16, v11
    v_and_b32 v14, 0xffff0000, v13
    v_lshlrev_b32 v13, 16, v13
    v_lshlrev_b32 v15, 16, v148
    v_and_b32 v16, 0xffff0000, v148
    v_lshlrev_b32 v17, 16, v149
    v_and_b32 v18, 0xffff0000, v149
    v_mov_b32 v9, s37
    v_mul_f32 v19, v11, v11
    v_mul_f32 v132, v12, v12
    v_mul_f32 v133, v13, v13
    v_mul_f32 v134, v14, v14
    v_fma_f32 v19, v19, s38, v9
    v_fma_f32 v132, v132, s38, v9
    v_fma_f32 v133, v133, s38, v9
    v_fma_f32 v134, v134, s38, v9
    v_mul_f32 v19, v19, v11
    v_mul_f32 v132, v132, v12
    v_mul_f32 v133, v133, v13
    v_mul_f32 v134, v134, v14
    v_exp_f32 v19, v19
    v_exp_f32 v132, v132
    v_exp_f32 v133, v133
    v_exp_f32 v134, v134
    v_add_f32 v19, 1.0, v19
    v_add_f32 v132, 1.0, v132
    v_add_f32 v133, 1.0, v133
    v_add_f32 v134, 1.0, v134
    v_rcp_f32 v19, v19
    v_rcp_f32 v132, v132
    v_rcp_f32 v133, v133
    v_rcp_f32 v134, v134
    v_mul_f32 v19, v19, v11
    v_mul_f32 v132, v132, v12
    v_mul_f32 v133, v133, v13
    v_mul_f32 v134, v134, v14
    v_cvt_pk_bf16_f32 v8, v19, v132
    v_cvt_pk_bf16_f32 v9, v133, v134
    v_lshlrev_b32 v19, 16, v8
    v_and_b32 v132, 0xffff0000, v8
    v_lshlrev_b32 v133, 16, v9
    v_and_b32 v134, 0xffff0000, v9
    v_mul_f32 v19, v19, v15
    v_mul_f32 v132, v132, v16
    v_mul_f32 v133, v133, v17
    v_mul_f32 v134, v134, v18
    v_cvt_pk_bf16_f32 v136, v19, v132
    v_cvt_pk_bf16_f32 v137, v133, v134
    v_add_u32 v135, 114688, v10
    buffer_store_dwordx2 v[136:137], v135, s[28:31], s26 offen offset:160
    v_cvt_pk_bf16_f32 v11, v72, v73
    v_cvt_pk_bf16_f32 v13, v74, v75
    v_and_b32 v12, 0xffff0000, v11
    v_lshlrev_b32 v11, 16, v11
    v_and_b32 v14, 0xffff0000, v13
    v_lshlrev_b32 v13, 16, v13
    v_lshlrev_b32 v15, 16, v150
    v_and_b32 v16, 0xffff0000, v150
    v_lshlrev_b32 v17, 16, v151
    v_and_b32 v18, 0xffff0000, v151
    v_mov_b32 v9, s37
    v_mul_f32 v19, v11, v11
    v_mul_f32 v132, v12, v12
    v_mul_f32 v133, v13, v13
    v_mul_f32 v134, v14, v14
    v_fma_f32 v19, v19, s38, v9
    v_fma_f32 v132, v132, s38, v9
    v_fma_f32 v133, v133, s38, v9
    v_fma_f32 v134, v134, s38, v9
    v_mul_f32 v19, v19, v11
    v_mul_f32 v132, v132, v12
    v_mul_f32 v133, v133, v13
    v_mul_f32 v134, v134, v14
    v_exp_f32 v19, v19
    v_exp_f32 v132, v132
    v_exp_f32 v133, v133
    v_exp_f32 v134, v134
    v_add_f32 v19, 1.0, v19
    v_add_f32 v132, 1.0, v132
    v_add_f32 v133, 1.0, v133
    v_add_f32 v134, 1.0, v134
    v_rcp_f32 v19, v19
    v_rcp_f32 v132, v132
    v_rcp_f32 v133, v133
    v_rcp_f32 v134, v134
    v_mul_f32 v19, v19, v11
    v_mul_f32 v132, v132, v12
    v_mul_f32 v133, v133, v13
    v_mul_f32 v134, v134, v14
    v_cvt_pk_bf16_f32 v8, v19, v132
    v_cvt_pk_bf16_f32 v9, v133, v134
    v_lshlrev_b32 v19, 16, v8
    v_and_b32 v132, 0xffff0000, v8
    v_lshlrev_b32 v133, 16, v9
    v_and_b32 v134, 0xffff0000, v9
    v_mul_f32 v19, v19, v15
    v_mul_f32 v132, v132, v16
    v_mul_f32 v133, v133, v17
    v_mul_f32 v134, v134, v18
    v_cvt_pk_bf16_f32 v136, v19, v132
    v_cvt_pk_bf16_f32 v137, v133, v134
    v_add_u32 v135, 114688, v10
    buffer_store_dwordx2 v[136:137], v135, s[28:31], s26 offen offset:192
    s_branch G1_FD
G1_FU:
    ds_read_b64 v[12:13], v3 offset:7168
    ds_read_b64 v[14:15], v3 offset:7680
    ds_read_b64 v[16:17], v3 offset:8192
    ds_read_b64 v[18:19], v3 offset:8704
    ds_read_b64 v[132:133], v3 offset:9216
    ds_read_b64 v[134:135], v3 offset:9728
    ds_read_b64 v[136:137], v3 offset:10240
    ds_read_b64 v[138:139], v3 offset:10752
    ds_read_b64 v[140:141], v3 offset:11264
    ds_read_b64 v[142:143], v3 offset:11776
    ds_read_b64 v[144:145], v3 offset:12288
    ds_read_b64 v[146:147], v3 offset:12800
    ds_read_b64 v[148:149], v3 offset:13312
    ds_read_b64 v[150:151], v3 offset:13824
    s_waitcnt lgkmcnt(0)
    v_cvt_pk_bf16_f32 v11, v76, v77
    v_cvt_pk_bf16_f32 v153, v78, v79
    v_and_b32 v152, 0xffff0000, v11
    v_lshlrev_b32 v11, 16, v11
    v_and_b32 v154, 0xffff0000, v153
    v_lshlrev_b32 v153, 16, v153
    v_lshlrev_b32 v155, 16, v12
    v_and_b32 v156, 0xffff0000, v12
    v_lshlrev_b32 v157, 16, v13
    v_and_b32 v158, 0xffff0000, v13
    v_mov_b32 v9, s37
    v_mul_f32 v159, v155, v155
    v_mul_f32 v160, v156, v156
    v_mul_f32 v161, v157, v157
    v_mul_f32 v162, v158, v158
    v_fma_f32 v159, v159, s38, v9
    v_fma_f32 v160, v160, s38, v9
    v_fma_f32 v161, v161, s38, v9
    v_fma_f32 v162, v162, s38, v9
    v_mul_f32 v159, v159, v155
    v_mul_f32 v160, v160, v156
    v_mul_f32 v161, v161, v157
    v_mul_f32 v162, v162, v158
    v_exp_f32 v159, v159
    v_exp_f32 v160, v160
    v_exp_f32 v161, v161
    v_exp_f32 v162, v162
    v_add_f32 v159, 1.0, v159
    v_add_f32 v160, 1.0, v160
    v_add_f32 v161, 1.0, v161
    v_add_f32 v162, 1.0, v162
    v_rcp_f32 v159, v159
    v_rcp_f32 v160, v160
    v_rcp_f32 v161, v161
    v_rcp_f32 v162, v162
    v_mul_f32 v159, v159, v155
    v_mul_f32 v160, v160, v156
    v_mul_f32 v161, v161, v157
    v_mul_f32 v162, v162, v158
    v_cvt_pk_bf16_f32 v8, v159, v160
    v_cvt_pk_bf16_f32 v9, v161, v162
    v_lshlrev_b32 v159, 16, v8
    v_and_b32 v160, 0xffff0000, v8
    v_lshlrev_b32 v161, 16, v9
    v_and_b32 v162, 0xffff0000, v9
    v_mul_f32 v159, v159, v11
    v_mul_f32 v160, v160, v152
    v_mul_f32 v161, v161, v153
    v_mul_f32 v162, v162, v154
    v_cvt_pk_bf16_f32 v164, v159, v160
    v_cvt_pk_bf16_f32 v165, v161, v162
    v_add_u32 v163, 229376, v10
    buffer_store_dwordx2 v[164:165], v163, s[28:31], s26 offen offset:0
    v_cvt_pk_bf16_f32 v11, v80, v81
    v_cvt_pk_bf16_f32 v13, v82, v83
    v_and_b32 v12, 0xffff0000, v11
    v_lshlrev_b32 v11, 16, v11
    v_and_b32 v152, 0xffff0000, v13
    v_lshlrev_b32 v13, 16, v13
    v_lshlrev_b32 v153, 16, v14
    v_and_b32 v154, 0xffff0000, v14
    v_lshlrev_b32 v155, 16, v15
    v_and_b32 v156, 0xffff0000, v15
    v_mov_b32 v9, s37
    v_mul_f32 v157, v153, v153
    v_mul_f32 v158, v154, v154
    v_mul_f32 v159, v155, v155
    v_mul_f32 v160, v156, v156
    v_fma_f32 v157, v157, s38, v9
    v_fma_f32 v158, v158, s38, v9
    v_fma_f32 v159, v159, s38, v9
    v_fma_f32 v160, v160, s38, v9
    v_mul_f32 v157, v157, v153
    v_mul_f32 v158, v158, v154
    v_mul_f32 v159, v159, v155
    v_mul_f32 v160, v160, v156
    v_exp_f32 v157, v157
    v_exp_f32 v158, v158
    v_exp_f32 v159, v159
    v_exp_f32 v160, v160
    v_add_f32 v157, 1.0, v157
    v_add_f32 v158, 1.0, v158
    v_add_f32 v159, 1.0, v159
    v_add_f32 v160, 1.0, v160
    v_rcp_f32 v157, v157
    v_rcp_f32 v158, v158
    v_rcp_f32 v159, v159
    v_rcp_f32 v160, v160
    v_mul_f32 v157, v157, v153
    v_mul_f32 v158, v158, v154
    v_mul_f32 v159, v159, v155
    v_mul_f32 v160, v160, v156
    v_cvt_pk_bf16_f32 v8, v157, v158
    v_cvt_pk_bf16_f32 v9, v159, v160
    v_lshlrev_b32 v157, 16, v8
    v_and_b32 v158, 0xffff0000, v8
    v_lshlrev_b32 v159, 16, v9
    v_and_b32 v160, 0xffff0000, v9
    v_mul_f32 v157, v157, v11
    v_mul_f32 v158, v158, v12
    v_mul_f32 v159, v159, v13
    v_mul_f32 v160, v160, v152
    v_cvt_pk_bf16_f32 v162, v157, v158
    v_cvt_pk_bf16_f32 v163, v159, v160
    v_add_u32 v161, 229376, v10
    buffer_store_dwordx2 v[162:163], v161, s[28:31], s26 offen offset:32
    v_cvt_pk_bf16_f32 v11, v84, v85
    v_cvt_pk_bf16_f32 v13, v86, v87
    v_and_b32 v12, 0xffff0000, v11
    v_lshlrev_b32 v11, 16, v11
    v_and_b32 v14, 0xffff0000, v13
    v_lshlrev_b32 v13, 16, v13
    v_lshlrev_b32 v15, 16, v16
    v_and_b32 v152, 0xffff0000, v16
    v_lshlrev_b32 v153, 16, v17
    v_and_b32 v154, 0xffff0000, v17
    v_mov_b32 v9, s37
    v_mul_f32 v155, v15, v15
    v_mul_f32 v156, v152, v152
    v_mul_f32 v157, v153, v153
    v_mul_f32 v158, v154, v154
    v_fma_f32 v155, v155, s38, v9
    v_fma_f32 v156, v156, s38, v9
    v_fma_f32 v157, v157, s38, v9
    v_fma_f32 v158, v158, s38, v9
    v_mul_f32 v155, v155, v15
    v_mul_f32 v156, v156, v152
    v_mul_f32 v157, v157, v153
    v_mul_f32 v158, v158, v154
    v_exp_f32 v155, v155
    v_exp_f32 v156, v156
    v_exp_f32 v157, v157
    v_exp_f32 v158, v158
    v_add_f32 v155, 1.0, v155
    v_add_f32 v156, 1.0, v156
    v_add_f32 v157, 1.0, v157
    v_add_f32 v158, 1.0, v158
    v_rcp_f32 v155, v155
    v_rcp_f32 v156, v156
    v_rcp_f32 v157, v157
    v_rcp_f32 v158, v158
    v_mul_f32 v155, v155, v15
    v_mul_f32 v156, v156, v152
    v_mul_f32 v157, v157, v153
    v_mul_f32 v158, v158, v154
    v_cvt_pk_bf16_f32 v8, v155, v156
    v_cvt_pk_bf16_f32 v9, v157, v158
    v_lshlrev_b32 v155, 16, v8
    v_and_b32 v156, 0xffff0000, v8
    v_lshlrev_b32 v157, 16, v9
    v_and_b32 v158, 0xffff0000, v9
    v_mul_f32 v155, v155, v11
    v_mul_f32 v156, v156, v12
    v_mul_f32 v157, v157, v13
    v_mul_f32 v158, v158, v14
    v_cvt_pk_bf16_f32 v160, v155, v156
    v_cvt_pk_bf16_f32 v161, v157, v158
    v_add_u32 v159, 229376, v10
    buffer_store_dwordx2 v[160:161], v159, s[28:31], s26 offen offset:64
    v_cvt_pk_bf16_f32 v11, v88, v89
    v_cvt_pk_bf16_f32 v13, v90, v91
    v_and_b32 v12, 0xffff0000, v11
    v_lshlrev_b32 v11, 16, v11
    v_and_b32 v14, 0xffff0000, v13
    v_lshlrev_b32 v13, 16, v13
    v_lshlrev_b32 v15, 16, v18
    v_and_b32 v16, 0xffff0000, v18
    v_lshlrev_b32 v17, 16, v19
    v_and_b32 v152, 0xffff0000, v19
    v_mov_b32 v9, s37
    v_mul_f32 v153, v15, v15
    v_mul_f32 v154, v16, v16
    v_mul_f32 v155, v17, v17
    v_mul_f32 v156, v152, v152
    v_fma_f32 v153, v153, s38, v9
    v_fma_f32 v154, v154, s38, v9
    v_fma_f32 v155, v155, s38, v9
    v_fma_f32 v156, v156, s38, v9
    v_mul_f32 v153, v153, v15
    v_mul_f32 v154, v154, v16
    v_mul_f32 v155, v155, v17
    v_mul_f32 v156, v156, v152
    v_exp_f32 v153, v153
    v_exp_f32 v154, v154
    v_exp_f32 v155, v155
    v_exp_f32 v156, v156
    v_add_f32 v153, 1.0, v153
    v_add_f32 v154, 1.0, v154
    v_add_f32 v155, 1.0, v155
    v_add_f32 v156, 1.0, v156
    v_rcp_f32 v153, v153
    v_rcp_f32 v154, v154
    v_rcp_f32 v155, v155
    v_rcp_f32 v156, v156
    v_mul_f32 v153, v153, v15
    v_mul_f32 v154, v154, v16
    v_mul_f32 v155, v155, v17
    v_mul_f32 v156, v156, v152
    v_cvt_pk_bf16_f32 v8, v153, v154
    v_cvt_pk_bf16_f32 v9, v155, v156
    v_lshlrev_b32 v153, 16, v8
    v_and_b32 v154, 0xffff0000, v8
    v_lshlrev_b32 v155, 16, v9
    v_and_b32 v156, 0xffff0000, v9
    v_mul_f32 v153, v153, v11
    v_mul_f32 v154, v154, v12
    v_mul_f32 v155, v155, v13
    v_mul_f32 v156, v156, v14
    v_cvt_pk_bf16_f32 v158, v153, v154
    v_cvt_pk_bf16_f32 v159, v155, v156
    v_add_u32 v157, 229376, v10
    buffer_store_dwordx2 v[158:159], v157, s[28:31], s26 offen offset:96
    v_cvt_pk_bf16_f32 v11, v92, v93
    v_cvt_pk_bf16_f32 v13, v94, v95
    v_and_b32 v12, 0xffff0000, v11
    v_lshlrev_b32 v11, 16, v11
    v_and_b32 v14, 0xffff0000, v13
    v_lshlrev_b32 v13, 16, v13
    v_lshlrev_b32 v15, 16, v132
    v_and_b32 v16, 0xffff0000, v132
    v_lshlrev_b32 v17, 16, v133
    v_and_b32 v18, 0xffff0000, v133
    v_mov_b32 v9, s37
    v_mul_f32 v19, v15, v15
    v_mul_f32 v152, v16, v16
    v_mul_f32 v153, v17, v17
    v_mul_f32 v154, v18, v18
    v_fma_f32 v19, v19, s38, v9
    v_fma_f32 v152, v152, s38, v9
    v_fma_f32 v153, v153, s38, v9
    v_fma_f32 v154, v154, s38, v9
    v_mul_f32 v19, v19, v15
    v_mul_f32 v152, v152, v16
    v_mul_f32 v153, v153, v17
    v_mul_f32 v154, v154, v18
    v_exp_f32 v19, v19
    v_exp_f32 v152, v152
    v_exp_f32 v153, v153
    v_exp_f32 v154, v154
    v_add_f32 v19, 1.0, v19
    v_add_f32 v152, 1.0, v152
    v_add_f32 v153, 1.0, v153
    v_add_f32 v154, 1.0, v154
    v_rcp_f32 v19, v19
    v_rcp_f32 v152, v152
    v_rcp_f32 v153, v153
    v_rcp_f32 v154, v154
    v_mul_f32 v19, v19, v15
    v_mul_f32 v152, v152, v16
    v_mul_f32 v153, v153, v17
    v_mul_f32 v154, v154, v18
    v_cvt_pk_bf16_f32 v8, v19, v152
    v_cvt_pk_bf16_f32 v9, v153, v154
    v_lshlrev_b32 v19, 16, v8
    v_and_b32 v152, 0xffff0000, v8
    v_lshlrev_b32 v153, 16, v9
    v_and_b32 v154, 0xffff0000, v9
    v_mul_f32 v19, v19, v11
    v_mul_f32 v152, v152, v12
    v_mul_f32 v153, v153, v13
    v_mul_f32 v154, v154, v14
    v_cvt_pk_bf16_f32 v156, v19, v152
    v_cvt_pk_bf16_f32 v157, v153, v154
    v_add_u32 v155, 229376, v10
    buffer_store_dwordx2 v[156:157], v155, s[28:31], s26 offen offset:128
    v_cvt_pk_bf16_f32 v11, v96, v97
    v_cvt_pk_bf16_f32 v13, v98, v99
    v_and_b32 v12, 0xffff0000, v11
    v_lshlrev_b32 v11, 16, v11
    v_and_b32 v14, 0xffff0000, v13
    v_lshlrev_b32 v13, 16, v13
    v_lshlrev_b32 v15, 16, v134
    v_and_b32 v16, 0xffff0000, v134
    v_lshlrev_b32 v17, 16, v135
    v_and_b32 v18, 0xffff0000, v135
    v_mov_b32 v9, s37
    v_mul_f32 v19, v15, v15
    v_mul_f32 v132, v16, v16
    v_mul_f32 v133, v17, v17
    v_mul_f32 v152, v18, v18
    v_fma_f32 v19, v19, s38, v9
    v_fma_f32 v132, v132, s38, v9
    v_fma_f32 v133, v133, s38, v9
    v_fma_f32 v152, v152, s38, v9
    v_mul_f32 v19, v19, v15
    v_mul_f32 v132, v132, v16
    v_mul_f32 v133, v133, v17
    v_mul_f32 v152, v152, v18
    v_exp_f32 v19, v19
    v_exp_f32 v132, v132
    v_exp_f32 v133, v133
    v_exp_f32 v152, v152
    v_add_f32 v19, 1.0, v19
    v_add_f32 v132, 1.0, v132
    v_add_f32 v133, 1.0, v133
    v_add_f32 v152, 1.0, v152
    v_rcp_f32 v19, v19
    v_rcp_f32 v132, v132
    v_rcp_f32 v133, v133
    v_rcp_f32 v152, v152
    v_mul_f32 v19, v19, v15
    v_mul_f32 v132, v132, v16
    v_mul_f32 v133, v133, v17
    v_mul_f32 v152, v152, v18
    v_cvt_pk_bf16_f32 v8, v19, v132
    v_cvt_pk_bf16_f32 v9, v133, v152
    v_lshlrev_b32 v19, 16, v8
    v_and_b32 v132, 0xffff0000, v8
    v_lshlrev_b32 v133, 16, v9
    v_and_b32 v152, 0xffff0000, v9
    v_mul_f32 v19, v19, v11
    v_mul_f32 v132, v132, v12
    v_mul_f32 v133, v133, v13
    v_mul_f32 v152, v152, v14
    v_cvt_pk_bf16_f32 v154, v19, v132
    v_cvt_pk_bf16_f32 v155, v133, v152
    v_add_u32 v153, 229376, v10
    buffer_store_dwordx2 v[154:155], v153, s[28:31], s26 offen offset:160
    v_cvt_pk_bf16_f32 v11, v100, v101
    v_cvt_pk_bf16_f32 v13, v102, v103
    v_and_b32 v12, 0xffff0000, v11
    v_lshlrev_b32 v11, 16, v11
    v_and_b32 v14, 0xffff0000, v13
    v_lshlrev_b32 v13, 16, v13
    v_lshlrev_b32 v15, 16, v136
    v_and_b32 v16, 0xffff0000, v136
    v_lshlrev_b32 v17, 16, v137
    v_and_b32 v18, 0xffff0000, v137
    v_mov_b32 v9, s37
    v_mul_f32 v19, v15, v15
    v_mul_f32 v132, v16, v16
    v_mul_f32 v133, v17, v17
    v_mul_f32 v134, v18, v18
    v_fma_f32 v19, v19, s38, v9
    v_fma_f32 v132, v132, s38, v9
    v_fma_f32 v133, v133, s38, v9
    v_fma_f32 v134, v134, s38, v9
    v_mul_f32 v19, v19, v15
    v_mul_f32 v132, v132, v16
    v_mul_f32 v133, v133, v17
    v_mul_f32 v134, v134, v18
    v_exp_f32 v19, v19
    v_exp_f32 v132, v132
    v_exp_f32 v133, v133
    v_exp_f32 v134, v134
    v_add_f32 v19, 1.0, v19
    v_add_f32 v132, 1.0, v132
    v_add_f32 v133, 1.0, v133
    v_add_f32 v134, 1.0, v134
    v_rcp_f32 v19, v19
    v_rcp_f32 v132, v132
    v_rcp_f32 v133, v133
    v_rcp_f32 v134, v134
    v_mul_f32 v19, v19, v15
    v_mul_f32 v132, v132, v16
    v_mul_f32 v133, v133, v17
    v_mul_f32 v134, v134, v18
    v_cvt_pk_bf16_f32 v8, v19, v132
    v_cvt_pk_bf16_f32 v9, v133, v134
    v_lshlrev_b32 v19, 16, v8
    v_and_b32 v132, 0xffff0000, v8
    v_lshlrev_b32 v133, 16, v9
    v_and_b32 v134, 0xffff0000, v9
    v_mul_f32 v19, v19, v11
    v_mul_f32 v132, v132, v12
    v_mul_f32 v133, v133, v13
    v_mul_f32 v134, v134, v14
    v_cvt_pk_bf16_f32 v152, v19, v132
    v_cvt_pk_bf16_f32 v153, v133, v134
    v_add_u32 v135, 229376, v10
    buffer_store_dwordx2 v[152:153], v135, s[28:31], s26 offen offset:192
    v_cvt_pk_bf16_f32 v11, v104, v105
    v_cvt_pk_bf16_f32 v13, v106, v107
    v_and_b32 v12, 0xffff0000, v11
    v_lshlrev_b32 v11, 16, v11
    v_and_b32 v14, 0xffff0000, v13
    v_lshlrev_b32 v13, 16, v13
    v_lshlrev_b32 v15, 16, v138
    v_and_b32 v16, 0xffff0000, v138
    v_lshlrev_b32 v17, 16, v139
    v_and_b32 v18, 0xffff0000, v139
    v_mov_b32 v9, s37
    v_mul_f32 v19, v15, v15
    v_mul_f32 v132, v16, v16
    v_mul_f32 v133, v17, v17
    v_mul_f32 v134, v18, v18
    v_fma_f32 v19, v19, s38, v9
    v_fma_f32 v132, v132, s38, v9
    v_fma_f32 v133, v133, s38, v9
    v_fma_f32 v134, v134, s38, v9
    v_mul_f32 v19, v19, v15
    v_mul_f32 v132, v132, v16
    v_mul_f32 v133, v133, v17
    v_mul_f32 v134, v134, v18
    v_exp_f32 v19, v19
    v_exp_f32 v132, v132
    v_exp_f32 v133, v133
    v_exp_f32 v134, v134
    v_add_f32 v19, 1.0, v19
    v_add_f32 v132, 1.0, v132
    v_add_f32 v133, 1.0, v133
    v_add_f32 v134, 1.0, v134
    v_rcp_f32 v19, v19
    v_rcp_f32 v132, v132
    v_rcp_f32 v133, v133
    v_rcp_f32 v134, v134
    v_mul_f32 v19, v19, v15
    v_mul_f32 v132, v132, v16
    v_mul_f32 v133, v133, v17
    v_mul_f32 v134, v134, v18
    v_cvt_pk_bf16_f32 v8, v19, v132
    v_cvt_pk_bf16_f32 v9, v133, v134
    v_lshlrev_b32 v19, 16, v8
    v_and_b32 v132, 0xffff0000, v8
    v_lshlrev_b32 v133, 16, v9
    v_and_b32 v134, 0xffff0000, v9
    v_mul_f32 v19, v19, v11
    v_mul_f32 v132, v132, v12
    v_mul_f32 v133, v133, v13
    v_mul_f32 v134, v134, v14
    v_cvt_pk_bf16_f32 v136, v19, v132
    v_cvt_pk_bf16_f32 v137, v133, v134
    v_add_u32 v135, 344064, v10
    buffer_store_dwordx2 v[136:137], v135, s[28:31], s26 offen offset:0
    v_cvt_pk_bf16_f32 v11, v108, v109
    v_cvt_pk_bf16_f32 v13, v110, v111
    v_and_b32 v12, 0xffff0000, v11
    v_lshlrev_b32 v11, 16, v11
    v_and_b32 v14, 0xffff0000, v13
    v_lshlrev_b32 v13, 16, v13
    v_lshlrev_b32 v15, 16, v140
    v_and_b32 v16, 0xffff0000, v140
    v_lshlrev_b32 v17, 16, v141
    v_and_b32 v18, 0xffff0000, v141
    v_mov_b32 v9, s37
    v_mul_f32 v19, v15, v15
    v_mul_f32 v132, v16, v16
    v_mul_f32 v133, v17, v17
    v_mul_f32 v134, v18, v18
    v_fma_f32 v19, v19, s38, v9
    v_fma_f32 v132, v132, s38, v9
    v_fma_f32 v133, v133, s38, v9
    v_fma_f32 v134, v134, s38, v9
    v_mul_f32 v19, v19, v15
    v_mul_f32 v132, v132, v16
    v_mul_f32 v133, v133, v17
    v_mul_f32 v134, v134, v18
    v_exp_f32 v19, v19
    v_exp_f32 v132, v132
    v_exp_f32 v133, v133
    v_exp_f32 v134, v134
    v_add_f32 v19, 1.0, v19
    v_add_f32 v132, 1.0, v132
    v_add_f32 v133, 1.0, v133
    v_add_f32 v134, 1.0, v134
    v_rcp_f32 v19, v19
    v_rcp_f32 v132, v132
    v_rcp_f32 v133, v133
    v_rcp_f32 v134, v134
    v_mul_f32 v19, v19, v15
    v_mul_f32 v132, v132, v16
    v_mul_f32 v133, v133, v17
    v_mul_f32 v134, v134, v18
    v_cvt_pk_bf16_f32 v8, v19, v132
    v_cvt_pk_bf16_f32 v9, v133, v134
    v_lshlrev_b32 v19, 16, v8
    v_and_b32 v132, 0xffff0000, v8
    v_lshlrev_b32 v133, 16, v9
    v_and_b32 v134, 0xffff0000, v9
    v_mul_f32 v19, v19, v11
    v_mul_f32 v132, v132, v12
    v_mul_f32 v133, v133, v13
    v_mul_f32 v134, v134, v14
    v_cvt_pk_bf16_f32 v136, v19, v132
    v_cvt_pk_bf16_f32 v137, v133, v134
    v_add_u32 v135, 344064, v10
    buffer_store_dwordx2 v[136:137], v135, s[28:31], s26 offen offset:32
    v_cvt_pk_bf16_f32 v11, v112, v113
    v_cvt_pk_bf16_f32 v13, v114, v115
    v_and_b32 v12, 0xffff0000, v11
    v_lshlrev_b32 v11, 16, v11
    v_and_b32 v14, 0xffff0000, v13
    v_lshlrev_b32 v13, 16, v13
    v_lshlrev_b32 v15, 16, v142
    v_and_b32 v16, 0xffff0000, v142
    v_lshlrev_b32 v17, 16, v143
    v_and_b32 v18, 0xffff0000, v143
    v_mov_b32 v9, s37
    v_mul_f32 v19, v15, v15
    v_mul_f32 v132, v16, v16
    v_mul_f32 v133, v17, v17
    v_mul_f32 v134, v18, v18
    v_fma_f32 v19, v19, s38, v9
    v_fma_f32 v132, v132, s38, v9
    v_fma_f32 v133, v133, s38, v9
    v_fma_f32 v134, v134, s38, v9
    v_mul_f32 v19, v19, v15
    v_mul_f32 v132, v132, v16
    v_mul_f32 v133, v133, v17
    v_mul_f32 v134, v134, v18
    v_exp_f32 v19, v19
    v_exp_f32 v132, v132
    v_exp_f32 v133, v133
    v_exp_f32 v134, v134
    v_add_f32 v19, 1.0, v19
    v_add_f32 v132, 1.0, v132
    v_add_f32 v133, 1.0, v133
    v_add_f32 v134, 1.0, v134
    v_rcp_f32 v19, v19
    v_rcp_f32 v132, v132
    v_rcp_f32 v133, v133
    v_rcp_f32 v134, v134
    v_mul_f32 v19, v19, v15
    v_mul_f32 v132, v132, v16
    v_mul_f32 v133, v133, v17
    v_mul_f32 v134, v134, v18
    v_cvt_pk_bf16_f32 v8, v19, v132
    v_cvt_pk_bf16_f32 v9, v133, v134
    v_lshlrev_b32 v19, 16, v8
    v_and_b32 v132, 0xffff0000, v8
    v_lshlrev_b32 v133, 16, v9
    v_and_b32 v134, 0xffff0000, v9
    v_mul_f32 v19, v19, v11
    v_mul_f32 v132, v132, v12
    v_mul_f32 v133, v133, v13
    v_mul_f32 v134, v134, v14
    v_cvt_pk_bf16_f32 v136, v19, v132
    v_cvt_pk_bf16_f32 v137, v133, v134
    v_add_u32 v135, 344064, v10
    buffer_store_dwordx2 v[136:137], v135, s[28:31], s26 offen offset:64
    v_cvt_pk_bf16_f32 v11, v116, v117
    v_cvt_pk_bf16_f32 v13, v118, v119
    v_and_b32 v12, 0xffff0000, v11
    v_lshlrev_b32 v11, 16, v11
    v_and_b32 v14, 0xffff0000, v13
    v_lshlrev_b32 v13, 16, v13
    v_lshlrev_b32 v15, 16, v144
    v_and_b32 v16, 0xffff0000, v144
    v_lshlrev_b32 v17, 16, v145
    v_and_b32 v18, 0xffff0000, v145
    v_mov_b32 v9, s37
    v_mul_f32 v19, v15, v15
    v_mul_f32 v132, v16, v16
    v_mul_f32 v133, v17, v17
    v_mul_f32 v134, v18, v18
    v_fma_f32 v19, v19, s38, v9
    v_fma_f32 v132, v132, s38, v9
    v_fma_f32 v133, v133, s38, v9
    v_fma_f32 v134, v134, s38, v9
    v_mul_f32 v19, v19, v15
    v_mul_f32 v132, v132, v16
    v_mul_f32 v133, v133, v17
    v_mul_f32 v134, v134, v18
    v_exp_f32 v19, v19
    v_exp_f32 v132, v132
    v_exp_f32 v133, v133
    v_exp_f32 v134, v134
    v_add_f32 v19, 1.0, v19
    v_add_f32 v132, 1.0, v132
    v_add_f32 v133, 1.0, v133
    v_add_f32 v134, 1.0, v134
    v_rcp_f32 v19, v19
    v_rcp_f32 v132, v132
    v_rcp_f32 v133, v133
    v_rcp_f32 v134, v134
    v_mul_f32 v19, v19, v15
    v_mul_f32 v132, v132, v16
    v_mul_f32 v133, v133, v17
    v_mul_f32 v134, v134, v18
    v_cvt_pk_bf16_f32 v8, v19, v132
    v_cvt_pk_bf16_f32 v9, v133, v134
    v_lshlrev_b32 v19, 16, v8
    v_and_b32 v132, 0xffff0000, v8
    v_lshlrev_b32 v133, 16, v9
    v_and_b32 v134, 0xffff0000, v9
    v_mul_f32 v19, v19, v11
    v_mul_f32 v132, v132, v12
    v_mul_f32 v133, v133, v13
    v_mul_f32 v134, v134, v14
    v_cvt_pk_bf16_f32 v136, v19, v132
    v_cvt_pk_bf16_f32 v137, v133, v134
    v_add_u32 v135, 344064, v10
    buffer_store_dwordx2 v[136:137], v135, s[28:31], s26 offen offset:96
    v_cvt_pk_bf16_f32 v11, v120, v121
    v_cvt_pk_bf16_f32 v13, v122, v123
    v_and_b32 v12, 0xffff0000, v11
    v_lshlrev_b32 v11, 16, v11
    v_and_b32 v14, 0xffff0000, v13
    v_lshlrev_b32 v13, 16, v13
    v_lshlrev_b32 v15, 16, v146
    v_and_b32 v16, 0xffff0000, v146
    v_lshlrev_b32 v17, 16, v147
    v_and_b32 v18, 0xffff0000, v147
    v_mov_b32 v9, s37
    v_mul_f32 v19, v15, v15
    v_mul_f32 v132, v16, v16
    v_mul_f32 v133, v17, v17
    v_mul_f32 v134, v18, v18
    v_fma_f32 v19, v19, s38, v9
    v_fma_f32 v132, v132, s38, v9
    v_fma_f32 v133, v133, s38, v9
    v_fma_f32 v134, v134, s38, v9
    v_mul_f32 v19, v19, v15
    v_mul_f32 v132, v132, v16
    v_mul_f32 v133, v133, v17
    v_mul_f32 v134, v134, v18
    v_exp_f32 v19, v19
    v_exp_f32 v132, v132
    v_exp_f32 v133, v133
    v_exp_f32 v134, v134
    v_add_f32 v19, 1.0, v19
    v_add_f32 v132, 1.0, v132
    v_add_f32 v133, 1.0, v133
    v_add_f32 v134, 1.0, v134
    v_rcp_f32 v19, v19
    v_rcp_f32 v132, v132
    v_rcp_f32 v133, v133
    v_rcp_f32 v134, v134
    v_mul_f32 v19, v19, v15
    v_mul_f32 v132, v132, v16
    v_mul_f32 v133, v133, v17
    v_mul_f32 v134, v134, v18
    v_cvt_pk_bf16_f32 v8, v19, v132
    v_cvt_pk_bf16_f32 v9, v133, v134
    v_lshlrev_b32 v19, 16, v8
    v_and_b32 v132, 0xffff0000, v8
    v_lshlrev_b32 v133, 16, v9
    v_and_b32 v134, 0xffff0000, v9
    v_mul_f32 v19, v19, v11
    v_mul_f32 v132, v132, v12
    v_mul_f32 v133, v133, v13
    v_mul_f32 v134, v134, v14
    v_cvt_pk_bf16_f32 v136, v19, v132
    v_cvt_pk_bf16_f32 v137, v133, v134
    v_add_u32 v135, 344064, v10
    buffer_store_dwordx2 v[136:137], v135, s[28:31], s26 offen offset:128
    v_cvt_pk_bf16_f32 v11, v124, v125
    v_cvt_pk_bf16_f32 v13, v126, v127
    v_and_b32 v12, 0xffff0000, v11
    v_lshlrev_b32 v11, 16, v11
    v_and_b32 v14, 0xffff0000, v13
    v_lshlrev_b32 v13, 16, v13
    v_lshlrev_b32 v15, 16, v148
    v_and_b32 v16, 0xffff0000, v148
    v_lshlrev_b32 v17, 16, v149
    v_and_b32 v18, 0xffff0000, v149
    v_mov_b32 v9, s37
    v_mul_f32 v19, v15, v15
    v_mul_f32 v132, v16, v16
    v_mul_f32 v133, v17, v17
    v_mul_f32 v134, v18, v18
    v_fma_f32 v19, v19, s38, v9
    v_fma_f32 v132, v132, s38, v9
    v_fma_f32 v133, v133, s38, v9
    v_fma_f32 v134, v134, s38, v9
    v_mul_f32 v19, v19, v15
    v_mul_f32 v132, v132, v16
    v_mul_f32 v133, v133, v17
    v_mul_f32 v134, v134, v18
    v_exp_f32 v19, v19
    v_exp_f32 v132, v132
    v_exp_f32 v133, v133
    v_exp_f32 v134, v134
    v_add_f32 v19, 1.0, v19
    v_add_f32 v132, 1.0, v132
    v_add_f32 v133, 1.0, v133
    v_add_f32 v134, 1.0, v134
    v_rcp_f32 v19, v19
    v_rcp_f32 v132, v132
    v_rcp_f32 v133, v133
    v_rcp_f32 v134, v134
    v_mul_f32 v19, v19, v15
    v_mul_f32 v132, v132, v16
    v_mul_f32 v133, v133, v17
    v_mul_f32 v134, v134, v18
    v_cvt_pk_bf16_f32 v8, v19, v132
    v_cvt_pk_bf16_f32 v9, v133, v134
    v_lshlrev_b32 v19, 16, v8
    v_and_b32 v132, 0xffff0000, v8
    v_lshlrev_b32 v133, 16, v9
    v_and_b32 v134, 0xffff0000, v9
    v_mul_f32 v19, v19, v11
    v_mul_f32 v132, v132, v12
    v_mul_f32 v133, v133, v13
    v_mul_f32 v134, v134, v14
    v_cvt_pk_bf16_f32 v136, v19, v132
    v_cvt_pk_bf16_f32 v137, v133, v134
    v_add_u32 v135, 344064, v10
    buffer_store_dwordx2 v[136:137], v135, s[28:31], s26 offen offset:160
    v_cvt_pk_bf16_f32 v11, v128, v129
    v_cvt_pk_bf16_f32 v13, v130, v131
    v_and_b32 v12, 0xffff0000, v11
    v_lshlrev_b32 v11, 16, v11
    v_and_b32 v14, 0xffff0000, v13
    v_lshlrev_b32 v13, 16, v13
    v_lshlrev_b32 v15, 16, v150
    v_and_b32 v16, 0xffff0000, v150
    v_lshlrev_b32 v17, 16, v151
    v_and_b32 v18, 0xffff0000, v151
    v_mov_b32 v9, s37
    v_mul_f32 v19, v15, v15
    v_mul_f32 v132, v16, v16
    v_mul_f32 v133, v17, v17
    v_mul_f32 v134, v18, v18
    v_fma_f32 v19, v19, s38, v9
    v_fma_f32 v132, v132, s38, v9
    v_fma_f32 v133, v133, s38, v9
    v_fma_f32 v134, v134, s38, v9
    v_mul_f32 v19, v19, v15
    v_mul_f32 v132, v132, v16
    v_mul_f32 v133, v133, v17
    v_mul_f32 v134, v134, v18
    v_exp_f32 v19, v19
    v_exp_f32 v132, v132
    v_exp_f32 v133, v133
    v_exp_f32 v134, v134
    v_add_f32 v19, 1.0, v19
    v_add_f32 v132, 1.0, v132
    v_add_f32 v133, 1.0, v133
    v_add_f32 v134, 1.0, v134
    v_rcp_f32 v19, v19
    v_rcp_f32 v132, v132
    v_rcp_f32 v133, v133
    v_rcp_f32 v134, v134
    v_mul_f32 v19, v19, v15
    v_mul_f32 v132, v132, v16
    v_mul_f32 v133, v133, v17
    v_mul_f32 v134, v134, v18
    v_cvt_pk_bf16_f32 v8, v19, v132
    v_cvt_pk_bf16_f32 v9, v133, v134
    v_lshlrev_b32 v19, 16, v8
    v_and_b32 v132, 0xffff0000, v8
    v_lshlrev_b32 v133, 16, v9
    v_and_b32 v134, 0xffff0000, v9
    v_mul_f32 v19, v19, v11
    v_mul_f32 v132, v132, v12
    v_mul_f32 v133, v133, v13
    v_mul_f32 v134, v134, v14
    v_cvt_pk_bf16_f32 v136, v19, v132
    v_cvt_pk_bf16_f32 v137, v133, v134
    v_add_u32 v135, 344064, v10
    buffer_store_dwordx2 v[136:137], v135, s[28:31], s26 offen offset:192
G1_FD:
    s_waitcnt vmcnt(0)
G1_END:
    s_endpgm
.globl k4_gemm2_kernel
.p2align 8
.type k4_gemm2_kernel,@function
k4_gemm2_kernel:
    s_cmp_ge_u32 s2, 256
    s_cbranch_scc1 G2_END
    s_load_dwordx2 s[4:5], s[0:1], 72
    s_load_dwordx2 s[6:7], s[0:1], 48
    s_load_dwordx2 s[8:9], s[0:1], 0
    s_load_dwordx2 s[10:11], s[0:1], 56
    v_and_b32 v1, 63, v0
    v_lshrrev_b32 v2, 6, v0
    s_nop 0
    v_readfirstlane_b32 s20, v2
    s_and_b32 s25, s2, 7
    s_lshr_b32 s26, s2, 3
    s_lshr_b32 s21, s25, 1
    s_lshl_b32 s21, s21, 2
    s_lshr_b32 s27, s26, 3
    s_add_u32 s21, s21, s27
    s_and_b32 s22, s25, 1
    s_lshl_b32 s22, s22, 3
    s_and_b32 s27, s26, 7
    s_add_u32 s22, s22, s27
    s_and_b32 s23, s20, 1
    s_lshr_b32 s24, s20, 1
    s_waitcnt lgkmcnt(0)
    s_add_u32 s12, s4, 67108864
    s_addc_u32 s13, s5, 0
    s_mov_b32 s14, 14680064
    s_mov_b32 s15, 0x00020000
    s_mov_b32 s16, s6
    s_mov_b32 s17, s7
    s_mov_b32 s18, 7340032
    s_mov_b32 s19, 0x00020000
    s_lshl_b32 s25, s21, 7
    v_lshrrev_b32 v3, 4, v1
    v_add_u32 v3, 0, v3
    v_and_b32 v4, 15, v1
    v_xor_b32 v4, v4, v3
    v_lshl_add_u32 v3, v2, 4, v3
    v_add_u32 v3, s25, v3
    s_mov_b32 s26, 7168
    v_mul_lo_u32 v6, v3, s26
    v_lshl_add_u32 v6, v4, 4, v6
    v_lshrrev_b32 v3, 4, v1
    v_add_u32 v3, 4, v3
    v_and_b32 v4, 15, v1
    v_xor_b32 v4, v4, v3
    v_lshl_add_u32 v3, v2, 4, v3
    v_add_u32 v3, s25, v3
    s_mov_b32 s26, 7168
    v_mul_lo_u32 v7, v3, s26
    v_lshl_add_u32 v7, v4, 4, v7
    v_lshrrev_b32 v3, 4, v1
    v_add_u32 v3, 8, v3
    v_and_b32 v4, 15, v1
    v_xor_b32 v4, v4, v3
    v_lshl_add_u32 v3, v2, 4, v3
    v_add_u32 v3, s25, v3
    s_mov_b32 s26, 7168
    v_mul_lo_u32 v8, v3, s26
    v_lshl_add_u32 v8, v4, 4, v8
    v_lshrrev_b32 v3, 4, v1
    v_add_u32 v3, 12, v3
    v_and_b32 v4, 15, v1
    v_xor_b32 v4, v4, v3
    v_lshl_add_u32 v3, v2, 4, v3
    v_add_u32 v3, s25, v3
    s_mov_b32 s26, 7168
    v_mul_lo_u32 v9, v3, s26
    v_lshl_add_u32 v9, v4, 4, v9
    v_lshrrev_b32 v3, 4, v1
    v_and_b32 v3, 1, v3
    v_and_b32 v4, 7, v1
    v_lshrrev_b32 v5, 1, v4
    v_xor_b32 v5, v5, v3
    v_lshlrev_b32 v5, 1, v5
    v_and_b32 v4, 1, v4
    v_or_b32 v5, v5, v4
    v_lshrrev_b32 v3, 3, v1
    v_lshl_add_u32 v3, v2, 4, v3
    v_lshlrev_b32 v10, 11, v3
    v_lshl_add_u32 v10, v5, 4, v10
    s_lshl_b32 s25, s22, 7
    v_add_u32 v10, s25, v10
    v_lshrrev_b32 v3, 4, v1
    v_and_b32 v3, 1, v3
    v_or_b32 v3, 2, v3
    v_and_b32 v4, 7, v1
    v_lshrrev_b32 v5, 1, v4
    v_xor_b32 v5, v5, v3
    v_lshlrev_b32 v5, 1, v5
    v_and_b32 v4, 1, v4
    v_or_b32 v5, v5, v4
    v_lshrrev_b32 v3, 3, v1
    v_lshl_add_u32 v3, v2, 4, v3
    v_add_u32 v3, 8, v3
    v_lshlrev_b32 v11, 11, v3
    v_lshl_add_u32 v11, v5, 4, v11
    s_lshl_b32 s25, s22, 7
    v_add_u32 v11, s25, v11
    s_lshl_b32 s32, s20, 12
    s_lshl_b32 s33, s20, 11
    s_add_u32 s33, s33, 32768
    s_mov_b32 s34, 0
    s_mov_b32 s35, 0
    v_lshrrev_b32 v3, 4, v1
    v_lshrrev_b32 v4, 2, v1
    v_and_b32 v4, 3, v4
    v_lshl_add_u32 v5, v3, 3, v4
    s_lshl_b32 s25, s24, 5
    v_add_u32 v5, s25, v5
    v_lshlrev_b32 v5, 7, v5
    v_lshrrev_b32 v27, 1, v4
    v_and_b32 v27, 1, v27
    v_and_b32 v3, 1, v3
    v_lshl_or_b32 v27, v3, 1, v27
    v_and_b32 v4, 3, v1
    v_lshl_add_u32 v5, v4, 3, v5
    v_xor_b32 v3, 0, v27
    v_lshl_add_u32 v12, v3, 5, v5
    v_add_u32 v12, 32768, v12
    v_add_u32 v16, 49152, v12
    v_add_u32 v20, 98304, v12
    v_xor_b32 v3, 1, v27
    v_lshl_add_u32 v13, v3, 5, v5
    v_add_u32 v13, 32768, v13
    v_add_u32 v17, 49152, v13
    v_add_u32 v21, 98304, v13
    v_xor_b32 v3, 2, v27
    v_lshl_add_u32 v14, v3, 5, v5
    v_add_u32 v14, 32768, v14
    v_add_u32 v18, 49152, v14
    v_add_u32 v22, 98304, v14
    v_xor_b32 v3, 3, v27
    v_lshl_add_u32 v15, v3, 5, v5
    v_add_u32 v15, 32768, v15
    v_add_u32 v19, 49152, v15
    v_add_u32 v23, 98304, v15
    v_and_b32 v3, 15, v1
    v_lshrrev_b32 v4, 4, v1
    s_lshl_b32 s25, s24, 2
    v_add_u32 v4, s25, v4
    v_xor_b32 v4, v4, v3
    s_lshl_b32 s25, s23, 6
    v_add_u32 v3, s25, v3
    v_lshlrev_b32 v24, 8, v3
    v_lshl_add_u32 v24, v4, 4, v24
    v_add_u32 v25, 49152, v24
    v_add_u32 v26, 98304, v24
    v_mov_b32 v28, 0
    v_mov_b32 v29, 0
    v_mov_b32 v30, 0
    v_mov_b32 v31, 0
    v_mov_b32 v32, 0
    v_mov_b32 v33, 0
    v_mov_b32 v34, 0
    v_mov_b32 v35, 0
    v_mov_b32 v36, 0
    v_mov_b32 v37, 0
    v_mov_b32 v38, 0
    v_mov_b32 v39, 0
    v_mov_b32 v40, 0
    v_mov_b32 v41, 0
    v_mov_b32 v42, 0
    v_mov_b32 v43, 0
    v_mov_b32 v44, 0
    v_mov_b32 v45, 0
    v_mov_b32 v46, 0
    v_mov_b32 v47, 0
    v_mov_b32 v48, 0
    v_mov_b32 v49, 0
    v_mov_b32 v50, 0
    v_mov_b32 v51, 0
    v_mov_b32 v52, 0
    v_mov_b32 v53, 0
    v_mov_b32 v54, 0
    v_mov_b32 v55, 0
    v_mov_b32 v56, 0
    v_mov_b32 v57, 0
    v_mov_b32 v58, 0
    v_mov_b32 v59, 0
    v_mov_b32 v60, 0
    v_mov_b32 v61, 0
    v_mov_b32 v62, 0
    v_mov_b32 v63, 0
    v_mov_b32 v64, 0
    v_mov_b32 v65, 0
    v_mov_b32 v66, 0
    v_mov_b32 v67, 0
    v_mov_b32 v68, 0
    v_mov_b32 v69, 0
    v_mov_b32 v70, 0
    v_mov_b32 v71, 0
    v_mov_b32 v72, 0
    v_mov_b32 v73, 0
    v_mov_b32 v74, 0
    v_mov_b32 v75, 0
    v_mov_b32 v76, 0
    v_mov_b32 v77, 0
    v_mov_b32 v78, 0
    v_mov_b32 v79, 0
    v_mov_b32 v80, 0
    v_mov_b32 v81, 0
    v_mov_b32 v82, 0
    v_mov_b32 v83, 0
    v_mov_b32 v84, 0
    v_mov_b32 v85, 0
    v_mov_b32 v86, 0
    v_mov_b32 v87, 0
    v_mov_b32 v88, 0
    v_mov_b32 v89, 0
    v_mov_b32 v90, 0
    v_mov_b32 v91, 0
    s_add_u32 m0, s32, 0
    s_nop 0
    buffer_load_dwordx4 v6, s[12:15], s34 offen lds
    s_add_u32 m0, s32, 1024
    s_nop 0
    buffer_load_dwordx4 v7, s[12:15], s34 offen lds
    s_add_u32 m0, s32, 2048
    s_nop 0
    buffer_load_dwordx4 v8, s[12:15], s34 offen lds
    s_add_u32 m0, s32, 3072
    s_nop 0
    buffer_load_dwordx4 v9, s[12:15], s34 offen lds
    s_add_u32 m0, s33, 0
    s_nop 0
    buffer_load_dwordx4 v10, s[16:19], s35 offen lds
    s_add_u32 m0, s33, 1024
    s_nop 0
    buffer_load_dwordx4 v11, s[16:19], s35 offen lds
    s_add_u32 s34, s34, 256
    s_add_u32 s35, s35, 262144
    s_add_u32 m0, s32, 49152
    s_nop 0
    buffer_load_dwordx4 v6, s[12:15], s34 offen lds
    s_add_u32 m0, s32, 50176
    s_nop 0
    buffer_load_dwordx4 v7, s[12:15], s34 offen lds
    s_add_u32 m0, s32, 51200
    s_nop 0
    buffer_load_dwordx4 v8, s[12:15], s34 offen lds
    s_add_u32 m0, s32, 52224
    s_nop 0
    buffer_load_dwordx4 v9, s[12:15], s34 offen lds
    s_add_u32 m0, s33, 49152
    s_nop 0
    buffer_load_dwordx4 v10, s[16:19], s35 offen lds
    s_add_u32 m0, s33, 50176
    s_nop 0
    buffer_load_dwordx4 v11, s[16:19], s35 offen lds
    s_add_u32 s34, s34, 256
    s_add_u32 s35, s35, 262144
    s_waitcnt vmcnt(6)
    s_barrier
    s_mov_b32 s36, 0
G2_LOOP:
    s_add_u32 m0, s32, 98304
    s_nop 0
    buffer_load_dwordx4 v6, s[12:15], s34 offen lds
    s_add_u32 m0, s32, 99328
    s_nop 0
    buffer_load_dwordx4 v7, s[12:15], s34 offen lds
    s_add_u32 m0, s32, 100352
    s_nop 0
    buffer_load_dwordx4 v8, s[12:15], s34 offen lds
    s_add_u32 m0, s32, 101376
    s_nop 0
    buffer_load_dwordx4 v9, s[12:15], s34 offen lds
    s_add_u32 m0, s33, 98304
    s_nop 0
    buffer_load_dwordx4 v10, s[16:19], s35 offen lds
    s_add_u32 m0, s33, 99328
    s_nop 0
    buffer_load_dwordx4 v11, s[16:19], s35 offen lds
    s_add_u32 s34, s34, 256
    s_add_u32 s35, s35, 262144
    ds_read_b128 v[92:95], v24 offset:0
    ds_read_b128 v[96:99], v24 offset:4096
    ds_read_b128 v[100:103], v24 offset:8192
    ds_read_b128 v[104:107], v24 offset:12288
    ds_read_b64_tr_b16 v[108:109], v12
    ds_read_b64_tr_b16 v[110:111], v12 offset:512
    ds_read_b64_tr_b16 v[112:113], v13
    ds_read_b64_tr_b16 v[114:115], v13 offset:512
    ds_read_b64_tr_b16 v[116:117], v14
    ds_read_b64_tr_b16 v[118:119], v14 offset:512
    ds_read_b64_tr_b16 v[120:121], v15
    ds_read_b64_tr_b16 v[122:123], v15 offset:512
    s_waitcnt lgkmcnt(0)
    v_mfma_f32_16x16x32_bf16 v[28:31], v[108:111], v[92:95], v[28:31]
    v_mfma_f32_16x16x32_bf16 v[32:35], v[112:115], v[92:95], v[32:35]
    v_mfma_f32_16x16x32_bf16 v[36:39], v[116:119], v[92:95], v[36:39]
    v_mfma_f32_16x16x32_bf16 v[40:43], v[120:123], v[92:95], v[40:43]
    v_mfma_f32_16x16x32_bf16 v[44:47], v[108:111], v[96:99], v[44:47]
    v_mfma_f32_16x16x32_bf16 v[48:51], v[112:115], v[96:99], v[48:51]
    v_mfma_f32_16x16x32_bf16 v[52:55], v[116:119], v[96:99], v[52:55]
    v_mfma_f32_16x16x32_bf16 v[56:59], v[120:123], v[96:99], v[56:59]
    v_mfma_f32_16x16x32_bf16 v[60:63], v[108:111], v[100:103], v[60:63]
    v_mfma_f32_16x16x32_bf16 v[64:67], v[112:115], v[100:103], v[64:67]
    v_mfma_f32_16x16x32_bf16 v[68:71], v[116:119], v[100:103], v[68:71]
    v_mfma_f32_16x16x32_bf16 v[72:75], v[120:123], v[100:103], v[72:75]
    v_mfma_f32_16x16x32_bf16 v[76:79], v[108:111], v[104:107], v[76:79]
    v_mfma_f32_16x16x32_bf16 v[80:83], v[112:115], v[104:107], v[80:83]
    v_mfma_f32_16x16x32_bf16 v[84:87], v[116:119], v[104:107], v[84:87]
    v_mfma_f32_16x16x32_bf16 v[88:91], v[120:123], v[104:107], v[88:91]
    s_waitcnt vmcnt(6)
    s_barrier
    s_add_u32 m0, s32, 0
    s_nop 0
    buffer_load_dwordx4 v6, s[12:15], s34 offen lds
    s_add_u32 m0, s32, 1024
    s_nop 0
    buffer_load_dwordx4 v7, s[12:15], s34 offen lds
    s_add_u32 m0, s32, 2048
    s_nop 0
    buffer_load_dwordx4 v8, s[12:15], s34 offen lds
    s_add_u32 m0, s32, 3072
    s_nop 0
    buffer_load_dwordx4 v9, s[12:15], s34 offen lds
    s_add_u32 m0, s33, 0
    s_nop 0
    buffer_load_dwordx4 v10, s[16:19], s35 offen lds
    s_add_u32 m0, s33, 1024
    s_nop 0
    buffer_load_dwordx4 v11, s[16:19], s35 offen lds
    s_add_u32 s34, s34, 256
    s_add_u32 s35, s35, 262144
    ds_read_b128 v[92:95], v25 offset:0
    ds_read_b128 v[96:99], v25 offset:4096
    ds_read_b128 v[100:103], v25 offset:8192
    ds_read_b128 v[104:107], v25 offset:12288
    ds_read_b64_tr_b16 v[108:109], v16
    ds_read_b64_tr_b16 v[110:111], v16 offset:512
    ds_read_b64_tr_b16 v[112:113], v17
    ds_read_b64_tr_b16 v[114:115], v17 offset:512
    ds_read_b64_tr_b16 v[116:117], v18
    ds_read_b64_tr_b16 v[118:119], v18 offset:512
    ds_read_b64_tr_b16 v[120:121], v19
    ds_read_b64_tr_b16 v[122:123], v19 offset:512
    s_waitcnt lgkmcnt(0)
    v_mfma_f32_16x16x32_bf16 v[28:31], v[108:111], v[92:95], v[28:31]
    v_mfma_f32_16x16x32_bf16 v[32:35], v[112:115], v[92:95], v[32:35]
    v_mfma_f32_16x16x32_bf16 v[36:39], v[116:119], v[92:95], v[36:39]
    v_mfma_f32_16x16x32_bf16 v[40:43], v[120:123], v[92:95], v[40:43]
    v_mfma_f32_16x16x32_bf16 v[44:47], v[108:111], v[96:99], v[44:47]
    v_mfma_f32_16x16x32_bf16 v[48:51], v[112:115], v[96:99], v[48:51]
    v_mfma_f32_16x16x32_bf16 v[52:55], v[116:119], v[96:99], v[52:55]
    v_mfma_f32_16x16x32_bf16 v[56:59], v[120:123], v[96:99], v[56:59]
    v_mfma_f32_16x16x32_bf16 v[60:63], v[108:111], v[100:103], v[60:63]
    v_mfma_f32_16x16x32_bf16 v[64:67], v[112:115], v[100:103], v[64:67]
    v_mfma_f32_16x16x32_bf16 v[68:71], v[116:119], v[100:103], v[68:71]
    v_mfma_f32_16x16x32_bf16 v[72:75], v[120:123], v[100:103], v[72:75]
    v_mfma_f32_16x16x32_bf16 v[76:79], v[108:111], v[104:107], v[76:79]
    v_mfma_f32_16x16x32_bf16 v[80:83], v[112:115], v[104:107], v[80:83]
    v_mfma_f32_16x16x32_bf16 v[84:87], v[116:119], v[104:107], v[84:87]
    v_mfma_f32_16x16x32_bf16 v[88:91], v[120:123], v[104:107], v[88:91]
    s_waitcnt vmcnt(6)
    s_barrier
    s_add_u32 m0, s32, 49152
    s_nop 0
    buffer_load_dwordx4 v6, s[12:15], s34 offen lds
    s_add_u32 m0, s32, 50176
    s_nop 0
    buffer_load_dwordx4 v7, s[12:15], s34 offen lds
    s_add_u32 m0, s32, 51200
    s_nop 0
    buffer_load_dwordx4 v8, s[12:15], s34 offen lds
    s_add_u32 m0, s32, 52224
    s_nop 0
    buffer_load_dwordx4 v9, s[12:15], s34 offen lds
    s_add_u32 m0, s33, 49152
    s_nop 0
    buffer_load_dwordx4 v10, s[16:19], s35 offen lds
    s_add_u32 m0, s33, 50176
    s_nop 0
    buffer_load_dwordx4 v11, s[16:19], s35 offen lds
    s_add_u32 s34, s34, 256
    s_add_u32 s35, s35, 262144
    ds_read_b128 v[92:95], v26 offset:0
    ds_read_b128 v[96:99], v26 offset:4096
    ds_read_b128 v[100:103], v26 offset:8192
    ds_read_b128 v[104:107], v26 offset:12288
    ds_read_b64_tr_b16 v[108:109], v20
    ds_read_b64_tr_b16 v[110:111], v20 offset:512
    ds_read_b64_tr_b16 v[112:113], v21
    ds_read_b64_tr_b16 v[114:115], v21 offset:512
    ds_read_b64_tr_b16 v[116:117], v22
    ds_read_b64_tr_b16 v[118:119], v22 offset:512
    ds_read_b64_tr_b16 v[120:121], v23
    ds_read_b64_tr_b16 v[122:123], v23 offset:512
    s_waitcnt lgkmcnt(0)
    v_mfma_f32_16x16x32_bf16 v[28:31], v[108:111], v[92:95], v[28:31]
    v_mfma_f32_16x16x32_bf16 v[32:35], v[112:115], v[92:95], v[32:35]
    v_mfma_f32_16x16x32_bf16 v[36:39], v[116:119], v[92:95], v[36:39]
    v_mfma_f32_16x16x32_bf16 v[40:43], v[120:123], v[92:95], v[40:43]
    v_mfma_f32_16x16x32_bf16 v[44:47], v[108:111], v[96:99], v[44:47]
    v_mfma_f32_16x16x32_bf16 v[48:51], v[112:115], v[96:99], v[48:51]
    v_mfma_f32_16x16x32_bf16 v[52:55], v[116:119], v[96:99], v[52:55]
    v_mfma_f32_16x16x32_bf16 v[56:59], v[120:123], v[96:99], v[56:59]
    v_mfma_f32_16x16x32_bf16 v[60:63], v[108:111], v[100:103], v[60:63]
    v_mfma_f32_16x16x32_bf16 v[64:67], v[112:115], v[100:103], v[64:67]
    v_mfma_f32_16x16x32_bf16 v[68:71], v[116:119], v[100:103], v[68:71]
    v_mfma_f32_16x16x32_bf16 v[72:75], v[120:123], v[100:103], v[72:75]
    v_mfma_f32_16x16x32_bf16 v[76:79], v[108:111], v[104:107], v[76:79]
    v_mfma_f32_16x16x32_bf16 v[80:83], v[112:115], v[104:107], v[80:83]
    v_mfma_f32_16x16x32_bf16 v[84:87], v[116:119], v[104:107], v[84:87]
    v_mfma_f32_16x16x32_bf16 v[88:91], v[120:123], v[104:107], v[88:91]
    s_waitcnt vmcnt(6)
    s_barrier
    s_add_u32 s36, s36, 1
    s_cmp_lt_u32 s36, 8
    s_cbranch_scc1 G2_LOOP
    s_add_u32 m0, s32, 98304
    s_nop 0
    buffer_load_dwordx4 v6, s[12:15], s34 offen lds
    s_add_u32 m0, s32, 99328
    s_nop 0
    buffer_load_dwordx4 v7, s[12:15], s34 offen lds
    s_add_u32 m0, s32, 100352
    s_nop 0
    buffer_load_dwordx4 v8, s[12:15], s34 offen lds
    s_add_u32 m0, s32, 101376
    s_nop 0
    buffer_load_dwordx4 v9, s[12:15], s34 offen lds
    s_add_u32 m0, s33, 98304
    s_nop 0
    buffer_load_dwordx4 v10, s[16:19], s35 offen lds
    s_add_u32 m0, s33, 99328
    s_nop 0
    buffer_load_dwordx4 v11, s[16:19], s35 offen lds
    s_add_u32 s34, s34, 256
    s_add_u32 s35, s35, 262144
    ds_read_b128 v[92:95], v24 offset:0
    ds_read_b128 v[96:99], v24 offset:4096
    ds_read_b128 v[100:103], v24 offset:8192
    ds_read_b128 v[104:107], v24 offset:12288
    ds_read_b64_tr_b16 v[108:109], v12
    ds_read_b64_tr_b16 v[110:111], v12 offset:512
    ds_read_b64_tr_b16 v[112:113], v13
    ds_read_b64_tr_b16 v[114:115], v13 offset:512
    ds_read_b64_tr_b16 v[116:117], v14
    ds_read_b64_tr_b16 v[118:119], v14 offset:512
    ds_read_b64_tr_b16 v[120:121], v15
    ds_read_b64_tr_b16 v[122:123], v15 offset:512
    s_waitcnt lgkmcnt(0)
    v_mfma_f32_16x16x32_bf16 v[28:31], v[108:111], v[92:95], v[28:31]
    v_mfma_f32_16x16x32_bf16 v[32:35], v[112:115], v[92:95], v[32:35]
    v_mfma_f32_16x16x32_bf16 v[36:39], v[116:119], v[92:95], v[36:39]
    v_mfma_f32_16x16x32_bf16 v[40:43], v[120:123], v[92:95], v[40:43]
    v_mfma_f32_16x16x32_bf16 v[44:47], v[108:111], v[96:99], v[44:47]
    v_mfma_f32_16x16x32_bf16 v[48:51], v[112:115], v[96:99], v[48:51]
    v_mfma_f32_16x16x32_bf16 v[52:55], v[116:119], v[96:99], v[52:55]
    v_mfma_f32_16x16x32_bf16 v[56:59], v[120:123], v[96:99], v[56:59]
    v_mfma_f32_16x16x32_bf16 v[60:63], v[108:111], v[100:103], v[60:63]
    v_mfma_f32_16x16x32_bf16 v[64:67], v[112:115], v[100:103], v[64:67]
    v_mfma_f32_16x16x32_bf16 v[68:71], v[116:119], v[100:103], v[68:71]
    v_mfma_f32_16x16x32_bf16 v[72:75], v[120:123], v[100:103], v[72:75]
    v_mfma_f32_16x16x32_bf16 v[76:79], v[108:111], v[104:107], v[76:79]
    v_mfma_f32_16x16x32_bf16 v[80:83], v[112:115], v[104:107], v[80:83]
    v_mfma_f32_16x16x32_bf16 v[84:87], v[116:119], v[104:107], v[84:87]
    v_mfma_f32_16x16x32_bf16 v[88:91], v[120:123], v[104:107], v[88:91]
    s_waitcnt vmcnt(6)
    s_barrier
    s_add_u32 m0, s32, 0
    s_nop 0
    buffer_load_dwordx4 v6, s[12:15], s34 offen lds
    s_add_u32 m0, s32, 1024
    s_nop 0
    buffer_load_dwordx4 v7, s[12:15], s34 offen lds
    s_add_u32 m0, s32, 2048
    s_nop 0
    buffer_load_dwordx4 v8, s[12:15], s34 offen lds
    s_add_u32 m0, s32, 3072
    s_nop 0
    buffer_load_dwordx4 v9, s[12:15], s34 offen lds
    s_add_u32 m0, s33, 0
    s_nop 0
    buffer_load_dwordx4 v10, s[16:19], s35 offen lds
    s_add_u32 m0, s33, 1024
    s_nop 0
    buffer_load_dwordx4 v11, s[16:19], s35 offen lds
    s_add_u32 s34, s34, 256
    s_add_u32 s35, s35, 262144
    ds_read_b128 v[92:95], v25 offset:0
    ds_read_b128 v[96:99], v25 offset:4096
    ds_read_b128 v[100:103], v25 offset:8192
    ds_read_b128 v[104:107], v25 offset:12288
    ds_read_b64_tr_b16 v[108:109], v16
    ds_read_b64_tr_b16 v[110:111], v16 offset:512
    ds_read_b64_tr_b16 v[112:113], v17
    ds_read_b64_tr_b16 v[114:115], v17 offset:512
    ds_read_b64_tr_b16 v[116:117], v18
    ds_read_b64_tr_b16 v[118:119], v18 offset:512
    ds_read_b64_tr_b16 v[120:121], v19
    ds_read_b64_tr_b16 v[122:123], v19 offset:512
    s_waitcnt lgkmcnt(0)
    v_mfma_f32_16x16x32_bf16 v[28:31], v[108:111], v[92:95], v[28:31]
    v_mfma_f32_16x16x32_bf16 v[32:35], v[112:115], v[92:95], v[32:35]
    v_mfma_f32_16x16x32_bf16 v[36:39], v[116:119], v[92:95], v[36:39]
    v_mfma_f32_16x16x32_bf16 v[40:43], v[120:123], v[92:95], v[40:43]
    v_mfma_f32_16x16x32_bf16 v[44:47], v[108:111], v[96:99], v[44:47]
    v_mfma_f32_16x16x32_bf16 v[48:51], v[112:115], v[96:99], v[48:51]
    v_mfma_f32_16x16x32_bf16 v[52:55], v[116:119], v[96:99], v[52:55]
    v_mfma_f32_16x16x32_bf16 v[56:59], v[120:123], v[96:99], v[56:59]
    v_mfma_f32_16x16x32_bf16 v[60:63], v[108:111], v[100:103], v[60:63]
    v_mfma_f32_16x16x32_bf16 v[64:67], v[112:115], v[100:103], v[64:67]
    v_mfma_f32_16x16x32_bf16 v[68:71], v[116:119], v[100:103], v[68:71]
    v_mfma_f32_16x16x32_bf16 v[72:75], v[120:123], v[100:103], v[72:75]
    v_mfma_f32_16x16x32_bf16 v[76:79], v[108:111], v[104:107], v[76:79]
    v_mfma_f32_16x16x32_bf16 v[80:83], v[112:115], v[104:107], v[80:83]
    v_mfma_f32_16x16x32_bf16 v[84:87], v[116:119], v[104:107], v[84:87]
    v_mfma_f32_16x16x32_bf16 v[88:91], v[120:123], v[104:107], v[88:91]
    s_waitcnt vmcnt(6)
    s_barrier
    ds_read_b128 v[92:95], v26 offset:0
    ds_read_b128 v[96:99], v26 offset:4096
    ds_read_b128 v[100:103], v26 offset:8192
    ds_read_b128 v[104:107], v26 offset:12288
    ds_read_b64_tr_b16 v[108:109], v20
    ds_read_b64_tr_b16 v[110:111], v20 offset:512
    ds_read_b64_tr_b16 v[112:113], v21
    ds_read_b64_tr_b16 v[114:115], v21 offset:512
    ds_read_b64_tr_b16 v[116:117], v22
    ds_read_b64_tr_b16 v[118:119], v22 offset:512
    ds_read_b64_tr_b16 v[120:121], v23
    ds_read_b64_tr_b16 v[122:123], v23 offset:512
    s_waitcnt lgkmcnt(0)
    v_mfma_f32_16x16x32_bf16 v[28:31], v[108:111], v[92:95], v[28:31]
    v_mfma_f32_16x16x32_bf16 v[32:35], v[112:115], v[92:95], v[32:35]
    v_mfma_f32_16x16x32_bf16 v[36:39], v[116:119], v[92:95], v[36:39]
    v_mfma_f32_16x16x32_bf16 v[40:43], v[120:123], v[92:95], v[40:43]
    v_mfma_f32_16x16x32_bf16 v[44:47], v[108:111], v[96:99], v[44:47]
    v_mfma_f32_16x16x32_bf16 v[48:51], v[112:115], v[96:99], v[48:51]
    v_mfma_f32_16x16x32_bf16 v[52:55], v[116:119], v[96:99], v[52:55]
    v_mfma_f32_16x16x32_bf16 v[56:59], v[120:123], v[96:99], v[56:59]
    v_mfma_f32_16x16x32_bf16 v[60:63], v[108:111], v[100:103], v[60:63]
    v_mfma_f32_16x16x32_bf16 v[64:67], v[112:115], v[100:103], v[64:67]
    v_mfma_f32_16x16x32_bf16 v[68:71], v[116:119], v[100:103], v[68:71]
    v_mfma_f32_16x16x32_bf16 v[72:75], v[120:123], v[100:103], v[72:75]
    v_mfma_f32_16x16x32_bf16 v[76:79], v[108:111], v[104:107], v[76:79]
    v_mfma_f32_16x16x32_bf16 v[80:83], v[112:115], v[104:107], v[80:83]
    v_mfma_f32_16x16x32_bf16 v[84:87], v[116:119], v[104:107], v[84:87]
    v_mfma_f32_16x16x32_bf16 v[88:91], v[120:123], v[104:107], v[88:91]
    s_waitcnt vmcnt(0)
    s_barrier
    ds_read_b128 v[92:95], v24 offset:0
    ds_read_b128 v[96:99], v24 offset:4096
    ds_read_b128 v[100:103], v24 offset:8192
    ds_read_b128 v[104:107], v24 offset:12288
    ds_read_b64_tr_b16 v[108:109], v12
    ds_read_b64_tr_b16 v[110:111], v12 offset:512
    ds_read_b64_tr_b16 v[112:113], v13
    ds_read_b64_tr_b16 v[114:115], v13 offset:512
    ds_read_b64_tr_b16 v[116:117], v14
    ds_read_b64_tr_b16 v[118:119], v14 offset:512
    ds_read_b64_tr_b16 v[120:121], v15
    ds_read_b64_tr_b16 v[122:123], v15 offset:512
    s_waitcnt lgkmcnt(0)
    v_mfma_f32_16x16x32_bf16 v[28:31], v[108:111], v[92:95], v[28:31]
    v_mfma_f32_16x16x32_bf16 v[32:35], v[112:115], v[92:95], v[32:35]
    v_mfma_f32_16x16x32_bf16 v[36:39], v[116:119], v[92:95], v[36:39]
    v_mfma_f32_16x16x32_bf16 v[40:43], v[120:123], v[92:95], v[40:43]
    v_mfma_f32_16x16x32_bf16 v[44:47], v[108:111], v[96:99], v[44:47]
    v_mfma_f32_16x16x32_bf16 v[48:51], v[112:115], v[96:99], v[48:51]
    v_mfma_f32_16x16x32_bf16 v[52:55], v[116:119], v[96:99], v[52:55]
    v_mfma_f32_16x16x32_bf16 v[56:59], v[120:123], v[96:99], v[56:59]
    v_mfma_f32_16x16x32_bf16 v[60:63], v[108:111], v[100:103], v[60:63]
    v_mfma_f32_16x16x32_bf16 v[64:67], v[112:115], v[100:103], v[64:67]
    v_mfma_f32_16x16x32_bf16 v[68:71], v[116:119], v[100:103], v[68:71]
    v_mfma_f32_16x16x32_bf16 v[72:75], v[120:123], v[100:103], v[72:75]
    v_mfma_f32_16x16x32_bf16 v[76:79], v[108:111], v[104:107], v[76:79]
    v_mfma_f32_16x16x32_bf16 v[80:83], v[112:115], v[104:107], v[80:83]
    v_mfma_f32_16x16x32_bf16 v[84:87], v[116:119], v[104:107], v[84:87]
    v_mfma_f32_16x16x32_bf16 v[88:91], v[120:123], v[104:107], v[88:91]
    s_barrier
    v_lshlrev_b32 v6, 4, v1
    s_lshl_b32 s25, s23, 16
    s_lshl_b32 s26, s24, 12
    s_add_u32 s25, s25, s26
    v_add_u32 v3, s25, v6
    s_cmp_eq_u32 s24, 0
    s_cbranch_scc1 G2_SKW_1
    ds_write_b128 v3, v[28:31] offset:0
    ds_write_b128 v3, v[32:35] offset:1024
    ds_write_b128 v3, v[36:39] offset:2048
    ds_write_b128 v3, v[40:43] offset:3072
G2_SKW_1:
    s_cmp_eq_u32 s24, 1
    s_cbranch_scc1 G2_SKW_2
    ds_write_b128 v3, v[44:47] offset:16384
    ds_write_b128 v3, v[48:51] offset:17408
    ds_write_b128 v3, v[52:55] offset:18432
    ds_write_b128 v3, v[56:59] offset:19456
G2_SKW_2:
    s_cmp_eq_u32 s24, 2
    s_cbranch_scc1 G2_SKW_3
    ds_write_b128 v3, v[60:63] offset:32768
    ds_write_b128 v3, v[64:67] offset:33792
    ds_write_b128 v3, v[68:71] offset:34816
    ds_write_b128 v3, v[72:75] offset:35840
G2_SKW_3:
    s_cmp_eq_u32 s24, 3
    s_cbranch_scc1 G2_SKW_4
    ds_write_b128 v3, v[76:79] offset:49152
    ds_write_b128 v3, v[80:83] offset:50176
    ds_write_b128 v3, v[84:87] offset:51200
    ds_write_b128 v3, v[88:91] offset:52224
G2_SKW_4:
    s_waitcnt lgkmcnt(0)
    s_barrier
    s_lshl_b32 s25, s23, 16
    s_lshl_b32 s26, s24, 14
    s_add_u32 s25, s25, s26
    v_add_u32 v3, s25, v6
    v_and_b32 v4, 15, v1
    s_lshl_b32 s25, s21, 7
    s_lshl_b32 s26, s23, 6
    s_add_u32 s25, s25, s26
    s_lshl_b32 s26, s24, 4
    s_add_u32 s25, s25, s26
    v_add_u32 v4, s25, v4
    v_lshlrev_b32 v7, 11, v4
    v_lshrrev_b32 v4, 4, v1
    v_lshl_add_u32 v7, v4, 3, v7
    s_lshl_b32 s25, s22, 7
    v_add_u32 v7, s25, v7
    s_mov_b32 s36, s8
    s_mov_b32 s37, s9
    s_mov_b32 s38, 4194304
    s_mov_b32 s39, 0x00020000
    s_add_u32 s40, s4, 50331648
    s_addc_u32 s41, s5, 0
    s_mov_b32 s42, 4194304
    s_mov_b32 s43, 0x00020000
    s_mov_b32 s44, s10
    s_mov_b32 s45, s11
    s_mov_b32 s46, 4194304
    s_mov_b32 s47, 0x00020000
    s_mov_b32 s48, 0xbfb8aa3b
    s_cmp_eq_u32 s24, 0
    s_cbranch_scc0 G2_NF_5
    buffer_load_dwordx2 v[8:9], v7, s[36:39], 0 offen offset:0
    buffer_load_dwordx2 v[10:11], v7, s[40:43], 0 offen offset:0
    buffer_load_dwordx2 v[12:13], v7, s[36:39], 0 offen offset:32
    buffer_load_dwordx2 v[14:15], v7, s[40:43], 0 offen offset:32
    buffer_load_dwordx2 v[16:17], v7, s[36:39], 0 offen offset:64
    buffer_load_dwordx2 v[18:19], v7, s[40:43], 0 offen offset:64
    buffer_load_dwordx2 v[20:21], v7, s[36:39], 0 offen offset:96
    buffer_load_dwordx2 v[22:23], v7, s[40:43], 0 offen offset:96
    ds_read_b128 v[24:27], v3 offset:4096
    ds_read_b128 v[92:95], v3 offset:8192
    ds_read_b128 v[96:99], v3 offset:12288
    s_waitcnt lgkmcnt(0)
    v_add_f32 v28, v28, v24
    v_add_f32 v29, v29, v25
    v_add_f32 v30, v30, v26
    v_add_f32 v31, v31, v27
    v_add_f32 v28, v28, v92
    v_add_f32 v29, v29, v93
    v_add_f32 v30, v30, v94
    v_add_f32 v31, v31, v95
    v_add_f32 v28, v28, v96
    v_add_f32 v29, v29, v97
    v_add_f32 v30, v30, v98
    v_add_f32 v31, v31, v99
    ds_read_b128 v[24:27], v3 offset:5120
    ds_read_b128 v[92:95], v3 offset:9216
    ds_read_b128 v[96:99], v3 offset:13312
    s_waitcnt lgkmcnt(0)
    v_add_f32 v32, v32, v24
    v_add_f32 v33, v33, v25
    v_add_f32 v34, v34, v26
    v_add_f32 v35, v35, v27
    v_add_f32 v32, v32, v92
    v_add_f32 v33, v33, v93
    v_add_f32 v34, v34, v94
    v_add_f32 v35, v35, v95
    v_add_f32 v32, v32, v96
    v_add_f32 v33, v33, v97
    v_add_f32 v34, v34, v98
    v_add_f32 v35, v35, v99
    ds_read_b128 v[24:27], v3 offset:6144
    ds_read_b128 v[92:95], v3 offset:10240
    ds_read_b128 v[96:99], v3 offset:14336
    s_waitcnt lgkmcnt(0)
    v_add_f32 v36, v36, v24
    v_add_f32 v37, v37, v25
    v_add_f32 v38, v38, v26
    v_add_f32 v39, v39, v27
    v_add_f32 v36, v36, v92
    v_add_f32 v37, v37, v93
    v_add_f32 v38, v38, v94
    v_add_f32 v39, v39, v95
    v_add_f32 v36, v36, v96
    v_add_f32 v37, v37, v97
    v_add_f32 v38, v38, v98
    v_add_f32 v39, v39, v99
    ds_read_b128 v[24:27], v3 offset:7168
    ds_read_b128 v[92:95], v3 offset:11264
    ds_read_b128 v[96:99], v3 offset:15360
    s_waitcnt lgkmcnt(0)
    v_add_f32 v40, v40, v24
    v_add_f32 v41, v41, v25
    v_add_f32 v42, v42, v26
    v_add_f32 v43, v43, v27
    v_add_f32 v40, v40, v92
    v_add_f32 v41, v41, v93
    v_add_f32 v42, v42, v94
    v_add_f32 v43, v43, v95
    v_add_f32 v40, v40, v96
    v_add_f32 v41, v41, v97
    v_add_f32 v42, v42, v98
    v_add_f32 v43, v43, v99
    s_waitcnt vmcnt(0)
    v_cvt_pk_bf16_f32 v24, v28, v29
    v_cvt_pk_bf16_f32 v26, v30, v31
    v_and_b32 v25, 0xffff0000, v24
    v_lshlrev_b32 v24, 16, v24
    v_and_b32 v27, 0xffff0000, v26
    v_lshlrev_b32 v26, 16, v26
    v_mul_f32 v92, s48, v24
    v_mul_f32 v93, s48, v25
    v_mul_f32 v94, s48, v26
    v_mul_f32 v95, s48, v27
    v_exp_f32 v92, v92
    v_exp_f32 v93, v93
    v_exp_f32 v94, v94
    v_exp_f32 v95, v95
    v_add_f32 v92, 1.0, v92
    v_add_f32 v93, 1.0, v93
    v_add_f32 v94, 1.0, v94
    v_add_f32 v95, 1.0, v95
    v_rcp_f32 v92, v92
    v_rcp_f32 v93, v93
    v_rcp_f32 v94, v94
    v_rcp_f32 v95, v95
    v_mul_f32 v92, v92, v24
    v_mul_f32 v93, v93, v25
    v_mul_f32 v94, v94, v26
    v_mul_f32 v95, v95, v27
    v_cvt_pk_bf16_f32 v4, v92, v93
    v_cvt_pk_bf16_f32 v5, v94, v95
    v_lshlrev_b32 v92, 16, v4
    v_and_b32 v93, 0xffff0000, v4
    v_lshlrev_b32 v94, 16, v5
    v_and_b32 v95, 0xffff0000, v5
    v_lshlrev_b32 v96, 16, v10
    v_and_b32 v97, 0xffff0000, v10
    v_lshlrev_b32 v98, 16, v11
    v_and_b32 v99, 0xffff0000, v11
    v_mul_f32 v96, v96, v92
    v_mul_f32 v97, v97, v93
    v_mul_f32 v98, v98, v94
    v_mul_f32 v99, v99, v95
    v_cvt_pk_bf16_f32 v4, v96, v97
    v_cvt_pk_bf16_f32 v5, v98, v99
    v_lshlrev_b32 v96, 16, v4
    v_and_b32 v97, 0xffff0000, v4
    v_lshlrev_b32 v98, 16, v5
    v_and_b32 v99, 0xffff0000, v5
    v_lshlrev_b32 v24, 16, v8
    v_and_b32 v25, 0xffff0000, v8
    v_lshlrev_b32 v26, 16, v9
    v_and_b32 v27, 0xffff0000, v9
    v_add_f32 v24, v24, v96
    v_add_f32 v25, v25, v97
    v_add_f32 v26, v26, v98
    v_add_f32 v27, v27, v99
    v_cvt_pk_bf16_f32 v8, v24, v25
    v_cvt_pk_bf16_f32 v9, v26, v27
    buffer_store_dwordx2 v[8:9], v7, s[44:47], 0 offen offset:0
    v_cvt_pk_bf16_f32 v24, v32, v33
    v_cvt_pk_bf16_f32 v26, v34, v35
    v_and_b32 v25, 0xffff0000, v24
    v_lshlrev_b32 v24, 16, v24
    v_and_b32 v27, 0xffff0000, v26
    v_lshlrev_b32 v26, 16, v26
    v_mul_f32 v92, s48, v24
    v_mul_f32 v93, s48, v25
    v_mul_f32 v94, s48, v26
    v_mul_f32 v95, s48, v27
    v_exp_f32 v92, v92
    v_exp_f32 v93, v93
    v_exp_f32 v94, v94
    v_exp_f32 v95, v95
    v_add_f32 v92, 1.0, v92
    v_add_f32 v93, 1.0, v93
    v_add_f32 v94, 1.0, v94
    v_add_f32 v95, 1.0, v95
    v_rcp_f32 v92, v92
    v_rcp_f32 v93, v93
    v_rcp_f32 v94, v94
    v_rcp_f32 v95, v95
    v_mul_f32 v92, v92, v24
    v_mul_f32 v93, v93, v25
    v_mul_f32 v94, v94, v26
    v_mul_f32 v95, v95, v27
    v_cvt_pk_bf16_f32 v4, v92, v93
    v_cvt_pk_bf16_f32 v5, v94, v95
    v_lshlrev_b32 v92, 16, v4
    v_and_b32 v93, 0xffff0000, v4
    v_lshlrev_b32 v94, 16, v5
    v_and_b32 v95, 0xffff0000, v5
    v_lshlrev_b32 v96, 16, v14
    v_and_b32 v97, 0xffff0000, v14
    v_lshlrev_b32 v98, 16, v15
    v_and_b32 v99, 0xffff0000, v15
    v_mul_f32 v96, v96, v92
    v_mul_f32 v97, v97, v93
    v_mul_f32 v98, v98, v94
    v_mul_f32 v99, v99, v95
    v_cvt_pk_bf16_f32 v4, v96, v97
    v_cvt_pk_bf16_f32 v5, v98, v99
    v_lshlrev_b32 v96, 16, v4
    v_and_b32 v97, 0xffff0000, v4
    v_lshlrev_b32 v98, 16, v5
    v_and_b32 v99, 0xffff0000, v5
    v_lshlrev_b32 v24, 16, v12
    v_and_b32 v25, 0xffff0000, v12
    v_lshlrev_b32 v26, 16, v13
    v_and_b32 v27, 0xffff0000, v13
    v_add_f32 v24, v24, v96
    v_add_f32 v25, v25, v97
    v_add_f32 v26, v26, v98
    v_add_f32 v27, v27, v99
    v_cvt_pk_bf16_f32 v12, v24, v25
    v_cvt_pk_bf16_f32 v13, v26, v27
    buffer_store_dwordx2 v[12:13], v7, s[44:47], 0 offen offset:32
    v_cvt_pk_bf16_f32 v24, v36, v37
    v_cvt_pk_bf16_f32 v26, v38, v39
    v_and_b32 v25, 0xffff0000, v24
    v_lshlrev_b32 v24, 16, v24
    v_and_b32 v27, 0xffff0000, v26
    v_lshlrev_b32 v26, 16, v26
    v_mul_f32 v92, s48, v24
    v_mul_f32 v93, s48, v25
    v_mul_f32 v94, s48, v26
    v_mul_f32 v95, s48, v27
    v_exp_f32 v92, v92
    v_exp_f32 v93, v93
    v_exp_f32 v94, v94
    v_exp_f32 v95, v95
    v_add_f32 v92, 1.0, v92
    v_add_f32 v93, 1.0, v93
    v_add_f32 v94, 1.0, v94
    v_add_f32 v95, 1.0, v95
    v_rcp_f32 v92, v92
    v_rcp_f32 v93, v93
    v_rcp_f32 v94, v94
    v_rcp_f32 v95, v95
    v_mul_f32 v92, v92, v24
    v_mul_f32 v93, v93, v25
    v_mul_f32 v94, v94, v26
    v_mul_f32 v95, v95, v27
    v_cvt_pk_bf16_f32 v4, v92, v93
    v_cvt_pk_bf16_f32 v5, v94, v95
    v_lshlrev_b32 v92, 16, v4
    v_and_b32 v93, 0xffff0000, v4
    v_lshlrev_b32 v94, 16, v5
    v_and_b32 v95, 0xffff0000, v5
    v_lshlrev_b32 v96, 16, v18
    v_and_b32 v97, 0xffff0000, v18
    v_lshlrev_b32 v98, 16, v19
    v_and_b32 v99, 0xffff0000, v19
    v_mul_f32 v96, v96, v92
    v_mul_f32 v97, v97, v93
    v_mul_f32 v98, v98, v94
    v_mul_f32 v99, v99, v95
    v_cvt_pk_bf16_f32 v4, v96, v97
    v_cvt_pk_bf16_f32 v5, v98, v99
    v_lshlrev_b32 v96, 16, v4
    v_and_b32 v97, 0xffff0000, v4
    v_lshlrev_b32 v98, 16, v5
    v_and_b32 v99, 0xffff0000, v5
    v_lshlrev_b32 v24, 16, v16
    v_and_b32 v25, 0xffff0000, v16
    v_lshlrev_b32 v26, 16, v17
    v_and_b32 v27, 0xffff0000, v17
    v_add_f32 v24, v24, v96
    v_add_f32 v25, v25, v97
    v_add_f32 v26, v26, v98
    v_add_f32 v27, v27, v99
    v_cvt_pk_bf16_f32 v16, v24, v25
    v_cvt_pk_bf16_f32 v17, v26, v27
    buffer_store_dwordx2 v[16:17], v7, s[44:47], 0 offen offset:64
    v_cvt_pk_bf16_f32 v24, v40, v41
    v_cvt_pk_bf16_f32 v26, v42, v43
    v_and_b32 v25, 0xffff0000, v24
    v_lshlrev_b32 v24, 16, v24
    v_and_b32 v27, 0xffff0000, v26
    v_lshlrev_b32 v26, 16, v26
    v_mul_f32 v92, s48, v24
    v_mul_f32 v93, s48, v25
    v_mul_f32 v94, s48, v26
    v_mul_f32 v95, s48, v27
    v_exp_f32 v92, v92
    v_exp_f32 v93, v93
    v_exp_f32 v94, v94
    v_exp_f32 v95, v95
    v_add_f32 v92, 1.0, v92
    v_add_f32 v93, 1.0, v93
    v_add_f32 v94, 1.0, v94
    v_add_f32 v95, 1.0, v95
    v_rcp_f32 v92, v92
    v_rcp_f32 v93, v93
    v_rcp_f32 v94, v94
    v_rcp_f32 v95, v95
    v_mul_f32 v92, v92, v24
    v_mul_f32 v93, v93, v25
    v_mul_f32 v94, v94, v26
    v_mul_f32 v95, v95, v27
    v_cvt_pk_bf16_f32 v4, v92, v93
    v_cvt_pk_bf16_f32 v5, v94, v95
    v_lshlrev_b32 v92, 16, v4
    v_and_b32 v93, 0xffff0000, v4
    v_lshlrev_b32 v94, 16, v5
    v_and_b32 v95, 0xffff0000, v5
    v_lshlrev_b32 v96, 16, v22
    v_and_b32 v97, 0xffff0000, v22
    v_lshlrev_b32 v98, 16, v23
    v_and_b32 v99, 0xffff0000, v23
    v_mul_f32 v96, v96, v92
    v_mul_f32 v97, v97, v93
    v_mul_f32 v98, v98, v94
    v_mul_f32 v99, v99, v95
    v_cvt_pk_bf16_f32 v4, v96, v97
    v_cvt_pk_bf16_f32 v5, v98, v99
    v_lshlrev_b32 v96, 16, v4
    v_and_b32 v97, 0xffff0000, v4
    v_lshlrev_b32 v98, 16, v5
    v_and_b32 v99, 0xffff0000, v5
    v_lshlrev_b32 v24, 16, v20
    v_and_b32 v25, 0xffff0000, v20
    v_lshlrev_b32 v26, 16, v21
    v_and_b32 v27, 0xffff0000, v21
    v_add_f32 v24, v24, v96
    v_add_f32 v25, v25, v97
    v_add_f32 v26, v26, v98
    v_add_f32 v27, v27, v99
    v_cvt_pk_bf16_f32 v20, v24, v25
    v_cvt_pk_bf16_f32 v21, v26, v27
    buffer_store_dwordx2 v[20:21], v7, s[44:47], 0 offen offset:96
G2_NF_5:
    s_cmp_eq_u32 s24, 1
    s_cbranch_scc0 G2_NF_6
    buffer_load_dwordx2 v[8:9], v7, s[36:39], 0 offen offset:0
    buffer_load_dwordx2 v[10:11], v7, s[40:43], 0 offen offset:0
    buffer_load_dwordx2 v[12:13], v7, s[36:39], 0 offen offset:32
    buffer_load_dwordx2 v[14:15], v7, s[40:43], 0 offen offset:32
    buffer_load_dwordx2 v[16:17], v7, s[36:39], 0 offen offset:64
    buffer_load_dwordx2 v[18:19], v7, s[40:43], 0 offen offset:64
    buffer_load_dwordx2 v[20:21], v7, s[36:39], 0 offen offset:96
    buffer_load_dwordx2 v[22:23], v7, s[40:43], 0 offen offset:96
    ds_read_b128 v[24:27], v3 offset:0
    ds_read_b128 v[92:95], v3 offset:8192
    ds_read_b128 v[96:99], v3 offset:12288
    s_waitcnt lgkmcnt(0)
    v_add_f32 v44, v44, v24
    v_add_f32 v45, v45, v25
    v_add_f32 v46, v46, v26
    v_add_f32 v47, v47, v27
    v_add_f32 v44, v44, v92
    v_add_f32 v45, v45, v93
    v_add_f32 v46, v46, v94
    v_add_f32 v47, v47, v95
    v_add_f32 v44, v44, v96
    v_add_f32 v45, v45, v97
    v_add_f32 v46, v46, v98
    v_add_f32 v47, v47, v99
    ds_read_b128 v[24:27], v3 offset:1024
    ds_read_b128 v[92:95], v3 offset:9216
    ds_read_b128 v[96:99], v3 offset:13312
    s_waitcnt lgkmcnt(0)
    v_add_f32 v48, v48, v24
    v_add_f32 v49, v49, v25
    v_add_f32 v50, v50, v26
    v_add_f32 v51, v51, v27
    v_add_f32 v48, v48, v92
    v_add_f32 v49, v49, v93
    v_add_f32 v50, v50, v94
    v_add_f32 v51, v51, v95
    v_add_f32 v48, v48, v96
    v_add_f32 v49, v49, v97
    v_add_f32 v50, v50, v98
    v_add_f32 v51, v51, v99
    ds_read_b128 v[24:27], v3 offset:2048
    ds_read_b128 v[92:95], v3 offset:10240
    ds_read_b128 v[96:99], v3 offset:14336
    s_waitcnt lgkmcnt(0)
    v_add_f32 v52, v52, v24
    v_add_f32 v53, v53, v25
    v_add_f32 v54, v54, v26
    v_add_f32 v55, v55, v27
    v_add_f32 v52, v52, v92
    v_add_f32 v53, v53, v93
    v_add_f32 v54, v54, v94
    v_add_f32 v55, v55, v95
    v_add_f32 v52, v52, v96
    v_add_f32 v53, v53, v97
    v_add_f32 v54, v54, v98
    v_add_f32 v55, v55, v99
    ds_read_b128 v[24:27], v3 offset:3072
    ds_read_b128 v[92:95], v3 offset:11264
    ds_read_b128 v[96:99], v3 offset:15360
    s_waitcnt lgkmcnt(0)
    v_add_f32 v56, v56, v24
    v_add_f32 v57, v57, v25
    v_add_f32 v58, v58, v26
    v_add_f32 v59, v59, v27
    v_add_f32 v56, v56, v92
    v_add_f32 v57, v57, v93
    v_add_f32 v58, v58, v94
    v_add_f32 v59, v59, v95
    v_add_f32 v56, v56, v96
    v_add_f32 v57, v57, v97
    v_add_f32 v58, v58, v98
    v_add_f32 v59, v59, v99
    s_waitcnt vmcnt(0)
    v_cvt_pk_bf16_f32 v24, v44, v45
    v_cvt_pk_bf16_f32 v26, v46, v47
    v_and_b32 v25, 0xffff0000, v24
    v_lshlrev_b32 v24, 16, v24
    v_and_b32 v27, 0xffff0000, v26
    v_lshlrev_b32 v26, 16, v26
    v_mul_f32 v92, s48, v24
    v_mul_f32 v93, s48, v25
    v_mul_f32 v94, s48, v26
    v_mul_f32 v95, s48, v27
    v_exp_f32 v92, v92
    v_exp_f32 v93, v93
    v_exp_f32 v94, v94
    v_exp_f32 v95, v95
    v_add_f32 v92, 1.0, v92
    v_add_f32 v93, 1.0, v93
    v_add_f32 v94, 1.0, v94
    v_add_f32 v95, 1.0, v95
    v_rcp_f32 v92, v92
    v_rcp_f32 v93, v93
    v_rcp_f32 v94, v94
    v_rcp_f32 v95, v95
    v_mul_f32 v92, v92, v24
    v_mul_f32 v93, v93, v25
    v_mul_f32 v94, v94, v26
    v_mul_f32 v95, v95, v27
    v_cvt_pk_bf16_f32 v4, v92, v93
    v_cvt_pk_bf16_f32 v5, v94, v95
    v_lshlrev_b32 v92, 16, v4
    v_and_b32 v93, 0xffff0000, v4
    v_lshlrev_b32 v94, 16, v5
    v_and_b32 v95, 0xffff0000, v5
    v_lshlrev_b32 v96, 16, v10
    v_and_b32 v97, 0xffff0000, v10
    v_lshlrev_b32 v98, 16, v11
    v_and_b32 v99, 0xffff0000, v11
    v_mul_f32 v96, v96, v92
    v_mul_f32 v97, v97, v93
    v_mul_f32 v98, v98, v94
    v_mul_f32 v99, v99, v95
    v_cvt_pk_bf16_f32 v4, v96, v97
    v_cvt_pk_bf16_f32 v5, v98, v99
    v_lshlrev_b32 v96, 16, v4
    v_and_b32 v97, 0xffff0000, v4
    v_lshlrev_b32 v98, 16, v5
    v_and_b32 v99, 0xffff0000, v5
    v_lshlrev_b32 v24, 16, v8
    v_and_b32 v25, 0xffff0000, v8
    v_lshlrev_b32 v26, 16, v9
    v_and_b32 v27, 0xffff0000, v9
    v_add_f32 v24, v24, v96
    v_add_f32 v25, v25, v97
    v_add_f32 v26, v26, v98
    v_add_f32 v27, v27, v99
    v_cvt_pk_bf16_f32 v8, v24, v25
    v_cvt_pk_bf16_f32 v9, v26, v27
    buffer_store_dwordx2 v[8:9], v7, s[44:47], 0 offen offset:0
    v_cvt_pk_bf16_f32 v24, v48, v49
    v_cvt_pk_bf16_f32 v26, v50, v51
    v_and_b32 v25, 0xffff0000, v24
    v_lshlrev_b32 v24, 16, v24
    v_and_b32 v27, 0xffff0000, v26
    v_lshlrev_b32 v26, 16, v26
    v_mul_f32 v92, s48, v24
    v_mul_f32 v93, s48, v25
    v_mul_f32 v94, s48, v26
    v_mul_f32 v95, s48, v27
    v_exp_f32 v92, v92
    v_exp_f32 v93, v93
    v_exp_f32 v94, v94
    v_exp_f32 v95, v95
    v_add_f32 v92, 1.0, v92
    v_add_f32 v93, 1.0, v93
    v_add_f32 v94, 1.0, v94
    v_add_f32 v95, 1.0, v95
    v_rcp_f32 v92, v92
    v_rcp_f32 v93, v93
    v_rcp_f32 v94, v94
    v_rcp_f32 v95, v95
    v_mul_f32 v92, v92, v24
    v_mul_f32 v93, v93, v25
    v_mul_f32 v94, v94, v26
    v_mul_f32 v95, v95, v27
    v_cvt_pk_bf16_f32 v4, v92, v93
    v_cvt_pk_bf16_f32 v5, v94, v95
    v_lshlrev_b32 v92, 16, v4
    v_and_b32 v93, 0xffff0000, v4
    v_lshlrev_b32 v94, 16, v5
    v_and_b32 v95, 0xffff0000, v5
    v_lshlrev_b32 v96, 16, v14
    v_and_b32 v97, 0xffff0000, v14
    v_lshlrev_b32 v98, 16, v15
    v_and_b32 v99, 0xffff0000, v15
    v_mul_f32 v96, v96, v92
    v_mul_f32 v97, v97, v93
    v_mul_f32 v98, v98, v94
    v_mul_f32 v99, v99, v95
    v_cvt_pk_bf16_f32 v4, v96, v97
    v_cvt_pk_bf16_f32 v5, v98, v99
    v_lshlrev_b32 v96, 16, v4
    v_and_b32 v97, 0xffff0000, v4
    v_lshlrev_b32 v98, 16, v5
    v_and_b32 v99, 0xffff0000, v5
    v_lshlrev_b32 v24, 16, v12
    v_and_b32 v25, 0xffff0000, v12
    v_lshlrev_b32 v26, 16, v13
    v_and_b32 v27, 0xffff0000, v13
    v_add_f32 v24, v24, v96
    v_add_f32 v25, v25, v97
    v_add_f32 v26, v26, v98
    v_add_f32 v27, v27, v99
    v_cvt_pk_bf16_f32 v12, v24, v25
    v_cvt_pk_bf16_f32 v13, v26, v27
    buffer_store_dwordx2 v[12:13], v7, s[44:47], 0 offen offset:32
    v_cvt_pk_bf16_f32 v24, v52, v53
    v_cvt_pk_bf16_f32 v26, v54, v55
    v_and_b32 v25, 0xffff0000, v24
    v_lshlrev_b32 v24, 16, v24
    v_and_b32 v27, 0xffff0000, v26
    v_lshlrev_b32 v26, 16, v26
    v_mul_f32 v92, s48, v24
    v_mul_f32 v93, s48, v25
    v_mul_f32 v94, s48, v26
    v_mul_f32 v95, s48, v27
    v_exp_f32 v92, v92
    v_exp_f32 v93, v93
    v_exp_f32 v94, v94
    v_exp_f32 v95, v95
    v_add_f32 v92, 1.0, v92
    v_add_f32 v93, 1.0, v93
    v_add_f32 v94, 1.0, v94
    v_add_f32 v95, 1.0, v95
    v_rcp_f32 v92, v92
    v_rcp_f32 v93, v93
    v_rcp_f32 v94, v94
    v_rcp_f32 v95, v95
    v_mul_f32 v92, v92, v24
    v_mul_f32 v93, v93, v25
    v_mul_f32 v94, v94, v26
    v_mul_f32 v95, v95, v27
    v_cvt_pk_bf16_f32 v4, v92, v93
    v_cvt_pk_bf16_f32 v5, v94, v95
    v_lshlrev_b32 v92, 16, v4
    v_and_b32 v93, 0xffff0000, v4
    v_lshlrev_b32 v94, 16, v5
    v_and_b32 v95, 0xffff0000, v5
    v_lshlrev_b32 v96, 16, v18
    v_and_b32 v97, 0xffff0000, v18
    v_lshlrev_b32 v98, 16, v19
    v_and_b32 v99, 0xffff0000, v19
    v_mul_f32 v96, v96, v92
    v_mul_f32 v97, v97, v93
    v_mul_f32 v98, v98, v94
    v_mul_f32 v99, v99, v95
    v_cvt_pk_bf16_f32 v4, v96, v97
    v_cvt_pk_bf16_f32 v5, v98, v99
    v_lshlrev_b32 v96, 16, v4
    v_and_b32 v97, 0xffff0000, v4
    v_lshlrev_b32 v98, 16, v5
    v_and_b32 v99, 0xffff0000, v5
    v_lshlrev_b32 v24, 16, v16
    v_and_b32 v25, 0xffff0000, v16
    v_lshlrev_b32 v26, 16, v17
    v_and_b32 v27, 0xffff0000, v17
    v_add_f32 v24, v24, v96
    v_add_f32 v25, v25, v97
    v_add_f32 v26, v26, v98
    v_add_f32 v27, v27, v99
    v_cvt_pk_bf16_f32 v16, v24, v25
    v_cvt_pk_bf16_f32 v17, v26, v27
    buffer_store_dwordx2 v[16:17], v7, s[44:47], 0 offen offset:64
    v_cvt_pk_bf16_f32 v24, v56, v57
    v_cvt_pk_bf16_f32 v26, v58, v59
    v_and_b32 v25, 0xffff0000, v24
    v_lshlrev_b32 v24, 16, v24
    v_and_b32 v27, 0xffff0000, v26
    v_lshlrev_b32 v26, 16, v26
    v_mul_f32 v92, s48, v24
    v_mul_f32 v93, s48, v25
    v_mul_f32 v94, s48, v26
    v_mul_f32 v95, s48, v27
    v_exp_f32 v92, v92
    v_exp_f32 v93, v93
    v_exp_f32 v94, v94
    v_exp_f32 v95, v95
    v_add_f32 v92, 1.0, v92
    v_add_f32 v93, 1.0, v93
    v_add_f32 v94, 1.0, v94
    v_add_f32 v95, 1.0, v95
    v_rcp_f32 v92, v92
    v_rcp_f32 v93, v93
    v_rcp_f32 v94, v94
    v_rcp_f32 v95, v95
    v_mul_f32 v92, v92, v24
    v_mul_f32 v93, v93, v25
    v_mul_f32 v94, v94, v26
    v_mul_f32 v95, v95, v27
    v_cvt_pk_bf16_f32 v4, v92, v93
    v_cvt_pk_bf16_f32 v5, v94, v95
    v_lshlrev_b32 v92, 16, v4
    v_and_b32 v93, 0xffff0000, v4
    v_lshlrev_b32 v94, 16, v5
    v_and_b32 v95, 0xffff0000, v5
    v_lshlrev_b32 v96, 16, v22
    v_and_b32 v97, 0xffff0000, v22
    v_lshlrev_b32 v98, 16, v23
    v_and_b32 v99, 0xffff0000, v23
    v_mul_f32 v96, v96, v92
    v_mul_f32 v97, v97, v93
    v_mul_f32 v98, v98, v94
    v_mul_f32 v99, v99, v95
    v_cvt_pk_bf16_f32 v4, v96, v97
    v_cvt_pk_bf16_f32 v5, v98, v99
    v_lshlrev_b32 v96, 16, v4
    v_and_b32 v97, 0xffff0000, v4
    v_lshlrev_b32 v98, 16, v5
    v_and_b32 v99, 0xffff0000, v5
    v_lshlrev_b32 v24, 16, v20
    v_and_b32 v25, 0xffff0000, v20
    v_lshlrev_b32 v26, 16, v21
    v_and_b32 v27, 0xffff0000, v21
    v_add_f32 v24, v24, v96
    v_add_f32 v25, v25, v97
    v_add_f32 v26, v26, v98
    v_add_f32 v27, v27, v99
    v_cvt_pk_bf16_f32 v20, v24, v25
    v_cvt_pk_bf16_f32 v21, v26, v27
    buffer_store_dwordx2 v[20:21], v7, s[44:47], 0 offen offset:96
G2_NF_6:
    s_cmp_eq_u32 s24, 2
    s_cbranch_scc0 G2_NF_7
    buffer_load_dwordx2 v[8:9], v7, s[36:39], 0 offen offset:0
    buffer_load_dwordx2 v[10:11], v7, s[40:43], 0 offen offset:0
    buffer_load_dwordx2 v[12:13], v7, s[36:39], 0 offen offset:32
    buffer_load_dwordx2 v[14:15], v7, s[40:43], 0 offen offset:32
    buffer_load_dwordx2 v[16:17], v7, s[36:39], 0 offen offset:64
    buffer_load_dwordx2 v[18:19], v7, s[40:43], 0 offen offset:64
    buffer_load_dwordx2 v[20:21], v7, s[36:39], 0 offen offset:96
    buffer_load_dwordx2 v[22:23], v7, s[40:43], 0 offen offset:96
    ds_read_b128 v[24:27], v3 offset:0
    ds_read_b128 v[92:95], v3 offset:4096
    ds_read_b128 v[96:99], v3 offset:12288
    s_waitcnt lgkmcnt(0)
    v_add_f32 v60, v60, v24
    v_add_f32 v61, v61, v25
    v_add_f32 v62, v62, v26
    v_add_f32 v63, v63, v27
    v_add_f32 v60, v60, v92
    v_add_f32 v61, v61, v93
    v_add_f32 v62, v62, v94
    v_add_f32 v63, v63, v95
    v_add_f32 v60, v60, v96
    v_add_f32 v61, v61, v97
    v_add_f32 v62, v62, v98
    v_add_f32 v63, v63, v99
    ds_read_b128 v[24:27], v3 offset:1024
    ds_read_b128 v[92:95], v3 offset:5120
    ds_read_b128 v[96:99], v3 offset:13312
    s_waitcnt lgkmcnt(0)
    v_add_f32 v64, v64, v24
    v_add_f32 v65, v65, v25
    v_add_f32 v66, v66, v26
    v_add_f32 v67, v67, v27
    v_add_f32 v64, v64, v92
    v_add_f32 v65, v65, v93
    v_add_f32 v66, v66, v94
    v_add_f32 v67, v67, v95
    v_add_f32 v64, v64, v96
    v_add_f32 v65, v65, v97
    v_add_f32 v66, v66, v98
    v_add_f32 v67, v67, v99
    ds_read_b128 v[24:27], v3 offset:2048
    ds_read_b128 v[92:95], v3 offset:6144
    ds_read_b128 v[96:99], v3 offset:14336
    s_waitcnt lgkmcnt(0)
    v_add_f32 v68, v68, v24
    v_add_f32 v69, v69, v25
    v_add_f32 v70, v70, v26
    v_add_f32 v71, v71, v27
    v_add_f32 v68, v68, v92
    v_add_f32 v69, v69, v93
    v_add_f32 v70, v70, v94
    v_add_f32 v71, v71, v95
    v_add_f32 v68, v68, v96
    v_add_f32 v69, v69, v97
    v_add_f32 v70, v70, v98
    v_add_f32 v71, v71, v99
    ds_read_b128 v[24:27], v3 offset:3072
    ds_read_b128 v[92:95], v3 offset:7168
    ds_read_b128 v[96:99], v3 offset:15360
    s_waitcnt lgkmcnt(0)
    v_add_f32 v72, v72, v24
    v_add_f32 v73, v73, v25
    v_add_f32 v74, v74, v26
    v_add_f32 v75, v75, v27
    v_add_f32 v72, v72, v92
    v_add_f32 v73, v73, v93
    v_add_f32 v74, v74, v94
    v_add_f32 v75, v75, v95
    v_add_f32 v72, v72, v96
    v_add_f32 v73, v73, v97
    v_add_f32 v74, v74, v98
    v_add_f32 v75, v75, v99
    s_waitcnt vmcnt(0)
    v_cvt_pk_bf16_f32 v24, v60, v61
    v_cvt_pk_bf16_f32 v26, v62, v63
    v_and_b32 v25, 0xffff0000, v24
    v_lshlrev_b32 v24, 16, v24
    v_and_b32 v27, 0xffff0000, v26
    v_lshlrev_b32 v26, 16, v26
    v_mul_f32 v92, s48, v24
    v_mul_f32 v93, s48, v25
    v_mul_f32 v94, s48, v26
    v_mul_f32 v95, s48, v27
    v_exp_f32 v92, v92
    v_exp_f32 v93, v93
    v_exp_f32 v94, v94
    v_exp_f32 v95, v95
    v_add_f32 v92, 1.0, v92
    v_add_f32 v93, 1.0, v93
    v_add_f32 v94, 1.0, v94
    v_add_f32 v95, 1.0, v95
    v_rcp_f32 v92, v92
    v_rcp_f32 v93, v93
    v_rcp_f32 v94, v94
    v_rcp_f32 v95, v95
    v_mul_f32 v92, v92, v24
    v_mul_f32 v93, v93, v25
    v_mul_f32 v94, v94, v26
    v_mul_f32 v95, v95, v27
    v_cvt_pk_bf16_f32 v4, v92, v93
    v_cvt_pk_bf16_f32 v5, v94, v95
    v_lshlrev_b32 v92, 16, v4
    v_and_b32 v93, 0xffff0000, v4
    v_lshlrev_b32 v94, 16, v5
    v_and_b32 v95, 0xffff0000, v5
    v_lshlrev_b32 v96, 16, v10
    v_and_b32 v97, 0xffff0000, v10
    v_lshlrev_b32 v98, 16, v11
    v_and_b32 v99, 0xffff0000, v11
    v_mul_f32 v96, v96, v92
    v_mul_f32 v97, v97, v93
    v_mul_f32 v98, v98, v94
    v_mul_f32 v99, v99, v95
    v_cvt_pk_bf16_f32 v4, v96, v97
    v_cvt_pk_bf16_f32 v5, v98, v99
    v_lshlrev_b32 v96, 16, v4
    v_and_b32 v97, 0xffff0000, v4
    v_lshlrev_b32 v98, 16, v5
    v_and_b32 v99, 0xffff0000, v5
    v_lshlrev_b32 v24, 16, v8
    v_and_b32 v25, 0xffff0000, v8
    v_lshlrev_b32 v26, 16, v9
    v_and_b32 v27, 0xffff0000, v9
    v_add_f32 v24, v24, v96
    v_add_f32 v25, v25, v97
    v_add_f32 v26, v26, v98
    v_add_f32 v27, v27, v99
    v_cvt_pk_bf16_f32 v8, v24, v25
    v_cvt_pk_bf16_f32 v9, v26, v27
    buffer_store_dwordx2 v[8:9], v7, s[44:47], 0 offen offset:0
    v_cvt_pk_bf16_f32 v24, v64, v65
    v_cvt_pk_bf16_f32 v26, v66, v67
    v_and_b32 v25, 0xffff0000, v24
    v_lshlrev_b32 v24, 16, v24
    v_and_b32 v27, 0xffff0000, v26
    v_lshlrev_b32 v26, 16, v26
    v_mul_f32 v92, s48, v24
    v_mul_f32 v93, s48, v25
    v_mul_f32 v94, s48, v26
    v_mul_f32 v95, s48, v27
    v_exp_f32 v92, v92
    v_exp_f32 v93, v93
    v_exp_f32 v94, v94
    v_exp_f32 v95, v95
    v_add_f32 v92, 1.0, v92
    v_add_f32 v93, 1.0, v93
    v_add_f32 v94, 1.0, v94
    v_add_f32 v95, 1.0, v95
    v_rcp_f32 v92, v92
    v_rcp_f32 v93, v93
    v_rcp_f32 v94, v94
    v_rcp_f32 v95, v95
    v_mul_f32 v92, v92, v24
    v_mul_f32 v93, v93, v25
    v_mul_f32 v94, v94, v26
    v_mul_f32 v95, v95, v27
    v_cvt_pk_bf16_f32 v4, v92, v93
    v_cvt_pk_bf16_f32 v5, v94, v95
    v_lshlrev_b32 v92, 16, v4
    v_and_b32 v93, 0xffff0000, v4
    v_lshlrev_b32 v94, 16, v5
    v_and_b32 v95, 0xffff0000, v5
    v_lshlrev_b32 v96, 16, v14
    v_and_b32 v97, 0xffff0000, v14
    v_lshlrev_b32 v98, 16, v15
    v_and_b32 v99, 0xffff0000, v15
    v_mul_f32 v96, v96, v92
    v_mul_f32 v97, v97, v93
    v_mul_f32 v98, v98, v94
    v_mul_f32 v99, v99, v95
    v_cvt_pk_bf16_f32 v4, v96, v97
    v_cvt_pk_bf16_f32 v5, v98, v99
    v_lshlrev_b32 v96, 16, v4
    v_and_b32 v97, 0xffff0000, v4
    v_lshlrev_b32 v98, 16, v5
    v_and_b32 v99, 0xffff0000, v5
    v_lshlrev_b32 v24, 16, v12
    v_and_b32 v25, 0xffff0000, v12
    v_lshlrev_b32 v26, 16, v13
    v_and_b32 v27, 0xffff0000, v13
    v_add_f32 v24, v24, v96
    v_add_f32 v25, v25, v97
    v_add_f32 v26, v26, v98
    v_add_f32 v27, v27, v99
    v_cvt_pk_bf16_f32 v12, v24, v25
    v_cvt_pk_bf16_f32 v13, v26, v27
    buffer_store_dwordx2 v[12:13], v7, s[44:47], 0 offen offset:32
    v_cvt_pk_bf16_f32 v24, v68, v69
    v_cvt_pk_bf16_f32 v26, v70, v71
    v_and_b32 v25, 0xffff0000, v24
    v_lshlrev_b32 v24, 16, v24
    v_and_b32 v27, 0xffff0000, v26
    v_lshlrev_b32 v26, 16, v26
    v_mul_f32 v92, s48, v24
    v_mul_f32 v93, s48, v25
    v_mul_f32 v94, s48, v26
    v_mul_f32 v95, s48, v27
    v_exp_f32 v92, v92
    v_exp_f32 v93, v93
    v_exp_f32 v94, v94
    v_exp_f32 v95, v95
    v_add_f32 v92, 1.0, v92
    v_add_f32 v93, 1.0, v93
    v_add_f32 v94, 1.0, v94
    v_add_f32 v95, 1.0, v95
    v_rcp_f32 v92, v92
    v_rcp_f32 v93, v93
    v_rcp_f32 v94, v94
    v_rcp_f32 v95, v95
    v_mul_f32 v92, v92, v24
    v_mul_f32 v93, v93, v25
    v_mul_f32 v94, v94, v26
    v_mul_f32 v95, v95, v27
    v_cvt_pk_bf16_f32 v4, v92, v93
    v_cvt_pk_bf16_f32 v5, v94, v95
    v_lshlrev_b32 v92, 16, v4
    v_and_b32 v93, 0xffff0000, v4
    v_lshlrev_b32 v94, 16, v5
    v_and_b32 v95, 0xffff0000, v5
    v_lshlrev_b32 v96, 16, v18
    v_and_b32 v97, 0xffff0000, v18
    v_lshlrev_b32 v98, 16, v19
    v_and_b32 v99, 0xffff0000, v19
    v_mul_f32 v96, v96, v92
    v_mul_f32 v97, v97, v93
    v_mul_f32 v98, v98, v94
    v_mul_f32 v99, v99, v95
    v_cvt_pk_bf16_f32 v4, v96, v97
    v_cvt_pk_bf16_f32 v5, v98, v99
    v_lshlrev_b32 v96, 16, v4
    v_and_b32 v97, 0xffff0000, v4
    v_lshlrev_b32 v98, 16, v5
    v_and_b32 v99, 0xffff0000, v5
    v_lshlrev_b32 v24, 16, v16
    v_and_b32 v25, 0xffff0000, v16
    v_lshlrev_b32 v26, 16, v17
    v_and_b32 v27, 0xffff0000, v17
    v_add_f32 v24, v24, v96
    v_add_f32 v25, v25, v97
    v_add_f32 v26, v26, v98
    v_add_f32 v27, v27, v99
    v_cvt_pk_bf16_f32 v16, v24, v25
    v_cvt_pk_bf16_f32 v17, v26, v27
    buffer_store_dwordx2 v[16:17], v7, s[44:47], 0 offen offset:64
    v_cvt_pk_bf16_f32 v24, v72, v73
    v_cvt_pk_bf16_f32 v26, v74, v75
    v_and_b32 v25, 0xffff0000, v24
    v_lshlrev_b32 v24, 16, v24
    v_and_b32 v27, 0xffff0000, v26
    v_lshlrev_b32 v26, 16, v26
    v_mul_f32 v92, s48, v24
    v_mul_f32 v93, s48, v25
    v_mul_f32 v94, s48, v26
    v_mul_f32 v95, s48, v27
    v_exp_f32 v92, v92
    v_exp_f32 v93, v93
    v_exp_f32 v94, v94
    v_exp_f32 v95, v95
    v_add_f32 v92, 1.0, v92
    v_add_f32 v93, 1.0, v93
    v_add_f32 v94, 1.0, v94
    v_add_f32 v95, 1.0, v95
    v_rcp_f32 v92, v92
    v_rcp_f32 v93, v93
    v_rcp_f32 v94, v94
    v_rcp_f32 v95, v95
    v_mul_f32 v92, v92, v24
    v_mul_f32 v93, v93, v25
    v_mul_f32 v94, v94, v26
    v_mul_f32 v95, v95, v27
    v_cvt_pk_bf16_f32 v4, v92, v93
    v_cvt_pk_bf16_f32 v5, v94, v95
    v_lshlrev_b32 v92, 16, v4
    v_and_b32 v93, 0xffff0000, v4
    v_lshlrev_b32 v94, 16, v5
    v_and_b32 v95, 0xffff0000, v5
    v_lshlrev_b32 v96, 16, v22
    v_and_b32 v97, 0xffff0000, v22
    v_lshlrev_b32 v98, 16, v23
    v_and_b32 v99, 0xffff0000, v23
    v_mul_f32 v96, v96, v92
    v_mul_f32 v97, v97, v93
    v_mul_f32 v98, v98, v94
    v_mul_f32 v99, v99, v95
    v_cvt_pk_bf16_f32 v4, v96, v97
    v_cvt_pk_bf16_f32 v5, v98, v99
    v_lshlrev_b32 v96, 16, v4
    v_and_b32 v97, 0xffff0000, v4
    v_lshlrev_b32 v98, 16, v5
    v_and_b32 v99, 0xffff0000, v5
    v_lshlrev_b32 v24, 16, v20
    v_and_b32 v25, 0xffff0000, v20
    v_lshlrev_b32 v26, 16, v21
    v_and_b32 v27, 0xffff0000, v21
    v_add_f32 v24, v24, v96
    v_add_f32 v25, v25, v97
    v_add_f32 v26, v26, v98
    v_add_f32 v27, v27, v99
    v_cvt_pk_bf16_f32 v20, v24, v25
    v_cvt_pk_bf16_f32 v21, v26, v27
    buffer_store_dwordx2 v[20:21], v7, s[44:47], 0 offen offset:96
G2_NF_7:
    s_cmp_eq_u32 s24, 3
    s_cbranch_scc0 G2_NF_8
    buffer_load_dwordx2 v[8:9], v7, s[36:39], 0 offen offset:0
    buffer_load_dwordx2 v[10:11], v7, s[40:43], 0 offen offset:0
    buffer_load_dwordx2 v[12:13], v7, s[36:39], 0 offen offset:32
    buffer_load_dwordx2 v[14:15], v7, s[40:43], 0 offen offset:32
    buffer_load_dwordx2 v[16:17], v7, s[36:39], 0 offen offset:64
    buffer_load_dwordx2 v[18:19], v7, s[40:43], 0 offen offset:64
    buffer_load_dwordx2 v[20:21], v7, s[36:39], 0 offen offset:96
    buffer_load_dwordx2 v[22:23], v7, s[40:43], 0 offen offset:96
    ds_read_b128 v[24:27], v3 offset:0
    ds_read_b128 v[92:95], v3 offset:4096
    ds_read_b128 v[96:99], v3 offset:8192
    s_waitcnt lgkmcnt(0)
    v_add_f32 v76, v76, v24
    v_add_f32 v77, v77, v25
    v_add_f32 v78, v78, v26
    v_add_f32 v79, v79, v27
    v_add_f32 v76, v76, v92
    v_add_f32 v77, v77, v93
    v_add_f32 v78, v78, v94
    v_add_f32 v79, v79, v95
    v_add_f32 v76, v76, v96
    v_add_f32 v77, v77, v97
    v_add_f32 v78, v78, v98
    v_add_f32 v79, v79, v99
    ds_read_b128 v[24:27], v3 offset:1024
    ds_read_b128 v[92:95], v3 offset:5120
    ds_read_b128 v[96:99], v3 offset:9216
    s_waitcnt lgkmcnt(0)
    v_add_f32 v80, v80, v24
    v_add_f32 v81, v81, v25
    v_add_f32 v82, v82, v26
    v_add_f32 v83, v83, v27
    v_add_f32 v80, v80, v92
    v_add_f32 v81, v81, v93
    v_add_f32 v82, v82, v94
    v_add_f32 v83, v83, v95
    v_add_f32 v80, v80, v96
    v_add_f32 v81, v81, v97
    v_add_f32 v82, v82, v98
    v_add_f32 v83, v83, v99
    ds_read_b128 v[24:27], v3 offset:2048
    ds_read_b128 v[92:95], v3 offset:6144
    ds_read_b128 v[96:99], v3 offset:10240
    s_waitcnt lgkmcnt(0)
    v_add_f32 v84, v84, v24
    v_add_f32 v85, v85, v25
    v_add_f32 v86, v86, v26
    v_add_f32 v87, v87, v27
    v_add_f32 v84, v84, v92
    v_add_f32 v85, v85, v93
    v_add_f32 v86, v86, v94
    v_add_f32 v87, v87, v95
    v_add_f32 v84, v84, v96
    v_add_f32 v85, v85, v97
    v_add_f32 v86, v86, v98
    v_add_f32 v87, v87, v99
    ds_read_b128 v[24:27], v3 offset:3072
    ds_read_b128 v[92:95], v3 offset:7168
    ds_read_b128 v[96:99], v3 offset:11264
    s_waitcnt lgkmcnt(0)
    v_add_f32 v88, v88, v24
    v_add_f32 v89, v89, v25
    v_add_f32 v90, v90, v26
    v_add_f32 v91, v91, v27
    v_add_f32 v88, v88, v92
    v_add_f32 v89, v89, v93
    v_add_f32 v90, v90, v94
    v_add_f32 v91, v91, v95
    v_add_f32 v88, v88, v96
    v_add_f32 v89, v89, v97
    v_add_f32 v90, v90, v98
    v_add_f32 v91, v91, v99
    s_waitcnt vmcnt(0)
    v_cvt_pk_bf16_f32 v24, v76, v77
    v_cvt_pk_bf16_f32 v26, v78, v79
    v_and_b32 v25, 0xffff0000, v24
    v_lshlrev_b32 v24, 16, v24
    v_and_b32 v27, 0xffff0000, v26
    v_lshlrev_b32 v26, 16, v26
    v_mul_f32 v92, s48, v24
    v_mul_f32 v93, s48, v25
    v_mul_f32 v94, s48, v26
    v_mul_f32 v95, s48, v27
    v_exp_f32 v92, v92
    v_exp_f32 v93, v93
    v_exp_f32 v94, v94
    v_exp_f32 v95, v95
    v_add_f32 v92, 1.0, v92
    v_add_f32 v93, 1.0, v93
    v_add_f32 v94, 1.0, v94
    v_add_f32 v95, 1.0, v95
    v_rcp_f32 v92, v92
    v_rcp_f32 v93, v93
    v_rcp_f32 v94, v94
    v_rcp_f32 v95, v95
    v_mul_f32 v92, v92, v24
    v_mul_f32 v93, v93, v25
    v_mul_f32 v94, v94, v26
    v_mul_f32 v95, v95, v27
    v_cvt_pk_bf16_f32 v4, v92, v93
    v_cvt_pk_bf16_f32 v5, v94, v95
    v_lshlrev_b32 v92, 16, v4
    v_and_b32 v93, 0xffff0000, v4
    v_lshlrev_b32 v94, 16, v5
    v_and_b32 v95, 0xffff0000, v5
    v_lshlrev_b32 v96, 16, v10
    v_and_b32 v97, 0xffff0000, v10
    v_lshlrev_b32 v98, 16, v11
    v_and_b32 v99, 0xffff0000, v11
    v_mul_f32 v96, v96, v92
    v_mul_f32 v97, v97, v93
    v_mul_f32 v98, v98, v94
    v_mul_f32 v99, v99, v95
    v_cvt_pk_bf16_f32 v4, v96, v97
    v_cvt_pk_bf16_f32 v5, v98, v99
    v_lshlrev_b32 v96, 16, v4
    v_and_b32 v97, 0xffff0000, v4
    v_lshlrev_b32 v98, 16, v5
    v_and_b32 v99, 0xffff0000, v5
    v_lshlrev_b32 v24, 16, v8
    v_and_b32 v25, 0xffff0000, v8
    v_lshlrev_b32 v26, 16, v9
    v_and_b32 v27, 0xffff0000, v9
    v_add_f32 v24, v24, v96
    v_add_f32 v25, v25, v97
    v_add_f32 v26, v26, v98
    v_add_f32 v27, v27, v99
    v_cvt_pk_bf16_f32 v8, v24, v25
    v_cvt_pk_bf16_f32 v9, v26, v27
    buffer_store_dwordx2 v[8:9], v7, s[44:47], 0 offen offset:0
    v_cvt_pk_bf16_f32 v24, v80, v81
    v_cvt_pk_bf16_f32 v26, v82, v83
    v_and_b32 v25, 0xffff0000, v24
    v_lshlrev_b32 v24, 16, v24
    v_and_b32 v27, 0xffff0000, v26
    v_lshlrev_b32 v26, 16, v26
    v_mul_f32 v92, s48, v24
    v_mul_f32 v93, s48, v25
    v_mul_f32 v94, s48, v26
    v_mul_f32 v95, s48, v27
    v_exp_f32 v92, v92
    v_exp_f32 v93, v93
    v_exp_f32 v94, v94
    v_exp_f32 v95, v95
    v_add_f32 v92, 1.0, v92
    v_add_f32 v93, 1.0, v93
    v_add_f32 v94, 1.0, v94
    v_add_f32 v95, 1.0, v95
    v_rcp_f32 v92, v92
    v_rcp_f32 v93, v93
    v_rcp_f32 v94, v94
    v_rcp_f32 v95, v95
    v_mul_f32 v92, v92, v24
    v_mul_f32 v93, v93, v25
    v_mul_f32 v94, v94, v26
    v_mul_f32 v95, v95, v27
    v_cvt_pk_bf16_f32 v4, v92, v93
    v_cvt_pk_bf16_f32 v5, v94, v95
    v_lshlrev_b32 v92, 16, v4
    v_and_b32 v93, 0xffff0000, v4
    v_lshlrev_b32 v94, 16, v5
    v_and_b32 v95, 0xffff0000, v5
    v_lshlrev_b32 v96, 16, v14
    v_and_b32 v97, 0xffff0000, v14
    v_lshlrev_b32 v98, 16, v15
    v_and_b32 v99, 0xffff0000, v15
    v_mul_f32 v96, v96, v92
    v_mul_f32 v97, v97, v93
    v_mul_f32 v98, v98, v94
    v_mul_f32 v99, v99, v95
    v_cvt_pk_bf16_f32 v4, v96, v97
    v_cvt_pk_bf16_f32 v5, v98, v99
    v_lshlrev_b32 v96, 16, v4
    v_and_b32 v97, 0xffff0000, v4
    v_lshlrev_b32 v98, 16, v5
    v_and_b32 v99, 0xffff0000, v5
    v_lshlrev_b32 v24, 16, v12
    v_and_b32 v25, 0xffff0000, v12
    v_lshlrev_b32 v26, 16, v13
    v_and_b32 v27, 0xffff0000, v13
    v_add_f32 v24, v24, v96
    v_add_f32 v25, v25, v97
    v_add_f32 v26, v26, v98
    v_add_f32 v27, v27, v99
    v_cvt_pk_bf16_f32 v12, v24, v25
    v_cvt_pk_bf16_f32 v13, v26, v27
    buffer_store_dwordx2 v[12:13], v7, s[44:47], 0 offen offset:32
    v_cvt_pk_bf16_f32 v24, v84, v85
    v_cvt_pk_bf16_f32 v26, v86, v87
    v_and_b32 v25, 0xffff0000, v24
    v_lshlrev_b32 v24, 16, v24
    v_and_b32 v27, 0xffff0000, v26
    v_lshlrev_b32 v26, 16, v26
    v_mul_f32 v92, s48, v24
    v_mul_f32 v93, s48, v25
    v_mul_f32 v94, s48, v26
    v_mul_f32 v95, s48, v27
    v_exp_f32 v92, v92
    v_exp_f32 v93, v93
    v_exp_f32 v94, v94
    v_exp_f32 v95, v95
    v_add_f32 v92, 1.0, v92
    v_add_f32 v93, 1.0, v93
    v_add_f32 v94, 1.0, v94
    v_add_f32 v95, 1.0, v95
    v_rcp_f32 v92, v92
    v_rcp_f32 v93, v93
    v_rcp_f32 v94, v94
    v_rcp_f32 v95, v95
    v_mul_f32 v92, v92, v24
    v_mul_f32 v93, v93, v25
    v_mul_f32 v94, v94, v26
    v_mul_f32 v95, v95, v27
    v_cvt_pk_bf16_f32 v4, v92, v93
    v_cvt_pk_bf16_f32 v5, v94, v95
    v_lshlrev_b32 v92, 16, v4
    v_and_b32 v93, 0xffff0000, v4
    v_lshlrev_b32 v94, 16, v5
    v_and_b32 v95, 0xffff0000, v5
    v_lshlrev_b32 v96, 16, v18
    v_and_b32 v97, 0xffff0000, v18
    v_lshlrev_b32 v98, 16, v19
    v_and_b32 v99, 0xffff0000, v19
    v_mul_f32 v96, v96, v92
    v_mul_f32 v97, v97, v93
    v_mul_f32 v98, v98, v94
    v_mul_f32 v99, v99, v95
    v_cvt_pk_bf16_f32 v4, v96, v97
    v_cvt_pk_bf16_f32 v5, v98, v99
    v_lshlrev_b32 v96, 16, v4
    v_and_b32 v97, 0xffff0000, v4
    v_lshlrev_b32 v98, 16, v5
    v_and_b32 v99, 0xffff0000, v5
    v_lshlrev_b32 v24, 16, v16
    v_and_b32 v25, 0xffff0000, v16
    v_lshlrev_b32 v26, 16, v17
    v_and_b32 v27, 0xffff0000, v17
    v_add_f32 v24, v24, v96
    v_add_f32 v25, v25, v97
    v_add_f32 v26, v26, v98
    v_add_f32 v27, v27, v99
    v_cvt_pk_bf16_f32 v16, v24, v25
    v_cvt_pk_bf16_f32 v17, v26, v27
    buffer_store_dwordx2 v[16:17], v7, s[44:47], 0 offen offset:64
    v_cvt_pk_bf16_f32 v24, v88, v89
    v_cvt_pk_bf16_f32 v26, v90, v91
    v_and_b32 v25, 0xffff0000, v24
    v_lshlrev_b32 v24, 16, v24
    v_and_b32 v27, 0xffff0000, v26
    v_lshlrev_b32 v26, 16, v26
    v_mul_f32 v92, s48, v24
    v_mul_f32 v93, s48, v25
    v_mul_f32 v94, s48, v26
    v_mul_f32 v95, s48, v27
    v_exp_f32 v92, v92
    v_exp_f32 v93, v93
    v_exp_f32 v94, v94
    v_exp_f32 v95, v95
    v_add_f32 v92, 1.0, v92
    v_add_f32 v93, 1.0, v93
    v_add_f32 v94, 1.0, v94
    v_add_f32 v95, 1.0, v95
    v_rcp_f32 v92, v92
    v_rcp_f32 v93, v93
    v_rcp_f32 v94, v94
    v_rcp_f32 v95, v95
    v_mul_f32 v92, v92, v24
    v_mul_f32 v93, v93, v25
    v_mul_f32 v94, v94, v26
    v_mul_f32 v95, v95, v27
    v_cvt_pk_bf16_f32 v4, v92, v93
    v_cvt_pk_bf16_f32 v5, v94, v95
    v_lshlrev_b32 v92, 16, v4
    v_and_b32 v93, 0xffff0000, v4
    v_lshlrev_b32 v94, 16, v5
    v_and_b32 v95, 0xffff0000, v5
    v_lshlrev_b32 v96, 16, v22
    v_and_b32 v97, 0xffff0000, v22
    v_lshlrev_b32 v98, 16, v23
    v_and_b32 v99, 0xffff0000, v23
    v_mul_f32 v96, v96, v92
    v_mul_f32 v97, v97, v93
    v_mul_f32 v98, v98, v94
    v_mul_f32 v99, v99, v95
    v_cvt_pk_bf16_f32 v4, v96, v97
    v_cvt_pk_bf16_f32 v5, v98, v99
    v_lshlrev_b32 v96, 16, v4
    v_and_b32 v97, 0xffff0000, v4
    v_lshlrev_b32 v98, 16, v5
    v_and_b32 v99, 0xffff0000, v5
    v_lshlrev_b32 v24, 16, v20
    v_and_b32 v25, 0xffff0000, v20
    v_lshlrev_b32 v26, 16, v21
    v_and_b32 v27, 0xffff0000, v21
    v_add_f32 v24, v24, v96
    v_add_f32 v25, v25, v97
    v_add_f32 v26, v26, v98
    v_add_f32 v27, v27, v99
    v_cvt_pk_bf16_f32 v20, v24, v25
    v_cvt_pk_bf16_f32 v21, v26, v27
    buffer_store_dwordx2 v[20:21], v7, s[44:47], 0 offen offset:96
G2_NF_8:
    s_waitcnt vmcnt(0)
G2_END:
    s_endpgm
.section .rodata,"a"
.p2align 6
.amdhsa_kernel k1_rowfft_kernel
  .amdhsa_next_free_vgpr 154
  .amdhsa_next_free_sgpr 102
  .amdhsa_accum_offset 156
  .amdhsa_group_segment_fixed_size 0
  .amdhsa_kernarg_size 80
  .amdhsa_user_sgpr_count 2
  .amdhsa_user_sgpr_kernarg_segment_ptr 1
  .amdhsa_system_sgpr_workgroup_id_x 1
.end_amdhsa_kernel
.p2align 6
.amdhsa_kernel k2_colfft_kernel
  .amdhsa_next_free_vgpr 170
  .amdhsa_next_free_sgpr 102
  .amdhsa_accum_offset 172
  .amdhsa_group_segment_fixed_size 0
  .amdhsa_kernarg_size 80
  .amdhsa_user_sgpr_count 2
  .amdhsa_user_sgpr_kernarg_segment_ptr 1
  .amdhsa_system_sgpr_workgroup_id_x 1
.end_amdhsa_kernel
.p2align 6
.amdhsa_kernel k3_irfft_kernel
  .amdhsa_next_free_vgpr 140
  .amdhsa_next_free_sgpr 102
  .amdhsa_accum_offset 140
  .amdhsa_group_segment_fixed_size 0
  .amdhsa_kernarg_size 80
  .amdhsa_user_sgpr_count 2
  .amdhsa_user_sgpr_kernarg_segment_ptr 1
  .amdhsa_system_sgpr_workgroup_id_x 1
.end_amdhsa_kernel
.p2align 6
.amdhsa_kernel k2_gemm1_kernel
  .amdhsa_next_free_vgpr 220
  .amdhsa_next_free_sgpr 102
  .amdhsa_accum_offset 220
  .amdhsa_group_segment_fixed_size 0
  .amdhsa_kernarg_size 80
  .amdhsa_user_sgpr_count 2
  .amdhsa_user_sgpr_kernarg_segment_ptr 1
  .amdhsa_system_sgpr_workgroup_id_x 1
.end_amdhsa_kernel
.p2align 6
.amdhsa_kernel k4_gemm2_kernel
  .amdhsa_next_free_vgpr 124
  .amdhsa_next_free_sgpr 102
  .amdhsa_accum_offset 124
  .amdhsa_group_segment_fixed_size 0
  .amdhsa_kernarg_size 80
  .amdhsa_user_sgpr_count 2
  .amdhsa_user_sgpr_kernarg_segment_ptr 1
  .amdhsa_system_sgpr_workgroup_id_x 1
.end_amdhsa_kernel
.p2align 8
T1024_tw1A:
.long 0x3f800000, 0x00000000, 0x3f800000, 0x00000000, 0x3f800000, 0x00000000, 0x3f800000, 0x00000000
.long 0x3f800000, 0x00000000, 0x3f800000, 0x00000000, 0x3f800000, 0x00000000, 0x3f800000, 0x00000000
.long 0x3f800000, 0x00000000, 0x3f800000, 0x00000000, 0x3f800000, 0x00000000, 0x3f800000, 0x00000000
.long 0x3f800000, 0x00000000, 0x3f800000, 0x00000000, 0x3f800000, 0x00000000, 0x3f800000, 0x00000000
.long 0x3f800000, 0x00000000, 0x3f800000, 0x00000000, 0x3f800000, 0x00000000, 0x3f800000, 0x00000000
.long 0x3f800000, 0x00000000, 0x3f800000, 0x00000000, 0x3f800000, 0x00000000, 0x3f800000, 0x00000000
.long 0x3f800000, 0x00000000, 0x3f800000, 0x00000000, 0x3f800000, 0x00000000, 0x3f800000, 0x00000000
.long 0x3f800000, 0x00000000, 0x3f800000, 0x00000000, 0x3f800000, 0x00000000, 0x3f800000, 0x00000000
.long 0x3f800000, 0x00000000, 0x3f800000, 0x00000000, 0x3f800000, 0x00000000, 0x3f800000, 0x00000000
.long 0x3f800000, 0x00000000, 0x3f800000, 0x00000000, 0x3f800000, 0x00000000, 0x3f800000, 0x00000000
.long 0x3f800000, 0x00000000, 0x3f800000, 0x00000000, 0x3f800000, 0x00000000, 0x3f800000, 0x00000000
.long 0x3f800000, 0x00000000, 0x3f800000, 0x00000000, 0x3f800000, 0x00000000, 0x3f800000, 0x00000000
.long 0x3f800000, 0x00000000, 0x3f800000, 0x00000000, 0x3f800000, 0x00000000, 0x3f800000, 0x00000000
.long 0x3f800000, 0x00000000, 0x3f800000, 0x00000000, 0x3f800000, 0x00000000, 0x3f800000, 0x00000000
.long 0x3f800000, 0x00000000, 0x3f800000, 0x00000000, 0x3f800000, 0x00000000, 0x3f800000, 0x00000000
.long 0x3f800000, 0x00000000, 0x3f800000, 0x00000000, 0x3f800000, 0x00000000, 0x3f800000, 0x00000000
.long 0x3f800000, 0x00000000, 0x3f7ffec4, 0xbbc90f88, 0x3f7ffb11, 0xbc490e90, 0x3f7ff4e6, 0xbc96c9b6
.long 0x3f7fec43, 0xbcc90ab0, 0x3f7fe129, 0xbcfb49ba, 0x3f7fd397, 0xbd16c32c, 0x3f7fc38f, 0xbd2fe007
.long 0x3f7fb10f, 0xbd48fb30, 0x3f7f9c18, 0xbd621469, 0x3f7f84ab, 0xbd7b2b74, 0x3f7f6ac7, 0xbd8a200a
.long 0x3f7f4e6d, 0xbd96a905, 0x3f7f2f9d, 0xbda3308c, 0x3f7f0e58, 0xbdafb680, 0x3f7eea9d, 0xbdbc3ac3
.long 0x3f7ec46d, 0xbdc8bd36, 0x3f7e9bc9, 0xbdd53db9, 0x3f7e70b0, 0xbde1bc2e, 0x3f7e4323, 0xbdee3876
.long 0x3f7e1324, 0xbdfab273, 0x3f7de0b1, 0xbe039502, 0x3f7dabcc, 0xbe09cf86, 0x3f7d7474, 0xbe1008b7
.long 0x3f7d3aac, 0xbe164083, 0x3f7cfe73, 0xbe1c76de, 0x3f7cbfc9, 0xbe22abb6, 0x3f7c7eb0, 0xbe28defc
.long 0x3f7c3b28, 0xbe2f10a2, 0x3f7bf531, 0xbe354098, 0x3f7baccd, 0xbe3b6ecf, 0x3f7b61fc, 0xbe419b37
.long 0x3f7b14be, 0xbe47c5c2, 0x3f7ac516, 0xbe4dee60, 0x3f7a7302, 0xbe541501, 0x3f7a1e84, 0xbe5a3997
.long 0x3f79c79d, 0xbe605c13, 0x3f796e4e, 0xbe667c66, 0x3f791298, 0xbe6c9a7f, 0x3f78b47b, 0xbe72b651
.long 0x3f7853f8, 0xbe78cfcc, 0x3f77f110, 0xbe7ee6e1, 0x3f778bc5, 0xbe827dc0, 0x3f772417, 0xbe8586ce
.long 0x3f76ba07, 0xbe888e93, 0x3f764d97, 0xbe8b9507, 0x3f75dec6, 0xbe8e9a22, 0x3f756d97, 0xbe919ddd
.long 0x3f74fa0b, 0xbe94a031, 0x3f748422, 0xbe97a117, 0x3f740bdd, 0xbe9aa086, 0x3f73913f, 0xbe9d9e78
.long 0x3f731447, 0xbea09ae5, 0x3f7294f8, 0xbea395c5, 0x3f721352, 0xbea68f12, 0x3f718f57, 0xbea986c4
.long 0x3f710908, 0xbeac7cd4, 0x3f708066, 0xbeaf713a, 0x3f6ff573, 0xbeb263ef, 0x3f6f6830, 0xbeb554ec
.long 0x3f6ed89e, 0xbeb8442a, 0x3f6e46be, 0xbebb31a0, 0x3f6db293, 0xbebe1d4a, 0x3f6d1c1d, 0xbec1071e
.long 0x3f800000, 0x00000000, 0x3f7ffb11, 0xbc490e90, 0x3f7fec43, 0xbcc90ab0, 0x3f7fd397, 0xbd16c32c
.long 0x3f7fb10f, 0xbd48fb30, 0x3f7f84ab, 0xbd7b2b74, 0x3f7f4e6d, 0xbd96a905, 0x3f7f0e58, 0xbdafb680
.long 0x3f7ec46d, 0xbdc8bd36, 0x3f7e70b0, 0xbde1bc2e, 0x3f7e1324, 0xbdfab273, 0x3f7dabcc, 0xbe09cf86
.long 0x3f7d3aac, 0xbe164083, 0x3f7cbfc9, 0xbe22abb6, 0x3f7c3b28, 0xbe2f10a2, 0x3f7baccd, 0xbe3b6ecf
.long 0x3f7b14be, 0xbe47c5c2, 0x3f7a7302, 0xbe541501, 0x3f79c79d, 0xbe605c13, 0x3f791298, 0xbe6c9a7f
.long 0x3f7853f8, 0xbe78cfcc, 0x3f778bc5, 0xbe827dc0, 0x3f76ba07, 0xbe888e93, 0x3f75dec6, 0xbe8e9a22
.long 0x3f74fa0b, 0xbe94a031, 0x3f740bdd, 0xbe9aa086, 0x3f731447, 0xbea09ae5, 0x3f721352, 0xbea68f12
.long 0x3f710908, 0xbeac7cd4, 0x3f6ff573, 0xbeb263ef, 0x3f6ed89e, 0xbeb8442a, 0x3f6db293, 0xbebe1d4a
.long 0x3f6c835e, 0xbec3ef15, 0x3f6b4b0c, 0xbec9b953, 0x3f6a09a7, 0xbecf7bca, 0x3f68bf3c, 0xbed53641
.long 0x3f676bd8, 0xbedae880, 0x3f660f88, 0xbee0924f, 0x3f64aa59, 0xbee63375, 0x3f633c5a, 0xbeebcbbb
.long 0x3f61c598, 0xbef15aea, 0x3f604621, 0xbef6e0cb, 0x3f5ebe05, 0xbefc5d27, 0x3f5d2d53, 0xbf00e7e4
.long 0x3f5b941a, 0xbf039c3d, 0x3f59f26a, 0xbf064b82, 0x3f584853, 0xbf08f59b, 0x3f5695e5, 0xbf0b9a6b
.long 0x3f54db31, 0xbf0e39da, 0x3f531849, 0xbf10d3cd, 0x3f514d3d, 0xbf13682a, 0x3f4f7a1f, 0xbf15f6d9
.long 0x3f4d9f02, 0xbf187fc0, 0x3f4bbbf8, 0xbf1b02c6, 0x3f49d112, 0xbf1d7fd1, 0x3f47de65, 0xbf1ff6cb
.long 0x3f45e403, 0xbf226799, 0x3f43e200, 0xbf24d225, 0x3f41d870, 0xbf273656, 0x3f3fc767, 0xbf299415
.long 0x3f3daef9, 0xbf2beb4a, 0x3f3b8f3b, 0xbf2e3bde, 0x3f396842, 0xbf3085bb, 0x3f373a23, 0xbf32c8c9
.long 0x3f800000, 0x00000000, 0x3f7ff4e6, 0xbc96c9b6, 0x3f7fd397, 0xbd16c32c, 0x3f7f9c18, 0xbd621469
.long 0x3f7f4e6d, 0xbd96a905, 0x3f7eea9d, 0xbdbc3ac3, 0x3f7e70b0, 0xbde1bc2e, 0x3f7de0b1, 0xbe039502
.long 0x3f7d3aac, 0xbe164083, 0x3f7c7eb0, 0xbe28defc, 0x3f7baccd, 0xbe3b6ecf, 0x3f7ac516, 0xbe4dee60
.long 0x3f79c79d, 0xbe605c13, 0x3f78b47b, 0xbe72b651, 0x3f778bc5, 0xbe827dc0, 0x3f764d97, 0xbe8b9507
.long 0x3f74fa0b, 0xbe94a031, 0x3f73913f, 0xbe9d9e78, 0x3f721352, 0xbea68f12, 0x3f708066, 0xbeaf713a
.long 0x3f6ed89e, 0xbeb8442a, 0x3f6d1c1d, 0xbec1071e, 0x3f6b4b0c, 0xbec9b953, 0x3f696591, 0xbed25a09
.long 0x3f676bd8, 0xbedae880, 0x3f655e0b, 0xbee363fa, 0x3f633c5a, 0xbeebcbbb, 0x3f6106f2, 0xbef41f07
.long 0x3f5ebe05, 0xbefc5d27, 0x3f5c61c7, 0xbf0242b1, 0x3f59f26a, 0xbf064b82, 0x3f577026, 0xbf0a48ad
.long 0x3f54db31, 0xbf0e39da, 0x3f5233c6, 0xbf121eb0, 0x3f4f7a1f, 0xbf15f6d9, 0x3f4cae79, 0xbf19c200
.long 0x3f49d112, 0xbf1d7fd1, 0x3f46e22a, 0xbf212ff9, 0x3f43e200, 0xbf24d225, 0x3f40d0da, 0xbf286605
.long 0x3f3daef9, 0xbf2beb4a, 0x3f3a7ca4, 0xbf2f61a5, 0x3f373a23, 0xbf32c8c9, 0x3f33e7bc, 0xbf36206c
.long 0x3f3085bb, 0xbf396842, 0x3f2d1469, 0xbf3ca003, 0x3f299415, 0xbf3fc767, 0x3f26050a, 0xbf42de29
.long 0x3f226799, 0xbf45e403, 0x3f1ebc12, 0xbf48d8b3, 0x3f1b02c6, 0xbf4bbbf8, 0x3f173c07, 0xbf4e8d90
.long 0x3f13682a, 0xbf514d3d, 0x3f0f8784, 0xbf53fac3, 0x3f0b9a6b, 0xbf5695e5, 0x3f07a136, 0xbf591e6a
.long 0x3f039c3d, 0xbf5b941a, 0x3eff17b2, 0xbf5df6be, 0x3ef6e0cb, 0xbf604621, 0x3eee9479, 0xbf628210
.long 0x3ee63375, 0xbf64aa59, 0x3eddbe79, 0xbf66becc, 0x3ed53641, 0xbf68bf3c, 0x3ecc9b8b, 0xbf6aab7b
.long 0x3f800000, 0x00000000, 0x3f7fec43, 0xbcc90ab0, 0x3f7fb10f, 0xbd48fb30, 0x3f7f4e6d, 0xbd96a905
.long 0x3f7ec46d, 0xbdc8bd36, 0x3f7e1324, 0xbdfab273, 0x3f7d3aac, 0xbe164083, 0x3f7c3b28, 0xbe2f10a2
.long 0x3f7b14be, 0xbe47c5c2, 0x3f79c79d, 0xbe605c13, 0x3f7853f8, 0xbe78cfcc, 0x3f76ba07, 0xbe888e93
.long 0x3f74fa0b, 0xbe94a031, 0x3f731447, 0xbea09ae5, 0x3f710908, 0xbeac7cd4, 0x3f6ed89e, 0xbeb8442a
.long 0x3f6c835e, 0xbec3ef15, 0x3f6a09a7, 0xbecf7bca, 0x3f676bd8, 0xbedae880, 0x3f64aa59, 0xbee63375
.long 0x3f61c598, 0xbef15aea, 0x3f5ebe05, 0xbefc5d27, 0x3f5b941a, 0xbf039c3d, 0x3f584853, 0xbf08f59b
.long 0x3f54db31, 0xbf0e39da, 0x3f514d3d, 0xbf13682a, 0x3f4d9f02, 0xbf187fc0, 0x3f49d112, 0xbf1d7fd1
.long 0x3f45e403, 0xbf226799, 0x3f41d870, 0xbf273656, 0x3f3daef9, 0xbf2beb4a, 0x3f396842, 0xbf3085bb
.long 0x3f3504f3, 0xbf3504f3, 0x3f3085bb, 0xbf396842, 0x3f2beb4a, 0xbf3daef9, 0x3f273656, 0xbf41d870
.long 0x3f226799, 0xbf45e403, 0x3f1d7fd1, 0xbf49d112, 0x3f187fc0, 0xbf4d9f02, 0x3f13682a, 0xbf514d3d
.long 0x3f0e39da, 0xbf54db31, 0x3f08f59b, 0xbf584853, 0x3f039c3d, 0xbf5b941a, 0x3efc5d27, 0xbf5ebe05
.long 0x3ef15aea, 0xbf61c598, 0x3ee63375, 0xbf64aa59, 0x3edae880, 0xbf676bd8, 0x3ecf7bca, 0xbf6a09a7
.long 0x3ec3ef15, 0xbf6c835e, 0x3eb8442a, 0xbf6ed89e, 0x3eac7cd4, 0xbf710908, 0x3ea09ae5, 0xbf731447
.long 0x3e94a031, 0xbf74fa0b, 0x3e888e93, 0xbf76ba07, 0x3e78cfcc, 0xbf7853f8, 0x3e605c13, 0xbf79c79d
.long 0x3e47c5c2, 0xbf7b14be, 0x3e2f10a2, 0xbf7c3b28, 0x3e164083, 0xbf7d3aac, 0x3dfab273, 0xbf7e1324
.long 0x3dc8bd36, 0xbf7ec46d, 0x3d96a905, 0xbf7f4e6d, 0x3d48fb30, 0xbf7fb10f, 0x3cc90ab0, 0xbf7fec43
.long 0x3f800000, 0x00000000, 0x3f7fe129, 0xbcfb49ba, 0x3f7f84ab, 0xbd7b2b74, 0x3f7eea9d, 0xbdbc3ac3
.long 0x3f7e1324, 0xbdfab273, 0x3f7cfe73, 0xbe1c76de, 0x3f7baccd, 0xbe3b6ecf, 0x3f7a1e84, 0xbe5a3997
.long 0x3f7853f8, 0xbe78cfcc, 0x3f764d97, 0xbe8b9507, 0x3f740bdd, 0xbe9aa086, 0x3f718f57, 0xbea986c4
.long 0x3f6ed89e, 0xbeb8442a, 0x3f6be858, 0xbec6d529, 0x3f68bf3c, 0xbed53641, 0x3f655e0b, 0xbee363fa
.long 0x3f61c598, 0xbef15aea, 0x3f5df6be, 0xbeff17b2, 0x3f59f26a, 0xbf064b82, 0x3f55b993, 0xbf0cead0
.long 0x3f514d3d, 0xbf13682a, 0x3f4cae79, 0xbf19c200, 0x3f47de65, 0xbf1ff6cb, 0x3f42de29, 0xbf26050a
.long 0x3f3daef9, 0xbf2beb4a, 0x3f385216, 0xbf31a81d, 0x3f32c8c9, 0xbf373a23, 0x3f2d1469, 0xbf3ca003
.long 0x3f273656, 0xbf41d870, 0x3f212ff9, 0xbf46e22a, 0x3f1b02c6, 0xbf4bbbf8, 0x3f14b039, 0xbf5064af
.long 0x3f0e39da, 0xbf54db31, 0x3f07a136, 0xbf591e6a, 0x3f00e7e4, 0xbf5d2d53, 0x3ef41f07, 0xbf6106f2
.long 0x3ee63375, 0xbf64aa59, 0x3ed8106b, 0xbf6816a8, 0x3ec9b953, 0xbf6b4b0c, 0x3ebb31a0, 0xbf6e46be
.long 0x3eac7cd4, 0xbf710908, 0x3e9d9e78, 0xbf73913f, 0x3e8e9a22, 0xbf75dec6, 0x3e7ee6e1, 0xbf77f110
.long 0x3e605c13, 0xbf79c79d, 0x3e419b37, 0xbf7b61fc, 0x3e22abb6, 0xbf7cbfc9, 0x3e039502, 0xbf7de0b1
.long 0x3dc8bd36, 0xbf7ec46d, 0x3d8a200a, 0xbf7f6ac7, 0x3d16c32c, 0xbf7fd397, 0x3bc90f88, 0xbf7ffec4
.long 0xbcc90ab0, 0xbf7fec43, 0xbd621469, 0xbf7f9c18, 0xbdafb680, 0xbf7f0e58, 0xbdee3876, 0xbf7e4323
.long 0xbe164083, 0xbf7d3aac, 0xbe354098, 0xbf7bf531, 0xbe541501, 0xbf7a7302, 0xbe72b651, 0xbf78b47b
.long 0xbe888e93, 0xbf76ba07, 0xbe97a117, 0xbf748422, 0xbea68f12, 0xbf721352, 0xbeb554ec, 0xbf6f6830
.long 0x3f800000, 0x00000000, 0x3f7fd397, 0xbd16c32c, 0x3f7f4e6d, 0xbd96a905, 0x3f7e70b0, 0xbde1bc2e
.long 0x3f7d3aac, 0xbe164083, 0x3f7baccd, 0xbe3b6ecf, 0x3f79c79d, 0xbe605c13, 0x3f778bc5, 0xbe827dc0
.long 0x3f74fa0b, 0xbe94a031, 0x3f721352, 0xbea68f12, 0x3f6ed89e, 0xbeb8442a, 0x3f6b4b0c, 0xbec9b953
.long 0x3f676bd8, 0xbedae880, 0x3f633c5a, 0xbeebcbbb, 0x3f5ebe05, 0xbefc5d27, 0x3f59f26a, 0xbf064b82
.long 0x3f54db31, 0xbf0e39da, 0x3f4f7a1f, 0xbf15f6d9, 0x3f49d112, 0xbf1d7fd1, 0x3f43e200, 0xbf24d225
.long 0x3f3daef9, 0xbf2beb4a, 0x3f373a23, 0xbf32c8c9, 0x3f3085bb, 0xbf396842, 0x3f299415, 0xbf3fc767
.long 0x3f226799, 0xbf45e403, 0x3f1b02c6, 0xbf4bbbf8, 0x3f13682a, 0xbf514d3d, 0x3f0b9a6b, 0xbf5695e5
.long 0x3f039c3d, 0xbf5b941a, 0x3ef6e0cb, 0xbf604621, 0x3ee63375, 0xbf64aa59, 0x3ed53641, 0xbf68bf3c
.long 0x3ec3ef15, 0xbf6c835e, 0x3eb263ef, 0xbf6ff573, 0x3ea09ae5, 0xbf731447, 0x3e8e9a22, 0xbf75dec6
.long 0x3e78cfcc, 0xbf7853f8, 0x3e541501, 0xbf7a7302, 0x3e2f10a2, 0xbf7c3b28, 0x3e09cf86, 0xbf7dabcc
.long 0x3dc8bd36, 0xbf7ec46d, 0x3d7b2b74, 0xbf7f84ab, 0x3cc90ab0, 0xbf7fec43, 0xbc490e90, 0xbf7ffb11
.long 0xbd48fb30, 0xbf7fb10f, 0xbdafb680, 0xbf7f0e58, 0xbdfab273, 0xbf7e1324, 0xbe22abb6, 0xbf7cbfc9
.long 0xbe47c5c2, 0xbf7b14be, 0xbe6c9a7f, 0xbf791298, 0xbe888e93, 0xbf76ba07, 0xbe9aa086, 0xbf740bdd
.long 0xbeac7cd4, 0xbf710908, 0xbebe1d4a, 0xbf6db293, 0xbecf7bca, 0xbf6a09a7, 0xbee0924f, 0xbf660f88
.long 0xbef15aea, 0xbf61c598, 0xbf00e7e4, 0xbf5d2d53, 0xbf08f59b, 0xbf584853, 0xbf10d3cd, 0xbf531849
.long 0xbf187fc0, 0xbf4d9f02, 0xbf1ff6cb, 0xbf47de65, 0xbf273656, 0xbf41d870, 0xbf2e3bde, 0xbf3b8f3b
.long 0x3f800000, 0x00000000, 0x3f7fc38f, 0xbd2fe007, 0x3f7f0e58, 0xbdafb680, 0x3f7de0b1, 0xbe039502
.long 0x3f7c3b28, 0xbe2f10a2, 0x3f7a1e84, 0xbe5a3997, 0x3f778bc5, 0xbe827dc0, 0x3f748422, 0xbe97a117
.long 0x3f710908, 0xbeac7cd4, 0x3f6d1c1d, 0xbec1071e, 0x3f68bf3c, 0xbed53641, 0x3f63f473, 0xbee900b7
.long 0x3f5ebe05, 0xbefc5d27, 0x3f591e6a, 0xbf07a136, 0x3f531849, 0xbf10d3cd, 0x3f4cae79, 0xbf19c200
.long 0x3f45e403, 0xbf226799, 0x3f3ebc1b, 0xbf2ac082, 0x3f373a23, 0xbf32c8c9, 0x3f2f61a5, 0xbf3a7ca4
.long 0x3f273656, 0xbf41d870, 0x3f1ebc12, 0xbf48d8b3, 0x3f15f6d9, 0xbf4f7a1f, 0x3f0cead0, 0xbf55b993
.long 0x3f039c3d, 0xbf5b941a, 0x3ef41f07, 0xbf6106f2, 0x3ee0924f, 0xbf660f88, 0x3ecc9b8b, 0xbf6aab7b
.long 0x3eb8442a, 0xbf6ed89e, 0x3ea395c5, 0xbf7294f8, 0x3e8e9a22, 0xbf75dec6, 0x3e72b651, 0xbf78b47b
.long 0x3e47c5c2, 0xbf7b14be, 0x3e1c76de, 0xbf7cfe73, 0x3de1bc2e, 0xbf7e70b0, 0x3d8a200a, 0xbf7f6ac7
.long 0x3cc90ab0, 0xbf7fec43, 0xbc96c9b6, 0xbf7ff4e6, 0xbd7b2b74, 0xbf7f84ab, 0xbdd53db9, 0xbf7e9bc9
.long 0xbe164083, 0xbf7d3aac, 0xbe419b37, 0xbf7b61fc, 0xbe6c9a7f, 0xbf791298, 0xbe8b9507, 0xbf764d97
.long 0xbea09ae5, 0xbf731447, 0xbeb554ec, 0xbf6f6830, 0xbec9b953, 0xbf6b4b0c, 0xbeddbe79, 0xbf66becc
.long 0xbef15aea, 0xbf61c598, 0xbf0242b1, 0xbf5c61c7, 0xbf0b9a6b, 0xbf5695e5, 0xbf14b039, 0xbf5064af
.long 0xbf1d7fd1, 0xbf49d112, 0xbf26050a, 0xbf42de29, 0xbf2e3bde, 0xbf3b8f3b, 0xbf36206c, 0xbf33e7bc
.long 0xbf3daef9, 0xbf2beb4a, 0xbf44e3f5, 0xbf239da9, 0xbf4bbbf8, 0xbf1b02c6, 0xbf5233c6, 0xbf121eb0
.long 0xbf584853, 0xbf08f59b, 0xbf5df6be, 0xbeff17b2, 0xbf633c5a, 0xbeebcbbb, 0xbf6816a8, 0xbed8106b
.long 0x3f800000, 0x00000000, 0x3f7fb10f, 0xbd48fb30, 0x3f7ec46d, 0xbdc8bd36, 0x3f7d3aac, 0xbe164083
.long 0x3f7b14be, 0xbe47c5c2, 0x3f7853f8, 0xbe78cfcc, 0x3f74fa0b, 0xbe94a031, 0x3f710908, 0xbeac7cd4
.long 0x3f6c835e, 0xbec3ef15, 0x3f676bd8, 0xbedae880, 0x3f61c598, 0xbef15aea, 0x3f5b941a, 0xbf039c3d
.long 0x3f54db31, 0xbf0e39da, 0x3f4d9f02, 0xbf187fc0, 0x3f45e403, 0xbf226799, 0x3f3daef9, 0xbf2beb4a
.long 0x3f3504f3, 0xbf3504f3, 0x3f2beb4a, 0xbf3daef9, 0x3f226799, 0xbf45e403, 0x3f187fc0, 0xbf4d9f02
.long 0x3f0e39da, 0xbf54db31, 0x3f039c3d, 0xbf5b941a, 0x3ef15aea, 0xbf61c598, 0x3edae880, 0xbf676bd8
.long 0x3ec3ef15, 0xbf6c835e, 0x3eac7cd4, 0xbf710908, 0x3e94a031, 0xbf74fa0b, 0x3e78cfcc, 0xbf7853f8
.long 0x3e47c5c2, 0xbf7b14be, 0x3e164083, 0xbf7d3aac, 0x3dc8bd36, 0xbf7ec46d, 0x3d48fb30, 0xbf7fb10f
.long 0x248d3132, 0xbf800000, 0xbd48fb30, 0xbf7fb10f, 0xbdc8bd36, 0xbf7ec46d, 0xbe164083, 0xbf7d3aac
.long 0xbe47c5c2, 0xbf7b14be, 0xbe78cfcc, 0xbf7853f8, 0xbe94a031, 0xbf74fa0b, 0xbeac7cd4, 0xbf710908
.long 0xbec3ef15, 0xbf6c835e, 0xbedae880, 0xbf676bd8, 0xbef15aea, 0xbf61c598, 0xbf039c3d, 0xbf5b941a
.long 0xbf0e39da, 0xbf54db31, 0xbf187fc0, 0xbf4d9f02, 0xbf226799, 0xbf45e403, 0xbf2beb4a, 0xbf3daef9
.long 0xbf3504f3, 0xbf3504f3, 0xbf3daef9, 0xbf2beb4a, 0xbf45e403, 0xbf226799, 0xbf4d9f02, 0xbf187fc0
.long 0xbf54db31, 0xbf0e39da, 0xbf5b941a, 0xbf039c3d, 0xbf61c598, 0xbef15aea, 0xbf676bd8, 0xbedae880
.long 0xbf6c835e, 0xbec3ef15, 0xbf710908, 0xbeac7cd4, 0xbf74fa0b, 0xbe94a031, 0xbf7853f8, 0xbe78cfcc
.long 0xbf7b14be, 0xbe47c5c2, 0xbf7d3aac, 0xbe164083, 0xbf7ec46d, 0xbdc8bd36, 0xbf7fb10f, 0xbd48fb30
.long 0x3f800000, 0x00000000, 0x3f7f9c18, 0xbd621469, 0x3f7e70b0, 0xbde1bc2e, 0x3f7c7eb0, 0xbe28defc
.long 0x3f79c79d, 0xbe605c13, 0x3f764d97, 0xbe8b9507, 0x3f721352, 0xbea68f12, 0x3f6d1c1d, 0xbec1071e
.long 0x3f676bd8, 0xbedae880, 0x3f6106f2, 0xbef41f07, 0x3f59f26a, 0xbf064b82, 0x3f5233c6, 0xbf121eb0
.long 0x3f49d112, 0xbf1d7fd1, 0x3f40d0da, 0xbf286605, 0x3f373a23, 0xbf32c8c9, 0x3f2d1469, 0xbf3ca003
.long 0x3f226799, 0xbf45e403, 0x3f173c07, 0xbf4e8d90, 0x3f0b9a6b, 0xbf5695e5, 0x3eff17b2, 0xbf5df6be
.long 0x3ee63375, 0xbf64aa59, 0x3ecc9b8b, 0xbf6aab7b, 0x3eb263ef, 0xbf6ff573, 0x3e97a117, 0xbf748422
.long 0x3e78cfcc, 0xbf7853f8, 0x3e419b37, 0xbf7b61fc, 0x3e09cf86, 0xbf7dabcc, 0x3da3308c, 0xbf7f2f9d
.long 0x3cc90ab0, 0xbf7fec43, 0xbcfb49ba, 0xbf7fe129, 0xbdafb680, 0xbf7f0e58, 0xbe1008b7, 0xbf7d7474
.long 0xbe47c5c2, 0xbf7b14be, 0xbe7ee6e1, 0xbf77f110, 0xbe9aa086, 0xbf740bdd, 0xbeb554ec, 0xbf6f6830
.long 0xbecf7bca, 0xbf6a09a7, 0xbee900b7, 0xbf63f473, 0xbf00e7e4, 0xbf5d2d53, 0xbf0cead0, 0xbf55b993
.long 0xbf187fc0, 0xbf4d9f02, 0xbf239da9, 0xbf44e3f5, 0xbf2e3bde, 0xbf3b8f3b, 0xbf385216, 0xbf31a81d
.long 0xbf41d870, 0xbf273656, 0xbf4ac77f, 0xbf1c420c, 0xbf531849, 0xbf10d3cd, 0xbf5ac450, 0xbf04f484
.long 0xbf61c598, 0xbef15aea, 0xbf6816a8, 0xbed8106b, 0xbf6db293, 0xbebe1d4a, 0xbf7294f8, 0xbea395c5
.long 0xbf76ba07, 0xbe888e93, 0xbf7a1e84, 0xbe5a3997, 0xbf7cbfc9, 0xbe22abb6, 0xbf7e9bc9, 0xbdd53db9
.long 0xbf7fb10f, 0xbd48fb30, 0xbf7ffec4, 0x3bc90f88, 0xbf7f84ab, 0x3d7b2b74, 0xbf7e4323, 0x3dee3876
.long 0xbf7c3b28, 0x3e2f10a2, 0xbf796e4e, 0x3e667c66, 0xbf75dec6, 0x3e8e9a22, 0xbf718f57, 0x3ea986c4
.long 0x3f800000, 0x00000000, 0x3f7f84ab, 0xbd7b2b74, 0x3f7e1324, 0xbdfab273, 0x3f7baccd, 0xbe3b6ecf
.long 0x3f7853f8, 0xbe78cfcc, 0x3f740bdd, 0xbe9aa086, 0x3f6ed89e, 0xbeb8442a, 0x3f68bf3c, 0xbed53641
.long 0x3f61c598, 0xbef15aea, 0x3f59f26a, 0xbf064b82, 0x3f514d3d, 0xbf13682a, 0x3f47de65, 0xbf1ff6cb
.long 0x3f3daef9, 0xbf2beb4a, 0x3f32c8c9, 0xbf373a23, 0x3f273656, 0xbf41d870, 0x3f1b02c6, 0xbf4bbbf8
.long 0x3f0e39da, 0xbf54db31, 0x3f00e7e4, 0xbf5d2d53, 0x3ee63375, 0xbf64aa59, 0x3ec9b953, 0xbf6b4b0c
.long 0x3eac7cd4, 0xbf710908, 0x3e8e9a22, 0xbf75dec6, 0x3e605c13, 0xbf79c79d, 0x3e22abb6, 0xbf7cbfc9
.long 0x3dc8bd36, 0xbf7ec46d, 0x3d16c32c, 0xbf7fd397, 0xbcc90ab0, 0xbf7fec43, 0xbdafb680, 0xbf7f0e58
.long 0xbe164083, 0xbf7d3aac, 0xbe541501, 0xbf7a7302, 0xbe888e93, 0xbf76ba07, 0xbea68f12, 0xbf721352
.long 0xbec3ef15, 0xbf6c835e, 0xbee0924f, 0xbf660f88, 0xbefc5d27, 0xbf5ebe05, 0xbf0b9a6b, 0xbf5695e5
.long 0xbf187fc0, 0xbf4d9f02, 0xbf24d225, 0xbf43e200, 0xbf3085bb, 0xbf396842, 0xbf3b8f3b, 0xbf2e3bde
.long 0xbf45e403, 0xbf226799, 0xbf4f7a1f, 0xbf15f6d9, 0xbf584853, 0xbf08f59b, 0xbf604621, 0xbef6e0cb
.long 0xbf676bd8, 0xbedae880, 0xbf6db293, 0xbebe1d4a, 0xbf731447, 0xbea09ae5, 0xbf778bc5, 0xbe827dc0
.long 0xbf7b14be, 0xbe47c5c2, 0xbf7dabcc, 0xbe09cf86, 0xbf7f4e6d, 0xbd96a905, 0xbf7ffb11, 0xbc490e90
.long 0xbf7fb10f, 0x3d48fb30, 0xbf7e70b0, 0x3de1bc2e, 0xbf7c3b28, 0x3e2f10a2, 0xbf791298, 0x3e6c9a7f
.long 0xbf74fa0b, 0x3e94a031, 0xbf6ff573, 0x3eb263ef, 0xbf6a09a7, 0x3ecf7bca, 0xbf633c5a, 0x3eebcbbb
.long 0xbf5b941a, 0x3f039c3d, 0xbf531849, 0x3f10d3cd, 0xbf49d112, 0x3f1d7fd1, 0xbf3fc767, 0x3f299415
.long 0x3f800000, 0x00000000, 0x3f7f6ac7, 0xbd8a200a, 0x3f7dabcc, 0xbe09cf86, 0x3f7ac516, 0xbe4dee60
.long 0x3f76ba07, 0xbe888e93, 0x3f718f57, 0xbea986c4, 0x3f6b4b0c, 0xbec9b953, 0x3f63f473, 0xbee900b7
.long 0x3f5b941a, 0xbf039c3d, 0x3f5233c6, 0xbf121eb0, 0x3f47de65, 0xbf1ff6cb, 0x3f3ca003, 0xbf2d1469
.long 0x3f3085bb, 0xbf396842, 0x3f239da9, 0xbf44e3f5, 0x3f15f6d9, 0xbf4f7a1f, 0x3f07a136, 0xbf591e6a
.long 0x3ef15aea, 0xbf61c598, 0x3ed25a09, 0xbf696591, 0x3eb263ef, 0xbf6ff573, 0x3e919ddd, 0xbf756d97
.long 0x3e605c13, 0xbf79c79d, 0x3e1c76de, 0xbf7cfe73, 0x3dafb680, 0xbf7f0e58, 0x3c96c9b6, 0xbf7ff4e6
.long 0xbd48fb30, 0xbf7fb10f, 0xbdee3876, 0xbf7e4323, 0xbe3b6ecf, 0xbf7baccd, 0xbe7ee6e1, 0xbf77f110
.long 0xbea09ae5, 0xbf731447, 0xbec1071e, 0xbf6d1c1d, 0xbee0924f, 0xbf660f88, 0xbeff17b2, 0xbf5df6be
.long 0xbf0e39da, 0xbf54db31, 0xbf1c420c, 0xbf4ac77f, 0xbf299415, 0xbf3fc767, 0xbf36206c, 0xbf33e7bc
.long 0xbf41d870, 0xbf273656, 0xbf4cae79, 0xbf19c200, 0xbf5695e5, 0xbf0b9a6b, 0xbf5f8327, 0xbef9a02d
.long 0xbf676bd8, 0xbedae880, 0xbf6e46be, 0xbebb31a0, 0xbf740bdd, 0xbe9aa086, 0xbf78b47b, 0xbe72b651
.long 0xbf7c3b28, 0xbe2f10a2, 0xbf7e9bc9, 0xbdd53db9, 0xbf7fd397, 0xbd16c32c, 0xbf7fe129, 0x3cfb49ba
.long 0xbf7ec46d, 0x3dc8bd36, 0xbf7c7eb0, 0x3e28defc, 0xbf791298, 0x3e6c9a7f, 0xbf748422, 0x3e97a117
.long 0xbf6ed89e, 0x3eb8442a, 0xbf6816a8, 0x3ed8106b, 0xbf604621, 0x3ef6e0cb, 0xbf577026, 0x3f0a48ad
.long 0xbf4d9f02, 0x3f187fc0, 0xbf42de29, 0x3f26050a, 0xbf373a23, 0x3f32c8c9, 0xbf2ac082, 0x3f3ebc1b
.long 0xbf1d7fd1, 0x3f49d112, 0xbf0f8784, 0x3f53fac3, 0xbf00e7e4, 0x3f5d2d53, 0xbee363fa, 0x3f655e0b
.long 0x3f800000, 0x00000000, 0x3f7f4e6d, 0xbd96a905, 0x3f7d3aac, 0xbe164083, 0x3f79c79d, 0xbe605c13
.long 0x3f74fa0b, 0xbe94a031, 0x3f6ed89e, 0xbeb8442a, 0x3f676bd8, 0xbedae880, 0x3f5ebe05, 0xbefc5d27
.long 0x3f54db31, 0xbf0e39da, 0x3f49d112, 0xbf1d7fd1, 0x3f3daef9, 0xbf2beb4a, 0x3f3085bb, 0xbf396842
.long 0x3f226799, 0xbf45e403, 0x3f13682a, 0xbf514d3d, 0x3f039c3d, 0xbf5b941a, 0x3ee63375, 0xbf64aa59
.long 0x3ec3ef15, 0xbf6c835e, 0x3ea09ae5, 0xbf731447, 0x3e78cfcc, 0xbf7853f8, 0x3e2f10a2, 0xbf7c3b28
.long 0x3dc8bd36, 0xbf7ec46d, 0x3cc90ab0, 0xbf7fec43, 0xbd48fb30, 0xbf7fb10f, 0xbdfab273, 0xbf7e1324
.long 0xbe47c5c2, 0xbf7b14be, 0xbe888e93, 0xbf76ba07, 0xbeac7cd4, 0xbf710908, 0xbecf7bca, 0xbf6a09a7
.long 0xbef15aea, 0xbf61c598, 0xbf08f59b, 0xbf584853, 0xbf187fc0, 0xbf4d9f02, 0xbf273656, 0xbf41d870
.long 0xbf3504f3, 0xbf3504f3, 0xbf41d870, 0xbf273656, 0xbf4d9f02, 0xbf187fc0, 0xbf584853, 0xbf08f59b
.long 0xbf61c598, 0xbef15aea, 0xbf6a09a7, 0xbecf7bca, 0xbf710908, 0xbeac7cd4, 0xbf76ba07, 0xbe888e93
.long 0xbf7b14be, 0xbe47c5c2, 0xbf7e1324, 0xbdfab273, 0xbf7fb10f, 0xbd48fb30, 0xbf7fec43, 0x3cc90ab0
.long 0xbf7ec46d, 0x3dc8bd36, 0xbf7c3b28, 0x3e2f10a2, 0xbf7853f8, 0x3e78cfcc, 0xbf731447, 0x3ea09ae5
.long 0xbf6c835e, 0x3ec3ef15, 0xbf64aa59, 0x3ee63375, 0xbf5b941a, 0x3f039c3d, 0xbf514d3d, 0x3f13682a
.long 0xbf45e403, 0x3f226799, 0xbf396842, 0x3f3085bb, 0xbf2beb4a, 0x3f3daef9, 0xbf1d7fd1, 0x3f49d112
.long 0xbf0e39da, 0x3f54db31, 0xbefc5d27, 0x3f5ebe05, 0xbedae880, 0x3f676bd8, 0xbeb8442a, 0x3f6ed89e
.long 0xbe94a031, 0x3f74fa0b, 0xbe605c13, 0x3f79c79d, 0xbe164083, 0x3f7d3aac, 0xbd96a905, 0x3f7f4e6d
.long 0x3f800000, 0x00000000, 0x3f7f2f9d, 0xbda3308c, 0x3f7cbfc9, 0xbe22abb6, 0x3f78b47b, 0xbe72b651
.long 0x3f731447, 0xbea09ae5, 0x3f6be858, 0xbec6d529, 0x3f633c5a, 0xbeebcbbb, 0x3f591e6a, 0xbf07a136
.long 0x3f4d9f02, 0xbf187fc0, 0x3f40d0da, 0xbf286605, 0x3f32c8c9, 0xbf373a23, 0x3f239da9, 0xbf44e3f5
.long 0x3f13682a, 0xbf514d3d, 0x3f0242b1, 0xbf5c61c7, 0x3ee0924f, 0xbf660f88, 0x3ebb31a0, 0xbf6e46be
.long 0x3e94a031, 0xbf74fa0b, 0x3e5a3997, 0xbf7a1e84, 0x3e09cf86, 0xbf7dabcc, 0x3d621469, 0xbf7f9c18
.long 0xbcc90ab0, 0xbf7fec43, 0xbdd53db9, 0xbf7e9bc9, 0xbe3b6ecf, 0xbf7baccd, 0xbe8586ce, 0xbf772417
.long 0xbeac7cd4, 0xbf710908, 0xbed25a09, 0xbf696591, 0xbef6e0cb, 0xbf604621, 0xbf0cead0, 0xbf55b993
.long 0xbf1d7fd1, 0xbf49d112, 0xbf2d1469, 0xbf3ca003, 0xbf3b8f3b, 0xbf2e3bde, 0xbf48d8b3, 0xbf1ebc12
.long 0xbf54db31, 0xbf0e39da, 0xbf5f8327, 0xbef9a02d, 0xbf68bf3c, 0xbed53641, 0xbf708066, 0xbeaf713a
.long 0xbf76ba07, 0xbe888e93, 0xbf7b61fc, 0xbe419b37, 0xbf7e70b0, 0xbde1bc2e, 0xbf7fe129, 0xbcfb49ba
.long 0xbf7fb10f, 0x3d48fb30, 0xbf7de0b1, 0x3e039502, 0xbf7a7302, 0x3e541501, 0xbf756d97, 0x3e919ddd
.long 0xbf6ed89e, 0x3eb8442a, 0xbf66becc, 0x3eddbe79, 0xbf5d2d53, 0x3f00e7e4, 0xbf5233c6, 0x3f121eb0
.long 0xbf45e403, 0x3f226799, 0xbf385216, 0x3f31a81d, 0xbf299415, 0x3f3fc767, 0xbf19c200, 0x3f4cae79
.long 0xbf08f59b, 0x3f584853, 0xbeee9479, 0x3f628210, 0xbec9b953, 0x3f6b4b0c, 0xbea395c5, 0x3f7294f8
.long 0xbe78cfcc, 0x3f7853f8, 0xbe28defc, 0x3f7c7eb0, 0xbdafb680, 0x3f7f0e58, 0xbbc90f88, 0x3f7ffec4
.long 0x3d96a905, 0x3f7f4e6d, 0x3e1c76de, 0x3f7cfe73, 0x3e6c9a7f, 0x3f791298, 0x3e9d9e78, 0x3f73913f
.long 0x3f800000, 0x00000000, 0x3f7f0e58, 0xbdafb680, 0x3f7c3b28, 0xbe2f10a2, 0x3f778bc5, 0xbe827dc0
.long 0x3f710908, 0xbeac7cd4, 0x3f68bf3c, 0xbed53641, 0x3f5ebe05, 0xbefc5d27, 0x3f531849, 0xbf10d3cd
.long 0x3f45e403, 0xbf226799, 0x3f373a23, 0xbf32c8c9, 0x3f273656, 0xbf41d870, 0x3f15f6d9, 0xbf4f7a1f
.long 0x3f039c3d, 0xbf5b941a, 0x3ee0924f, 0xbf660f88, 0x3eb8442a, 0xbf6ed89e, 0x3e8e9a22, 0xbf75dec6
.long 0x3e47c5c2, 0xbf7b14be, 0x3de1bc2e, 0xbf7e70b0, 0x3cc90ab0, 0xbf7fec43, 0xbd7b2b74, 0xbf7f84ab
.long 0xbe164083, 0xbf7d3aac, 0xbe6c9a7f, 0xbf791298, 0xbea09ae5, 0xbf731447, 0xbec9b953, 0xbf6b4b0c
.long 0xbef15aea, 0xbf61c598, 0xbf0b9a6b, 0xbf5695e5, 0xbf1d7fd1, 0xbf49d112, 0xbf2e3bde, 0xbf3b8f3b
.long 0xbf3daef9, 0xbf2beb4a, 0xbf4bbbf8, 0xbf1b02c6, 0xbf584853, 0xbf08f59b, 0xbf633c5a, 0xbeebcbbb
.long 0xbf6c835e, 0xbec3ef15, 0xbf740bdd, 0xbe9aa086, 0xbf79c79d, 0xbe605c13, 0xbf7dabcc, 0xbe09cf86
.long 0xbf7fb10f, 0xbd48fb30, 0xbf7fd397, 0x3d16c32c, 0xbf7e1324, 0x3dfab273, 0xbf7a7302, 0x3e541501
.long 0xbf74fa0b, 0x3e94a031, 0xbf6db293, 0x3ebe1d4a, 0xbf64aa59, 0x3ee63375, 0xbf59f26a, 0x3f064b82
.long 0xbf4d9f02, 0x3f187fc0, 0xbf3fc767, 0x3f299415, 0xbf3085bb, 0x3f396842, 0xbf1ff6cb, 0x3f47de65
.long 0xbf0e39da, 0x3f54db31, 0xbef6e0cb, 0x3f604621, 0xbecf7bca, 0x3f6a09a7, 0xbea68f12, 0x3f721352
.long 0xbe78cfcc, 0x3f7853f8, 0xbe22abb6, 0x3f7cbfc9, 0xbd96a905, 0x3f7f4e6d, 0x3c490e90, 0x3f7ffb11
.long 0x3dc8bd36, 0x3f7ec46d, 0x3e3b6ecf, 0x3f7baccd, 0x3e888e93, 0x3f76ba07, 0x3eb263ef, 0x3f6ff573
.long 0x3edae880, 0x3f676bd8, 0x3f00e7e4, 0x3f5d2d53, 0x3f13682a, 0x3f514d3d, 0x3f24d225, 0x3f43e200
.long 0x3f800000, 0x00000000, 0x3f7eea9d, 0xbdbc3ac3, 0x3f7baccd, 0xbe3b6ecf, 0x3f764d97, 0xbe8b9507
.long 0x3f6ed89e, 0xbeb8442a, 0x3f655e0b, 0xbee363fa, 0x3f59f26a, 0xbf064b82, 0x3f4cae79, 0xbf19c200
.long 0x3f3daef9, 0xbf2beb4a, 0x3f2d1469, 0xbf3ca003, 0x3f1b02c6, 0xbf4bbbf8, 0x3f07a136, 0xbf591e6a
.long 0x3ee63375, 0xbf64aa59, 0x3ebb31a0, 0xbf6e46be, 0x3e8e9a22, 0xbf75dec6, 0x3e419b37, 0xbf7b61fc
.long 0x3dc8bd36, 0xbf7ec46d, 0x3bc90f88, 0xbf7ffec4, 0xbdafb680, 0xbf7f0e58, 0xbe354098, 0xbf7bf531
.long 0xbe888e93, 0xbf76ba07, 0xbeb554ec, 0xbf6f6830, 0xbee0924f, 0xbf660f88, 0xbf04f484, 0xbf5ac450
.long 0xbf187fc0, 0xbf4d9f02, 0xbf2ac082, 0xbf3ebc1b, 0xbf3b8f3b, 0xbf2e3bde, 0xbf4ac77f, 0xbf1c420c
.long 0xbf584853, 0xbf08f59b, 0xbf63f473, 0xbee900b7, 0xbf6db293, 0xbebe1d4a, 0xbf756d97, 0xbe919ddd
.long 0xbf7b14be, 0xbe47c5c2, 0xbf7e9bc9, 0xbdd53db9, 0xbf7ffb11, 0xbc490e90, 0xbf7f2f9d, 0x3da3308c
.long 0xbf7c3b28, 0x3e2f10a2, 0xbf772417, 0x3e8586ce, 0xbf6ff573, 0x3eb263ef, 0xbf66becc, 0x3eddbe79
.long 0xbf5b941a, 0x3f039c3d, 0xbf4e8d90, 0x3f173c07, 0xbf3fc767, 0x3f299415, 0xbf2f61a5, 0x3f3a7ca4
.long 0xbf1d7fd1, 0x3f49d112, 0xbf0a48ad, 0x3f577026, 0xbeebcbbb, 0x3f633c5a, 0xbec1071e, 0x3f6d1c1d
.long 0xbe94a031, 0x3f74fa0b, 0xbe4dee60, 0x3f7ac516, 0xbde1bc2e, 0x3f7e70b0, 0xbc96c9b6, 0x3f7ff4e6
.long 0x3d96a905, 0x3f7f4e6d, 0x3e28defc, 0x3f7c7eb0, 0x3e827dc0, 0x3f778bc5, 0x3eaf713a, 0x3f708066
.long 0x3edae880, 0x3f676bd8, 0x3f0242b1, 0x3f5c61c7, 0x3f15f6d9, 0x3f4f7a1f, 0x3f286605, 0x3f40d0da
.long 0x3f396842, 0x3f3085bb, 0x3f48d8b3, 0x3f1ebc12, 0x3f5695e5, 0x3f0b9a6b, 0x3f628210, 0x3eee9479
T1024_tw2A:
.long 0x3f800000, 0x00000000, 0x3f800000, 0x00000000, 0x3f800000, 0x00000000, 0x3f800000, 0x00000000
.long 0x3f800000, 0x00000000, 0x3f800000, 0x00000000, 0x3f800000, 0x00000000, 0x3f800000, 0x00000000
.long 0x3f800000, 0x00000000, 0x3f800000, 0x00000000, 0x3f800000, 0x00000000, 0x3f800000, 0x00000000
.long 0x3f800000, 0x00000000, 0x3f800000, 0x00000000, 0x3f800000, 0x00000000, 0x3f800000, 0x00000000
.long 0x3f800000, 0x00000000, 0x3f800000, 0x00000000, 0x3f800000, 0x00000000, 0x3f800000, 0x00000000
.long 0x3f800000, 0x00000000, 0x3f800000, 0x00000000, 0x3f800000, 0x00000000, 0x3f800000, 0x00000000
.long 0x3f800000, 0x00000000, 0x3f800000, 0x00000000, 0x3f800000, 0x00000000, 0x3f800000, 0x00000000
.long 0x3f800000, 0x00000000, 0x3f800000, 0x00000000, 0x3f800000, 0x00000000, 0x3f800000, 0x00000000
.long 0x3f800000, 0x00000000, 0x3f800000, 0x00000000, 0x3f800000, 0x00000000, 0x3f800000, 0x00000000
.long 0x3f800000, 0x00000000, 0x3f800000, 0x00000000, 0x3f800000, 0x00000000, 0x3f800000, 0x00000000
.long 0x3f800000, 0x00000000, 0x3f800000, 0x00000000, 0x3f800000, 0x00000000, 0x3f800000, 0x00000000
.long 0x3f800000, 0x00000000, 0x3f800000, 0x00000000, 0x3f800000, 0x00000000, 0x3f800000, 0x00000000
.long 0x3f800000, 0x00000000, 0x3f800000, 0x00000000, 0x3f800000, 0x00000000, 0x3f800000, 0x00000000
.long 0x3f800000, 0x00000000, 0x3f800000, 0x00000000, 0x3f800000, 0x00000000, 0x3f800000, 0x00000000
.long 0x3f800000, 0x00000000, 0x3f800000, 0x00000000, 0x3f800000, 0x00000000, 0x3f800000, 0x00000000
.long 0x3f800000, 0x00000000, 0x3f800000, 0x00000000, 0x3f800000, 0x00000000, 0x3f800000, 0x00000000
.long 0x3f800000, 0x00000000, 0x3f7ec46d, 0xbdc8bd36, 0x3f7b14be, 0xbe47c5c2, 0x3f74fa0b, 0xbe94a031
.long 0x3f800000, 0x00000000, 0x3f7ec46d, 0xbdc8bd36, 0x3f7b14be, 0xbe47c5c2, 0x3f74fa0b, 0xbe94a031
.long 0x3f800000, 0x00000000, 0x3f7ec46d, 0xbdc8bd36, 0x3f7b14be, 0xbe47c5c2, 0x3f74fa0b, 0xbe94a031
.long 0x3f800000, 0x00000000, 0x3f7ec46d, 0xbdc8bd36, 0x3f7b14be, 0xbe47c5c2, 0x3f74fa0b, 0xbe94a031
.long 0x3f800000, 0x00000000, 0x3f7ec46d, 0xbdc8bd36, 0x3f7b14be, 0xbe47c5c2, 0x3f74fa0b, 0xbe94a031
.long 0x3f800000, 0x00000000, 0x3f7ec46d, 0xbdc8bd36, 0x3f7b14be, 0xbe47c5c2, 0x3f74fa0b, 0xbe94a031
.long 0x3f800000, 0x00000000, 0x3f7ec46d, 0xbdc8bd36, 0x3f7b14be, 0xbe47c5c2, 0x3f74fa0b, 0xbe94a031
.long 0x3f800000, 0x00000000, 0x3f7ec46d, 0xbdc8bd36, 0x3f7b14be, 0xbe47c5c2, 0x3f74fa0b, 0xbe94a031
.long 0x3f800000, 0x00000000, 0x3f7ec46d, 0xbdc8bd36, 0x3f7b14be, 0xbe47c5c2, 0x3f74fa0b, 0xbe94a031
.long 0x3f800000, 0x00000000, 0x3f7ec46d, 0xbdc8bd36, 0x3f7b14be, 0xbe47c5c2, 0x3f74fa0b, 0xbe94a031
.long 0x3f800000, 0x00000000, 0x3f7ec46d, 0xbdc8bd36, 0x3f7b14be, 0xbe47c5c2, 0x3f74fa0b, 0xbe94a031
.long 0x3f800000, 0x00000000, 0x3f7ec46d, 0xbdc8bd36, 0x3f7b14be, 0xbe47c5c2, 0x3f74fa0b, 0xbe94a031
.long 0x3f800000, 0x00000000, 0x3f7ec46d, 0xbdc8bd36, 0x3f7b14be, 0xbe47c5c2, 0x3f74fa0b, 0xbe94a031
.long 0x3f800000, 0x00000000, 0x3f7ec46d, 0xbdc8bd36, 0x3f7b14be, 0xbe47c5c2, 0x3f74fa0b, 0xbe94a031
.long 0x3f800000, 0x00000000, 0x3f7ec46d, 0xbdc8bd36, 0x3f7b14be, 0xbe47c5c2, 0x3f74fa0b, 0xbe94a031
.long 0x3f800000, 0x00000000, 0x3f7ec46d, 0xbdc8bd36, 0x3f7b14be, 0xbe47c5c2, 0x3f74fa0b, 0xbe94a031
.long 0x3f800000, 0x00000000, 0x3f7b14be, 0xbe47c5c2, 0x3f6c835e, 0xbec3ef15, 0x3f54db31, 0xbf0e39da
.long 0x3f800000, 0x00000000, 0x3f7b14be, 0xbe47c5c2, 0x3f6c835e, 0xbec3ef15, 0x3f54db31, 0xbf0e39da
.long 0x3f800000, 0x00000000, 0x3f7b14be, 0xbe47c5c2, 0x3f6c835e, 0xbec3ef15, 0x3f54db31, 0xbf0e39da
.long 0x3f800000, 0x00000000, 0x3f7b14be, 0xbe47c5c2, 0x3f6c835e, 0xbec3ef15, 0x3f54db31, 0xbf0e39da
.long 0x3f800000, 0x00000000, 0x3f7b14be, 0xbe47c5c2, 0x3f6c835e, 0xbec3ef15, 0x3f54db31, 0xbf0e39da
.long 0x3f800000, 0x00000000, 0x3f7b14be, 0xbe47c5c2, 0x3f6c835e, 0xbec3ef15, 0x3f54db31, 0xbf0e39da
.long 0x3f800000, 0x00000000, 0x3f7b14be, 0xbe47c5c2, 0x3f6c835e, 0xbec3ef15, 0x3f54db31, 0xbf0e39da
.long 0x3f800000, 0x00000000, 0x3f7b14be, 0xbe47c5c2, 0x3f6c835e, 0xbec3ef15, 0x3f54db31, 0xbf0e39da
.long 0x3f800000, 0x00000000, 0x3f7b14be, 0xbe47c5c2, 0x3f6c835e, 0xbec3ef15, 0x3f54db31, 0xbf0e39da
.long 0x3f800000, 0x00000000, 0x3f7b14be, 0xbe47c5c2, 0x3f6c835e, 0xbec3ef15, 0x3f54db31, 0xbf0e39da
.long 0x3f800000, 0x00000000, 0x3f7b14be, 0xbe47c5c2, 0x3f6c835e, 0xbec3ef15, 0x3f54db31, 0xbf0e39da
.long 0x3f800000, 0x00000000, 0x3f7b14be, 0xbe47c5c2, 0x3f6c835e, 0xbec3ef15, 0x3f54db31, 0xbf0e39da
.long 0x3f800000, 0x00000000, 0x3f7b14be, 0xbe47c5c2, 0x3f6c835e, 0xbec3ef15, 0x3f54db31, 0xbf0e39da
.long 0x3f800000, 0x00000000, 0x3f7b14be, 0xbe47c5c2, 0x3f6c835e, 0xbec3ef15, 0x3f54db31, 0xbf0e39da
.long 0x3f800000, 0x00000000, 0x3f7b14be, 0xbe47c5c2, 0x3f6c835e, 0xbec3ef15, 0x3f54db31, 0xbf0e39da
.long 0x3f800000, 0x00000000, 0x3f7b14be, 0xbe47c5c2, 0x3f6c835e, 0xbec3ef15, 0x3f54db31, 0xbf0e39da
.long 0x3f800000, 0x00000000, 0x3f74fa0b, 0xbe94a031, 0x3f54db31, 0xbf0e39da, 0x3f226799, 0xbf45e403
.long 0x3f800000, 0x00000000, 0x3f74fa0b, 0xbe94a031, 0x3f54db31, 0xbf0e39da, 0x3f226799, 0xbf45e403
.long 0x3f800000, 0x00000000, 0x3f74fa0b, 0xbe94a031, 0x3f54db31, 0xbf0e39da, 0x3f226799, 0xbf45e403
.long 0x3f800000, 0x00000000, 0x3f74fa0b, 0xbe94a031, 0x3f54db31, 0xbf0e39da, 0x3f226799, 0xbf45e403
.long 0x3f800000, 0x00000000, 0x3f74fa0b, 0xbe94a031, 0x3f54db31, 0xbf0e39da, 0x3f226799, 0xbf45e403
.long 0x3f800000, 0x00000000, 0x3f74fa0b, 0xbe94a031, 0x3f54db31, 0xbf0e39da, 0x3f226799, 0xbf45e403
.long 0x3f800000, 0x00000000, 0x3f74fa0b, 0xbe94a031, 0x3f54db31, 0xbf0e39da, 0x3f226799, 0xbf45e403
.long 0x3f800000, 0x00000000, 0x3f74fa0b, 0xbe94a031, 0x3f54db31, 0xbf0e39da, 0x3f226799, 0xbf45e403
.long 0x3f800000, 0x00000000, 0x3f74fa0b, 0xbe94a031, 0x3f54db31, 0xbf0e39da, 0x3f226799, 0xbf45e403
.long 0x3f800000, 0x00000000, 0x3f74fa0b, 0xbe94a031, 0x3f54db31, 0xbf0e39da, 0x3f226799, 0xbf45e403
.long 0x3f800000, 0x00000000, 0x3f74fa0b, 0xbe94a031, 0x3f54db31, 0xbf0e39da, 0x3f226799, 0xbf45e403
.long 0x3f800000, 0x00000000, 0x3f74fa0b, 0xbe94a031, 0x3f54db31, 0xbf0e39da, 0x3f226799, 0xbf45e403
.long 0x3f800000, 0x00000000, 0x3f74fa0b, 0xbe94a031, 0x3f54db31, 0xbf0e39da, 0x3f226799, 0xbf45e403
.long 0x3f800000, 0x00000000, 0x3f74fa0b, 0xbe94a031, 0x3f54db31, 0xbf0e39da, 0x3f226799, 0xbf45e403
.long 0x3f800000, 0x00000000, 0x3f74fa0b, 0xbe94a031, 0x3f54db31, 0xbf0e39da, 0x3f226799, 0xbf45e403
.long 0x3f800000, 0x00000000, 0x3f74fa0b, 0xbe94a031, 0x3f54db31, 0xbf0e39da, 0x3f226799, 0xbf45e403
.long 0x3f800000, 0x00000000, 0x3f6c835e, 0xbec3ef15, 0x3f3504f3, 0xbf3504f3, 0x3ec3ef15, 0xbf6c835e
.long 0x3f800000, 0x00000000, 0x3f6c835e, 0xbec3ef15, 0x3f3504f3, 0xbf3504f3, 0x3ec3ef15, 0xbf6c835e
.long 0x3f800000, 0x00000000, 0x3f6c835e, 0xbec3ef15, 0x3f3504f3, 0xbf3504f3, 0x3ec3ef15, 0xbf6c835e
.long 0x3f800000, 0x00000000, 0x3f6c835e, 0xbec3ef15, 0x3f3504f3, 0xbf3504f3, 0x3ec3ef15, 0xbf6c835e
.long 0x3f800000, 0x00000000, 0x3f6c835e, 0xbec3ef15, 0x3f3504f3, 0xbf3504f3, 0x3ec3ef15, 0xbf6c835e
.long 0x3f800000, 0x00000000, 0x3f6c835e, 0xbec3ef15, 0x3f3504f3, 0xbf3504f3, 0x3ec3ef15, 0xbf6c835e
.long 0x3f800000, 0x00000000, 0x3f6c835e, 0xbec3ef15, 0x3f3504f3, 0xbf3504f3, 0x3ec3ef15, 0xbf6c835e
.long 0x3f800000, 0x00000000, 0x3f6c835e, 0xbec3ef15, 0x3f3504f3, 0xbf3504f3, 0x3ec3ef15, 0xbf6c835e
.long 0x3f800000, 0x00000000, 0x3f6c835e, 0xbec3ef15, 0x3f3504f3, 0xbf3504f3, 0x3ec3ef15, 0xbf6c835e
.long 0x3f800000, 0x00000000, 0x3f6c835e, 0xbec3ef15, 0x3f3504f3, 0xbf3504f3, 0x3ec3ef15, 0xbf6c835e
.long 0x3f800000, 0x00000000, 0x3f6c835e, 0xbec3ef15, 0x3f3504f3, 0xbf3504f3, 0x3ec3ef15, 0xbf6c835e
.long 0x3f800000, 0x00000000, 0x3f6c835e, 0xbec3ef15, 0x3f3504f3, 0xbf3504f3, 0x3ec3ef15, 0xbf6c835e
.long 0x3f800000, 0x00000000, 0x3f6c835e, 0xbec3ef15, 0x3f3504f3, 0xbf3504f3, 0x3ec3ef15, 0xbf6c835e
.long 0x3f800000, 0x00000000, 0x3f6c835e, 0xbec3ef15, 0x3f3504f3, 0xbf3504f3, 0x3ec3ef15, 0xbf6c835e
.long 0x3f800000, 0x00000000, 0x3f6c835e, 0xbec3ef15, 0x3f3504f3, 0xbf3504f3, 0x3ec3ef15, 0xbf6c835e
.long 0x3f800000, 0x00000000, 0x3f6c835e, 0xbec3ef15, 0x3f3504f3, 0xbf3504f3, 0x3ec3ef15, 0xbf6c835e
.long 0x3f800000, 0x00000000, 0x3f61c598, 0xbef15aea, 0x3f0e39da, 0xbf54db31, 0x3dc8bd36, 0xbf7ec46d
.long 0x3f800000, 0x00000000, 0x3f61c598, 0xbef15aea, 0x3f0e39da, 0xbf54db31, 0x3dc8bd36, 0xbf7ec46d
.long 0x3f800000, 0x00000000, 0x3f61c598, 0xbef15aea, 0x3f0e39da, 0xbf54db31, 0x3dc8bd36, 0xbf7ec46d
.long 0x3f800000, 0x00000000, 0x3f61c598, 0xbef15aea, 0x3f0e39da, 0xbf54db31, 0x3dc8bd36, 0xbf7ec46d
.long 0x3f800000, 0x00000000, 0x3f61c598, 0xbef15aea, 0x3f0e39da, 0xbf54db31, 0x3dc8bd36, 0xbf7ec46d
.long 0x3f800000, 0x00000000, 0x3f61c598, 0xbef15aea, 0x3f0e39da, 0xbf54db31, 0x3dc8bd36, 0xbf7ec46d
.long 0x3f800000, 0x00000000, 0x3f61c598, 0xbef15aea, 0x3f0e39da, 0xbf54db31, 0x3dc8bd36, 0xbf7ec46d
.long 0x3f800000, 0x00000000, 0x3f61c598, 0xbef15aea, 0x3f0e39da, 0xbf54db31, 0x3dc8bd36, 0xbf7ec46d
.long 0x3f800000, 0x00000000, 0x3f61c598, 0xbef15aea, 0x3f0e39da, 0xbf54db31, 0x3dc8bd36, 0xbf7ec46d
.long 0x3f800000, 0x00000000, 0x3f61c598, 0xbef15aea, 0x3f0e39da, 0xbf54db31, 0x3dc8bd36, 0xbf7ec46d
.long 0x3f800000, 0x00000000, 0x3f61c598, 0xbef15aea, 0x3f0e39da, 0xbf54db31, 0x3dc8bd36, 0xbf7ec46d
.long 0x3f800000, 0x00000000, 0x3f61c598, 0xbef15aea, 0x3f0e39da, 0xbf54db31, 0x3dc8bd36, 0xbf7ec46d
.long 0x3f800000, 0x00000000, 0x3f61c598, 0xbef15aea, 0x3f0e39da, 0xbf54db31, 0x3dc8bd36, 0xbf7ec46d
.long 0x3f800000, 0x00000000, 0x3f61c598, 0xbef15aea, 0x3f0e39da, 0xbf54db31, 0x3dc8bd36, 0xbf7ec46d
.long 0x3f800000, 0x00000000, 0x3f61c598, 0xbef15aea, 0x3f0e39da, 0xbf54db31, 0x3dc8bd36, 0xbf7ec46d
.long 0x3f800000, 0x00000000, 0x3f61c598, 0xbef15aea, 0x3f0e39da, 0xbf54db31, 0x3dc8bd36, 0xbf7ec46d
.long 0x3f800000, 0x00000000, 0x3f54db31, 0xbf0e39da, 0x3ec3ef15, 0xbf6c835e, 0xbe47c5c2, 0xbf7b14be
.long 0x3f800000, 0x00000000, 0x3f54db31, 0xbf0e39da, 0x3ec3ef15, 0xbf6c835e, 0xbe47c5c2, 0xbf7b14be
.long 0x3f800000, 0x00000000, 0x3f54db31, 0xbf0e39da, 0x3ec3ef15, 0xbf6c835e, 0xbe47c5c2, 0xbf7b14be
.long 0x3f800000, 0x00000000, 0x3f54db31, 0xbf0e39da, 0x3ec3ef15, 0xbf6c835e, 0xbe47c5c2, 0xbf7b14be
.long 0x3f800000, 0x00000000, 0x3f54db31, 0xbf0e39da, 0x3ec3ef15, 0xbf6c835e, 0xbe47c5c2, 0xbf7b14be
.long 0x3f800000, 0x00000000, 0x3f54db31, 0xbf0e39da, 0x3ec3ef15, 0xbf6c835e, 0xbe47c5c2, 0xbf7b14be
.long 0x3f800000, 0x00000000, 0x3f54db31, 0xbf0e39da, 0x3ec3ef15, 0xbf6c835e, 0xbe47c5c2, 0xbf7b14be
.long 0x3f800000, 0x00000000, 0x3f54db31, 0xbf0e39da, 0x3ec3ef15, 0xbf6c835e, 0xbe47c5c2, 0xbf7b14be
.long 0x3f800000, 0x00000000, 0x3f54db31, 0xbf0e39da, 0x3ec3ef15, 0xbf6c835e, 0xbe47c5c2, 0xbf7b14be
.long 0x3f800000, 0x00000000, 0x3f54db31, 0xbf0e39da, 0x3ec3ef15, 0xbf6c835e, 0xbe47c5c2, 0xbf7b14be
.long 0x3f800000, 0x00000000, 0x3f54db31, 0xbf0e39da, 0x3ec3ef15, 0xbf6c835e, 0xbe47c5c2, 0xbf7b14be
.long 0x3f800000, 0x00000000, 0x3f54db31, 0xbf0e39da, 0x3ec3ef15, 0xbf6c835e, 0xbe47c5c2, 0xbf7b14be
.long 0x3f800000, 0x00000000, 0x3f54db31, 0xbf0e39da, 0x3ec3ef15, 0xbf6c835e, 0xbe47c5c2, 0xbf7b14be
.long 0x3f800000, 0x00000000, 0x3f54db31, 0xbf0e39da, 0x3ec3ef15, 0xbf6c835e, 0xbe47c5c2, 0xbf7b14be
.long 0x3f800000, 0x00000000, 0x3f54db31, 0xbf0e39da, 0x3ec3ef15, 0xbf6c835e, 0xbe47c5c2, 0xbf7b14be
.long 0x3f800000, 0x00000000, 0x3f54db31, 0xbf0e39da, 0x3ec3ef15, 0xbf6c835e, 0xbe47c5c2, 0xbf7b14be
.long 0x3f800000, 0x00000000, 0x3f45e403, 0xbf226799, 0x3e47c5c2, 0xbf7b14be, 0xbef15aea, 0xbf61c598
.long 0x3f800000, 0x00000000, 0x3f45e403, 0xbf226799, 0x3e47c5c2, 0xbf7b14be, 0xbef15aea, 0xbf61c598
.long 0x3f800000, 0x00000000, 0x3f45e403, 0xbf226799, 0x3e47c5c2, 0xbf7b14be, 0xbef15aea, 0xbf61c598
.long 0x3f800000, 0x00000000, 0x3f45e403, 0xbf226799, 0x3e47c5c2, 0xbf7b14be, 0xbef15aea, 0xbf61c598
.long 0x3f800000, 0x00000000, 0x3f45e403, 0xbf226799, 0x3e47c5c2, 0xbf7b14be, 0xbef15aea, 0xbf61c598
.long 0x3f800000, 0x00000000, 0x3f45e403, 0xbf226799, 0x3e47c5c2, 0xbf7b14be, 0xbef15aea, 0xbf61c598
.long 0x3f800000, 0x00000000, 0x3f45e403, 0xbf226799, 0x3e47c5c2, 0xbf7b14be, 0xbef15aea, 0xbf61c598
.long 0x3f800000, 0x00000000, 0x3f45e403, 0xbf226799, 0x3e47c5c2, 0xbf7b14be, 0xbef15aea, 0xbf61c598
.long 0x3f800000, 0x00000000, 0x3f45e403, 0xbf226799, 0x3e47c5c2, 0xbf7b14be, 0xbef15aea, 0xbf61c598
.long 0x3f800000, 0x00000000, 0x3f45e403, 0xbf226799, 0x3e47c5c2, 0xbf7b14be, 0xbef15aea, 0xbf61c598
.long 0x3f800000, 0x00000000, 0x3f45e403, 0xbf226799, 0x3e47c5c2, 0xbf7b14be, 0xbef15aea, 0xbf61c598
.long 0x3f800000, 0x00000000, 0x3f45e403, 0xbf226799, 0x3e47c5c2, 0xbf7b14be, 0xbef15aea, 0xbf61c598
.long 0x3f800000, 0x00000000, 0x3f45e403, 0xbf226799, 0x3e47c5c2, 0xbf7b14be, 0xbef15aea, 0xbf61c598
.long 0x3f800000, 0x00000000, 0x3f45e403, 0xbf226799, 0x3e47c5c2, 0xbf7b14be, 0xbef15aea, 0xbf61c598
.long 0x3f800000, 0x00000000, 0x3f45e403, 0xbf226799, 0x3e47c5c2, 0xbf7b14be, 0xbef15aea, 0xbf61c598
.long 0x3f800000, 0x00000000, 0x3f45e403, 0xbf226799, 0x3e47c5c2, 0xbf7b14be, 0xbef15aea, 0xbf61c598
.long 0x3f800000, 0x00000000, 0x3f3504f3, 0xbf3504f3, 0x248d3132, 0xbf800000, 0xbf3504f3, 0xbf3504f3
.long 0x3f800000, 0x00000000, 0x3f3504f3, 0xbf3504f3, 0x248d3132, 0xbf800000, 0xbf3504f3, 0xbf3504f3
.long 0x3f800000, 0x00000000, 0x3f3504f3, 0xbf3504f3, 0x248d3132, 0xbf800000, 0xbf3504f3, 0xbf3504f3
.long 0x3f800000, 0x00000000, 0x3f3504f3, 0xbf3504f3, 0x248d3132, 0xbf800000, 0xbf3504f3, 0xbf3504f3
.long 0x3f800000, 0x00000000, 0x3f3504f3, 0xbf3504f3, 0x248d3132, 0xbf800000, 0xbf3504f3, 0xbf3504f3
.long 0x3f800000, 0x00000000, 0x3f3504f3, 0xbf3504f3, 0x248d3132, 0xbf800000, 0xbf3504f3, 0xbf3504f3
.long 0x3f800000, 0x00000000, 0x3f3504f3, 0xbf3504f3, 0x248d3132, 0xbf800000, 0xbf3504f3, 0xbf3504f3
.long 0x3f800000, 0x00000000, 0x3f3504f3, 0xbf3504f3, 0x248d3132, 0xbf800000, 0xbf3504f3, 0xbf3504f3
.long 0x3f800000, 0x00000000, 0x3f3504f3, 0xbf3504f3, 0x248d3132, 0xbf800000, 0xbf3504f3, 0xbf3504f3
.long 0x3f800000, 0x00000000, 0x3f3504f3, 0xbf3504f3, 0x248d3132, 0xbf800000, 0xbf3504f3, 0xbf3504f3
.long 0x3f800000, 0x00000000, 0x3f3504f3, 0xbf3504f3, 0x248d3132, 0xbf800000, 0xbf3504f3, 0xbf3504f3
.long 0x3f800000, 0x00000000, 0x3f3504f3, 0xbf3504f3, 0x248d3132, 0xbf800000, 0xbf3504f3, 0xbf3504f3
.long 0x3f800000, 0x00000000, 0x3f3504f3, 0xbf3504f3, 0x248d3132, 0xbf800000, 0xbf3504f3, 0xbf3504f3
.long 0x3f800000, 0x00000000, 0x3f3504f3, 0xbf3504f3, 0x248d3132, 0xbf800000, 0xbf3504f3, 0xbf3504f3
.long 0x3f800000, 0x00000000, 0x3f3504f3, 0xbf3504f3, 0x248d3132, 0xbf800000, 0xbf3504f3, 0xbf3504f3
.long 0x3f800000, 0x00000000, 0x3f3504f3, 0xbf3504f3, 0x248d3132, 0xbf800000, 0xbf3504f3, 0xbf3504f3
.long 0x3f800000, 0x00000000, 0x3f226799, 0xbf45e403, 0xbe47c5c2, 0xbf7b14be, 0xbf61c598, 0xbef15aea
.long 0x3f800000, 0x00000000, 0x3f226799, 0xbf45e403, 0xbe47c5c2, 0xbf7b14be, 0xbf61c598, 0xbef15aea
.long 0x3f800000, 0x00000000, 0x3f226799, 0xbf45e403, 0xbe47c5c2, 0xbf7b14be, 0xbf61c598, 0xbef15aea
.long 0x3f800000, 0x00000000, 0x3f226799, 0xbf45e403, 0xbe47c5c2, 0xbf7b14be, 0xbf61c598, 0xbef15aea
.long 0x3f800000, 0x00000000, 0x3f226799, 0xbf45e403, 0xbe47c5c2, 0xbf7b14be, 0xbf61c598, 0xbef15aea
.long 0x3f800000, 0x00000000, 0x3f226799, 0xbf45e403, 0xbe47c5c2, 0xbf7b14be, 0xbf61c598, 0xbef15aea
.long 0x3f800000, 0x00000000, 0x3f226799, 0xbf45e403, 0xbe47c5c2, 0xbf7b14be, 0xbf61c598, 0xbef15aea
.long 0x3f800000, 0x00000000, 0x3f226799, 0xbf45e403, 0xbe47c5c2, 0xbf7b14be, 0xbf61c598, 0xbef15aea
.long 0x3f800000, 0x00000000, 0x3f226799, 0xbf45e403, 0xbe47c5c2, 0xbf7b14be, 0xbf61c598, 0xbef15aea
.long 0x3f800000, 0x00000000, 0x3f226799, 0xbf45e403, 0xbe47c5c2, 0xbf7b14be, 0xbf61c598, 0xbef15aea
.long 0x3f800000, 0x00000000, 0x3f226799, 0xbf45e403, 0xbe47c5c2, 0xbf7b14be, 0xbf61c598, 0xbef15aea
.long 0x3f800000, 0x00000000, 0x3f226799, 0xbf45e403, 0xbe47c5c2, 0xbf7b14be, 0xbf61c598, 0xbef15aea
.long 0x3f800000, 0x00000000, 0x3f226799, 0xbf45e403, 0xbe47c5c2, 0xbf7b14be, 0xbf61c598, 0xbef15aea
.long 0x3f800000, 0x00000000, 0x3f226799, 0xbf45e403, 0xbe47c5c2, 0xbf7b14be, 0xbf61c598, 0xbef15aea
.long 0x3f800000, 0x00000000, 0x3f226799, 0xbf45e403, 0xbe47c5c2, 0xbf7b14be, 0xbf61c598, 0xbef15aea
.long 0x3f800000, 0x00000000, 0x3f226799, 0xbf45e403, 0xbe47c5c2, 0xbf7b14be, 0xbf61c598, 0xbef15aea
.long 0x3f800000, 0x00000000, 0x3f0e39da, 0xbf54db31, 0xbec3ef15, 0xbf6c835e, 0xbf7b14be, 0xbe47c5c2
.long 0x3f800000, 0x00000000, 0x3f0e39da, 0xbf54db31, 0xbec3ef15, 0xbf6c835e, 0xbf7b14be, 0xbe47c5c2
.long 0x3f800000, 0x00000000, 0x3f0e39da, 0xbf54db31, 0xbec3ef15, 0xbf6c835e, 0xbf7b14be, 0xbe47c5c2
.long 0x3f800000, 0x00000000, 0x3f0e39da, 0xbf54db31, 0xbec3ef15, 0xbf6c835e, 0xbf7b14be, 0xbe47c5c2
.long 0x3f800000, 0x00000000, 0x3f0e39da, 0xbf54db31, 0xbec3ef15, 0xbf6c835e, 0xbf7b14be, 0xbe47c5c2
.long 0x3f800000, 0x00000000, 0x3f0e39da, 0xbf54db31, 0xbec3ef15, 0xbf6c835e, 0xbf7b14be, 0xbe47c5c2
.long 0x3f800000, 0x00000000, 0x3f0e39da, 0xbf54db31, 0xbec3ef15, 0xbf6c835e, 0xbf7b14be, 0xbe47c5c2
.long 0x3f800000, 0x00000000, 0x3f0e39da, 0xbf54db31, 0xbec3ef15, 0xbf6c835e, 0xbf7b14be, 0xbe47c5c2
.long 0x3f800000, 0x00000000, 0x3f0e39da, 0xbf54db31, 0xbec3ef15, 0xbf6c835e, 0xbf7b14be, 0xbe47c5c2
.long 0x3f800000, 0x00000000, 0x3f0e39da, 0xbf54db31, 0xbec3ef15, 0xbf6c835e, 0xbf7b14be, 0xbe47c5c2
.long 0x3f800000, 0x00000000, 0x3f0e39da, 0xbf54db31, 0xbec3ef15, 0xbf6c835e, 0xbf7b14be, 0xbe47c5c2
.long 0x3f800000, 0x00000000, 0x3f0e39da, 0xbf54db31, 0xbec3ef15, 0xbf6c835e, 0xbf7b14be, 0xbe47c5c2
.long 0x3f800000, 0x00000000, 0x3f0e39da, 0xbf54db31, 0xbec3ef15, 0xbf6c835e, 0xbf7b14be, 0xbe47c5c2
.long 0x3f800000, 0x00000000, 0x3f0e39da, 0xbf54db31, 0xbec3ef15, 0xbf6c835e, 0xbf7b14be, 0xbe47c5c2
.long 0x3f800000, 0x00000000, 0x3f0e39da, 0xbf54db31, 0xbec3ef15, 0xbf6c835e, 0xbf7b14be, 0xbe47c5c2
.long 0x3f800000, 0x00000000, 0x3f0e39da, 0xbf54db31, 0xbec3ef15, 0xbf6c835e, 0xbf7b14be, 0xbe47c5c2
.long 0x3f800000, 0x00000000, 0x3ef15aea, 0xbf61c598, 0xbf0e39da, 0xbf54db31, 0xbf7ec46d, 0x3dc8bd36
.long 0x3f800000, 0x00000000, 0x3ef15aea, 0xbf61c598, 0xbf0e39da, 0xbf54db31, 0xbf7ec46d, 0x3dc8bd36
.long 0x3f800000, 0x00000000, 0x3ef15aea, 0xbf61c598, 0xbf0e39da, 0xbf54db31, 0xbf7ec46d, 0x3dc8bd36
.long 0x3f800000, 0x00000000, 0x3ef15aea, 0xbf61c598, 0xbf0e39da, 0xbf54db31, 0xbf7ec46d, 0x3dc8bd36
.long 0x3f800000, 0x00000000, 0x3ef15aea, 0xbf61c598, 0xbf0e39da, 0xbf54db31, 0xbf7ec46d, 0x3dc8bd36
.long 0x3f800000, 0x00000000, 0x3ef15aea, 0xbf61c598, 0xbf0e39da, 0xbf54db31, 0xbf7ec46d, 0x3dc8bd36
.long 0x3f800000, 0x00000000, 0x3ef15aea, 0xbf61c598, 0xbf0e39da, 0xbf54db31, 0xbf7ec46d, 0x3dc8bd36
.long 0x3f800000, 0x00000000, 0x3ef15aea, 0xbf61c598, 0xbf0e39da, 0xbf54db31, 0xbf7ec46d, 0x3dc8bd36
.long 0x3f800000, 0x00000000, 0x3ef15aea, 0xbf61c598, 0xbf0e39da, 0xbf54db31, 0xbf7ec46d, 0x3dc8bd36
.long 0x3f800000, 0x00000000, 0x3ef15aea, 0xbf61c598, 0xbf0e39da, 0xbf54db31, 0xbf7ec46d, 0x3dc8bd36
.long 0x3f800000, 0x00000000, 0x3ef15aea, 0xbf61c598, 0xbf0e39da, 0xbf54db31, 0xbf7ec46d, 0x3dc8bd36
.long 0x3f800000, 0x00000000, 0x3ef15aea, 0xbf61c598, 0xbf0e39da, 0xbf54db31, 0xbf7ec46d, 0x3dc8bd36
.long 0x3f800000, 0x00000000, 0x3ef15aea, 0xbf61c598, 0xbf0e39da, 0xbf54db31, 0xbf7ec46d, 0x3dc8bd36
.long 0x3f800000, 0x00000000, 0x3ef15aea, 0xbf61c598, 0xbf0e39da, 0xbf54db31, 0xbf7ec46d, 0x3dc8bd36
.long 0x3f800000, 0x00000000, 0x3ef15aea, 0xbf61c598, 0xbf0e39da, 0xbf54db31, 0xbf7ec46d, 0x3dc8bd36
.long 0x3f800000, 0x00000000, 0x3ef15aea, 0xbf61c598, 0xbf0e39da, 0xbf54db31, 0xbf7ec46d, 0x3dc8bd36
.long 0x3f800000, 0x00000000, 0x3ec3ef15, 0xbf6c835e, 0xbf3504f3, 0xbf3504f3, 0xbf6c835e, 0x3ec3ef15
.long 0x3f800000, 0x00000000, 0x3ec3ef15, 0xbf6c835e, 0xbf3504f3, 0xbf3504f3, 0xbf6c835e, 0x3ec3ef15
.long 0x3f800000, 0x00000000, 0x3ec3ef15, 0xbf6c835e, 0xbf3504f3, 0xbf3504f3, 0xbf6c835e, 0x3ec3ef15
.long 0x3f800000, 0x00000000, 0x3ec3ef15, 0xbf6c835e, 0xbf3504f3, 0xbf3504f3, 0xbf6c835e, 0x3ec3ef15
.long 0x3f800000, 0x00000000, 0x3ec3ef15, 0xbf6c835e, 0xbf3504f3, 0xbf3504f3, 0xbf6c835e, 0x3ec3ef15
.long 0x3f800000, 0x00000000, 0x3ec3ef15, 0xbf6c835e, 0xbf3504f3, 0xbf3504f3, 0xbf6c835e, 0x3ec3ef15
.long 0x3f800000, 0x00000000, 0x3ec3ef15, 0xbf6c835e, 0xbf3504f3, 0xbf3504f3, 0xbf6c835e, 0x3ec3ef15
.long 0x3f800000, 0x00000000, 0x3ec3ef15, 0xbf6c835e, 0xbf3504f3, 0xbf3504f3, 0xbf6c835e, 0x3ec3ef15
.long 0x3f800000, 0x00000000, 0x3ec3ef15, 0xbf6c835e, 0xbf3504f3, 0xbf3504f3, 0xbf6c835e, 0x3ec3ef15
.long 0x3f800000, 0x00000000, 0x3ec3ef15, 0xbf6c835e, 0xbf3504f3, 0xbf3504f3, 0xbf6c835e, 0x3ec3ef15
.long 0x3f800000, 0x00000000, 0x3ec3ef15, 0xbf6c835e, 0xbf3504f3, 0xbf3504f3, 0xbf6c835e, 0x3ec3ef15
.long 0x3f800000, 0x00000000, 0x3ec3ef15, 0xbf6c835e, 0xbf3504f3, 0xbf3504f3, 0xbf6c835e, 0x3ec3ef15
.long 0x3f800000, 0x00000000, 0x3ec3ef15, 0xbf6c835e, 0xbf3504f3, 0xbf3504f3, 0xbf6c835e, 0x3ec3ef15
.long 0x3f800000, 0x00000000, 0x3ec3ef15, 0xbf6c835e, 0xbf3504f3, 0xbf3504f3, 0xbf6c835e, 0x3ec3ef15
.long 0x3f800000, 0x00000000, 0x3ec3ef15, 0xbf6c835e, 0xbf3504f3, 0xbf3504f3, 0xbf6c835e, 0x3ec3ef15
.long 0x3f800000, 0x00000000, 0x3ec3ef15, 0xbf6c835e, 0xbf3504f3, 0xbf3504f3, 0xbf6c835e, 0x3ec3ef15
.long 0x3f800000, 0x00000000, 0x3e94a031, 0xbf74fa0b, 0xbf54db31, 0xbf0e39da, 0xbf45e403, 0x3f226799
.long 0x3f800000, 0x00000000, 0x3e94a031, 0xbf74fa0b, 0xbf54db31, 0xbf0e39da, 0xbf45e403, 0x3f226799
.long 0x3f800000, 0x00000000, 0x3e94a031, 0xbf74fa0b, 0xbf54db31, 0xbf0e39da, 0xbf45e403, 0x3f226799
.long 0x3f800000, 0x00000000, 0x3e94a031, 0xbf74fa0b, 0xbf54db31, 0xbf0e39da, 0xbf45e403, 0x3f226799
.long 0x3f800000, 0x00000000, 0x3e94a031, 0xbf74fa0b, 0xbf54db31, 0xbf0e39da, 0xbf45e403, 0x3f226799
.long 0x3f800000, 0x00000000, 0x3e94a031, 0xbf74fa0b, 0xbf54db31, 0xbf0e39da, 0xbf45e403, 0x3f226799
.long 0x3f800000, 0x00000000, 0x3e94a031, 0xbf74fa0b, 0xbf54db31, 0xbf0e39da, 0xbf45e403, 0x3f226799
.long 0x3f800000, 0x00000000, 0x3e94a031, 0xbf74fa0b, 0xbf54db31, 0xbf0e39da, 0xbf45e403, 0x3f226799
.long 0x3f800000, 0x00000000, 0x3e94a031, 0xbf74fa0b, 0xbf54db31, 0xbf0e39da, 0xbf45e403, 0x3f226799
.long 0x3f800000, 0x00000000, 0x3e94a031, 0xbf74fa0b, 0xbf54db31, 0xbf0e39da, 0xbf45e403, 0x3f226799
.long 0x3f800000, 0x00000000, 0x3e94a031, 0xbf74fa0b, 0xbf54db31, 0xbf0e39da, 0xbf45e403, 0x3f226799
.long 0x3f800000, 0x00000000, 0x3e94a031, 0xbf74fa0b, 0xbf54db31, 0xbf0e39da, 0xbf45e403, 0x3f226799
.long 0x3f800000, 0x00000000, 0x3e94a031, 0xbf74fa0b, 0xbf54db31, 0xbf0e39da, 0xbf45e403, 0x3f226799
.long 0x3f800000, 0x00000000, 0x3e94a031, 0xbf74fa0b, 0xbf54db31, 0xbf0e39da, 0xbf45e403, 0x3f226799
.long 0x3f800000, 0x00000000, 0x3e94a031, 0xbf74fa0b, 0xbf54db31, 0xbf0e39da, 0xbf45e403, 0x3f226799
.long 0x3f800000, 0x00000000, 0x3e94a031, 0xbf74fa0b, 0xbf54db31, 0xbf0e39da, 0xbf45e403, 0x3f226799
.long 0x3f800000, 0x00000000, 0x3e47c5c2, 0xbf7b14be, 0xbf6c835e, 0xbec3ef15, 0xbf0e39da, 0x3f54db31
.long 0x3f800000, 0x00000000, 0x3e47c5c2, 0xbf7b14be, 0xbf6c835e, 0xbec3ef15, 0xbf0e39da, 0x3f54db31
.long 0x3f800000, 0x00000000, 0x3e47c5c2, 0xbf7b14be, 0xbf6c835e, 0xbec3ef15, 0xbf0e39da, 0x3f54db31
.long 0x3f800000, 0x00000000, 0x3e47c5c2, 0xbf7b14be, 0xbf6c835e, 0xbec3ef15, 0xbf0e39da, 0x3f54db31
.long 0x3f800000, 0x00000000, 0x3e47c5c2, 0xbf7b14be, 0xbf6c835e, 0xbec3ef15, 0xbf0e39da, 0x3f54db31
.long 0x3f800000, 0x00000000, 0x3e47c5c2, 0xbf7b14be, 0xbf6c835e, 0xbec3ef15, 0xbf0e39da, 0x3f54db31
.long 0x3f800000, 0x00000000, 0x3e47c5c2, 0xbf7b14be, 0xbf6c835e, 0xbec3ef15, 0xbf0e39da, 0x3f54db31
.long 0x3f800000, 0x00000000, 0x3e47c5c2, 0xbf7b14be, 0xbf6c835e, 0xbec3ef15, 0xbf0e39da, 0x3f54db31
.long 0x3f800000, 0x00000000, 0x3e47c5c2, 0xbf7b14be, 0xbf6c835e, 0xbec3ef15, 0xbf0e39da, 0x3f54db31
.long 0x3f800000, 0x00000000, 0x3e47c5c2, 0xbf7b14be, 0xbf6c835e, 0xbec3ef15, 0xbf0e39da, 0x3f54db31
.long 0x3f800000, 0x00000000, 0x3e47c5c2, 0xbf7b14be, 0xbf6c835e, 0xbec3ef15, 0xbf0e39da, 0x3f54db31
.long 0x3f800000, 0x00000000, 0x3e47c5c2, 0xbf7b14be, 0xbf6c835e, 0xbec3ef15, 0xbf0e39da, 0x3f54db31
.long 0x3f800000, 0x00000000, 0x3e47c5c2, 0xbf7b14be, 0xbf6c835e, 0xbec3ef15, 0xbf0e39da, 0x3f54db31
.long 0x3f800000, 0x00000000, 0x3e47c5c2, 0xbf7b14be, 0xbf6c835e, 0xbec3ef15, 0xbf0e39da, 0x3f54db31
.long 0x3f800000, 0x00000000, 0x3e47c5c2, 0xbf7b14be, 0xbf6c835e, 0xbec3ef15, 0xbf0e39da, 0x3f54db31
.long 0x3f800000, 0x00000000, 0x3e47c5c2, 0xbf7b14be, 0xbf6c835e, 0xbec3ef15, 0xbf0e39da, 0x3f54db31
.long 0x3f800000, 0x00000000, 0x3dc8bd36, 0xbf7ec46d, 0xbf7b14be, 0xbe47c5c2, 0xbe94a031, 0x3f74fa0b
.long 0x3f800000, 0x00000000, 0x3dc8bd36, 0xbf7ec46d, 0xbf7b14be, 0xbe47c5c2, 0xbe94a031, 0x3f74fa0b
.long 0x3f800000, 0x00000000, 0x3dc8bd36, 0xbf7ec46d, 0xbf7b14be, 0xbe47c5c2, 0xbe94a031, 0x3f74fa0b
.long 0x3f800000, 0x00000000, 0x3dc8bd36, 0xbf7ec46d, 0xbf7b14be, 0xbe47c5c2, 0xbe94a031, 0x3f74fa0b
.long 0x3f800000, 0x00000000, 0x3dc8bd36, 0xbf7ec46d, 0xbf7b14be, 0xbe47c5c2, 0xbe94a031, 0x3f74fa0b
.long 0x3f800000, 0x00000000, 0x3dc8bd36, 0xbf7ec46d, 0xbf7b14be, 0xbe47c5c2, 0xbe94a031, 0x3f74fa0b
.long 0x3f800000, 0x00000000, 0x3dc8bd36, 0xbf7ec46d, 0xbf7b14be, 0xbe47c5c2, 0xbe94a031, 0x3f74fa0b
.long 0x3f800000, 0x00000000, 0x3dc8bd36, 0xbf7ec46d, 0xbf7b14be, 0xbe47c5c2, 0xbe94a031, 0x3f74fa0b
.long 0x3f800000, 0x00000000, 0x3dc8bd36, 0xbf7ec46d, 0xbf7b14be, 0xbe47c5c2, 0xbe94a031, 0x3f74fa0b
.long 0x3f800000, 0x00000000, 0x3dc8bd36, 0xbf7ec46d, 0xbf7b14be, 0xbe47c5c2, 0xbe94a031, 0x3f74fa0b
.long 0x3f800000, 0x00000000, 0x3dc8bd36, 0xbf7ec46d, 0xbf7b14be, 0xbe47c5c2, 0xbe94a031, 0x3f74fa0b
.long 0x3f800000, 0x00000000, 0x3dc8bd36, 0xbf7ec46d, 0xbf7b14be, 0xbe47c5c2, 0xbe94a031, 0x3f74fa0b
.long 0x3f800000, 0x00000000, 0x3dc8bd36, 0xbf7ec46d, 0xbf7b14be, 0xbe47c5c2, 0xbe94a031, 0x3f74fa0b
.long 0x3f800000, 0x00000000, 0x3dc8bd36, 0xbf7ec46d, 0xbf7b14be, 0xbe47c5c2, 0xbe94a031, 0x3f74fa0b
.long 0x3f800000, 0x00000000, 0x3dc8bd36, 0xbf7ec46d, 0xbf7b14be, 0xbe47c5c2, 0xbe94a031, 0x3f74fa0b
.long 0x3f800000, 0x00000000, 0x3dc8bd36, 0xbf7ec46d, 0xbf7b14be, 0xbe47c5c2, 0xbe94a031, 0x3f74fa0b
T2048_tw1A:
.long 0x3f800000, 0x00000000, 0x3f800000, 0x00000000, 0x3f800000, 0x00000000, 0x3f800000, 0x00000000
.long 0x3f800000, 0x00000000, 0x3f800000, 0x00000000, 0x3f800000, 0x00000000, 0x3f800000, 0x00000000
.long 0x3f800000, 0x00000000, 0x3f800000, 0x00000000, 0x3f800000, 0x00000000, 0x3f800000, 0x00000000
.long 0x3f800000, 0x00000000, 0x3f800000, 0x00000000, 0x3f800000, 0x00000000, 0x3f800000, 0x00000000
.long 0x3f800000, 0x00000000, 0x3f800000, 0x00000000, 0x3f800000, 0x00000000, 0x3f800000, 0x00000000
.long 0x3f800000, 0x00000000, 0x3f800000, 0x00000000, 0x3f800000, 0x00000000, 0x3f800000, 0x00000000
.long 0x3f800000, 0x00000000, 0x3f800000, 0x00000000, 0x3f800000, 0x00000000, 0x3f800000, 0x00000000
.long 0x3f800000, 0x00000000, 0x3f800000, 0x00000000, 0x3f800000, 0x00000000, 0x3f800000, 0x00000000
.long 0x3f800000, 0x00000000, 0x3f800000, 0x00000000, 0x3f800000, 0x00000000, 0x3f800000, 0x00000000
.long 0x3f800000, 0x00000000, 0x3f800000, 0x00000000, 0x3f800000, 0x00000000, 0x3f800000, 0x00000000
.long 0x3f800000, 0x00000000, 0x3f800000, 0x00000000, 0x3f800000, 0x00000000, 0x3f800000, 0x00000000
.long 0x3f800000, 0x00000000, 0x3f800000, 0x00000000, 0x3f800000, 0x00000000, 0x3f800000, 0x00000000
.long 0x3f800000, 0x00000000, 0x3f800000, 0x00000000, 0x3f800000, 0x00000000, 0x3f800000, 0x00000000
.long 0x3f800000, 0x00000000, 0x3f800000, 0x00000000, 0x3f800000, 0x00000000, 0x3f800000, 0x00000000
.long 0x3f800000, 0x00000000, 0x3f800000, 0x00000000, 0x3f800000, 0x00000000, 0x3f800000, 0x00000000
.long 0x3f800000, 0x00000000, 0x3f800000, 0x00000000, 0x3f800000, 0x00000000, 0x3f800000, 0x00000000
.long 0x3f800000, 0x00000000, 0x3f800000, 0x00000000, 0x3f800000, 0x00000000, 0x3f800000, 0x00000000
.long 0x3f800000, 0x00000000, 0x3f800000, 0x00000000, 0x3f800000, 0x00000000, 0x3f800000, 0x00000000
.long 0x3f800000, 0x00000000, 0x3f800000, 0x00000000, 0x3f800000, 0x00000000, 0x3f800000, 0x00000000
.long 0x3f800000, 0x00000000, 0x3f800000, 0x00000000, 0x3f800000, 0x00000000, 0x3f800000, 0x00000000
.long 0x3f800000, 0x00000000, 0x3f800000, 0x00000000, 0x3f800000, 0x00000000, 0x3f800000, 0x00000000
.long 0x3f800000, 0x00000000, 0x3f800000, 0x00000000, 0x3f800000, 0x00000000, 0x3f800000, 0x00000000
.long 0x3f800000, 0x00000000, 0x3f800000, 0x00000000, 0x3f800000, 0x00000000, 0x3f800000, 0x00000000
.long 0x3f800000, 0x00000000, 0x3f800000, 0x00000000, 0x3f800000, 0x00000000, 0x3f800000, 0x00000000
.long 0x3f800000, 0x00000000, 0x3f800000, 0x00000000, 0x3f800000, 0x00000000, 0x3f800000, 0x00000000
.long 0x3f800000, 0x00000000, 0x3f800000, 0x00000000, 0x3f800000, 0x00000000, 0x3f800000, 0x00000000
.long 0x3f800000, 0x00000000, 0x3f800000, 0x00000000, 0x3f800000, 0x00000000, 0x3f800000, 0x00000000
.long 0x3f800000, 0x00000000, 0x3f800000, 0x00000000, 0x3f800000, 0x00000000, 0x3f800000, 0x00000000
.long 0x3f800000, 0x00000000, 0x3f800000, 0x00000000, 0x3f800000, 0x00000000, 0x3f800000, 0x00000000
.long 0x3f800000, 0x00000000, 0x3f800000, 0x00000000, 0x3f800000, 0x00000000, 0x3f800000, 0x00000000
.long 0x3f800000, 0x00000000, 0x3f800000, 0x00000000, 0x3f800000, 0x00000000, 0x3f800000, 0x00000000
.long 0x3f800000, 0x00000000, 0x3f800000, 0x00000000, 0x3f800000, 0x00000000, 0x3f800000, 0x00000000
.long 0x3f800000, 0x00000000, 0x3f7fffb1, 0xbb490fc6, 0x3f7ffec4, 0xbbc90f88, 0x3f7ffd39, 0xbc16cb58
.long 0x3f7ffb11, 0xbc490e90, 0x3f7ff84a, 0xbc7b514b, 0x3f7ff4e6, 0xbc96c9b6, 0x3f7ff0e3, 0xbcafea69
.long 0x3f7fec43, 0xbcc90ab0, 0x3f7fe705, 0xbce22a7a, 0x3f7fe129, 0xbcfb49ba, 0x3f7fdaaf, 0xbd0a342f
.long 0x3f7fd397, 0xbd16c32c, 0x3f7fcbe2, 0xbd2351cb, 0x3f7fc38f, 0xbd2fe007, 0x3f7fba9e, 0xbd3c6dd5
.long 0x3f7fb10f, 0xbd48fb30, 0x3f7fa6e3, 0xbd55880e, 0x3f7f9c18, 0xbd621469, 0x3f7f90b1, 0xbd6ea038
.long 0x3f7f84ab, 0xbd7b2b74, 0x3f7f7808, 0xbd83db0a, 0x3f7f6ac7, 0xbd8a200a, 0x3f7f5ce9, 0xbd9064b4
.long 0x3f7f4e6d, 0xbd96a905, 0x3f7f3f54, 0xbd9cecf9, 0x3f7f2f9d, 0xbda3308c, 0x3f7f1f49, 0xbda973ba
.long 0x3f7f0e58, 0xbdafb680, 0x3f7efcc9, 0xbdb5f8da, 0x3f7eea9d, 0xbdbc3ac3, 0x3f7ed7d4, 0xbdc27c39
.long 0x3f7ec46d, 0xbdc8bd36, 0x3f7eb069, 0xbdcefdb7, 0x3f7e9bc9, 0xbdd53db9, 0x3f7e868b, 0xbddb7d37
.long 0x3f7e70b0, 0xbde1bc2e, 0x3f7e5a38, 0xbde7fa9a, 0x3f7e4323, 0xbdee3876, 0x3f7e2b72, 0xbdf475c0
.long 0x3f7e1324, 0xbdfab273, 0x3f7dfa38, 0xbe007745, 0x3f7de0b1, 0xbe039502, 0x3f7dc68c, 0xbe06b26e
.long 0x3f7dabcc, 0xbe09cf86, 0x3f7d906e, 0xbe0cec4a, 0x3f7d7474, 0xbe1008b7, 0x3f7d57de, 0xbe1324ca
.long 0x3f7d3aac, 0xbe164083, 0x3f7d1cdd, 0xbe195be0, 0x3f7cfe73, 0xbe1c76de, 0x3f7cdf6c, 0xbe1f917b
.long 0x3f7cbfc9, 0xbe22abb6, 0x3f7c9f8a, 0xbe25c58c, 0x3f7c7eb0, 0xbe28defc, 0x3f7c5d3a, 0xbe2bf804
.long 0x3f7c3b28, 0xbe2f10a2, 0x3f7c187a, 0xbe3228d4, 0x3f7bf531, 0xbe354098, 0x3f7bd14d, 0xbe3857ec
.long 0x3f7baccd, 0xbe3b6ecf, 0x3f7b87b2, 0xbe3e853e, 0x3f7b61fc, 0xbe419b37, 0x3f7b3bab, 0xbe44b0b9
.long 0x3f7b14be, 0xbe47c5c2, 0x3f7aed37, 0xbe4ada4f, 0x3f7ac516, 0xbe4dee60, 0x3f7a9c59, 0xbe5101f1
.long 0x3f7a7302, 0xbe541501, 0x3f7a4910, 0xbe57278f, 0x3f7a1e84, 0xbe5a3997, 0x3f79f35e, 0xbe5d4b1a
.long 0x3f79c79d, 0xbe605c13, 0x3f799b43, 0xbe636c83, 0x3f796e4e, 0xbe667c66, 0x3f7940c0, 0xbe698bba
.long 0x3f791298, 0xbe6c9a7f, 0x3f78e3d6, 0xbe6fa8b2, 0x3f78b47b, 0xbe72b651, 0x3f788486, 0xbe75c35a
.long 0x3f7853f8, 0xbe78cfcc, 0x3f7822d1, 0xbe7bdba4, 0x3f77f110, 0xbe7ee6e1, 0x3f77beb7, 0xbe80f8c0
.long 0x3f778bc5, 0xbe827dc0, 0x3f77583a, 0xbe840270, 0x3f772417, 0xbe8586ce, 0x3f76ef5b, 0xbe870ada
.long 0x3f76ba07, 0xbe888e93, 0x3f76841b, 0xbe8a11f7, 0x3f764d97, 0xbe8b9507, 0x3f76167a, 0xbe8d17c0
.long 0x3f75dec6, 0xbe8e9a22, 0x3f75a67b, 0xbe901c2c, 0x3f756d97, 0xbe919ddd, 0x3f75341d, 0xbe931f35
.long 0x3f74fa0b, 0xbe94a031, 0x3f74bf62, 0xbe9620d2, 0x3f748422, 0xbe97a117, 0x3f74484b, 0xbe9920fe
.long 0x3f740bdd, 0xbe9aa086, 0x3f73ced9, 0xbe9c1faf, 0x3f73913f, 0xbe9d9e78, 0x3f73530e, 0xbe9f1cdf
.long 0x3f731447, 0xbea09ae5, 0x3f72d4eb, 0xbea21887, 0x3f7294f8, 0xbea395c5, 0x3f725470, 0xbea5129f
.long 0x3f721352, 0xbea68f12, 0x3f71d19f, 0xbea80b1f, 0x3f718f57, 0xbea986c4, 0x3f714c7a, 0xbeab0201
.long 0x3f710908, 0xbeac7cd4, 0x3f70c501, 0xbeadf73c, 0x3f708066, 0xbeaf713a, 0x3f703b37, 0xbeb0eacb
.long 0x3f6ff573, 0xbeb263ef, 0x3f6faf1b, 0xbeb3dca5, 0x3f6f6830, 0xbeb554ec, 0x3f6f20b0, 0xbeb6ccc3
.long 0x3f6ed89e, 0xbeb8442a, 0x3f6e8ff8, 0xbeb9bb1e, 0x3f6e46be, 0xbebb31a0, 0x3f6dfcf2, 0xbebca7af
.long 0x3f6db293, 0xbebe1d4a, 0x3f6d67a1, 0xbebf926f, 0x3f6d1c1d, 0xbec1071e, 0x3f6cd007, 0xbec27b55
.long 0x3f800000, 0x00000000, 0x3f7ffec4, 0xbbc90f88, 0x3f7ffb11, 0xbc490e90, 0x3f7ff4e6, 0xbc96c9b6
.long 0x3f7fec43, 0xbcc90ab0, 0x3f7fe129, 0xbcfb49ba, 0x3f7fd397, 0xbd16c32c, 0x3f7fc38f, 0xbd2fe007
.long 0x3f7fb10f, 0xbd48fb30, 0x3f7f9c18, 0xbd621469, 0x3f7f84ab, 0xbd7b2b74, 0x3f7f6ac7, 0xbd8a200a
.long 0x3f7f4e6d, 0xbd96a905, 0x3f7f2f9d, 0xbda3308c, 0x3f7f0e58, 0xbdafb680, 0x3f7eea9d, 0xbdbc3ac3
.long 0x3f7ec46d, 0xbdc8bd36, 0x3f7e9bc9, 0xbdd53db9, 0x3f7e70b0, 0xbde1bc2e, 0x3f7e4323, 0xbdee3876
.long 0x3f7e1324, 0xbdfab273, 0x3f7de0b1, 0xbe039502, 0x3f7dabcc, 0xbe09cf86, 0x3f7d7474, 0xbe1008b7
.long 0x3f7d3aac, 0xbe164083, 0x3f7cfe73, 0xbe1c76de, 0x3f7cbfc9, 0xbe22abb6, 0x3f7c7eb0, 0xbe28defc
.long 0x3f7c3b28, 0xbe2f10a2, 0x3f7bf531, 0xbe354098, 0x3f7baccd, 0xbe3b6ecf, 0x3f7b61fc, 0xbe419b37
.long 0x3f7b14be, 0xbe47c5c2, 0x3f7ac516, 0xbe4dee60, 0x3f7a7302, 0xbe541501, 0x3f7a1e84, 0xbe5a3997
.long 0x3f79c79d, 0xbe605c13, 0x3f796e4e, 0xbe667c66, 0x3f791298, 0xbe6c9a7f, 0x3f78b47b, 0xbe72b651
.long 0x3f7853f8, 0xbe78cfcc, 0x3f77f110, 0xbe7ee6e1, 0x3f778bc5, 0xbe827dc0, 0x3f772417, 0xbe8586ce
.long 0x3f76ba07, 0xbe888e93, 0x3f764d97, 0xbe8b9507, 0x3f75dec6, 0xbe8e9a22, 0x3f756d97, 0xbe919ddd
.long 0x3f74fa0b, 0xbe94a031, 0x3f748422, 0xbe97a117, 0x3f740bdd, 0xbe9aa086, 0x3f73913f, 0xbe9d9e78
.long 0x3f731447, 0xbea09ae5, 0x3f7294f8, 0xbea395c5, 0x3f721352, 0xbea68f12, 0x3f718f57, 0xbea986c4
.long 0x3f710908, 0xbeac7cd4, 0x3f708066, 0xbeaf713a, 0x3f6ff573, 0xbeb263ef, 0x3f6f6830, 0xbeb554ec
.long 0x3f6ed89e, 0xbeb8442a, 0x3f6e46be, 0xbebb31a0, 0x3f6db293, 0xbebe1d4a, 0x3f6d1c1d, 0xbec1071e
.long 0x3f6c835e, 0xbec3ef15, 0x3f6be858, 0xbec6d529, 0x3f6b4b0c, 0xbec9b953, 0x3f6aab7b, 0xbecc9b8b
.long 0x3f6a09a7, 0xbecf7bca, 0x3f696591, 0xbed25a09, 0x3f68bf3c, 0xbed53641, 0x3f6816a8, 0xbed8106b
.long 0x3f676bd8, 0xbedae880, 0x3f66becc, 0xbeddbe79, 0x3f660f88, 0xbee0924f, 0x3f655e0b, 0xbee363fa
.long 0x3f64aa59, 0xbee63375, 0x3f63f473, 0xbee900b7, 0x3f633c5a, 0xbeebcbbb, 0x3f628210, 0xbeee9479
.long 0x3f61c598, 0xbef15aea, 0x3f6106f2, 0xbef41f07, 0x3f604621, 0xbef6e0cb, 0x3f5f8327, 0xbef9a02d
.long 0x3f5ebe05, 0xbefc5d27, 0x3f5df6be, 0xbeff17b2, 0x3f5d2d53, 0xbf00e7e4, 0x3f5c61c7, 0xbf0242b1
.long 0x3f5b941a, 0xbf039c3d, 0x3f5ac450, 0xbf04f484, 0x3f59f26a, 0xbf064b82, 0x3f591e6a, 0xbf07a136
.long 0x3f584853, 0xbf08f59b, 0x3f577026, 0xbf0a48ad, 0x3f5695e5, 0xbf0b9a6b, 0x3f55b993, 0xbf0cead0
.long 0x3f54db31, 0xbf0e39da, 0x3f53fac3, 0xbf0f8784, 0x3f531849, 0xbf10d3cd, 0x3f5233c6, 0xbf121eb0
.long 0x3f514d3d, 0xbf13682a, 0x3f5064af, 0xbf14b039, 0x3f4f7a1f, 0xbf15f6d9, 0x3f4e8d90, 0xbf173c07
.long 0x3f4d9f02, 0xbf187fc0, 0x3f4cae79, 0xbf19c200, 0x3f4bbbf8, 0xbf1b02c6, 0x3f4ac77f, 0xbf1c420c
.long 0x3f49d112, 0xbf1d7fd1, 0x3f48d8b3, 0xbf1ebc12, 0x3f47de65, 0xbf1ff6cb, 0x3f46e22a, 0xbf212ff9
.long 0x3f45e403, 0xbf226799, 0x3f44e3f5, 0xbf239da9, 0x3f43e200, 0xbf24d225, 0x3f42de29, 0xbf26050a
.long 0x3f41d870, 0xbf273656, 0x3f40d0da, 0xbf286605, 0x3f3fc767, 0xbf299415, 0x3f3ebc1b, 0xbf2ac082
.long 0x3f3daef9, 0xbf2beb4a, 0x3f3ca003, 0xbf2d1469, 0x3f3b8f3b, 0xbf2e3bde, 0x3f3a7ca4, 0xbf2f61a5
.long 0x3f396842, 0xbf3085bb, 0x3f385216, 0xbf31a81d, 0x3f373a23, 0xbf32c8c9, 0x3f36206c, 0xbf33e7bc
.long 0x3f800000, 0x00000000, 0x3f7ffd39, 0xbc16cb58, 0x3f7ff4e6, 0xbc96c9b6, 0x3f7fe705, 0xbce22a7a
.long 0x3f7fd397, 0xbd16c32c, 0x3f7fba9e, 0xbd3c6dd5, 0x3f7f9c18, 0xbd621469, 0x3f7f7808, 0xbd83db0a
.long 0x3f7f4e6d, 0xbd96a905, 0x3f7f1f49, 0xbda973ba, 0x3f7eea9d, 0xbdbc3ac3, 0x3f7eb069, 0xbdcefdb7
.long 0x3f7e70b0, 0xbde1bc2e, 0x3f7e2b72, 0xbdf475c0, 0x3f7de0b1, 0xbe039502, 0x3f7d906e, 0xbe0cec4a
.long 0x3f7d3aac, 0xbe164083, 0x3f7cdf6c, 0xbe1f917b, 0x3f7c7eb0, 0xbe28defc, 0x3f7c187a, 0xbe3228d4
.long 0x3f7baccd, 0xbe3b6ecf, 0x3f7b3bab, 0xbe44b0b9, 0x3f7ac516, 0xbe4dee60, 0x3f7a4910, 0xbe57278f
.long 0x3f79c79d, 0xbe605c13, 0x3f7940c0, 0xbe698bba, 0x3f78b47b, 0xbe72b651, 0x3f7822d1, 0xbe7bdba4
.long 0x3f778bc5, 0xbe827dc0, 0x3f76ef5b, 0xbe870ada, 0x3f764d97, 0xbe8b9507, 0x3f75a67b, 0xbe901c2c
.long 0x3f74fa0b, 0xbe94a031, 0x3f74484b, 0xbe9920fe, 0x3f73913f, 0xbe9d9e78, 0x3f72d4eb, 0xbea21887
.long 0x3f721352, 0xbea68f12, 0x3f714c7a, 0xbeab0201, 0x3f708066, 0xbeaf713a, 0x3f6faf1b, 0xbeb3dca5
.long 0x3f6ed89e, 0xbeb8442a, 0x3f6dfcf2, 0xbebca7af, 0x3f6d1c1d, 0xbec1071e, 0x3f6c3624, 0xbec5625c
.long 0x3f6b4b0c, 0xbec9b953, 0x3f6a5ad9, 0xbece0bea, 0x3f696591, 0xbed25a09, 0x3f686b39, 0xbed6a399
.long 0x3f676bd8, 0xbedae880, 0x3f666771, 0xbedf28a9, 0x3f655e0b, 0xbee363fa, 0x3f644fac, 0xbee79a5d
.long 0x3f633c5a, 0xbeebcbbb, 0x3f62241a, 0xbeeff7fb, 0x3f6106f2, 0xbef41f07, 0x3f5fe4e9, 0xbef840c8
.long 0x3f5ebe05, 0xbefc5d27, 0x3f5d924d, 0xbf003a06, 0x3f5c61c7, 0xbf0242b1, 0x3f5b2c79, 0xbf044889
.long 0x3f59f26a, 0xbf064b82, 0x3f58b3a1, 0xbf084b92, 0x3f577026, 0xbf0a48ad, 0x3f5627fe, 0xbf0c42c9
.long 0x3f54db31, 0xbf0e39da, 0x3f5389c7, 0xbf102dd5, 0x3f5233c6, 0xbf121eb0, 0x3f50d937, 0xbf140c5f
.long 0x3f4f7a1f, 0xbf15f6d9, 0x3f4e1689, 0xbf17de12, 0x3f4cae79, 0xbf19c200, 0x3f4b41fa, 0xbf1ba299
.long 0x3f49d112, 0xbf1d7fd1, 0x3f485bca, 0xbf1f599f, 0x3f46e22a, 0xbf212ff9, 0x3f456439, 0xbf2302d3
.long 0x3f43e200, 0xbf24d225, 0x3f425b89, 0xbf269de3, 0x3f40d0da, 0xbf286605, 0x3f3f41fc, 0xbf2a2a80
.long 0x3f3daef9, 0xbf2beb4a, 0x3f3c17d9, 0xbf2da859, 0x3f3a7ca4, 0xbf2f61a5, 0x3f38dd65, 0xbf311722
.long 0x3f373a23, 0xbf32c8c9, 0x3f3592e7, 0xbf34768f, 0x3f33e7bc, 0xbf36206c, 0x3f3238aa, 0xbf37c655
.long 0x3f3085bb, 0xbf396842, 0x3f2ecef7, 0xbf3b0629, 0x3f2d1469, 0xbf3ca003, 0x3f2b561b, 0xbf3e35c5
.long 0x3f299415, 0xbf3fc767, 0x3f27ce61, 0xbf4154e1, 0x3f26050a, 0xbf42de29, 0x3f24381a, 0xbf446337
.long 0x3f226799, 0xbf45e403, 0x3f209393, 0xbf476085, 0x3f1ebc12, 0xbf48d8b3, 0x3f1ce11f, 0xbf4a4c87
.long 0x3f1b02c6, 0xbf4bbbf8, 0x3f19210f, 0xbf4d26fd, 0x3f173c07, 0xbf4e8d90, 0x3f1553b7, 0xbf4fefa8
.long 0x3f13682a, 0xbf514d3d, 0x3f11796b, 0xbf52a649, 0x3f0f8784, 0xbf53fac3, 0x3f0d9281, 0xbf554aa4
.long 0x3f0b9a6b, 0xbf5695e5, 0x3f099f4e, 0xbf57dc7f, 0x3f07a136, 0xbf591e6a, 0x3f05a02c, 0xbf5a5ba0
.long 0x3f039c3d, 0xbf5b941a, 0x3f019573, 0xbf5cc7d1, 0x3eff17b2, 0xbf5df6be, 0x3efafef7, 0xbf5f20db
.long 0x3ef6e0cb, 0xbf604621, 0x3ef2bd43, 0xbf61668a, 0x3eee9479, 0xbf628210, 0x3eea6681, 0xbf6398ac
.long 0x3ee63375, 0xbf64aa59, 0x3ee1fb6a, 0xbf65b710, 0x3eddbe79, 0xbf66becc, 0x3ed97cb9, 0xbf67c187
.long 0x3ed53641, 0xbf68bf3c, 0x3ed0eb2a, 0xbf69b7e4, 0x3ecc9b8b, 0xbf6aab7b, 0x3ec8477c, 0xbf6b99fb
.long 0x3f800000, 0x00000000, 0x3f7ffb11, 0xbc490e90, 0x3f7fec43, 0xbcc90ab0, 0x3f7fd397, 0xbd16c32c
.long 0x3f7fb10f, 0xbd48fb30, 0x3f7f84ab, 0xbd7b2b74, 0x3f7f4e6d, 0xbd96a905, 0x3f7f0e58, 0xbdafb680
.long 0x3f7ec46d, 0xbdc8bd36, 0x3f7e70b0, 0xbde1bc2e, 0x3f7e1324, 0xbdfab273, 0x3f7dabcc, 0xbe09cf86
.long 0x3f7d3aac, 0xbe164083, 0x3f7cbfc9, 0xbe22abb6, 0x3f7c3b28, 0xbe2f10a2, 0x3f7baccd, 0xbe3b6ecf
.long 0x3f7b14be, 0xbe47c5c2, 0x3f7a7302, 0xbe541501, 0x3f79c79d, 0xbe605c13, 0x3f791298, 0xbe6c9a7f
.long 0x3f7853f8, 0xbe78cfcc, 0x3f778bc5, 0xbe827dc0, 0x3f76ba07, 0xbe888e93, 0x3f75dec6, 0xbe8e9a22
.long 0x3f74fa0b, 0xbe94a031, 0x3f740bdd, 0xbe9aa086, 0x3f731447, 0xbea09ae5, 0x3f721352, 0xbea68f12
.long 0x3f710908, 0xbeac7cd4, 0x3f6ff573, 0xbeb263ef, 0x3f6ed89e, 0xbeb8442a, 0x3f6db293, 0xbebe1d4a
.long 0x3f6c835e, 0xbec3ef15, 0x3f6b4b0c, 0xbec9b953, 0x3f6a09a7, 0xbecf7bca, 0x3f68bf3c, 0xbed53641
.long 0x3f676bd8, 0xbedae880, 0x3f660f88, 0xbee0924f, 0x3f64aa59, 0xbee63375, 0x3f633c5a, 0xbeebcbbb
.long 0x3f61c598, 0xbef15aea, 0x3f604621, 0xbef6e0cb, 0x3f5ebe05, 0xbefc5d27, 0x3f5d2d53, 0xbf00e7e4
.long 0x3f5b941a, 0xbf039c3d, 0x3f59f26a, 0xbf064b82, 0x3f584853, 0xbf08f59b, 0x3f5695e5, 0xbf0b9a6b
.long 0x3f54db31, 0xbf0e39da, 0x3f531849, 0xbf10d3cd, 0x3f514d3d, 0xbf13682a, 0x3f4f7a1f, 0xbf15f6d9
.long 0x3f4d9f02, 0xbf187fc0, 0x3f4bbbf8, 0xbf1b02c6, 0x3f49d112, 0xbf1d7fd1, 0x3f47de65, 0xbf1ff6cb
.long 0x3f45e403, 0xbf226799, 0x3f43e200, 0xbf24d225, 0x3f41d870, 0xbf273656, 0x3f3fc767, 0xbf299415
.long 0x3f3daef9, 0xbf2beb4a, 0x3f3b8f3b, 0xbf2e3bde, 0x3f396842, 0xbf3085bb, 0x3f373a23, 0xbf32c8c9
.long 0x3f3504f3, 0xbf3504f3, 0x3f32c8c9, 0xbf373a23, 0x3f3085bb, 0xbf396842, 0x3f2e3bde, 0xbf3b8f3b
.long 0x3f2beb4a, 0xbf3daef9, 0x3f299415, 0xbf3fc767, 0x3f273656, 0xbf41d870, 0x3f24d225, 0xbf43e200
.long 0x3f226799, 0xbf45e403, 0x3f1ff6cb, 0xbf47de65, 0x3f1d7fd1, 0xbf49d112, 0x3f1b02c6, 0xbf4bbbf8
.long 0x3f187fc0, 0xbf4d9f02, 0x3f15f6d9, 0xbf4f7a1f, 0x3f13682a, 0xbf514d3d, 0x3f10d3cd, 0xbf531849
.long 0x3f0e39da, 0xbf54db31, 0x3f0b9a6b, 0xbf5695e5, 0x3f08f59b, 0xbf584853, 0x3f064b82, 0xbf59f26a
.long 0x3f039c3d, 0xbf5b941a, 0x3f00e7e4, 0xbf5d2d53, 0x3efc5d27, 0xbf5ebe05, 0x3ef6e0cb, 0xbf604621
.long 0x3ef15aea, 0xbf61c598, 0x3eebcbbb, 0xbf633c5a, 0x3ee63375, 0xbf64aa59, 0x3ee0924f, 0xbf660f88
.long 0x3edae880, 0xbf676bd8, 0x3ed53641, 0xbf68bf3c, 0x3ecf7bca, 0xbf6a09a7, 0x3ec9b953, 0xbf6b4b0c
.long 0x3ec3ef15, 0xbf6c835e, 0x3ebe1d4a, 0xbf6db293, 0x3eb8442a, 0xbf6ed89e, 0x3eb263ef, 0xbf6ff573
.long 0x3eac7cd4, 0xbf710908, 0x3ea68f12, 0xbf721352, 0x3ea09ae5, 0xbf731447, 0x3e9aa086, 0xbf740bdd
.long 0x3e94a031, 0xbf74fa0b, 0x3e8e9a22, 0xbf75dec6, 0x3e888e93, 0xbf76ba07, 0x3e827dc0, 0xbf778bc5
.long 0x3e78cfcc, 0xbf7853f8, 0x3e6c9a7f, 0xbf791298, 0x3e605c13, 0xbf79c79d, 0x3e541501, 0xbf7a7302
.long 0x3e47c5c2, 0xbf7b14be, 0x3e3b6ecf, 0xbf7baccd, 0x3e2f10a2, 0xbf7c3b28, 0x3e22abb6, 0xbf7cbfc9
.long 0x3e164083, 0xbf7d3aac, 0x3e09cf86, 0xbf7dabcc, 0x3dfab273, 0xbf7e1324, 0x3de1bc2e, 0xbf7e70b0
.long 0x3dc8bd36, 0xbf7ec46d, 0x3dafb680, 0xbf7f0e58, 0x3d96a905, 0xbf7f4e6d, 0x3d7b2b74, 0xbf7f84ab
.long 0x3d48fb30, 0xbf7fb10f, 0x3d16c32c, 0xbf7fd397, 0x3cc90ab0, 0xbf7fec43, 0x3c490e90, 0xbf7ffb11
.long 0x3f800000, 0x00000000, 0x3f7ff84a, 0xbc7b514b, 0x3f7fe129, 0xbcfb49ba, 0x3f7fba9e, 0xbd3c6dd5
.long 0x3f7f84ab, 0xbd7b2b74, 0x3f7f3f54, 0xbd9cecf9, 0x3f7eea9d, 0xbdbc3ac3, 0x3f7e868b, 0xbddb7d37
.long 0x3f7e1324, 0xbdfab273, 0x3f7d906e, 0xbe0cec4a, 0x3f7cfe73, 0xbe1c76de, 0x3f7c5d3a, 0xbe2bf804
.long 0x3f7baccd, 0xbe3b6ecf, 0x3f7aed37, 0xbe4ada4f, 0x3f7a1e84, 0xbe5a3997, 0x3f7940c0, 0xbe698bba
.long 0x3f7853f8, 0xbe78cfcc, 0x3f77583a, 0xbe840270, 0x3f764d97, 0xbe8b9507, 0x3f75341d, 0xbe931f35
.long 0x3f740bdd, 0xbe9aa086, 0x3f72d4eb, 0xbea21887, 0x3f718f57, 0xbea986c4, 0x3f703b37, 0xbeb0eacb
.long 0x3f6ed89e, 0xbeb8442a, 0x3f6d67a1, 0xbebf926f, 0x3f6be858, 0xbec6d529, 0x3f6a5ad9, 0xbece0bea
.long 0x3f68bf3c, 0xbed53641, 0x3f671599, 0xbedc53c1, 0x3f655e0b, 0xbee363fa, 0x3f6398ac, 0xbeea6681
.long 0x3f61c598, 0xbef15aea, 0x3f5fe4e9, 0xbef840c8, 0x3f5df6be, 0xbeff17b2, 0x3f5bfb34, 0xbf02ef9f
.long 0x3f59f26a, 0xbf064b82, 0x3f57dc7f, 0xbf099f4e, 0x3f55b993, 0xbf0cead0, 0x3f5389c7, 0xbf102dd5
.long 0x3f514d3d, 0xbf13682a, 0x3f4f0417, 0xbf16999f, 0x3f4cae79, 0xbf19c200, 0x3f4a4c87, 0xbf1ce11f
.long 0x3f47de65, 0xbf1ff6cb, 0x3f456439, 0xbf2302d3, 0x3f42de29, 0xbf26050a, 0x3f404c5c, 0xbf28fd41
.long 0x3f3daef9, 0xbf2beb4a, 0x3f3b0629, 0xbf2ecef7, 0x3f385216, 0xbf31a81d, 0x3f3592e7, 0xbf34768f
.long 0x3f32c8c9, 0xbf373a23, 0x3f2ff3e6, 0xbf39f2ac, 0x3f2d1469, 0xbf3ca003, 0x3f2a2a80, 0xbf3f41fc
.long 0x3f273656, 0xbf41d870, 0x3f24381a, 0xbf446337, 0x3f212ff9, 0xbf46e22a, 0x3f1e1e22, 0xbf495521
.long 0x3f1b02c6, 0xbf4bbbf8, 0x3f17de12, 0xbf4e1689, 0x3f14b039, 0xbf5064af, 0x3f11796b, 0xbf52a649
.long 0x3f0e39da, 0xbf54db31, 0x3f0af1b7, 0xbf570348, 0x3f07a136, 0xbf591e6a, 0x3f044889, 0xbf5b2c79
.long 0x3f00e7e4, 0xbf5d2d53, 0x3efafef7, 0xbf5f20db, 0x3ef41f07, 0xbf6106f2, 0x3eed3063, 0xbf62df7b
.long 0x3ee63375, 0xbf64aa59, 0x3edf28a9, 0xbf666771, 0x3ed8106b, 0xbf6816a8, 0x3ed0eb2a, 0xbf69b7e4
.long 0x3ec9b953, 0xbf6b4b0c, 0x3ec27b55, 0xbf6cd007, 0x3ebb31a0, 0xbf6e46be, 0x3eb3dca5, 0xbf6faf1b
.long 0x3eac7cd4, 0xbf710908, 0x3ea5129f, 0xbf725470, 0x3e9d9e78, 0xbf73913f, 0x3e9620d2, 0xbf74bf62
.long 0x3e8e9a22, 0xbf75dec6, 0x3e870ada, 0xbf76ef5b, 0x3e7ee6e1, 0xbf77f110, 0x3e6fa8b2, 0xbf78e3d6
.long 0x3e605c13, 0xbf79c79d, 0x3e5101f1, 0xbf7a9c59, 0x3e419b37, 0xbf7b61fc, 0x3e3228d4, 0xbf7c187a
.long 0x3e22abb6, 0xbf7cbfc9, 0x3e1324ca, 0xbf7d57de, 0x3e039502, 0xbf7de0b1, 0x3de7fa9a, 0xbf7e5a38
.long 0x3dc8bd36, 0xbf7ec46d, 0x3da973ba, 0xbf7f1f49, 0x3d8a200a, 0xbf7f6ac7, 0x3d55880e, 0xbf7fa6e3
.long 0x3d16c32c, 0xbf7fd397, 0x3cafea69, 0xbf7ff0e3, 0x3bc90f88, 0xbf7ffec4, 0xbc16cb58, 0xbf7ffd39
.long 0xbcc90ab0, 0xbf7fec43, 0xbd2351cb, 0xbf7fcbe2, 0xbd621469, 0xbf7f9c18, 0xbd9064b4, 0xbf7f5ce9
.long 0xbdafb680, 0xbf7f0e58, 0xbdcefdb7, 0xbf7eb069, 0xbdee3876, 0xbf7e4323, 0xbe06b26e, 0xbf7dc68c
.long 0xbe164083, 0xbf7d3aac, 0xbe25c58c, 0xbf7c9f8a, 0xbe354098, 0xbf7bf531, 0xbe44b0b9, 0xbf7b3bab
.long 0xbe541501, 0xbf7a7302, 0xbe636c83, 0xbf799b43, 0xbe72b651, 0xbf78b47b, 0xbe80f8c0, 0xbf77beb7
.long 0xbe888e93, 0xbf76ba07, 0xbe901c2c, 0xbf75a67b, 0xbe97a117, 0xbf748422, 0xbe9f1cdf, 0xbf73530e
.long 0xbea68f12, 0xbf721352, 0xbeadf73c, 0xbf70c501, 0xbeb554ec, 0xbf6f6830, 0xbebca7af, 0xbf6dfcf2
.long 0x3f800000, 0x00000000, 0x3f7ff4e6, 0xbc96c9b6, 0x3f7fd397, 0xbd16c32c, 0x3f7f9c18, 0xbd621469
.long 0x3f7f4e6d, 0xbd96a905, 0x3f7eea9d, 0xbdbc3ac3, 0x3f7e70b0, 0xbde1bc2e, 0x3f7de0b1, 0xbe039502
.long 0x3f7d3aac, 0xbe164083, 0x3f7c7eb0, 0xbe28defc, 0x3f7baccd, 0xbe3b6ecf, 0x3f7ac516, 0xbe4dee60
.long 0x3f79c79d, 0xbe605c13, 0x3f78b47b, 0xbe72b651, 0x3f778bc5, 0xbe827dc0, 0x3f764d97, 0xbe8b9507
.long 0x3f74fa0b, 0xbe94a031, 0x3f73913f, 0xbe9d9e78, 0x3f721352, 0xbea68f12, 0x3f708066, 0xbeaf713a
.long 0x3f6ed89e, 0xbeb8442a, 0x3f6d1c1d, 0xbec1071e, 0x3f6b4b0c, 0xbec9b953, 0x3f696591, 0xbed25a09
.long 0x3f676bd8, 0xbedae880, 0x3f655e0b, 0xbee363fa, 0x3f633c5a, 0xbeebcbbb, 0x3f6106f2, 0xbef41f07
.long 0x3f5ebe05, 0xbefc5d27, 0x3f5c61c7, 0xbf0242b1, 0x3f59f26a, 0xbf064b82, 0x3f577026, 0xbf0a48ad
.long 0x3f54db31, 0xbf0e39da, 0x3f5233c6, 0xbf121eb0, 0x3f4f7a1f, 0xbf15f6d9, 0x3f4cae79, 0xbf19c200
.long 0x3f49d112, 0xbf1d7fd1, 0x3f46e22a, 0xbf212ff9, 0x3f43e200, 0xbf24d225, 0x3f40d0da, 0xbf286605
.long 0x3f3daef9, 0xbf2beb4a, 0x3f3a7ca4, 0xbf2f61a5, 0x3f373a23, 0xbf32c8c9, 0x3f33e7bc, 0xbf36206c
.long 0x3f3085bb, 0xbf396842, 0x3f2d1469, 0xbf3ca003, 0x3f299415, 0xbf3fc767, 0x3f26050a, 0xbf42de29
.long 0x3f226799, 0xbf45e403, 0x3f1ebc12, 0xbf48d8b3, 0x3f1b02c6, 0xbf4bbbf8, 0x3f173c07, 0xbf4e8d90
.long 0x3f13682a, 0xbf514d3d, 0x3f0f8784, 0xbf53fac3, 0x3f0b9a6b, 0xbf5695e5, 0x3f07a136, 0xbf591e6a
.long 0x3f039c3d, 0xbf5b941a, 0x3eff17b2, 0xbf5df6be, 0x3ef6e0cb, 0xbf604621, 0x3eee9479, 0xbf628210
.long 0x3ee63375, 0xbf64aa59, 0x3eddbe79, 0xbf66becc, 0x3ed53641, 0xbf68bf3c, 0x3ecc9b8b, 0xbf6aab7b
.long 0x3ec3ef15, 0xbf6c835e, 0x3ebb31a0, 0xbf6e46be, 0x3eb263ef, 0xbf6ff573, 0x3ea986c4, 0xbf718f57
.long 0x3ea09ae5, 0xbf731447, 0x3e97a117, 0xbf748422, 0x3e8e9a22, 0xbf75dec6, 0x3e8586ce, 0xbf772417
.long 0x3e78cfcc, 0xbf7853f8, 0x3e667c66, 0xbf796e4e, 0x3e541501, 0xbf7a7302, 0x3e419b37, 0xbf7b61fc
.long 0x3e2f10a2, 0xbf7c3b28, 0x3e1c76de, 0xbf7cfe73, 0x3e09cf86, 0xbf7dabcc, 0x3dee3876, 0xbf7e4323
.long 0x3dc8bd36, 0xbf7ec46d, 0x3da3308c, 0xbf7f2f9d, 0x3d7b2b74, 0xbf7f84ab, 0x3d2fe007, 0xbf7fc38f
.long 0x3cc90ab0, 0xbf7fec43, 0x3bc90f88, 0xbf7ffec4, 0xbc490e90, 0xbf7ffb11, 0xbcfb49ba, 0xbf7fe129
.long 0xbd48fb30, 0xbf7fb10f, 0xbd8a200a, 0xbf7f6ac7, 0xbdafb680, 0xbf7f0e58, 0xbdd53db9, 0xbf7e9bc9
.long 0xbdfab273, 0xbf7e1324, 0xbe1008b7, 0xbf7d7474, 0xbe22abb6, 0xbf7cbfc9, 0xbe354098, 0xbf7bf531
.long 0xbe47c5c2, 0xbf7b14be, 0xbe5a3997, 0xbf7a1e84, 0xbe6c9a7f, 0xbf791298, 0xbe7ee6e1, 0xbf77f110
.long 0xbe888e93, 0xbf76ba07, 0xbe919ddd, 0xbf756d97, 0xbe9aa086, 0xbf740bdd, 0xbea395c5, 0xbf7294f8
.long 0xbeac7cd4, 0xbf710908, 0xbeb554ec, 0xbf6f6830, 0xbebe1d4a, 0xbf6db293, 0xbec6d529, 0xbf6be858
.long 0xbecf7bca, 0xbf6a09a7, 0xbed8106b, 0xbf6816a8, 0xbee0924f, 0xbf660f88, 0xbee900b7, 0xbf63f473
.long 0xbef15aea, 0xbf61c598, 0xbef9a02d, 0xbf5f8327, 0xbf00e7e4, 0xbf5d2d53, 0xbf04f484, 0xbf5ac450
.long 0xbf08f59b, 0xbf584853, 0xbf0cead0, 0xbf55b993, 0xbf10d3cd, 0xbf531849, 0xbf14b039, 0xbf5064af
.long 0xbf187fc0, 0xbf4d9f02, 0xbf1c420c, 0xbf4ac77f, 0xbf1ff6cb, 0xbf47de65, 0xbf239da9, 0xbf44e3f5
.long 0xbf273656, 0xbf41d870, 0xbf2ac082, 0xbf3ebc1b, 0xbf2e3bde, 0xbf3b8f3b, 0xbf31a81d, 0xbf385216
.long 0x3f800000, 0x00000000, 0x3f7ff0e3, 0xbcafea69, 0x3f7fc38f, 0xbd2fe007, 0x3f7f7808, 0xbd83db0a
.long 0x3f7f0e58, 0xbdafb680, 0x3f7e868b, 0xbddb7d37, 0x3f7de0b1, 0xbe039502, 0x3f7d1cdd, 0xbe195be0
.long 0x3f7c3b28, 0xbe2f10a2, 0x3f7b3bab, 0xbe44b0b9, 0x3f7a1e84, 0xbe5a3997, 0x3f78e3d6, 0xbe6fa8b2
.long 0x3f778bc5, 0xbe827dc0, 0x3f76167a, 0xbe8d17c0, 0x3f748422, 0xbe97a117, 0x3f72d4eb, 0xbea21887
.long 0x3f710908, 0xbeac7cd4, 0x3f6f20b0, 0xbeb6ccc3, 0x3f6d1c1d, 0xbec1071e, 0x3f6afb8c, 0xbecb2aae
.long 0x3f68bf3c, 0xbed53641, 0x3f666771, 0xbedf28a9, 0x3f63f473, 0xbee900b7, 0x3f61668a, 0xbef2bd43
.long 0x3f5ebe05, 0xbefc5d27, 0x3f5bfb34, 0xbf02ef9f, 0x3f591e6a, 0xbf07a136, 0x3f5627fe, 0xbf0c42c9
.long 0x3f531849, 0xbf10d3cd, 0x3f4fefa8, 0xbf1553b7, 0x3f4cae79, 0xbf19c200, 0x3f495521, 0xbf1e1e22
.long 0x3f45e403, 0xbf226799, 0x3f425b89, 0xbf269de3, 0x3f3ebc1b, 0xbf2ac082, 0x3f3b0629, 0xbf2ecef7
.long 0x3f373a23, 0xbf32c8c9, 0x3f33587a, 0xbf36ad7f, 0x3f2f61a5, 0xbf3a7ca4, 0x3f2b561b, 0xbf3e35c5
.long 0x3f273656, 0xbf41d870, 0x3f2302d3, 0xbf456439, 0x3f1ebc12, 0xbf48d8b3, 0x3f1a6293, 0xbf4c3578
.long 0x3f15f6d9, 0xbf4f7a1f, 0x3f11796b, 0xbf52a649, 0x3f0cead0, 0xbf55b993, 0x3f084b92, 0xbf58b3a1
.long 0x3f039c3d, 0xbf5b941a, 0x3efdbabb, 0xbf5e5aa6, 0x3ef41f07, 0xbf6106f2, 0x3eea6681, 0xbf6398ac
.long 0x3ee0924f, 0xbf660f88, 0x3ed6a399, 0xbf686b39, 0x3ecc9b8b, 0xbf6aab7b, 0x3ec27b55, 0xbf6cd007
.long 0x3eb8442a, 0xbf6ed89e, 0x3eadf73c, 0xbf70c501, 0x3ea395c5, 0xbf7294f8, 0x3e9920fe, 0xbf74484b
.long 0x3e8e9a22, 0xbf75dec6, 0x3e840270, 0xbf77583a, 0x3e72b651, 0xbf78b47b, 0x3e5d4b1a, 0xbf79f35e
.long 0x3e47c5c2, 0xbf7b14be, 0x3e3228d4, 0xbf7c187a, 0x3e1c76de, 0xbf7cfe73, 0x3e06b26e, 0xbf7dc68c
.long 0x3de1bc2e, 0xbf7e70b0, 0x3db5f8da, 0xbf7efcc9, 0x3d8a200a, 0xbf7f6ac7, 0x3d3c6dd5, 0xbf7fba9e
.long 0x3cc90ab0, 0xbf7fec43, 0x3b490fc6, 0xbf7fffb1, 0xbc96c9b6, 0xbf7ff4e6, 0xbd2351cb, 0xbf7fcbe2
.long 0xbd7b2b74, 0xbf7f84ab, 0xbda973ba, 0xbf7f1f49, 0xbdd53db9, 0xbf7e9bc9, 0xbe007745, 0xbf7dfa38
.long 0xbe164083, 0xbf7d3aac, 0xbe2bf804, 0xbf7c5d3a, 0xbe419b37, 0xbf7b61fc, 0xbe57278f, 0xbf7a4910
.long 0xbe6c9a7f, 0xbf791298, 0xbe80f8c0, 0xbf77beb7, 0xbe8b9507, 0xbf764d97, 0xbe9620d2, 0xbf74bf62
.long 0xbea09ae5, 0xbf731447, 0xbeab0201, 0xbf714c7a, 0xbeb554ec, 0xbf6f6830, 0xbebf926f, 0xbf6d67a1
.long 0xbec9b953, 0xbf6b4b0c, 0xbed3c867, 0xbf6912ae, 0xbeddbe79, 0xbf66becc, 0xbee79a5d, 0xbf644fac
.long 0xbef15aea, 0xbf61c598, 0xbefafef7, 0xbf5f20db, 0xbf0242b1, 0xbf5c61c7, 0xbf06f686, 0xbf5988ad
.long 0xbf0b9a6b, 0xbf5695e5, 0xbf102dd5, 0xbf5389c7, 0xbf14b039, 0xbf5064af, 0xbf19210f, 0xbf4d26fd
.long 0xbf1d7fd1, 0xbf49d112, 0xbf21cbfb, 0xbf466354, 0xbf26050a, 0xbf42de29, 0xbf2a2a80, 0xbf3f41fc
.long 0xbf2e3bde, 0xbf3b8f3b, 0xbf3238aa, 0xbf37c655, 0xbf36206c, 0xbf33e7bc, 0xbf39f2ac, 0xbf2ff3e6
.long 0xbf3daef9, 0xbf2beb4a, 0xbf4154e1, 0xbf27ce61, 0xbf44e3f5, 0xbf239da9, 0xbf485bca, 0xbf1f599f
.long 0xbf4bbbf8, 0xbf1b02c6, 0xbf4f0417, 0xbf16999f, 0xbf5233c6, 0xbf121eb0, 0xbf554aa4, 0xbf0d9281
.long 0xbf584853, 0xbf08f59b, 0xbf5b2c79, 0xbf044889, 0xbf5df6be, 0xbeff17b2, 0xbf60a6cf, 0xbef58035
.long 0xbf633c5a, 0xbeebcbbb, 0xbf65b710, 0xbee1fb6a, 0xbf6816a8, 0xbed8106b, 0xbf6a5ad9, 0xbece0bea
.long 0x3f800000, 0x00000000, 0x3f7fec43, 0xbcc90ab0, 0x3f7fb10f, 0xbd48fb30, 0x3f7f4e6d, 0xbd96a905
.long 0x3f7ec46d, 0xbdc8bd36, 0x3f7e1324, 0xbdfab273, 0x3f7d3aac, 0xbe164083, 0x3f7c3b28, 0xbe2f10a2
.long 0x3f7b14be, 0xbe47c5c2, 0x3f79c79d, 0xbe605c13, 0x3f7853f8, 0xbe78cfcc, 0x3f76ba07, 0xbe888e93
.long 0x3f74fa0b, 0xbe94a031, 0x3f731447, 0xbea09ae5, 0x3f710908, 0xbeac7cd4, 0x3f6ed89e, 0xbeb8442a
.long 0x3f6c835e, 0xbec3ef15, 0x3f6a09a7, 0xbecf7bca, 0x3f676bd8, 0xbedae880, 0x3f64aa59, 0xbee63375
.long 0x3f61c598, 0xbef15aea, 0x3f5ebe05, 0xbefc5d27, 0x3f5b941a, 0xbf039c3d, 0x3f584853, 0xbf08f59b
.long 0x3f54db31, 0xbf0e39da, 0x3f514d3d, 0xbf13682a, 0x3f4d9f02, 0xbf187fc0, 0x3f49d112, 0xbf1d7fd1
.long 0x3f45e403, 0xbf226799, 0x3f41d870, 0xbf273656, 0x3f3daef9, 0xbf2beb4a, 0x3f396842, 0xbf3085bb
.long 0x3f3504f3, 0xbf3504f3, 0x3f3085bb, 0xbf396842, 0x3f2beb4a, 0xbf3daef9, 0x3f273656, 0xbf41d870
.long 0x3f226799, 0xbf45e403, 0x3f1d7fd1, 0xbf49d112, 0x3f187fc0, 0xbf4d9f02, 0x3f13682a, 0xbf514d3d
.long 0x3f0e39da, 0xbf54db31, 0x3f08f59b, 0xbf584853, 0x3f039c3d, 0xbf5b941a, 0x3efc5d27, 0xbf5ebe05
.long 0x3ef15aea, 0xbf61c598, 0x3ee63375, 0xbf64aa59, 0x3edae880, 0xbf676bd8, 0x3ecf7bca, 0xbf6a09a7
.long 0x3ec3ef15, 0xbf6c835e, 0x3eb8442a, 0xbf6ed89e, 0x3eac7cd4, 0xbf710908, 0x3ea09ae5, 0xbf731447
.long 0x3e94a031, 0xbf74fa0b, 0x3e888e93, 0xbf76ba07, 0x3e78cfcc, 0xbf7853f8, 0x3e605c13, 0xbf79c79d
.long 0x3e47c5c2, 0xbf7b14be, 0x3e2f10a2, 0xbf7c3b28, 0x3e164083, 0xbf7d3aac, 0x3dfab273, 0xbf7e1324
.long 0x3dc8bd36, 0xbf7ec46d, 0x3d96a905, 0xbf7f4e6d, 0x3d48fb30, 0xbf7fb10f, 0x3cc90ab0, 0xbf7fec43
.long 0x248d3132, 0xbf800000, 0xbcc90ab0, 0xbf7fec43, 0xbd48fb30, 0xbf7fb10f, 0xbd96a905, 0xbf7f4e6d
.long 0xbdc8bd36, 0xbf7ec46d, 0xbdfab273, 0xbf7e1324, 0xbe164083, 0xbf7d3aac, 0xbe2f10a2, 0xbf7c3b28
.long 0xbe47c5c2, 0xbf7b14be, 0xbe605c13, 0xbf79c79d, 0xbe78cfcc, 0xbf7853f8, 0xbe888e93, 0xbf76ba07
.long 0xbe94a031, 0xbf74fa0b, 0xbea09ae5, 0xbf731447, 0xbeac7cd4, 0xbf710908, 0xbeb8442a, 0xbf6ed89e
.long 0xbec3ef15, 0xbf6c835e, 0xbecf7bca, 0xbf6a09a7, 0xbedae880, 0xbf676bd8, 0xbee63375, 0xbf64aa59
.long 0xbef15aea, 0xbf61c598, 0xbefc5d27, 0xbf5ebe05, 0xbf039c3d, 0xbf5b941a, 0xbf08f59b, 0xbf584853
.long 0xbf0e39da, 0xbf54db31, 0xbf13682a, 0xbf514d3d, 0xbf187fc0, 0xbf4d9f02, 0xbf1d7fd1, 0xbf49d112
.long 0xbf226799, 0xbf45e403, 0xbf273656, 0xbf41d870, 0xbf2beb4a, 0xbf3daef9, 0xbf3085bb, 0xbf396842
.long 0xbf3504f3, 0xbf3504f3, 0xbf396842, 0xbf3085bb, 0xbf3daef9, 0xbf2beb4a, 0xbf41d870, 0xbf273656
.long 0xbf45e403, 0xbf226799, 0xbf49d112, 0xbf1d7fd1, 0xbf4d9f02, 0xbf187fc0, 0xbf514d3d, 0xbf13682a
.long 0xbf54db31, 0xbf0e39da, 0xbf584853, 0xbf08f59b, 0xbf5b941a, 0xbf039c3d, 0xbf5ebe05, 0xbefc5d27
.long 0xbf61c598, 0xbef15aea, 0xbf64aa59, 0xbee63375, 0xbf676bd8, 0xbedae880, 0xbf6a09a7, 0xbecf7bca
.long 0xbf6c835e, 0xbec3ef15, 0xbf6ed89e, 0xbeb8442a, 0xbf710908, 0xbeac7cd4, 0xbf731447, 0xbea09ae5
.long 0xbf74fa0b, 0xbe94a031, 0xbf76ba07, 0xbe888e93, 0xbf7853f8, 0xbe78cfcc, 0xbf79c79d, 0xbe605c13
.long 0xbf7b14be, 0xbe47c5c2, 0xbf7c3b28, 0xbe2f10a2, 0xbf7d3aac, 0xbe164083, 0xbf7e1324, 0xbdfab273
.long 0xbf7ec46d, 0xbdc8bd36, 0xbf7f4e6d, 0xbd96a905, 0xbf7fb10f, 0xbd48fb30, 0xbf7fec43, 0xbcc90ab0
.long 0x3f800000, 0x00000000, 0x3f7fe705, 0xbce22a7a, 0x3f7f9c18, 0xbd621469, 0x3f7f1f49, 0xbda973ba
.long 0x3f7e70b0, 0xbde1bc2e, 0x3f7d906e, 0xbe0cec4a, 0x3f7c7eb0, 0xbe28defc, 0x3f7b3bab, 0xbe44b0b9
.long 0x3f79c79d, 0xbe605c13, 0x3f7822d1, 0xbe7bdba4, 0x3f764d97, 0xbe8b9507, 0x3f74484b, 0xbe9920fe
.long 0x3f721352, 0xbea68f12, 0x3f6faf1b, 0xbeb3dca5, 0x3f6d1c1d, 0xbec1071e, 0x3f6a5ad9, 0xbece0bea
.long 0x3f676bd8, 0xbedae880, 0x3f644fac, 0xbee79a5d, 0x3f6106f2, 0xbef41f07, 0x3f5d924d, 0xbf003a06
.long 0x3f59f26a, 0xbf064b82, 0x3f5627fe, 0xbf0c42c9, 0x3f5233c6, 0xbf121eb0, 0x3f4e1689, 0xbf17de12
.long 0x3f49d112, 0xbf1d7fd1, 0x3f456439, 0xbf2302d3, 0x3f40d0da, 0xbf286605, 0x3f3c17d9, 0xbf2da859
.long 0x3f373a23, 0xbf32c8c9, 0x3f3238aa, 0xbf37c655, 0x3f2d1469, 0xbf3ca003, 0x3f27ce61, 0xbf4154e1
.long 0x3f226799, 0xbf45e403, 0x3f1ce11f, 0xbf4a4c87, 0x3f173c07, 0xbf4e8d90, 0x3f11796b, 0xbf52a649
.long 0x3f0b9a6b, 0xbf5695e5, 0x3f05a02c, 0xbf5a5ba0, 0x3eff17b2, 0xbf5df6be, 0x3ef2bd43, 0xbf61668a
.long 0x3ee63375, 0xbf64aa59, 0x3ed97cb9, 0xbf67c187, 0x3ecc9b8b, 0xbf6aab7b, 0x3ebf926f, 0xbf6d67a1
.long 0x3eb263ef, 0xbf6ff573, 0x3ea5129f, 0xbf725470, 0x3e97a117, 0xbf748422, 0x3e8a11f7, 0xbf76841b
.long 0x3e78cfcc, 0xbf7853f8, 0x3e5d4b1a, 0xbf79f35e, 0x3e419b37, 0xbf7b61fc, 0x3e25c58c, 0xbf7c9f8a
.long 0x3e09cf86, 0xbf7dabcc, 0x3ddb7d37, 0xbf7e868b, 0x3da3308c, 0xbf7f2f9d, 0x3d55880e, 0xbf7fa6e3
.long 0x3cc90ab0, 0xbf7fec43, 0xbb490fc6, 0xbf7fffb1, 0xbcfb49ba, 0xbf7fe129, 0xbd6ea038, 0xbf7f90b1
.long 0xbdafb680, 0xbf7f0e58, 0xbde7fa9a, 0xbf7e5a38, 0xbe1008b7, 0xbf7d7474, 0xbe2bf804, 0xbf7c5d3a
.long 0xbe47c5c2, 0xbf7b14be, 0xbe636c83, 0xbf799b43, 0xbe7ee6e1, 0xbf77f110, 0xbe8d17c0, 0xbf76167a
.long 0xbe9aa086, 0xbf740bdd, 0xbea80b1f, 0xbf71d19f, 0xbeb554ec, 0xbf6f6830, 0xbec27b55, 0xbf6cd007
.long 0xbecf7bca, 0xbf6a09a7, 0xbedc53c1, 0xbf671599, 0xbee900b7, 0xbf63f473, 0xbef58035, 0xbf60a6cf
.long 0xbf00e7e4, 0xbf5d2d53, 0xbf06f686, 0xbf5988ad, 0xbf0cead0, 0xbf55b993, 0xbf12c39a, 0xbf51c0c2
.long 0xbf187fc0, 0xbf4d9f02, 0xbf1e1e22, 0xbf495521, 0xbf239da9, 0xbf44e3f5, 0xbf28fd41, 0xbf404c5c
.long 0xbf2e3bde, 0xbf3b8f3b, 0xbf33587a, 0xbf36ad7f, 0xbf385216, 0xbf31a81d, 0xbf3d27b8, 0xbf2c800f
.long 0xbf41d870, 0xbf273656, 0xbf466354, 0xbf21cbfb, 0xbf4ac77f, 0xbf1c420c, 0xbf4f0417, 0xbf16999f
.long 0xbf531849, 0xbf10d3cd, 0xbf570348, 0xbf0af1b7, 0xbf5ac450, 0xbf04f484, 0xbf5e5aa6, 0xbefdbabb
.long 0xbf61c598, 0xbef15aea, 0xbf650479, 0xbee4cbfe, 0xbf6816a8, 0xbed8106b, 0xbf6afb8c, 0xbecb2aae
.long 0xbf6db293, 0xbebe1d4a, 0xbf703b37, 0xbeb0eacb, 0xbf7294f8, 0xbea395c5, 0xbf74bf62, 0xbe9620d2
.long 0xbf76ba07, 0xbe888e93, 0xbf788486, 0xbe75c35a, 0xbf7a1e84, 0xbe5a3997, 0xbf7b87b2, 0xbe3e853e
.long 0xbf7cbfc9, 0xbe22abb6, 0xbf7dc68c, 0xbe06b26e, 0xbf7e9bc9, 0xbdd53db9, 0xbf7f3f54, 0xbd9cecf9
.long 0xbf7fb10f, 0xbd48fb30, 0xbf7ff0e3, 0xbcafea69, 0xbf7ffec4, 0x3bc90f88, 0xbf7fdaaf, 0x3d0a342f
.long 0xbf7f84ab, 0x3d7b2b74, 0xbf7efcc9, 0x3db5f8da, 0xbf7e4323, 0x3dee3876, 0xbf7d57de, 0x3e1324ca
.long 0xbf7c3b28, 0x3e2f10a2, 0xbf7aed37, 0x3e4ada4f, 0xbf796e4e, 0x3e667c66, 0xbf77beb7, 0x3e80f8c0
.long 0xbf75dec6, 0x3e8e9a22, 0xbf73ced9, 0x3e9c1faf, 0xbf718f57, 0x3ea986c4, 0xbf6f20b0, 0x3eb6ccc3
.long 0x3f800000, 0x00000000, 0x3f7fe129, 0xbcfb49ba, 0x3f7f84ab, 0xbd7b2b74, 0x3f7eea9d, 0xbdbc3ac3
.long 0x3f7e1324, 0xbdfab273, 0x3f7cfe73, 0xbe1c76de, 0x3f7baccd, 0xbe3b6ecf, 0x3f7a1e84, 0xbe5a3997
.long 0x3f7853f8, 0xbe78cfcc, 0x3f764d97, 0xbe8b9507, 0x3f740bdd, 0xbe9aa086, 0x3f718f57, 0xbea986c4
.long 0x3f6ed89e, 0xbeb8442a, 0x3f6be858, 0xbec6d529, 0x3f68bf3c, 0xbed53641, 0x3f655e0b, 0xbee363fa
.long 0x3f61c598, 0xbef15aea, 0x3f5df6be, 0xbeff17b2, 0x3f59f26a, 0xbf064b82, 0x3f55b993, 0xbf0cead0
.long 0x3f514d3d, 0xbf13682a, 0x3f4cae79, 0xbf19c200, 0x3f47de65, 0xbf1ff6cb, 0x3f42de29, 0xbf26050a
.long 0x3f3daef9, 0xbf2beb4a, 0x3f385216, 0xbf31a81d, 0x3f32c8c9, 0xbf373a23, 0x3f2d1469, 0xbf3ca003
.long 0x3f273656, 0xbf41d870, 0x3f212ff9, 0xbf46e22a, 0x3f1b02c6, 0xbf4bbbf8, 0x3f14b039, 0xbf5064af
.long 0x3f0e39da, 0xbf54db31, 0x3f07a136, 0xbf591e6a, 0x3f00e7e4, 0xbf5d2d53, 0x3ef41f07, 0xbf6106f2
.long 0x3ee63375, 0xbf64aa59, 0x3ed8106b, 0xbf6816a8, 0x3ec9b953, 0xbf6b4b0c, 0x3ebb31a0, 0xbf6e46be
.long 0x3eac7cd4, 0xbf710908, 0x3e9d9e78, 0xbf73913f, 0x3e8e9a22, 0xbf75dec6, 0x3e7ee6e1, 0xbf77f110
.long 0x3e605c13, 0xbf79c79d, 0x3e419b37, 0xbf7b61fc, 0x3e22abb6, 0xbf7cbfc9, 0x3e039502, 0xbf7de0b1
.long 0x3dc8bd36, 0xbf7ec46d, 0x3d8a200a, 0xbf7f6ac7, 0x3d16c32c, 0xbf7fd397, 0x3bc90f88, 0xbf7ffec4
.long 0xbcc90ab0, 0xbf7fec43, 0xbd621469, 0xbf7f9c18, 0xbdafb680, 0xbf7f0e58, 0xbdee3876, 0xbf7e4323
.long 0xbe164083, 0xbf7d3aac, 0xbe354098, 0xbf7bf531, 0xbe541501, 0xbf7a7302, 0xbe72b651, 0xbf78b47b
.long 0xbe888e93, 0xbf76ba07, 0xbe97a117, 0xbf748422, 0xbea68f12, 0xbf721352, 0xbeb554ec, 0xbf6f6830
.long 0xbec3ef15, 0xbf6c835e, 0xbed25a09, 0xbf696591, 0xbee0924f, 0xbf660f88, 0xbeee9479, 0xbf628210
.long 0xbefc5d27, 0xbf5ebe05, 0xbf04f484, 0xbf5ac450, 0xbf0b9a6b, 0xbf5695e5, 0xbf121eb0, 0xbf5233c6
.long 0xbf187fc0, 0xbf4d9f02, 0xbf1ebc12, 0xbf48d8b3, 0xbf24d225, 0xbf43e200, 0xbf2ac082, 0xbf3ebc1b
.long 0xbf3085bb, 0xbf396842, 0xbf36206c, 0xbf33e7bc, 0xbf3b8f3b, 0xbf2e3bde, 0xbf40d0da, 0xbf286605
.long 0xbf45e403, 0xbf226799, 0xbf4ac77f, 0xbf1c420c, 0xbf4f7a1f, 0xbf15f6d9, 0xbf53fac3, 0xbf0f8784
.long 0xbf584853, 0xbf08f59b, 0xbf5c61c7, 0xbf0242b1, 0xbf604621, 0xbef6e0cb, 0xbf63f473, 0xbee900b7
.long 0xbf676bd8, 0xbedae880, 0xbf6aab7b, 0xbecc9b8b, 0xbf6db293, 0xbebe1d4a, 0xbf708066, 0xbeaf713a
.long 0xbf731447, 0xbea09ae5, 0xbf756d97, 0xbe919ddd, 0xbf778bc5, 0xbe827dc0, 0xbf796e4e, 0xbe667c66
.long 0xbf7b14be, 0xbe47c5c2, 0xbf7c7eb0, 0xbe28defc, 0xbf7dabcc, 0xbe09cf86, 0xbf7e9bc9, 0xbdd53db9
.long 0xbf7f4e6d, 0xbd96a905, 0xbf7fc38f, 0xbd2fe007, 0xbf7ffb11, 0xbc490e90, 0xbf7ff4e6, 0x3c96c9b6
.long 0xbf7fb10f, 0x3d48fb30, 0xbf7f2f9d, 0x3da3308c, 0xbf7e70b0, 0x3de1bc2e, 0xbf7d7474, 0x3e1008b7
.long 0xbf7c3b28, 0x3e2f10a2, 0xbf7ac516, 0x3e4dee60, 0xbf791298, 0x3e6c9a7f, 0xbf772417, 0x3e8586ce
.long 0xbf74fa0b, 0x3e94a031, 0xbf7294f8, 0x3ea395c5, 0xbf6ff573, 0x3eb263ef, 0xbf6d1c1d, 0x3ec1071e
.long 0xbf6a09a7, 0x3ecf7bca, 0xbf66becc, 0x3eddbe79, 0xbf633c5a, 0x3eebcbbb, 0xbf5f8327, 0x3ef9a02d
.long 0xbf5b941a, 0x3f039c3d, 0xbf577026, 0x3f0a48ad, 0xbf531849, 0x3f10d3cd, 0xbf4e8d90, 0x3f173c07
.long 0xbf49d112, 0x3f1d7fd1, 0xbf44e3f5, 0x3f239da9, 0xbf3fc767, 0x3f299415, 0xbf3a7ca4, 0x3f2f61a5
.long 0x3f800000, 0x00000000, 0x3f7fdaaf, 0xbd0a342f, 0x3f7f6ac7, 0xbd8a200a, 0x3f7eb069, 0xbdcefdb7
.long 0x3f7dabcc, 0xbe09cf86, 0x3f7c5d3a, 0xbe2bf804, 0x3f7ac516, 0xbe4dee60, 0x3f78e3d6, 0xbe6fa8b2
.long 0x3f76ba07, 0xbe888e93, 0x3f74484b, 0xbe9920fe, 0x3f718f57, 0xbea986c4, 0x3f6e8ff8, 0xbeb9bb1e
.long 0x3f6b4b0c, 0xbec9b953, 0x3f67c187, 0xbed97cb9, 0x3f63f473, 0xbee900b7, 0x3f5fe4e9, 0xbef840c8
.long 0x3f5b941a, 0xbf039c3d, 0x3f570348, 0xbf0af1b7, 0x3f5233c6, 0xbf121eb0, 0x3f4d26fd, 0xbf19210f
.long 0x3f47de65, 0xbf1ff6cb, 0x3f425b89, 0xbf269de3, 0x3f3ca003, 0xbf2d1469, 0x3f36ad7f, 0xbf33587a
.long 0x3f3085bb, 0xbf396842, 0x3f2a2a80, 0xbf3f41fc, 0x3f239da9, 0xbf44e3f5, 0x3f1ce11f, 0xbf4a4c87
.long 0x3f15f6d9, 0xbf4f7a1f, 0x3f0ee0db, 0xbf546b3b, 0x3f07a136, 0xbf591e6a, 0x3f003a06, 0xbf5d924d
.long 0x3ef15aea, 0xbf61c598, 0x3ee1fb6a, 0xbf65b710, 0x3ed25a09, 0xbf696591, 0x3ec27b55, 0xbf6cd007
.long 0x3eb263ef, 0xbf6ff573, 0x3ea21887, 0xbf72d4eb, 0x3e919ddd, 0xbf756d97, 0x3e80f8c0, 0xbf77beb7
.long 0x3e605c13, 0xbf79c79d, 0x3e3e853e, 0xbf7b87b2, 0x3e1c76de, 0xbf7cfe73, 0x3df475c0, 0xbf7e2b72
.long 0x3dafb680, 0xbf7f0e58, 0x3d55880e, 0xbf7fa6e3, 0x3c96c9b6, 0xbf7ff4e6, 0xbc7b514b, 0xbf7ff84a
.long 0xbd48fb30, 0xbf7fb10f, 0xbda973ba, 0xbf7f1f49, 0xbdee3876, 0xbf7e4323, 0xbe195be0, 0xbf7d1cdd
.long 0xbe3b6ecf, 0xbf7baccd, 0xbe5d4b1a, 0xbf79f35e, 0xbe7ee6e1, 0xbf77f110, 0xbe901c2c, 0xbf75a67b
.long 0xbea09ae5, 0xbf731447, 0xbeb0eacb, 0xbf703b37, 0xbec1071e, 0xbf6d1c1d, 0xbed0eb2a, 0xbf69b7e4
.long 0xbee0924f, 0xbf660f88, 0xbeeff7fb, 0xbf62241a, 0xbeff17b2, 0xbf5df6be, 0xbf06f686, 0xbf5988ad
.long 0xbf0e39da, 0xbf54db31, 0xbf1553b7, 0xbf4fefa8, 0xbf1c420c, 0xbf4ac77f, 0xbf2302d3, 0xbf456439
.long 0xbf299415, 0xbf3fc767, 0xbf2ff3e6, 0xbf39f2ac, 0xbf36206c, 0xbf33e7bc, 0xbf3c17d9, 0xbf2da859
.long 0xbf41d870, 0xbf273656, 0xbf476085, 0xbf209393, 0xbf4cae79, 0xbf19c200, 0xbf51c0c2, 0xbf12c39a
.long 0xbf5695e5, 0xbf0b9a6b, 0xbf5b2c79, 0xbf044889, 0xbf5f8327, 0xbef9a02d, 0xbf6398ac, 0xbeea6681
.long 0xbf676bd8, 0xbedae880, 0xbf6afb8c, 0xbecb2aae, 0xbf6e46be, 0xbebb31a0, 0xbf714c7a, 0xbeab0201
.long 0xbf740bdd, 0xbe9aa086, 0xbf76841b, 0xbe8a11f7, 0xbf78b47b, 0xbe72b651, 0xbf7a9c59, 0xbe5101f1
.long 0xbf7c3b28, 0xbe2f10a2, 0xbf7d906e, 0xbe0cec4a, 0xbf7e9bc9, 0xbdd53db9, 0xbf7f5ce9, 0xbd9064b4
.long 0xbf7fd397, 0xbd16c32c, 0xbf7fffb1, 0xbb490fc6, 0xbf7fe129, 0x3cfb49ba, 0xbf7f7808, 0x3d83db0a
.long 0xbf7ec46d, 0x3dc8bd36, 0xbf7dc68c, 0x3e06b26e, 0xbf7c7eb0, 0x3e28defc, 0xbf7aed37, 0x3e4ada4f
.long 0xbf791298, 0x3e6c9a7f, 0xbf76ef5b, 0x3e870ada, 0xbf748422, 0x3e97a117, 0xbf71d19f, 0x3ea80b1f
.long 0xbf6ed89e, 0x3eb8442a, 0xbf6b99fb, 0x3ec8477c, 0xbf6816a8, 0x3ed8106b, 0xbf644fac, 0x3ee79a5d
.long 0xbf604621, 0x3ef6e0cb, 0xbf5bfb34, 0x3f02ef9f, 0xbf577026, 0x3f0a48ad, 0xbf52a649, 0x3f11796b
.long 0xbf4d9f02, 0x3f187fc0, 0xbf485bca, 0x3f1f599f, 0xbf42de29, 0x3f26050a, 0xbf3d27b8, 0x3f2c800f
.long 0xbf373a23, 0x3f32c8c9, 0xbf311722, 0x3f38dd65, 0xbf2ac082, 0x3f3ebc1b, 0xbf24381a, 0x3f446337
.long 0xbf1d7fd1, 0x3f49d112, 0xbf16999f, 0x3f4f0417, 0xbf0f8784, 0x3f53fac3, 0xbf084b92, 0x3f58b3a1
.long 0xbf00e7e4, 0x3f5d2d53, 0xbef2bd43, 0x3f61668a, 0xbee363fa, 0x3f655e0b, 0xbed3c867, 0x3f6912ae
.long 0x3f800000, 0x00000000, 0x3f7fd397, 0xbd16c32c, 0x3f7f4e6d, 0xbd96a905, 0x3f7e70b0, 0xbde1bc2e
.long 0x3f7d3aac, 0xbe164083, 0x3f7baccd, 0xbe3b6ecf, 0x3f79c79d, 0xbe605c13, 0x3f778bc5, 0xbe827dc0
.long 0x3f74fa0b, 0xbe94a031, 0x3f721352, 0xbea68f12, 0x3f6ed89e, 0xbeb8442a, 0x3f6b4b0c, 0xbec9b953
.long 0x3f676bd8, 0xbedae880, 0x3f633c5a, 0xbeebcbbb, 0x3f5ebe05, 0xbefc5d27, 0x3f59f26a, 0xbf064b82
.long 0x3f54db31, 0xbf0e39da, 0x3f4f7a1f, 0xbf15f6d9, 0x3f49d112, 0xbf1d7fd1, 0x3f43e200, 0xbf24d225
.long 0x3f3daef9, 0xbf2beb4a, 0x3f373a23, 0xbf32c8c9, 0x3f3085bb, 0xbf396842, 0x3f299415, 0xbf3fc767
.long 0x3f226799, 0xbf45e403, 0x3f1b02c6, 0xbf4bbbf8, 0x3f13682a, 0xbf514d3d, 0x3f0b9a6b, 0xbf5695e5
.long 0x3f039c3d, 0xbf5b941a, 0x3ef6e0cb, 0xbf604621, 0x3ee63375, 0xbf64aa59, 0x3ed53641, 0xbf68bf3c
.long 0x3ec3ef15, 0xbf6c835e, 0x3eb263ef, 0xbf6ff573, 0x3ea09ae5, 0xbf731447, 0x3e8e9a22, 0xbf75dec6
.long 0x3e78cfcc, 0xbf7853f8, 0x3e541501, 0xbf7a7302, 0x3e2f10a2, 0xbf7c3b28, 0x3e09cf86, 0xbf7dabcc
.long 0x3dc8bd36, 0xbf7ec46d, 0x3d7b2b74, 0xbf7f84ab, 0x3cc90ab0, 0xbf7fec43, 0xbc490e90, 0xbf7ffb11
.long 0xbd48fb30, 0xbf7fb10f, 0xbdafb680, 0xbf7f0e58, 0xbdfab273, 0xbf7e1324, 0xbe22abb6, 0xbf7cbfc9
.long 0xbe47c5c2, 0xbf7b14be, 0xbe6c9a7f, 0xbf791298, 0xbe888e93, 0xbf76ba07, 0xbe9aa086, 0xbf740bdd
.long 0xbeac7cd4, 0xbf710908, 0xbebe1d4a, 0xbf6db293, 0xbecf7bca, 0xbf6a09a7, 0xbee0924f, 0xbf660f88
.long 0xbef15aea, 0xbf61c598, 0xbf00e7e4, 0xbf5d2d53, 0xbf08f59b, 0xbf584853, 0xbf10d3cd, 0xbf531849
.long 0xbf187fc0, 0xbf4d9f02, 0xbf1ff6cb, 0xbf47de65, 0xbf273656, 0xbf41d870, 0xbf2e3bde, 0xbf3b8f3b
.long 0xbf3504f3, 0xbf3504f3, 0xbf3b8f3b, 0xbf2e3bde, 0xbf41d870, 0xbf273656, 0xbf47de65, 0xbf1ff6cb
.long 0xbf4d9f02, 0xbf187fc0, 0xbf531849, 0xbf10d3cd, 0xbf584853, 0xbf08f59b, 0xbf5d2d53, 0xbf00e7e4
.long 0xbf61c598, 0xbef15aea, 0xbf660f88, 0xbee0924f, 0xbf6a09a7, 0xbecf7bca, 0xbf6db293, 0xbebe1d4a
.long 0xbf710908, 0xbeac7cd4, 0xbf740bdd, 0xbe9aa086, 0xbf76ba07, 0xbe888e93, 0xbf791298, 0xbe6c9a7f
.long 0xbf7b14be, 0xbe47c5c2, 0xbf7cbfc9, 0xbe22abb6, 0xbf7e1324, 0xbdfab273, 0xbf7f0e58, 0xbdafb680
.long 0xbf7fb10f, 0xbd48fb30, 0xbf7ffb11, 0xbc490e90, 0xbf7fec43, 0x3cc90ab0, 0xbf7f84ab, 0x3d7b2b74
.long 0xbf7ec46d, 0x3dc8bd36, 0xbf7dabcc, 0x3e09cf86, 0xbf7c3b28, 0x3e2f10a2, 0xbf7a7302, 0x3e541501
.long 0xbf7853f8, 0x3e78cfcc, 0xbf75dec6, 0x3e8e9a22, 0xbf731447, 0x3ea09ae5, 0xbf6ff573, 0x3eb263ef
.long 0xbf6c835e, 0x3ec3ef15, 0xbf68bf3c, 0x3ed53641, 0xbf64aa59, 0x3ee63375, 0xbf604621, 0x3ef6e0cb
.long 0xbf5b941a, 0x3f039c3d, 0xbf5695e5, 0x3f0b9a6b, 0xbf514d3d, 0x3f13682a, 0xbf4bbbf8, 0x3f1b02c6
.long 0xbf45e403, 0x3f226799, 0xbf3fc767, 0x3f299415, 0xbf396842, 0x3f3085bb, 0xbf32c8c9, 0x3f373a23
.long 0xbf2beb4a, 0x3f3daef9, 0xbf24d225, 0x3f43e200, 0xbf1d7fd1, 0x3f49d112, 0xbf15f6d9, 0x3f4f7a1f
.long 0xbf0e39da, 0x3f54db31, 0xbf064b82, 0x3f59f26a, 0xbefc5d27, 0x3f5ebe05, 0xbeebcbbb, 0x3f633c5a
.long 0xbedae880, 0x3f676bd8, 0xbec9b953, 0x3f6b4b0c, 0xbeb8442a, 0x3f6ed89e, 0xbea68f12, 0x3f721352
.long 0xbe94a031, 0x3f74fa0b, 0xbe827dc0, 0x3f778bc5, 0xbe605c13, 0x3f79c79d, 0xbe3b6ecf, 0x3f7baccd
.long 0xbe164083, 0x3f7d3aac, 0xbde1bc2e, 0x3f7e70b0, 0xbd96a905, 0x3f7f4e6d, 0xbd16c32c, 0x3f7fd397
.long 0x3f800000, 0x00000000, 0x3f7fcbe2, 0xbd2351cb, 0x3f7f2f9d, 0xbda3308c, 0x3f7e2b72, 0xbdf475c0
.long 0x3f7cbfc9, 0xbe22abb6, 0x3f7aed37, 0xbe4ada4f, 0x3f78b47b, 0xbe72b651, 0x3f76167a, 0xbe8d17c0
.long 0x3f731447, 0xbea09ae5, 0x3f6faf1b, 0xbeb3dca5, 0x3f6be858, 0xbec6d529, 0x3f67c187, 0xbed97cb9
.long 0x3f633c5a, 0xbeebcbbb, 0x3f5e5aa6, 0xbefdbabb, 0x3f591e6a, 0xbf07a136, 0x3f5389c7, 0xbf102dd5
.long 0x3f4d9f02, 0xbf187fc0, 0x3f476085, 0xbf209393, 0x3f40d0da, 0xbf286605, 0x3f39f2ac, 0xbf2ff3e6
.long 0x3f32c8c9, 0xbf373a23, 0x3f2b561b, 0xbf3e35c5, 0x3f239da9, 0xbf44e3f5, 0x3f1ba299, 0xbf4b41fa
.long 0x3f13682a, 0xbf514d3d, 0x3f0af1b7, 0xbf570348, 0x3f0242b1, 0xbf5c61c7, 0x3ef2bd43, 0xbf61668a
.long 0x3ee0924f, 0xbf660f88, 0x3ece0bea, 0xbf6a5ad9, 0x3ebb31a0, 0xbf6e46be, 0x3ea80b1f, 0xbf71d19f
.long 0x3e94a031, 0xbf74fa0b, 0x3e80f8c0, 0xbf77beb7, 0x3e5a3997, 0xbf7a1e84, 0x3e3228d4, 0xbf7c187a
.long 0x3e09cf86, 0xbf7dabcc, 0x3dc27c39, 0xbf7ed7d4, 0x3d621469, 0xbf7f9c18, 0x3c7b514b, 0xbf7ff84a
.long 0xbcc90ab0, 0xbf7fec43, 0xbd83db0a, 0xbf7f7808, 0xbdd53db9, 0xbf7e9bc9, 0xbe1324ca, 0xbf7d57de
.long 0xbe3b6ecf, 0xbf7baccd, 0xbe636c83, 0xbf799b43, 0xbe8586ce, 0xbf772417, 0xbe9920fe, 0xbf74484b
.long 0xbeac7cd4, 0xbf710908, 0xbebf926f, 0xbf6d67a1, 0xbed25a09, 0xbf696591, 0xbee4cbfe, 0xbf650479
.long 0xbef6e0cb, 0xbf604621, 0xbf044889, 0xbf5b2c79, 0xbf0cead0, 0xbf55b993, 0xbf1553b7, 0xbf4fefa8
.long 0xbf1d7fd1, 0xbf49d112, 0xbf256bcb, 0xbf436051, 0xbf2d1469, 0xbf3ca003, 0xbf34768f, 0xbf3592e7
.long 0xbf3b8f3b, 0xbf2e3bde, 0xbf425b89, 0xbf269de3, 0xbf48d8b3, 0xbf1ebc12, 0xbf4f0417, 0xbf16999f
.long 0xbf54db31, 0xbf0e39da, 0xbf5a5ba0, 0xbf05a02c, 0xbf5f8327, 0xbef9a02d, 0xbf644fac, 0xbee79a5d
.long 0xbf68bf3c, 0xbed53641, 0xbf6cd007, 0xbec27b55, 0xbf708066, 0xbeaf713a, 0xbf73ced9, 0xbe9c1faf
.long 0xbf76ba07, 0xbe888e93, 0xbf7940c0, 0xbe698bba, 0xbf7b61fc, 0xbe419b37, 0xbf7d1cdd, 0xbe195be0
.long 0xbf7e70b0, 0xbde1bc2e, 0xbf7f5ce9, 0xbd9064b4, 0xbf7fe129, 0xbcfb49ba, 0xbf7ffd39, 0x3c16cb58
.long 0xbf7fb10f, 0x3d48fb30, 0xbf7efcc9, 0x3db5f8da, 0xbf7de0b1, 0x3e039502, 0xbf7c5d3a, 0x3e2bf804
.long 0xbf7a7302, 0x3e541501, 0xbf7822d1, 0x3e7bdba4, 0xbf756d97, 0x3e919ddd, 0xbf725470, 0x3ea5129f
.long 0xbf6ed89e, 0x3eb8442a, 0xbf6afb8c, 0x3ecb2aae, 0xbf66becc, 0x3eddbe79, 0xbf62241a, 0x3eeff7fb
.long 0xbf5d2d53, 0x3f00e7e4, 0xbf57dc7f, 0x3f099f4e, 0xbf5233c6, 0x3f121eb0, 0xbf4c3578, 0x3f1a6293
.long 0xbf45e403, 0x3f226799, 0xbf3f41fc, 0x3f2a2a80, 0xbf385216, 0x3f31a81d, 0xbf311722, 0x3f38dd65
.long 0xbf299415, 0x3f3fc767, 0xbf21cbfb, 0x3f466354, 0xbf19c200, 0x3f4cae79, 0xbf11796b, 0x3f52a649
.long 0xbf08f59b, 0x3f584853, 0xbf003a06, 0x3f5d924d, 0xbeee9479, 0x3f628210, 0xbedc53c1, 0x3f671599
.long 0xbec9b953, 0x3f6b4b0c, 0xbeb6ccc3, 0x3f6f20b0, 0xbea395c5, 0x3f7294f8, 0xbe901c2c, 0x3f75a67b
.long 0xbe78cfcc, 0x3f7853f8, 0xbe5101f1, 0x3f7a9c59, 0xbe28defc, 0x3f7c7eb0, 0xbe007745, 0x3f7dfa38
.long 0xbdafb680, 0x3f7f0e58, 0xbd3c6dd5, 0x3f7fba9e, 0xbbc90f88, 0x3f7ffec4, 0x3d0a342f, 0x3f7fdaaf
.long 0x3d96a905, 0x3f7f4e6d, 0x3de7fa9a, 0x3f7e5a38, 0x3e1c76de, 0x3f7cfe73, 0x3e44b0b9, 0x3f7b3bab
.long 0x3e6c9a7f, 0x3f791298, 0x3e8a11f7, 0x3f76841b, 0x3e9d9e78, 0x3f73913f, 0x3eb0eacb, 0x3f703b37
.long 0x3f800000, 0x00000000, 0x3f7fc38f, 0xbd2fe007, 0x3f7f0e58, 0xbdafb680, 0x3f7de0b1, 0xbe039502
.long 0x3f7c3b28, 0xbe2f10a2, 0x3f7a1e84, 0xbe5a3997, 0x3f778bc5, 0xbe827dc0, 0x3f748422, 0xbe97a117
.long 0x3f710908, 0xbeac7cd4, 0x3f6d1c1d, 0xbec1071e, 0x3f68bf3c, 0xbed53641, 0x3f63f473, 0xbee900b7
.long 0x3f5ebe05, 0xbefc5d27, 0x3f591e6a, 0xbf07a136, 0x3f531849, 0xbf10d3cd, 0x3f4cae79, 0xbf19c200
.long 0x3f45e403, 0xbf226799, 0x3f3ebc1b, 0xbf2ac082, 0x3f373a23, 0xbf32c8c9, 0x3f2f61a5, 0xbf3a7ca4
.long 0x3f273656, 0xbf41d870, 0x3f1ebc12, 0xbf48d8b3, 0x3f15f6d9, 0xbf4f7a1f, 0x3f0cead0, 0xbf55b993
.long 0x3f039c3d, 0xbf5b941a, 0x3ef41f07, 0xbf6106f2, 0x3ee0924f, 0xbf660f88, 0x3ecc9b8b, 0xbf6aab7b
.long 0x3eb8442a, 0xbf6ed89e, 0x3ea395c5, 0xbf7294f8, 0x3e8e9a22, 0xbf75dec6, 0x3e72b651, 0xbf78b47b
.long 0x3e47c5c2, 0xbf7b14be, 0x3e1c76de, 0xbf7cfe73, 0x3de1bc2e, 0xbf7e70b0, 0x3d8a200a, 0xbf7f6ac7
.long 0x3cc90ab0, 0xbf7fec43, 0xbc96c9b6, 0xbf7ff4e6, 0xbd7b2b74, 0xbf7f84ab, 0xbdd53db9, 0xbf7e9bc9
.long 0xbe164083, 0xbf7d3aac, 0xbe419b37, 0xbf7b61fc, 0xbe6c9a7f, 0xbf791298, 0xbe8b9507, 0xbf764d97
.long 0xbea09ae5, 0xbf731447, 0xbeb554ec, 0xbf6f6830, 0xbec9b953, 0xbf6b4b0c, 0xbeddbe79, 0xbf66becc
.long 0xbef15aea, 0xbf61c598, 0xbf0242b1, 0xbf5c61c7, 0xbf0b9a6b, 0xbf5695e5, 0xbf14b039, 0xbf5064af
.long 0xbf1d7fd1, 0xbf49d112, 0xbf26050a, 0xbf42de29, 0xbf2e3bde, 0xbf3b8f3b, 0xbf36206c, 0xbf33e7bc
.long 0xbf3daef9, 0xbf2beb4a, 0xbf44e3f5, 0xbf239da9, 0xbf4bbbf8, 0xbf1b02c6, 0xbf5233c6, 0xbf121eb0
.long 0xbf584853, 0xbf08f59b, 0xbf5df6be, 0xbeff17b2, 0xbf633c5a, 0xbeebcbbb, 0xbf6816a8, 0xbed8106b
.long 0xbf6c835e, 0xbec3ef15, 0xbf708066, 0xbeaf713a, 0xbf740bdd, 0xbe9aa086, 0xbf772417, 0xbe8586ce
.long 0xbf79c79d, 0xbe605c13, 0xbf7bf531, 0xbe354098, 0xbf7dabcc, 0xbe09cf86, 0xbf7eea9d, 0xbdbc3ac3
.long 0xbf7fb10f, 0xbd48fb30, 0xbf7ffec4, 0xbbc90f88, 0xbf7fd397, 0x3d16c32c, 0xbf7f2f9d, 0x3da3308c
.long 0xbf7e1324, 0x3dfab273, 0xbf7c7eb0, 0x3e28defc, 0xbf7a7302, 0x3e541501, 0xbf77f110, 0x3e7ee6e1
.long 0xbf74fa0b, 0x3e94a031, 0xbf718f57, 0x3ea986c4, 0xbf6db293, 0x3ebe1d4a, 0xbf696591, 0x3ed25a09
.long 0xbf64aa59, 0x3ee63375, 0xbf5f8327, 0x3ef9a02d, 0xbf59f26a, 0x3f064b82, 0xbf53fac3, 0x3f0f8784
.long 0xbf4d9f02, 0x3f187fc0, 0xbf46e22a, 0x3f212ff9, 0xbf3fc767, 0x3f299415, 0xbf385216, 0x3f31a81d
.long 0xbf3085bb, 0x3f396842, 0xbf286605, 0x3f40d0da, 0xbf1ff6cb, 0x3f47de65, 0xbf173c07, 0x3f4e8d90
.long 0xbf0e39da, 0x3f54db31, 0xbf04f484, 0x3f5ac450, 0xbef6e0cb, 0x3f604621, 0xbee363fa, 0x3f655e0b
.long 0xbecf7bca, 0x3f6a09a7, 0xbebb31a0, 0x3f6e46be, 0xbea68f12, 0x3f721352, 0xbe919ddd, 0x3f756d97
.long 0xbe78cfcc, 0x3f7853f8, 0xbe4dee60, 0x3f7ac516, 0xbe22abb6, 0x3f7cbfc9, 0xbdee3876, 0x3f7e4323
.long 0xbd96a905, 0x3f7f4e6d, 0xbcfb49ba, 0x3f7fe129, 0x3c490e90, 0x3f7ffb11, 0x3d621469, 0x3f7f9c18
.long 0x3dc8bd36, 0x3f7ec46d, 0x3e1008b7, 0x3f7d7474, 0x3e3b6ecf, 0x3f7baccd, 0x3e667c66, 0x3f796e4e
.long 0x3e888e93, 0x3f76ba07, 0x3e9d9e78, 0x3f73913f, 0x3eb263ef, 0x3f6ff573, 0x3ec6d529, 0x3f6be858
.long 0x3edae880, 0x3f676bd8, 0x3eee9479, 0x3f628210, 0x3f00e7e4, 0x3f5d2d53, 0x3f0a48ad, 0x3f577026
.long 0x3f13682a, 0x3f514d3d, 0x3f1c420c, 0x3f4ac77f, 0x3f24d225, 0x3f43e200, 0x3f2d1469, 0x3f3ca003
.long 0x3f800000, 0x00000000, 0x3f7fba9e, 0xbd3c6dd5, 0x3f7eea9d, 0xbdbc3ac3, 0x3f7d906e, 0xbe0cec4a
.long 0x3f7baccd, 0xbe3b6ecf, 0x3f7940c0, 0xbe698bba, 0x3f764d97, 0xbe8b9507, 0x3f72d4eb, 0xbea21887
.long 0x3f6ed89e, 0xbeb8442a, 0x3f6a5ad9, 0xbece0bea, 0x3f655e0b, 0xbee363fa, 0x3f5fe4e9, 0xbef840c8
.long 0x3f59f26a, 0xbf064b82, 0x3f5389c7, 0xbf102dd5, 0x3f4cae79, 0xbf19c200, 0x3f456439, 0xbf2302d3
.long 0x3f3daef9, 0xbf2beb4a, 0x3f3592e7, 0xbf34768f, 0x3f2d1469, 0xbf3ca003, 0x3f24381a, 0xbf446337
.long 0x3f1b02c6, 0xbf4bbbf8, 0x3f11796b, 0xbf52a649, 0x3f07a136, 0xbf591e6a, 0x3efafef7, 0xbf5f20db
.long 0x3ee63375, 0xbf64aa59, 0x3ed0eb2a, 0xbf69b7e4, 0x3ebb31a0, 0xbf6e46be, 0x3ea5129f, 0xbf725470
.long 0x3e8e9a22, 0xbf75dec6, 0x3e6fa8b2, 0xbf78e3d6, 0x3e419b37, 0xbf7b61fc, 0x3e1324ca, 0xbf7d57de
.long 0x3dc8bd36, 0xbf7ec46d, 0x3d55880e, 0xbf7fa6e3, 0x3bc90f88, 0xbf7ffec4, 0xbd2351cb, 0xbf7fcbe2
.long 0xbdafb680, 0xbf7f0e58, 0xbe06b26e, 0xbf7dc68c, 0xbe354098, 0xbf7bf531, 0xbe636c83, 0xbf799b43
.long 0xbe888e93, 0xbf76ba07, 0xbe9f1cdf, 0xbf73530e, 0xbeb554ec, 0xbf6f6830, 0xbecb2aae, 0xbf6afb8c
.long 0xbee0924f, 0xbf660f88, 0xbef58035, 0xbf60a6cf, 0xbf04f484, 0xbf5ac450, 0xbf0ee0db, 0xbf546b3b
.long 0xbf187fc0, 0xbf4d9f02, 0xbf21cbfb, 0xbf466354, 0xbf2ac082, 0xbf3ebc1b, 0xbf33587a, 0xbf36ad7f
.long 0xbf3b8f3b, 0xbf2e3bde, 0xbf436051, 0xbf256bcb, 0xbf4ac77f, 0xbf1c420c, 0xbf51c0c2, 0xbf12c39a
.long 0xbf584853, 0xbf08f59b, 0xbf5e5aa6, 0xbefdbabb, 0xbf63f473, 0xbee900b7, 0xbf6912ae, 0xbed3c867
.long 0xbf6db293, 0xbebe1d4a, 0xbf71d19f, 0xbea80b1f, 0xbf756d97, 0xbe919ddd, 0xbf788486, 0xbe75c35a
.long 0xbf7b14be, 0xbe47c5c2, 0xbf7d1cdd, 0xbe195be0, 0xbf7e9bc9, 0xbdd53db9, 0xbf7f90b1, 0xbd6ea038
.long 0xbf7ffb11, 0xbc490e90, 0xbf7fdaaf, 0x3d0a342f, 0xbf7f2f9d, 0x3da3308c, 0xbf7dfa38, 0x3e007745
.long 0xbf7c3b28, 0x3e2f10a2, 0xbf79f35e, 0x3e5d4b1a, 0xbf772417, 0x3e8586ce, 0xbf73ced9, 0x3e9c1faf
.long 0xbf6ff573, 0x3eb263ef, 0xbf6b99fb, 0x3ec8477c, 0xbf66becc, 0x3eddbe79, 0xbf61668a, 0x3ef2bd43
.long 0xbf5b941a, 0x3f039c3d, 0xbf554aa4, 0x3f0d9281, 0xbf4e8d90, 0x3f173c07, 0xbf476085, 0x3f209393
.long 0xbf3fc767, 0x3f299415, 0xbf37c655, 0x3f3238aa, 0xbf2f61a5, 0x3f3a7ca4, 0xbf269de3, 0x3f425b89
.long 0xbf1d7fd1, 0x3f49d112, 0xbf140c5f, 0x3f50d937, 0xbf0a48ad, 0x3f577026, 0xbf003a06, 0x3f5d924d
.long 0xbeebcbbb, 0x3f633c5a, 0xbed6a399, 0x3f686b39, 0xbec1071e, 0x3f6d1c1d, 0xbeab0201, 0x3f714c7a
.long 0xbe94a031, 0x3f74fa0b, 0xbe7bdba4, 0x3f7822d1, 0xbe4dee60, 0x3f7ac516, 0xbe1f917b, 0x3f7cdf6c
.long 0xbde1bc2e, 0x3f7e70b0, 0xbd83db0a, 0x3f7f7808, 0xbc96c9b6, 0x3f7ff4e6, 0x3ce22a7a, 0x3f7fe705
.long 0x3d96a905, 0x3f7f4e6d, 0x3df475c0, 0x3f7e2b72, 0x3e28defc, 0x3f7c7eb0, 0x3e57278f, 0x3f7a4910
.long 0x3e827dc0, 0x3f778bc5, 0x3e9920fe, 0x3f74484b, 0x3eaf713a, 0x3f708066, 0x3ec5625c, 0x3f6c3624
.long 0x3edae880, 0x3f676bd8, 0x3eeff7fb, 0x3f62241a, 0x3f0242b1, 0x3f5c61c7, 0x3f0c42c9, 0x3f5627fe
.long 0x3f15f6d9, 0x3f4f7a1f, 0x3f1f599f, 0x3f485bca, 0x3f286605, 0x3f40d0da, 0x3f311722, 0x3f38dd65
.long 0x3f396842, 0x3f3085bb, 0x3f4154e1, 0x3f27ce61, 0x3f48d8b3, 0x3f1ebc12, 0x3f4fefa8, 0x3f1553b7
.long 0x3f5695e5, 0x3f0b9a6b, 0x3f5cc7d1, 0x3f019573, 0x3f628210, 0x3eee9479, 0x3f67c187, 0x3ed97cb9
T2048_tw2A:
.long 0x3f800000, 0x00000000, 0x3f800000, 0x00000000, 0x3f800000, 0x00000000, 0x3f800000, 0x00000000
.long 0x3f800000, 0x00000000, 0x3f800000, 0x00000000, 0x3f800000, 0x00000000, 0x3f800000, 0x00000000
.long 0x3f800000, 0x00000000, 0x3f800000, 0x00000000, 0x3f800000, 0x00000000, 0x3f800000, 0x00000000
.long 0x3f800000, 0x00000000, 0x3f800000, 0x00000000, 0x3f800000, 0x00000000, 0x3f800000, 0x00000000
.long 0x3f800000, 0x00000000, 0x3f800000, 0x00000000, 0x3f800000, 0x00000000, 0x3f800000, 0x00000000
.long 0x3f800000, 0x00000000, 0x3f800000, 0x00000000, 0x3f800000, 0x00000000, 0x3f800000, 0x00000000
.long 0x3f800000, 0x00000000, 0x3f800000, 0x00000000, 0x3f800000, 0x00000000, 0x3f800000, 0x00000000
.long 0x3f800000, 0x00000000, 0x3f800000, 0x00000000, 0x3f800000, 0x00000000, 0x3f800000, 0x00000000
.long 0x3f800000, 0x00000000, 0x3f800000, 0x00000000, 0x3f800000, 0x00000000, 0x3f800000, 0x00000000
.long 0x3f800000, 0x00000000, 0x3f800000, 0x00000000, 0x3f800000, 0x00000000, 0x3f800000, 0x00000000
.long 0x3f800000, 0x00000000, 0x3f800000, 0x00000000, 0x3f800000, 0x00000000, 0x3f800000, 0x00000000
.long 0x3f800000, 0x00000000, 0x3f800000, 0x00000000, 0x3f800000, 0x00000000, 0x3f800000, 0x00000000
.long 0x3f800000, 0x00000000, 0x3f800000, 0x00000000, 0x3f800000, 0x00000000, 0x3f800000, 0x00000000
.long 0x3f800000, 0x00000000, 0x3f800000, 0x00000000, 0x3f800000, 0x00000000, 0x3f800000, 0x00000000
.long 0x3f800000, 0x00000000, 0x3f800000, 0x00000000, 0x3f800000, 0x00000000, 0x3f800000, 0x00000000
.long 0x3f800000, 0x00000000, 0x3f800000, 0x00000000, 0x3f800000, 0x00000000, 0x3f800000, 0x00000000
.long 0x3f800000, 0x00000000, 0x3f800000, 0x00000000, 0x3f800000, 0x00000000, 0x3f800000, 0x00000000
.long 0x3f800000, 0x00000000, 0x3f800000, 0x00000000, 0x3f800000, 0x00000000, 0x3f800000, 0x00000000
.long 0x3f800000, 0x00000000, 0x3f800000, 0x00000000, 0x3f800000, 0x00000000, 0x3f800000, 0x00000000
.long 0x3f800000, 0x00000000, 0x3f800000, 0x00000000, 0x3f800000, 0x00000000, 0x3f800000, 0x00000000
.long 0x3f800000, 0x00000000, 0x3f800000, 0x00000000, 0x3f800000, 0x00000000, 0x3f800000, 0x00000000
.long 0x3f800000, 0x00000000, 0x3f800000, 0x00000000, 0x3f800000, 0x00000000, 0x3f800000, 0x00000000
.long 0x3f800000, 0x00000000, 0x3f800000, 0x00000000, 0x3f800000, 0x00000000, 0x3f800000, 0x00000000
.long 0x3f800000, 0x00000000, 0x3f800000, 0x00000000, 0x3f800000, 0x00000000, 0x3f800000, 0x00000000
.long 0x3f800000, 0x00000000, 0x3f800000, 0x00000000, 0x3f800000, 0x00000000, 0x3f800000, 0x00000000
.long 0x3f800000, 0x00000000, 0x3f800000, 0x00000000, 0x3f800000, 0x00000000, 0x3f800000, 0x00000000
.long 0x3f800000, 0x00000000, 0x3f800000, 0x00000000, 0x3f800000, 0x00000000, 0x3f800000, 0x00000000
.long 0x3f800000, 0x00000000, 0x3f800000, 0x00000000, 0x3f800000, 0x00000000, 0x3f800000, 0x00000000
.long 0x3f800000, 0x00000000, 0x3f800000, 0x00000000, 0x3f800000, 0x00000000, 0x3f800000, 0x00000000
.long 0x3f800000, 0x00000000, 0x3f800000, 0x00000000, 0x3f800000, 0x00000000, 0x3f800000, 0x00000000
.long 0x3f800000, 0x00000000, 0x3f800000, 0x00000000, 0x3f800000, 0x00000000, 0x3f800000, 0x00000000
.long 0x3f800000, 0x00000000, 0x3f800000, 0x00000000, 0x3f800000, 0x00000000, 0x3f800000, 0x00000000
.long 0x3f800000, 0x00000000, 0x3f7fb10f, 0xbd48fb30, 0x3f7ec46d, 0xbdc8bd36, 0x3f7d3aac, 0xbe164083
.long 0x3f7b14be, 0xbe47c5c2, 0x3f7853f8, 0xbe78cfcc, 0x3f74fa0b, 0xbe94a031, 0x3f710908, 0xbeac7cd4
.long 0x3f800000, 0x00000000, 0x3f7fb10f, 0xbd48fb30, 0x3f7ec46d, 0xbdc8bd36, 0x3f7d3aac, 0xbe164083
.long 0x3f7b14be, 0xbe47c5c2, 0x3f7853f8, 0xbe78cfcc, 0x3f74fa0b, 0xbe94a031, 0x3f710908, 0xbeac7cd4
.long 0x3f800000, 0x00000000, 0x3f7fb10f, 0xbd48fb30, 0x3f7ec46d, 0xbdc8bd36, 0x3f7d3aac, 0xbe164083
.long 0x3f7b14be, 0xbe47c5c2, 0x3f7853f8, 0xbe78cfcc, 0x3f74fa0b, 0xbe94a031, 0x3f710908, 0xbeac7cd4
.long 0x3f800000, 0x00000000, 0x3f7fb10f, 0xbd48fb30, 0x3f7ec46d, 0xbdc8bd36, 0x3f7d3aac, 0xbe164083
.long 0x3f7b14be, 0xbe47c5c2, 0x3f7853f8, 0xbe78cfcc, 0x3f74fa0b, 0xbe94a031, 0x3f710908, 0xbeac7cd4
.long 0x3f800000, 0x00000000, 0x3f7fb10f, 0xbd48fb30, 0x3f7ec46d, 0xbdc8bd36, 0x3f7d3aac, 0xbe164083
.long 0x3f7b14be, 0xbe47c5c2, 0x3f7853f8, 0xbe78cfcc, 0x3f74fa0b, 0xbe94a031, 0x3f710908, 0xbeac7cd4
.long 0x3f800000, 0x00000000, 0x3f7fb10f, 0xbd48fb30, 0x3f7ec46d, 0xbdc8bd36, 0x3f7d3aac, 0xbe164083
.long 0x3f7b14be, 0xbe47c5c2, 0x3f7853f8, 0xbe78cfcc, 0x3f74fa0b, 0xbe94a031, 0x3f710908, 0xbeac7cd4
.long 0x3f800000, 0x00000000, 0x3f7fb10f, 0xbd48fb30, 0x3f7ec46d, 0xbdc8bd36, 0x3f7d3aac, 0xbe164083
.long 0x3f7b14be, 0xbe47c5c2, 0x3f7853f8, 0xbe78cfcc, 0x3f74fa0b, 0xbe94a031, 0x3f710908, 0xbeac7cd4
.long 0x3f800000, 0x00000000, 0x3f7fb10f, 0xbd48fb30, 0x3f7ec46d, 0xbdc8bd36, 0x3f7d3aac, 0xbe164083
.long 0x3f7b14be, 0xbe47c5c2, 0x3f7853f8, 0xbe78cfcc, 0x3f74fa0b, 0xbe94a031, 0x3f710908, 0xbeac7cd4
.long 0x3f800000, 0x00000000, 0x3f7fb10f, 0xbd48fb30, 0x3f7ec46d, 0xbdc8bd36, 0x3f7d3aac, 0xbe164083
.long 0x3f7b14be, 0xbe47c5c2, 0x3f7853f8, 0xbe78cfcc, 0x3f74fa0b, 0xbe94a031, 0x3f710908, 0xbeac7cd4
.long 0x3f800000, 0x00000000, 0x3f7fb10f, 0xbd48fb30, 0x3f7ec46d, 0xbdc8bd36, 0x3f7d3aac, 0xbe164083
.long 0x3f7b14be, 0xbe47c5c2, 0x3f7853f8, 0xbe78cfcc, 0x3f74fa0b, 0xbe94a031, 0x3f710908, 0xbeac7cd4
.long 0x3f800000, 0x00000000, 0x3f7fb10f, 0xbd48fb30, 0x3f7ec46d, 0xbdc8bd36, 0x3f7d3aac, 0xbe164083
.long 0x3f7b14be, 0xbe47c5c2, 0x3f7853f8, 0xbe78cfcc, 0x3f74fa0b, 0xbe94a031, 0x3f710908, 0xbeac7cd4
.long 0x3f800000, 0x00000000, 0x3f7fb10f, 0xbd48fb30, 0x3f7ec46d, 0xbdc8bd36, 0x3f7d3aac, 0xbe164083
.long 0x3f7b14be, 0xbe47c5c2, 0x3f7853f8, 0xbe78cfcc, 0x3f74fa0b, 0xbe94a031, 0x3f710908, 0xbeac7cd4
.long 0x3f800000, 0x00000000, 0x3f7fb10f, 0xbd48fb30, 0x3f7ec46d, 0xbdc8bd36, 0x3f7d3aac, 0xbe164083
.long 0x3f7b14be, 0xbe47c5c2, 0x3f7853f8, 0xbe78cfcc, 0x3f74fa0b, 0xbe94a031, 0x3f710908, 0xbeac7cd4
.long 0x3f800000, 0x00000000, 0x3f7fb10f, 0xbd48fb30, 0x3f7ec46d, 0xbdc8bd36, 0x3f7d3aac, 0xbe164083
.long 0x3f7b14be, 0xbe47c5c2, 0x3f7853f8, 0xbe78cfcc, 0x3f74fa0b, 0xbe94a031, 0x3f710908, 0xbeac7cd4
.long 0x3f800000, 0x00000000, 0x3f7fb10f, 0xbd48fb30, 0x3f7ec46d, 0xbdc8bd36, 0x3f7d3aac, 0xbe164083
.long 0x3f7b14be, 0xbe47c5c2, 0x3f7853f8, 0xbe78cfcc, 0x3f74fa0b, 0xbe94a031, 0x3f710908, 0xbeac7cd4
.long 0x3f800000, 0x00000000, 0x3f7fb10f, 0xbd48fb30, 0x3f7ec46d, 0xbdc8bd36, 0x3f7d3aac, 0xbe164083
.long 0x3f7b14be, 0xbe47c5c2, 0x3f7853f8, 0xbe78cfcc, 0x3f74fa0b, 0xbe94a031, 0x3f710908, 0xbeac7cd4
.long 0x3f800000, 0x00000000, 0x3f7ec46d, 0xbdc8bd36, 0x3f7b14be, 0xbe47c5c2, 0x3f74fa0b, 0xbe94a031
.long 0x3f6c835e, 0xbec3ef15, 0x3f61c598, 0xbef15aea, 0x3f54db31, 0xbf0e39da, 0x3f45e403, 0xbf226799
.long 0x3f800000, 0x00000000, 0x3f7ec46d, 0xbdc8bd36, 0x3f7b14be, 0xbe47c5c2, 0x3f74fa0b, 0xbe94a031
.long 0x3f6c835e, 0xbec3ef15, 0x3f61c598, 0xbef15aea, 0x3f54db31, 0xbf0e39da, 0x3f45e403, 0xbf226799
.long 0x3f800000, 0x00000000, 0x3f7ec46d, 0xbdc8bd36, 0x3f7b14be, 0xbe47c5c2, 0x3f74fa0b, 0xbe94a031
.long 0x3f6c835e, 0xbec3ef15, 0x3f61c598, 0xbef15aea, 0x3f54db31, 0xbf0e39da, 0x3f45e403, 0xbf226799
.long 0x3f800000, 0x00000000, 0x3f7ec46d, 0xbdc8bd36, 0x3f7b14be, 0xbe47c5c2, 0x3f74fa0b, 0xbe94a031
.long 0x3f6c835e, 0xbec3ef15, 0x3f61c598, 0xbef15aea, 0x3f54db31, 0xbf0e39da, 0x3f45e403, 0xbf226799
.long 0x3f800000, 0x00000000, 0x3f7ec46d, 0xbdc8bd36, 0x3f7b14be, 0xbe47c5c2, 0x3f74fa0b, 0xbe94a031
.long 0x3f6c835e, 0xbec3ef15, 0x3f61c598, 0xbef15aea, 0x3f54db31, 0xbf0e39da, 0x3f45e403, 0xbf226799
.long 0x3f800000, 0x00000000, 0x3f7ec46d, 0xbdc8bd36, 0x3f7b14be, 0xbe47c5c2, 0x3f74fa0b, 0xbe94a031
.long 0x3f6c835e, 0xbec3ef15, 0x3f61c598, 0xbef15aea, 0x3f54db31, 0xbf0e39da, 0x3f45e403, 0xbf226799
.long 0x3f800000, 0x00000000, 0x3f7ec46d, 0xbdc8bd36, 0x3f7b14be, 0xbe47c5c2, 0x3f74fa0b, 0xbe94a031
.long 0x3f6c835e, 0xbec3ef15, 0x3f61c598, 0xbef15aea, 0x3f54db31, 0xbf0e39da, 0x3f45e403, 0xbf226799
.long 0x3f800000, 0x00000000, 0x3f7ec46d, 0xbdc8bd36, 0x3f7b14be, 0xbe47c5c2, 0x3f74fa0b, 0xbe94a031
.long 0x3f6c835e, 0xbec3ef15, 0x3f61c598, 0xbef15aea, 0x3f54db31, 0xbf0e39da, 0x3f45e403, 0xbf226799
.long 0x3f800000, 0x00000000, 0x3f7ec46d, 0xbdc8bd36, 0x3f7b14be, 0xbe47c5c2, 0x3f74fa0b, 0xbe94a031
.long 0x3f6c835e, 0xbec3ef15, 0x3f61c598, 0xbef15aea, 0x3f54db31, 0xbf0e39da, 0x3f45e403, 0xbf226799
.long 0x3f800000, 0x00000000, 0x3f7ec46d, 0xbdc8bd36, 0x3f7b14be, 0xbe47c5c2, 0x3f74fa0b, 0xbe94a031
.long 0x3f6c835e, 0xbec3ef15, 0x3f61c598, 0xbef15aea, 0x3f54db31, 0xbf0e39da, 0x3f45e403, 0xbf226799
.long 0x3f800000, 0x00000000, 0x3f7ec46d, 0xbdc8bd36, 0x3f7b14be, 0xbe47c5c2, 0x3f74fa0b, 0xbe94a031
.long 0x3f6c835e, 0xbec3ef15, 0x3f61c598, 0xbef15aea, 0x3f54db31, 0xbf0e39da, 0x3f45e403, 0xbf226799
.long 0x3f800000, 0x00000000, 0x3f7ec46d, 0xbdc8bd36, 0x3f7b14be, 0xbe47c5c2, 0x3f74fa0b, 0xbe94a031
.long 0x3f6c835e, 0xbec3ef15, 0x3f61c598, 0xbef15aea, 0x3f54db31, 0xbf0e39da, 0x3f45e403, 0xbf226799
.long 0x3f800000, 0x00000000, 0x3f7ec46d, 0xbdc8bd36, 0x3f7b14be, 0xbe47c5c2, 0x3f74fa0b, 0xbe94a031
.long 0x3f6c835e, 0xbec3ef15, 0x3f61c598, 0xbef15aea, 0x3f54db31, 0xbf0e39da, 0x3f45e403, 0xbf226799
.long 0x3f800000, 0x00000000, 0x3f7ec46d, 0xbdc8bd36, 0x3f7b14be, 0xbe47c5c2, 0x3f74fa0b, 0xbe94a031
.long 0x3f6c835e, 0xbec3ef15, 0x3f61c598, 0xbef15aea, 0x3f54db31, 0xbf0e39da, 0x3f45e403, 0xbf226799
.long 0x3f800000, 0x00000000, 0x3f7ec46d, 0xbdc8bd36, 0x3f7b14be, 0xbe47c5c2, 0x3f74fa0b, 0xbe94a031
.long 0x3f6c835e, 0xbec3ef15, 0x3f61c598, 0xbef15aea, 0x3f54db31, 0xbf0e39da, 0x3f45e403, 0xbf226799
.long 0x3f800000, 0x00000000, 0x3f7ec46d, 0xbdc8bd36, 0x3f7b14be, 0xbe47c5c2, 0x3f74fa0b, 0xbe94a031
.long 0x3f6c835e, 0xbec3ef15, 0x3f61c598, 0xbef15aea, 0x3f54db31, 0xbf0e39da, 0x3f45e403, 0xbf226799
.long 0x3f800000, 0x00000000, 0x3f7d3aac, 0xbe164083, 0x3f74fa0b, 0xbe94a031, 0x3f676bd8, 0xbedae880
.long 0x3f54db31, 0xbf0e39da, 0x3f3daef9, 0xbf2beb4a, 0x3f226799, 0xbf45e403, 0x3f039c3d, 0xbf5b941a
.long 0x3f800000, 0x00000000, 0x3f7d3aac, 0xbe164083, 0x3f74fa0b, 0xbe94a031, 0x3f676bd8, 0xbedae880
.long 0x3f54db31, 0xbf0e39da, 0x3f3daef9, 0xbf2beb4a, 0x3f226799, 0xbf45e403, 0x3f039c3d, 0xbf5b941a
.long 0x3f800000, 0x00000000, 0x3f7d3aac, 0xbe164083, 0x3f74fa0b, 0xbe94a031, 0x3f676bd8, 0xbedae880
.long 0x3f54db31, 0xbf0e39da, 0x3f3daef9, 0xbf2beb4a, 0x3f226799, 0xbf45e403, 0x3f039c3d, 0xbf5b941a
.long 0x3f800000, 0x00000000, 0x3f7d3aac, 0xbe164083, 0x3f74fa0b, 0xbe94a031, 0x3f676bd8, 0xbedae880
.long 0x3f54db31, 0xbf0e39da, 0x3f3daef9, 0xbf2beb4a, 0x3f226799, 0xbf45e403, 0x3f039c3d, 0xbf5b941a
.long 0x3f800000, 0x00000000, 0x3f7d3aac, 0xbe164083, 0x3f74fa0b, 0xbe94a031, 0x3f676bd8, 0xbedae880
.long 0x3f54db31, 0xbf0e39da, 0x3f3daef9, 0xbf2beb4a, 0x3f226799, 0xbf45e403, 0x3f039c3d, 0xbf5b941a
.long 0x3f800000, 0x00000000, 0x3f7d3aac, 0xbe164083, 0x3f74fa0b, 0xbe94a031, 0x3f676bd8, 0xbedae880
.long 0x3f54db31, 0xbf0e39da, 0x3f3daef9, 0xbf2beb4a, 0x3f226799, 0xbf45e403, 0x3f039c3d, 0xbf5b941a
.long 0x3f800000, 0x00000000, 0x3f7d3aac, 0xbe164083, 0x3f74fa0b, 0xbe94a031, 0x3f676bd8, 0xbedae880
.long 0x3f54db31, 0xbf0e39da, 0x3f3daef9, 0xbf2beb4a, 0x3f226799, 0xbf45e403, 0x3f039c3d, 0xbf5b941a
.long 0x3f800000, 0x00000000, 0x3f7d3aac, 0xbe164083, 0x3f74fa0b, 0xbe94a031, 0x3f676bd8, 0xbedae880
.long 0x3f54db31, 0xbf0e39da, 0x3f3daef9, 0xbf2beb4a, 0x3f226799, 0xbf45e403, 0x3f039c3d, 0xbf5b941a
.long 0x3f800000, 0x00000000, 0x3f7d3aac, 0xbe164083, 0x3f74fa0b, 0xbe94a031, 0x3f676bd8, 0xbedae880
.long 0x3f54db31, 0xbf0e39da, 0x3f3daef9, 0xbf2beb4a, 0x3f226799, 0xbf45e403, 0x3f039c3d, 0xbf5b941a
.long 0x3f800000, 0x00000000, 0x3f7d3aac, 0xbe164083, 0x3f74fa0b, 0xbe94a031, 0x3f676bd8, 0xbedae880
.long 0x3f54db31, 0xbf0e39da, 0x3f3daef9, 0xbf2beb4a, 0x3f226799, 0xbf45e403, 0x3f039c3d, 0xbf5b941a
.long 0x3f800000, 0x00000000, 0x3f7d3aac, 0xbe164083, 0x3f74fa0b, 0xbe94a031, 0x3f676bd8, 0xbedae880
.long 0x3f54db31, 0xbf0e39da, 0x3f3daef9, 0xbf2beb4a, 0x3f226799, 0xbf45e403, 0x3f039c3d, 0xbf5b941a
.long 0x3f800000, 0x00000000, 0x3f7d3aac, 0xbe164083, 0x3f74fa0b, 0xbe94a031, 0x3f676bd8, 0xbedae880
.long 0x3f54db31, 0xbf0e39da, 0x3f3daef9, 0xbf2beb4a, 0x3f226799, 0xbf45e403, 0x3f039c3d, 0xbf5b941a
.long 0x3f800000, 0x00000000, 0x3f7d3aac, 0xbe164083, 0x3f74fa0b, 0xbe94a031, 0x3f676bd8, 0xbedae880
.long 0x3f54db31, 0xbf0e39da, 0x3f3daef9, 0xbf2beb4a, 0x3f226799, 0xbf45e403, 0x3f039c3d, 0xbf5b941a
.long 0x3f800000, 0x00000000, 0x3f7d3aac, 0xbe164083, 0x3f74fa0b, 0xbe94a031, 0x3f676bd8, 0xbedae880
.long 0x3f54db31, 0xbf0e39da, 0x3f3daef9, 0xbf2beb4a, 0x3f226799, 0xbf45e403, 0x3f039c3d, 0xbf5b941a
.long 0x3f800000, 0x00000000, 0x3f7d3aac, 0xbe164083, 0x3f74fa0b, 0xbe94a031, 0x3f676bd8, 0xbedae880
.long 0x3f54db31, 0xbf0e39da, 0x3f3daef9, 0xbf2beb4a, 0x3f226799, 0xbf45e403, 0x3f039c3d, 0xbf5b941a
.long 0x3f800000, 0x00000000, 0x3f7d3aac, 0xbe164083, 0x3f74fa0b, 0xbe94a031, 0x3f676bd8, 0xbedae880
.long 0x3f54db31, 0xbf0e39da, 0x3f3daef9, 0xbf2beb4a, 0x3f226799, 0xbf45e403, 0x3f039c3d, 0xbf5b941a
.long 0x3f800000, 0x00000000, 0x3f7b14be, 0xbe47c5c2, 0x3f6c835e, 0xbec3ef15, 0x3f54db31, 0xbf0e39da
.long 0x3f3504f3, 0xbf3504f3, 0x3f0e39da, 0xbf54db31, 0x3ec3ef15, 0xbf6c835e, 0x3e47c5c2, 0xbf7b14be
.long 0x3f800000, 0x00000000, 0x3f7b14be, 0xbe47c5c2, 0x3f6c835e, 0xbec3ef15, 0x3f54db31, 0xbf0e39da
.long 0x3f3504f3, 0xbf3504f3, 0x3f0e39da, 0xbf54db31, 0x3ec3ef15, 0xbf6c835e, 0x3e47c5c2, 0xbf7b14be
.long 0x3f800000, 0x00000000, 0x3f7b14be, 0xbe47c5c2, 0x3f6c835e, 0xbec3ef15, 0x3f54db31, 0xbf0e39da
.long 0x3f3504f3, 0xbf3504f3, 0x3f0e39da, 0xbf54db31, 0x3ec3ef15, 0xbf6c835e, 0x3e47c5c2, 0xbf7b14be
.long 0x3f800000, 0x00000000, 0x3f7b14be, 0xbe47c5c2, 0x3f6c835e, 0xbec3ef15, 0x3f54db31, 0xbf0e39da
.long 0x3f3504f3, 0xbf3504f3, 0x3f0e39da, 0xbf54db31, 0x3ec3ef15, 0xbf6c835e, 0x3e47c5c2, 0xbf7b14be
.long 0x3f800000, 0x00000000, 0x3f7b14be, 0xbe47c5c2, 0x3f6c835e, 0xbec3ef15, 0x3f54db31, 0xbf0e39da
.long 0x3f3504f3, 0xbf3504f3, 0x3f0e39da, 0xbf54db31, 0x3ec3ef15, 0xbf6c835e, 0x3e47c5c2, 0xbf7b14be
.long 0x3f800000, 0x00000000, 0x3f7b14be, 0xbe47c5c2, 0x3f6c835e, 0xbec3ef15, 0x3f54db31, 0xbf0e39da
.long 0x3f3504f3, 0xbf3504f3, 0x3f0e39da, 0xbf54db31, 0x3ec3ef15, 0xbf6c835e, 0x3e47c5c2, 0xbf7b14be
.long 0x3f800000, 0x00000000, 0x3f7b14be, 0xbe47c5c2, 0x3f6c835e, 0xbec3ef15, 0x3f54db31, 0xbf0e39da
.long 0x3f3504f3, 0xbf3504f3, 0x3f0e39da, 0xbf54db31, 0x3ec3ef15, 0xbf6c835e, 0x3e47c5c2, 0xbf7b14be
.long 0x3f800000, 0x00000000, 0x3f7b14be, 0xbe47c5c2, 0x3f6c835e, 0xbec3ef15, 0x3f54db31, 0xbf0e39da
.long 0x3f3504f3, 0xbf3504f3, 0x3f0e39da, 0xbf54db31, 0x3ec3ef15, 0xbf6c835e, 0x3e47c5c2, 0xbf7b14be
.long 0x3f800000, 0x00000000, 0x3f7b14be, 0xbe47c5c2, 0x3f6c835e, 0xbec3ef15, 0x3f54db31, 0xbf0e39da
.long 0x3f3504f3, 0xbf3504f3, 0x3f0e39da, 0xbf54db31, 0x3ec3ef15, 0xbf6c835e, 0x3e47c5c2, 0xbf7b14be
.long 0x3f800000, 0x00000000, 0x3f7b14be, 0xbe47c5c2, 0x3f6c835e, 0xbec3ef15, 0x3f54db31, 0xbf0e39da
.long 0x3f3504f3, 0xbf3504f3, 0x3f0e39da, 0xbf54db31, 0x3ec3ef15, 0xbf6c835e, 0x3e47c5c2, 0xbf7b14be
.long 0x3f800000, 0x00000000, 0x3f7b14be, 0xbe47c5c2, 0x3f6c835e, 0xbec3ef15, 0x3f54db31, 0xbf0e39da
.long 0x3f3504f3, 0xbf3504f3, 0x3f0e39da, 0xbf54db31, 0x3ec3ef15, 0xbf6c835e, 0x3e47c5c2, 0xbf7b14be
.long 0x3f800000, 0x00000000, 0x3f7b14be, 0xbe47c5c2, 0x3f6c835e, 0xbec3ef15, 0x3f54db31, 0xbf0e39da
.long 0x3f3504f3, 0xbf3504f3, 0x3f0e39da, 0xbf54db31, 0x3ec3ef15, 0xbf6c835e, 0x3e47c5c2, 0xbf7b14be
.long 0x3f800000, 0x00000000, 0x3f7b14be, 0xbe47c5c2, 0x3f6c835e, 0xbec3ef15, 0x3f54db31, 0xbf0e39da
.long 0x3f3504f3, 0xbf3504f3, 0x3f0e39da, 0xbf54db31, 0x3ec3ef15, 0xbf6c835e, 0x3e47c5c2, 0xbf7b14be
.long 0x3f800000, 0x00000000, 0x3f7b14be, 0xbe47c5c2, 0x3f6c835e, 0xbec3ef15, 0x3f54db31, 0xbf0e39da
.long 0x3f3504f3, 0xbf3504f3, 0x3f0e39da, 0xbf54db31, 0x3ec3ef15, 0xbf6c835e, 0x3e47c5c2, 0xbf7b14be
.long 0x3f800000, 0x00000000, 0x3f7b14be, 0xbe47c5c2, 0x3f6c835e, 0xbec3ef15, 0x3f54db31, 0xbf0e39da
.long 0x3f3504f3, 0xbf3504f3, 0x3f0e39da, 0xbf54db31, 0x3ec3ef15, 0xbf6c835e, 0x3e47c5c2, 0xbf7b14be
.long 0x3f800000, 0x00000000, 0x3f7b14be, 0xbe47c5c2, 0x3f6c835e, 0xbec3ef15, 0x3f54db31, 0xbf0e39da
.long 0x3f3504f3, 0xbf3504f3, 0x3f0e39da, 0xbf54db31, 0x3ec3ef15, 0xbf6c835e, 0x3e47c5c2, 0xbf7b14be
.long 0x3f800000, 0x00000000, 0x3f7853f8, 0xbe78cfcc, 0x3f61c598, 0xbef15aea, 0x3f3daef9, 0xbf2beb4a
.long 0x3f0e39da, 0xbf54db31, 0x3eac7cd4, 0xbf710908, 0x3dc8bd36, 0xbf7ec46d, 0xbe164083, 0xbf7d3aac
.long 0x3f800000, 0x00000000, 0x3f7853f8, 0xbe78cfcc, 0x3f61c598, 0xbef15aea, 0x3f3daef9, 0xbf2beb4a
.long 0x3f0e39da, 0xbf54db31, 0x3eac7cd4, 0xbf710908, 0x3dc8bd36, 0xbf7ec46d, 0xbe164083, 0xbf7d3aac
.long 0x3f800000, 0x00000000, 0x3f7853f8, 0xbe78cfcc, 0x3f61c598, 0xbef15aea, 0x3f3daef9, 0xbf2beb4a
.long 0x3f0e39da, 0xbf54db31, 0x3eac7cd4, 0xbf710908, 0x3dc8bd36, 0xbf7ec46d, 0xbe164083, 0xbf7d3aac
.long 0x3f800000, 0x00000000, 0x3f7853f8, 0xbe78cfcc, 0x3f61c598, 0xbef15aea, 0x3f3daef9, 0xbf2beb4a
.long 0x3f0e39da, 0xbf54db31, 0x3eac7cd4, 0xbf710908, 0x3dc8bd36, 0xbf7ec46d, 0xbe164083, 0xbf7d3aac
.long 0x3f800000, 0x00000000, 0x3f7853f8, 0xbe78cfcc, 0x3f61c598, 0xbef15aea, 0x3f3daef9, 0xbf2beb4a
.long 0x3f0e39da, 0xbf54db31, 0x3eac7cd4, 0xbf710908, 0x3dc8bd36, 0xbf7ec46d, 0xbe164083, 0xbf7d3aac
.long 0x3f800000, 0x00000000, 0x3f7853f8, 0xbe78cfcc, 0x3f61c598, 0xbef15aea, 0x3f3daef9, 0xbf2beb4a
.long 0x3f0e39da, 0xbf54db31, 0x3eac7cd4, 0xbf710908, 0x3dc8bd36, 0xbf7ec46d, 0xbe164083, 0xbf7d3aac
.long 0x3f800000, 0x00000000, 0x3f7853f8, 0xbe78cfcc, 0x3f61c598, 0xbef15aea, 0x3f3daef9, 0xbf2beb4a
.long 0x3f0e39da, 0xbf54db31, 0x3eac7cd4, 0xbf710908, 0x3dc8bd36, 0xbf7ec46d, 0xbe164083, 0xbf7d3aac
.long 0x3f800000, 0x00000000, 0x3f7853f8, 0xbe78cfcc, 0x3f61c598, 0xbef15aea, 0x3f3daef9, 0xbf2beb4a
.long 0x3f0e39da, 0xbf54db31, 0x3eac7cd4, 0xbf710908, 0x3dc8bd36, 0xbf7ec46d, 0xbe164083, 0xbf7d3aac
.long 0x3f800000, 0x00000000, 0x3f7853f8, 0xbe78cfcc, 0x3f61c598, 0xbef15aea, 0x3f3daef9, 0xbf2beb4a
.long 0x3f0e39da, 0xbf54db31, 0x3eac7cd4, 0xbf710908, 0x3dc8bd36, 0xbf7ec46d, 0xbe164083, 0xbf7d3aac
.long 0x3f800000, 0x00000000, 0x3f7853f8, 0xbe78cfcc, 0x3f61c598, 0xbef15aea, 0x3f3daef9, 0xbf2beb4a
.long 0x3f0e39da, 0xbf54db31, 0x3eac7cd4, 0xbf710908, 0x3dc8bd36, 0xbf7ec46d, 0xbe164083, 0xbf7d3aac
.long 0x3f800000, 0x00000000, 0x3f7853f8, 0xbe78cfcc, 0x3f61c598, 0xbef15aea, 0x3f3daef9, 0xbf2beb4a
.long 0x3f0e39da, 0xbf54db31, 0x3eac7cd4, 0xbf710908, 0x3dc8bd36, 0xbf7ec46d, 0xbe164083, 0xbf7d3aac
.long 0x3f800000, 0x00000000, 0x3f7853f8, 0xbe78cfcc, 0x3f61c598, 0xbef15aea, 0x3f3daef9, 0xbf2beb4a
.long 0x3f0e39da, 0xbf54db31, 0x3eac7cd4, 0xbf710908, 0x3dc8bd36, 0xbf7ec46d, 0xbe164083, 0xbf7d3aac
.long 0x3f800000, 0x00000000, 0x3f7853f8, 0xbe78cfcc, 0x3f61c598, 0xbef15aea, 0x3f3daef9, 0xbf2beb4a
.long 0x3f0e39da, 0xbf54db31, 0x3eac7cd4, 0xbf710908, 0x3dc8bd36, 0xbf7ec46d, 0xbe164083, 0xbf7d3aac
.long 0x3f800000, 0x00000000, 0x3f7853f8, 0xbe78cfcc, 0x3f61c598, 0xbef15aea, 0x3f3daef9, 0xbf2beb4a
.long 0x3f0e39da, 0xbf54db31, 0x3eac7cd4, 0xbf710908, 0x3dc8bd36, 0xbf7ec46d, 0xbe164083, 0xbf7d3aac
.long 0x3f800000, 0x00000000, 0x3f7853f8, 0xbe78cfcc, 0x3f61c598, 0xbef15aea, 0x3f3daef9, 0xbf2beb4a
.long 0x3f0e39da, 0xbf54db31, 0x3eac7cd4, 0xbf710908, 0x3dc8bd36, 0xbf7ec46d, 0xbe164083, 0xbf7d3aac
.long 0x3f800000, 0x00000000, 0x3f7853f8, 0xbe78cfcc, 0x3f61c598, 0xbef15aea, 0x3f3daef9, 0xbf2beb4a
.long 0x3f0e39da, 0xbf54db31, 0x3eac7cd4, 0xbf710908, 0x3dc8bd36, 0xbf7ec46d, 0xbe164083, 0xbf7d3aac
.long 0x3f800000, 0x00000000, 0x3f74fa0b, 0xbe94a031, 0x3f54db31, 0xbf0e39da, 0x3f226799, 0xbf45e403
.long 0x3ec3ef15, 0xbf6c835e, 0x3dc8bd36, 0xbf7ec46d, 0xbe47c5c2, 0xbf7b14be, 0xbef15aea, 0xbf61c598
.long 0x3f800000, 0x00000000, 0x3f74fa0b, 0xbe94a031, 0x3f54db31, 0xbf0e39da, 0x3f226799, 0xbf45e403
.long 0x3ec3ef15, 0xbf6c835e, 0x3dc8bd36, 0xbf7ec46d, 0xbe47c5c2, 0xbf7b14be, 0xbef15aea, 0xbf61c598
.long 0x3f800000, 0x00000000, 0x3f74fa0b, 0xbe94a031, 0x3f54db31, 0xbf0e39da, 0x3f226799, 0xbf45e403
.long 0x3ec3ef15, 0xbf6c835e, 0x3dc8bd36, 0xbf7ec46d, 0xbe47c5c2, 0xbf7b14be, 0xbef15aea, 0xbf61c598
.long 0x3f800000, 0x00000000, 0x3f74fa0b, 0xbe94a031, 0x3f54db31, 0xbf0e39da, 0x3f226799, 0xbf45e403
.long 0x3ec3ef15, 0xbf6c835e, 0x3dc8bd36, 0xbf7ec46d, 0xbe47c5c2, 0xbf7b14be, 0xbef15aea, 0xbf61c598
.long 0x3f800000, 0x00000000, 0x3f74fa0b, 0xbe94a031, 0x3f54db31, 0xbf0e39da, 0x3f226799, 0xbf45e403
.long 0x3ec3ef15, 0xbf6c835e, 0x3dc8bd36, 0xbf7ec46d, 0xbe47c5c2, 0xbf7b14be, 0xbef15aea, 0xbf61c598
.long 0x3f800000, 0x00000000, 0x3f74fa0b, 0xbe94a031, 0x3f54db31, 0xbf0e39da, 0x3f226799, 0xbf45e403
.long 0x3ec3ef15, 0xbf6c835e, 0x3dc8bd36, 0xbf7ec46d, 0xbe47c5c2, 0xbf7b14be, 0xbef15aea, 0xbf61c598
.long 0x3f800000, 0x00000000, 0x3f74fa0b, 0xbe94a031, 0x3f54db31, 0xbf0e39da, 0x3f226799, 0xbf45e403
.long 0x3ec3ef15, 0xbf6c835e, 0x3dc8bd36, 0xbf7ec46d, 0xbe47c5c2, 0xbf7b14be, 0xbef15aea, 0xbf61c598
.long 0x3f800000, 0x00000000, 0x3f74fa0b, 0xbe94a031, 0x3f54db31, 0xbf0e39da, 0x3f226799, 0xbf45e403
.long 0x3ec3ef15, 0xbf6c835e, 0x3dc8bd36, 0xbf7ec46d, 0xbe47c5c2, 0xbf7b14be, 0xbef15aea, 0xbf61c598
.long 0x3f800000, 0x00000000, 0x3f74fa0b, 0xbe94a031, 0x3f54db31, 0xbf0e39da, 0x3f226799, 0xbf45e403
.long 0x3ec3ef15, 0xbf6c835e, 0x3dc8bd36, 0xbf7ec46d, 0xbe47c5c2, 0xbf7b14be, 0xbef15aea, 0xbf61c598
.long 0x3f800000, 0x00000000, 0x3f74fa0b, 0xbe94a031, 0x3f54db31, 0xbf0e39da, 0x3f226799, 0xbf45e403
.long 0x3ec3ef15, 0xbf6c835e, 0x3dc8bd36, 0xbf7ec46d, 0xbe47c5c2, 0xbf7b14be, 0xbef15aea, 0xbf61c598
.long 0x3f800000, 0x00000000, 0x3f74fa0b, 0xbe94a031, 0x3f54db31, 0xbf0e39da, 0x3f226799, 0xbf45e403
.long 0x3ec3ef15, 0xbf6c835e, 0x3dc8bd36, 0xbf7ec46d, 0xbe47c5c2, 0xbf7b14be, 0xbef15aea, 0xbf61c598
.long 0x3f800000, 0x00000000, 0x3f74fa0b, 0xbe94a031, 0x3f54db31, 0xbf0e39da, 0x3f226799, 0xbf45e403
.long 0x3ec3ef15, 0xbf6c835e, 0x3dc8bd36, 0xbf7ec46d, 0xbe47c5c2, 0xbf7b14be, 0xbef15aea, 0xbf61c598
.long 0x3f800000, 0x00000000, 0x3f74fa0b, 0xbe94a031, 0x3f54db31, 0xbf0e39da, 0x3f226799, 0xbf45e403
.long 0x3ec3ef15, 0xbf6c835e, 0x3dc8bd36, 0xbf7ec46d, 0xbe47c5c2, 0xbf7b14be, 0xbef15aea, 0xbf61c598
.long 0x3f800000, 0x00000000, 0x3f74fa0b, 0xbe94a031, 0x3f54db31, 0xbf0e39da, 0x3f226799, 0xbf45e403
.long 0x3ec3ef15, 0xbf6c835e, 0x3dc8bd36, 0xbf7ec46d, 0xbe47c5c2, 0xbf7b14be, 0xbef15aea, 0xbf61c598
.long 0x3f800000, 0x00000000, 0x3f74fa0b, 0xbe94a031, 0x3f54db31, 0xbf0e39da, 0x3f226799, 0xbf45e403
.long 0x3ec3ef15, 0xbf6c835e, 0x3dc8bd36, 0xbf7ec46d, 0xbe47c5c2, 0xbf7b14be, 0xbef15aea, 0xbf61c598
.long 0x3f800000, 0x00000000, 0x3f74fa0b, 0xbe94a031, 0x3f54db31, 0xbf0e39da, 0x3f226799, 0xbf45e403
.long 0x3ec3ef15, 0xbf6c835e, 0x3dc8bd36, 0xbf7ec46d, 0xbe47c5c2, 0xbf7b14be, 0xbef15aea, 0xbf61c598
.long 0x3f800000, 0x00000000, 0x3f710908, 0xbeac7cd4, 0x3f45e403, 0xbf226799, 0x3f039c3d, 0xbf5b941a
.long 0x3e47c5c2, 0xbf7b14be, 0xbe164083, 0xbf7d3aac, 0xbef15aea, 0xbf61c598, 0xbf3daef9, 0xbf2beb4a
.long 0x3f800000, 0x00000000, 0x3f710908, 0xbeac7cd4, 0x3f45e403, 0xbf226799, 0x3f039c3d, 0xbf5b941a
.long 0x3e47c5c2, 0xbf7b14be, 0xbe164083, 0xbf7d3aac, 0xbef15aea, 0xbf61c598, 0xbf3daef9, 0xbf2beb4a
.long 0x3f800000, 0x00000000, 0x3f710908, 0xbeac7cd4, 0x3f45e403, 0xbf226799, 0x3f039c3d, 0xbf5b941a
.long 0x3e47c5c2, 0xbf7b14be, 0xbe164083, 0xbf7d3aac, 0xbef15aea, 0xbf61c598, 0xbf3daef9, 0xbf2beb4a
.long 0x3f800000, 0x00000000, 0x3f710908, 0xbeac7cd4, 0x3f45e403, 0xbf226799, 0x3f039c3d, 0xbf5b941a
.long 0x3e47c5c2, 0xbf7b14be, 0xbe164083, 0xbf7d3aac, 0xbef15aea, 0xbf61c598, 0xbf3daef9, 0xbf2beb4a
.long 0x3f800000, 0x00000000, 0x3f710908, 0xbeac7cd4, 0x3f45e403, 0xbf226799, 0x3f039c3d, 0xbf5b941a
.long 0x3e47c5c2, 0xbf7b14be, 0xbe164083, 0xbf7d3aac, 0xbef15aea, 0xbf61c598, 0xbf3daef9, 0xbf2beb4a
.long 0x3f800000, 0x00000000, 0x3f710908, 0xbeac7cd4, 0x3f45e403, 0xbf226799, 0x3f039c3d, 0xbf5b941a
.long 0x3e47c5c2, 0xbf7b14be, 0xbe164083, 0xbf7d3aac, 0xbef15aea, 0xbf61c598, 0xbf3daef9, 0xbf2beb4a
.long 0x3f800000, 0x00000000, 0x3f710908, 0xbeac7cd4, 0x3f45e403, 0xbf226799, 0x3f039c3d, 0xbf5b941a
.long 0x3e47c5c2, 0xbf7b14be, 0xbe164083, 0xbf7d3aac, 0xbef15aea, 0xbf61c598, 0xbf3daef9, 0xbf2beb4a
.long 0x3f800000, 0x00000000, 0x3f710908, 0xbeac7cd4, 0x3f45e403, 0xbf226799, 0x3f039c3d, 0xbf5b941a
.long 0x3e47c5c2, 0xbf7b14be, 0xbe164083, 0xbf7d3aac, 0xbef15aea, 0xbf61c598, 0xbf3daef9, 0xbf2beb4a
.long 0x3f800000, 0x00000000, 0x3f710908, 0xbeac7cd4, 0x3f45e403, 0xbf226799, 0x3f039c3d, 0xbf5b941a
.long 0x3e47c5c2, 0xbf7b14be, 0xbe164083, 0xbf7d3aac, 0xbef15aea, 0xbf61c598, 0xbf3daef9, 0xbf2beb4a
.long 0x3f800000, 0x00000000, 0x3f710908, 0xbeac7cd4, 0x3f45e403, 0xbf226799, 0x3f039c3d, 0xbf5b941a
.long 0x3e47c5c2, 0xbf7b14be, 0xbe164083, 0xbf7d3aac, 0xbef15aea, 0xbf61c598, 0xbf3daef9, 0xbf2beb4a
.long 0x3f800000, 0x00000000, 0x3f710908, 0xbeac7cd4, 0x3f45e403, 0xbf226799, 0x3f039c3d, 0xbf5b941a
.long 0x3e47c5c2, 0xbf7b14be, 0xbe164083, 0xbf7d3aac, 0xbef15aea, 0xbf61c598, 0xbf3daef9, 0xbf2beb4a
.long 0x3f800000, 0x00000000, 0x3f710908, 0xbeac7cd4, 0x3f45e403, 0xbf226799, 0x3f039c3d, 0xbf5b941a
.long 0x3e47c5c2, 0xbf7b14be, 0xbe164083, 0xbf7d3aac, 0xbef15aea, 0xbf61c598, 0xbf3daef9, 0xbf2beb4a
.long 0x3f800000, 0x00000000, 0x3f710908, 0xbeac7cd4, 0x3f45e403, 0xbf226799, 0x3f039c3d, 0xbf5b941a
.long 0x3e47c5c2, 0xbf7b14be, 0xbe164083, 0xbf7d3aac, 0xbef15aea, 0xbf61c598, 0xbf3daef9, 0xbf2beb4a
.long 0x3f800000, 0x00000000, 0x3f710908, 0xbeac7cd4, 0x3f45e403, 0xbf226799, 0x3f039c3d, 0xbf5b941a
.long 0x3e47c5c2, 0xbf7b14be, 0xbe164083, 0xbf7d3aac, 0xbef15aea, 0xbf61c598, 0xbf3daef9, 0xbf2beb4a
.long 0x3f800000, 0x00000000, 0x3f710908, 0xbeac7cd4, 0x3f45e403, 0xbf226799, 0x3f039c3d, 0xbf5b941a
.long 0x3e47c5c2, 0xbf7b14be, 0xbe164083, 0xbf7d3aac, 0xbef15aea, 0xbf61c598, 0xbf3daef9, 0xbf2beb4a
.long 0x3f800000, 0x00000000, 0x3f710908, 0xbeac7cd4, 0x3f45e403, 0xbf226799, 0x3f039c3d, 0xbf5b941a
.long 0x3e47c5c2, 0xbf7b14be, 0xbe164083, 0xbf7d3aac, 0xbef15aea, 0xbf61c598, 0xbf3daef9, 0xbf2beb4a
.long 0x3f800000, 0x00000000, 0x3f6c835e, 0xbec3ef15, 0x3f3504f3, 0xbf3504f3, 0x3ec3ef15, 0xbf6c835e
.long 0x248d3132, 0xbf800000, 0xbec3ef15, 0xbf6c835e, 0xbf3504f3, 0xbf3504f3, 0xbf6c835e, 0xbec3ef15
.long 0x3f800000, 0x00000000, 0x3f6c835e, 0xbec3ef15, 0x3f3504f3, 0xbf3504f3, 0x3ec3ef15, 0xbf6c835e
.long 0x248d3132, 0xbf800000, 0xbec3ef15, 0xbf6c835e, 0xbf3504f3, 0xbf3504f3, 0xbf6c835e, 0xbec3ef15
.long 0x3f800000, 0x00000000, 0x3f6c835e, 0xbec3ef15, 0x3f3504f3, 0xbf3504f3, 0x3ec3ef15, 0xbf6c835e
.long 0x248d3132, 0xbf800000, 0xbec3ef15, 0xbf6c835e, 0xbf3504f3, 0xbf3504f3, 0xbf6c835e, 0xbec3ef15
.long 0x3f800000, 0x00000000, 0x3f6c835e, 0xbec3ef15, 0x3f3504f3, 0xbf3504f3, 0x3ec3ef15, 0xbf6c835e
.long 0x248d3132, 0xbf800000, 0xbec3ef15, 0xbf6c835e, 0xbf3504f3, 0xbf3504f3, 0xbf6c835e, 0xbec3ef15
.long 0x3f800000, 0x00000000, 0x3f6c835e, 0xbec3ef15, 0x3f3504f3, 0xbf3504f3, 0x3ec3ef15, 0xbf6c835e
.long 0x248d3132, 0xbf800000, 0xbec3ef15, 0xbf6c835e, 0xbf3504f3, 0xbf3504f3, 0xbf6c835e, 0xbec3ef15
.long 0x3f800000, 0x00000000, 0x3f6c835e, 0xbec3ef15, 0x3f3504f3, 0xbf3504f3, 0x3ec3ef15, 0xbf6c835e
.long 0x248d3132, 0xbf800000, 0xbec3ef15, 0xbf6c835e, 0xbf3504f3, 0xbf3504f3, 0xbf6c835e, 0xbec3ef15
.long 0x3f800000, 0x00000000, 0x3f6c835e, 0xbec3ef15, 0x3f3504f3, 0xbf3504f3, 0x3ec3ef15, 0xbf6c835e
.long 0x248d3132, 0xbf800000, 0xbec3ef15, 0xbf6c835e, 0xbf3504f3, 0xbf3504f3, 0xbf6c835e, 0xbec3ef15
.long 0x3f800000, 0x00000000, 0x3f6c835e, 0xbec3ef15, 0x3f3504f3, 0xbf3504f3, 0x3ec3ef15, 0xbf6c835e
.long 0x248d3132, 0xbf800000, 0xbec3ef15, 0xbf6c835e, 0xbf3504f3, 0xbf3504f3, 0xbf6c835e, 0xbec3ef15
.long 0x3f800000, 0x00000000, 0x3f6c835e, 0xbec3ef15, 0x3f3504f3, 0xbf3504f3, 0x3ec3ef15, 0xbf6c835e
.long 0x248d3132, 0xbf800000, 0xbec3ef15, 0xbf6c835e, 0xbf3504f3, 0xbf3504f3, 0xbf6c835e, 0xbec3ef15
.long 0x3f800000, 0x00000000, 0x3f6c835e, 0xbec3ef15, 0x3f3504f3, 0xbf3504f3, 0x3ec3ef15, 0xbf6c835e
.long 0x248d3132, 0xbf800000, 0xbec3ef15, 0xbf6c835e, 0xbf3504f3, 0xbf3504f3, 0xbf6c835e, 0xbec3ef15
.long 0x3f800000, 0x00000000, 0x3f6c835e, 0xbec3ef15, 0x3f3504f3, 0xbf3504f3, 0x3ec3ef15, 0xbf6c835e
.long 0x248d3132, 0xbf800000, 0xbec3ef15, 0xbf6c835e, 0xbf3504f3, 0xbf3504f3, 0xbf6c835e, 0xbec3ef15
.long 0x3f800000, 0x00000000, 0x3f6c835e, 0xbec3ef15, 0x3f3504f3, 0xbf3504f3, 0x3ec3ef15, 0xbf6c835e
.long 0x248d3132, 0xbf800000, 0xbec3ef15, 0xbf6c835e, 0xbf3504f3, 0xbf3504f3, 0xbf6c835e, 0xbec3ef15
.long 0x3f800000, 0x00000000, 0x3f6c835e, 0xbec3ef15, 0x3f3504f3, 0xbf3504f3, 0x3ec3ef15, 0xbf6c835e
.long 0x248d3132, 0xbf800000, 0xbec3ef15, 0xbf6c835e, 0xbf3504f3, 0xbf3504f3, 0xbf6c835e, 0xbec3ef15
.long 0x3f800000, 0x00000000, 0x3f6c835e, 0xbec3ef15, 0x3f3504f3, 0xbf3504f3, 0x3ec3ef15, 0xbf6c835e
.long 0x248d3132, 0xbf800000, 0xbec3ef15, 0xbf6c835e, 0xbf3504f3, 0xbf3504f3, 0xbf6c835e, 0xbec3ef15
.long 0x3f800000, 0x00000000, 0x3f6c835e, 0xbec3ef15, 0x3f3504f3, 0xbf3504f3, 0x3ec3ef15, 0xbf6c835e
.long 0x248d3132, 0xbf800000, 0xbec3ef15, 0xbf6c835e, 0xbf3504f3, 0xbf3504f3, 0xbf6c835e, 0xbec3ef15
.long 0x3f800000, 0x00000000, 0x3f6c835e, 0xbec3ef15, 0x3f3504f3, 0xbf3504f3, 0x3ec3ef15, 0xbf6c835e
.long 0x248d3132, 0xbf800000, 0xbec3ef15, 0xbf6c835e, 0xbf3504f3, 0xbf3504f3, 0xbf6c835e, 0xbec3ef15
.long 0x3f800000, 0x00000000, 0x3f676bd8, 0xbedae880, 0x3f226799, 0xbf45e403, 0x3e78cfcc, 0xbf7853f8
.long 0xbe47c5c2, 0xbf7b14be, 0xbf187fc0, 0xbf4d9f02, 0xbf61c598, 0xbef15aea, 0xbf7fb10f, 0xbd48fb30
.long 0x3f800000, 0x00000000, 0x3f676bd8, 0xbedae880, 0x3f226799, 0xbf45e403, 0x3e78cfcc, 0xbf7853f8
.long 0xbe47c5c2, 0xbf7b14be, 0xbf187fc0, 0xbf4d9f02, 0xbf61c598, 0xbef15aea, 0xbf7fb10f, 0xbd48fb30
.long 0x3f800000, 0x00000000, 0x3f676bd8, 0xbedae880, 0x3f226799, 0xbf45e403, 0x3e78cfcc, 0xbf7853f8
.long 0xbe47c5c2, 0xbf7b14be, 0xbf187fc0, 0xbf4d9f02, 0xbf61c598, 0xbef15aea, 0xbf7fb10f, 0xbd48fb30
.long 0x3f800000, 0x00000000, 0x3f676bd8, 0xbedae880, 0x3f226799, 0xbf45e403, 0x3e78cfcc, 0xbf7853f8
.long 0xbe47c5c2, 0xbf7b14be, 0xbf187fc0, 0xbf4d9f02, 0xbf61c598, 0xbef15aea, 0xbf7fb10f, 0xbd48fb30
.long 0x3f800000, 0x00000000, 0x3f676bd8, 0xbedae880, 0x3f226799, 0xbf45e403, 0x3e78cfcc, 0xbf7853f8
.long 0xbe47c5c2, 0xbf7b14be, 0xbf187fc0, 0xbf4d9f02, 0xbf61c598, 0xbef15aea, 0xbf7fb10f, 0xbd48fb30
.long 0x3f800000, 0x00000000, 0x3f676bd8, 0xbedae880, 0x3f226799, 0xbf45e403, 0x3e78cfcc, 0xbf7853f8
.long 0xbe47c5c2, 0xbf7b14be, 0xbf187fc0, 0xbf4d9f02, 0xbf61c598, 0xbef15aea, 0xbf7fb10f, 0xbd48fb30
.long 0x3f800000, 0x00000000, 0x3f676bd8, 0xbedae880, 0x3f226799, 0xbf45e403, 0x3e78cfcc, 0xbf7853f8
.long 0xbe47c5c2, 0xbf7b14be, 0xbf187fc0, 0xbf4d9f02, 0xbf61c598, 0xbef15aea, 0xbf7fb10f, 0xbd48fb30
.long 0x3f800000, 0x00000000, 0x3f676bd8, 0xbedae880, 0x3f226799, 0xbf45e403, 0x3e78cfcc, 0xbf7853f8
.long 0xbe47c5c2, 0xbf7b14be, 0xbf187fc0, 0xbf4d9f02, 0xbf61c598, 0xbef15aea, 0xbf7fb10f, 0xbd48fb30
.long 0x3f800000, 0x00000000, 0x3f676bd8, 0xbedae880, 0x3f226799, 0xbf45e403, 0x3e78cfcc, 0xbf7853f8
.long 0xbe47c5c2, 0xbf7b14be, 0xbf187fc0, 0xbf4d9f02, 0xbf61c598, 0xbef15aea, 0xbf7fb10f, 0xbd48fb30
.long 0x3f800000, 0x00000000, 0x3f676bd8, 0xbedae880, 0x3f226799, 0xbf45e403, 0x3e78cfcc, 0xbf7853f8
.long 0xbe47c5c2, 0xbf7b14be, 0xbf187fc0, 0xbf4d9f02, 0xbf61c598, 0xbef15aea, 0xbf7fb10f, 0xbd48fb30
.long 0x3f800000, 0x00000000, 0x3f676bd8, 0xbedae880, 0x3f226799, 0xbf45e403, 0x3e78cfcc, 0xbf7853f8
.long 0xbe47c5c2, 0xbf7b14be, 0xbf187fc0, 0xbf4d9f02, 0xbf61c598, 0xbef15aea, 0xbf7fb10f, 0xbd48fb30
.long 0x3f800000, 0x00000000, 0x3f676bd8, 0xbedae880, 0x3f226799, 0xbf45e403, 0x3e78cfcc, 0xbf7853f8
.long 0xbe47c5c2, 0xbf7b14be, 0xbf187fc0, 0xbf4d9f02, 0xbf61c598, 0xbef15aea, 0xbf7fb10f, 0xbd48fb30
.long 0x3f800000, 0x00000000, 0x3f676bd8, 0xbedae880, 0x3f226799, 0xbf45e403, 0x3e78cfcc, 0xbf7853f8
.long 0xbe47c5c2, 0xbf7b14be, 0xbf187fc0, 0xbf4d9f02, 0xbf61c598, 0xbef15aea, 0xbf7fb10f, 0xbd48fb30
.long 0x3f800000, 0x00000000, 0x3f676bd8, 0xbedae880, 0x3f226799, 0xbf45e403, 0x3e78cfcc, 0xbf7853f8
.long 0xbe47c5c2, 0xbf7b14be, 0xbf187fc0, 0xbf4d9f02, 0xbf61c598, 0xbef15aea, 0xbf7fb10f, 0xbd48fb30
.long 0x3f800000, 0x00000000, 0x3f676bd8, 0xbedae880, 0x3f226799, 0xbf45e403, 0x3e78cfcc, 0xbf7853f8
.long 0xbe47c5c2, 0xbf7b14be, 0xbf187fc0, 0xbf4d9f02, 0xbf61c598, 0xbef15aea, 0xbf7fb10f, 0xbd48fb30
.long 0x3f800000, 0x00000000, 0x3f676bd8, 0xbedae880, 0x3f226799, 0xbf45e403, 0x3e78cfcc, 0xbf7853f8
.long 0xbe47c5c2, 0xbf7b14be, 0xbf187fc0, 0xbf4d9f02, 0xbf61c598, 0xbef15aea, 0xbf7fb10f, 0xbd48fb30
.long 0x3f800000, 0x00000000, 0x3f61c598, 0xbef15aea, 0x3f0e39da, 0xbf54db31, 0x3dc8bd36, 0xbf7ec46d
.long 0xbec3ef15, 0xbf6c835e, 0xbf45e403, 0xbf226799, 0xbf7b14be, 0xbe47c5c2, 0xbf74fa0b, 0x3e94a031
.long 0x3f800000, 0x00000000, 0x3f61c598, 0xbef15aea, 0x3f0e39da, 0xbf54db31, 0x3dc8bd36, 0xbf7ec46d
.long 0xbec3ef15, 0xbf6c835e, 0xbf45e403, 0xbf226799, 0xbf7b14be, 0xbe47c5c2, 0xbf74fa0b, 0x3e94a031
.long 0x3f800000, 0x00000000, 0x3f61c598, 0xbef15aea, 0x3f0e39da, 0xbf54db31, 0x3dc8bd36, 0xbf7ec46d
.long 0xbec3ef15, 0xbf6c835e, 0xbf45e403, 0xbf226799, 0xbf7b14be, 0xbe47c5c2, 0xbf74fa0b, 0x3e94a031
.long 0x3f800000, 0x00000000, 0x3f61c598, 0xbef15aea, 0x3f0e39da, 0xbf54db31, 0x3dc8bd36, 0xbf7ec46d
.long 0xbec3ef15, 0xbf6c835e, 0xbf45e403, 0xbf226799, 0xbf7b14be, 0xbe47c5c2, 0xbf74fa0b, 0x3e94a031
.long 0x3f800000, 0x00000000, 0x3f61c598, 0xbef15aea, 0x3f0e39da, 0xbf54db31, 0x3dc8bd36, 0xbf7ec46d
.long 0xbec3ef15, 0xbf6c835e, 0xbf45e403, 0xbf226799, 0xbf7b14be, 0xbe47c5c2, 0xbf74fa0b, 0x3e94a031
.long 0x3f800000, 0x00000000, 0x3f61c598, 0xbef15aea, 0x3f0e39da, 0xbf54db31, 0x3dc8bd36, 0xbf7ec46d
.long 0xbec3ef15, 0xbf6c835e, 0xbf45e403, 0xbf226799, 0xbf7b14be, 0xbe47c5c2, 0xbf74fa0b, 0x3e94a031
.long 0x3f800000, 0x00000000, 0x3f61c598, 0xbef15aea, 0x3f0e39da, 0xbf54db31, 0x3dc8bd36, 0xbf7ec46d
.long 0xbec3ef15, 0xbf6c835e, 0xbf45e403, 0xbf226799, 0xbf7b14be, 0xbe47c5c2, 0xbf74fa0b, 0x3e94a031
.long 0x3f800000, 0x00000000, 0x3f61c598, 0xbef15aea, 0x3f0e39da, 0xbf54db31, 0x3dc8bd36, 0xbf7ec46d
.long 0xbec3ef15, 0xbf6c835e, 0xbf45e403, 0xbf226799, 0xbf7b14be, 0xbe47c5c2, 0xbf74fa0b, 0x3e94a031
.long 0x3f800000, 0x00000000, 0x3f61c598, 0xbef15aea, 0x3f0e39da, 0xbf54db31, 0x3dc8bd36, 0xbf7ec46d
.long 0xbec3ef15, 0xbf6c835e, 0xbf45e403, 0xbf226799, 0xbf7b14be, 0xbe47c5c2, 0xbf74fa0b, 0x3e94a031
.long 0x3f800000, 0x00000000, 0x3f61c598, 0xbef15aea, 0x3f0e39da, 0xbf54db31, 0x3dc8bd36, 0xbf7ec46d
.long 0xbec3ef15, 0xbf6c835e, 0xbf45e403, 0xbf226799, 0xbf7b14be, 0xbe47c5c2, 0xbf74fa0b, 0x3e94a031
.long 0x3f800000, 0x00000000, 0x3f61c598, 0xbef15aea, 0x3f0e39da, 0xbf54db31, 0x3dc8bd36, 0xbf7ec46d
.long 0xbec3ef15, 0xbf6c835e, 0xbf45e403, 0xbf226799, 0xbf7b14be, 0xbe47c5c2, 0xbf74fa0b, 0x3e94a031
.long 0x3f800000, 0x00000000, 0x3f61c598, 0xbef15aea, 0x3f0e39da, 0xbf54db31, 0x3dc8bd36, 0xbf7ec46d
.long 0xbec3ef15, 0xbf6c835e, 0xbf45e403, 0xbf226799, 0xbf7b14be, 0xbe47c5c2, 0xbf74fa0b, 0x3e94a031
.long 0x3f800000, 0x00000000, 0x3f61c598, 0xbef15aea, 0x3f0e39da, 0xbf54db31, 0x3dc8bd36, 0xbf7ec46d
.long 0xbec3ef15, 0xbf6c835e, 0xbf45e403, 0xbf226799, 0xbf7b14be, 0xbe47c5c2, 0xbf74fa0b, 0x3e94a031
.long 0x3f800000, 0x00000000, 0x3f61c598, 0xbef15aea, 0x3f0e39da, 0xbf54db31, 0x3dc8bd36, 0xbf7ec46d
.long 0xbec3ef15, 0xbf6c835e, 0xbf45e403, 0xbf226799, 0xbf7b14be, 0xbe47c5c2, 0xbf74fa0b, 0x3e94a031
.long 0x3f800000, 0x00000000, 0x3f61c598, 0xbef15aea, 0x3f0e39da, 0xbf54db31, 0x3dc8bd36, 0xbf7ec46d
.long 0xbec3ef15, 0xbf6c835e, 0xbf45e403, 0xbf226799, 0xbf7b14be, 0xbe47c5c2, 0xbf74fa0b, 0x3e94a031
.long 0x3f800000, 0x00000000, 0x3f61c598, 0xbef15aea, 0x3f0e39da, 0xbf54db31, 0x3dc8bd36, 0xbf7ec46d
.long 0xbec3ef15, 0xbf6c835e, 0xbf45e403, 0xbf226799, 0xbf7b14be, 0xbe47c5c2, 0xbf74fa0b, 0x3e94a031
.long 0x3f800000, 0x00000000, 0x3f5b941a, 0xbf039c3d, 0x3ef15aea, 0xbf61c598, 0xbd48fb30, 0xbf7fb10f
.long 0xbf0e39da, 0xbf54db31, 0xbf676bd8, 0xbedae880, 0xbf7ec46d, 0x3dc8bd36, 0xbf4d9f02, 0x3f187fc0
.long 0x3f800000, 0x00000000, 0x3f5b941a, 0xbf039c3d, 0x3ef15aea, 0xbf61c598, 0xbd48fb30, 0xbf7fb10f
.long 0xbf0e39da, 0xbf54db31, 0xbf676bd8, 0xbedae880, 0xbf7ec46d, 0x3dc8bd36, 0xbf4d9f02, 0x3f187fc0
.long 0x3f800000, 0x00000000, 0x3f5b941a, 0xbf039c3d, 0x3ef15aea, 0xbf61c598, 0xbd48fb30, 0xbf7fb10f
.long 0xbf0e39da, 0xbf54db31, 0xbf676bd8, 0xbedae880, 0xbf7ec46d, 0x3dc8bd36, 0xbf4d9f02, 0x3f187fc0
.long 0x3f800000, 0x00000000, 0x3f5b941a, 0xbf039c3d, 0x3ef15aea, 0xbf61c598, 0xbd48fb30, 0xbf7fb10f
.long 0xbf0e39da, 0xbf54db31, 0xbf676bd8, 0xbedae880, 0xbf7ec46d, 0x3dc8bd36, 0xbf4d9f02, 0x3f187fc0
.long 0x3f800000, 0x00000000, 0x3f5b941a, 0xbf039c3d, 0x3ef15aea, 0xbf61c598, 0xbd48fb30, 0xbf7fb10f
.long 0xbf0e39da, 0xbf54db31, 0xbf676bd8, 0xbedae880, 0xbf7ec46d, 0x3dc8bd36, 0xbf4d9f02, 0x3f187fc0
.long 0x3f800000, 0x00000000, 0x3f5b941a, 0xbf039c3d, 0x3ef15aea, 0xbf61c598, 0xbd48fb30, 0xbf7fb10f
.long 0xbf0e39da, 0xbf54db31, 0xbf676bd8, 0xbedae880, 0xbf7ec46d, 0x3dc8bd36, 0xbf4d9f02, 0x3f187fc0
.long 0x3f800000, 0x00000000, 0x3f5b941a, 0xbf039c3d, 0x3ef15aea, 0xbf61c598, 0xbd48fb30, 0xbf7fb10f
.long 0xbf0e39da, 0xbf54db31, 0xbf676bd8, 0xbedae880, 0xbf7ec46d, 0x3dc8bd36, 0xbf4d9f02, 0x3f187fc0
.long 0x3f800000, 0x00000000, 0x3f5b941a, 0xbf039c3d, 0x3ef15aea, 0xbf61c598, 0xbd48fb30, 0xbf7fb10f
.long 0xbf0e39da, 0xbf54db31, 0xbf676bd8, 0xbedae880, 0xbf7ec46d, 0x3dc8bd36, 0xbf4d9f02, 0x3f187fc0
.long 0x3f800000, 0x00000000, 0x3f5b941a, 0xbf039c3d, 0x3ef15aea, 0xbf61c598, 0xbd48fb30, 0xbf7fb10f
.long 0xbf0e39da, 0xbf54db31, 0xbf676bd8, 0xbedae880, 0xbf7ec46d, 0x3dc8bd36, 0xbf4d9f02, 0x3f187fc0
.long 0x3f800000, 0x00000000, 0x3f5b941a, 0xbf039c3d, 0x3ef15aea, 0xbf61c598, 0xbd48fb30, 0xbf7fb10f
.long 0xbf0e39da, 0xbf54db31, 0xbf676bd8, 0xbedae880, 0xbf7ec46d, 0x3dc8bd36, 0xbf4d9f02, 0x3f187fc0
.long 0x3f800000, 0x00000000, 0x3f5b941a, 0xbf039c3d, 0x3ef15aea, 0xbf61c598, 0xbd48fb30, 0xbf7fb10f
.long 0xbf0e39da, 0xbf54db31, 0xbf676bd8, 0xbedae880, 0xbf7ec46d, 0x3dc8bd36, 0xbf4d9f02, 0x3f187fc0
.long 0x3f800000, 0x00000000, 0x3f5b941a, 0xbf039c3d, 0x3ef15aea, 0xbf61c598, 0xbd48fb30, 0xbf7fb10f
.long 0xbf0e39da, 0xbf54db31, 0xbf676bd8, 0xbedae880, 0xbf7ec46d, 0x3dc8bd36, 0xbf4d9f02, 0x3f187fc0
.long 0x3f800000, 0x00000000, 0x3f5b941a, 0xbf039c3d, 0x3ef15aea, 0xbf61c598, 0xbd48fb30, 0xbf7fb10f
.long 0xbf0e39da, 0xbf54db31, 0xbf676bd8, 0xbedae880, 0xbf7ec46d, 0x3dc8bd36, 0xbf4d9f02, 0x3f187fc0
.long 0x3f800000, 0x00000000, 0x3f5b941a, 0xbf039c3d, 0x3ef15aea, 0xbf61c598, 0xbd48fb30, 0xbf7fb10f
.long 0xbf0e39da, 0xbf54db31, 0xbf676bd8, 0xbedae880, 0xbf7ec46d, 0x3dc8bd36, 0xbf4d9f02, 0x3f187fc0
.long 0x3f800000, 0x00000000, 0x3f5b941a, 0xbf039c3d, 0x3ef15aea, 0xbf61c598, 0xbd48fb30, 0xbf7fb10f
.long 0xbf0e39da, 0xbf54db31, 0xbf676bd8, 0xbedae880, 0xbf7ec46d, 0x3dc8bd36, 0xbf4d9f02, 0x3f187fc0
.long 0x3f800000, 0x00000000, 0x3f5b941a, 0xbf039c3d, 0x3ef15aea, 0xbf61c598, 0xbd48fb30, 0xbf7fb10f
.long 0xbf0e39da, 0xbf54db31, 0xbf676bd8, 0xbedae880, 0xbf7ec46d, 0x3dc8bd36, 0xbf4d9f02, 0x3f187fc0
.long 0x3f800000, 0x00000000, 0x3f54db31, 0xbf0e39da, 0x3ec3ef15, 0xbf6c835e, 0xbe47c5c2, 0xbf7b14be
.long 0xbf3504f3, 0xbf3504f3, 0xbf7b14be, 0xbe47c5c2, 0xbf6c835e, 0x3ec3ef15, 0xbf0e39da, 0x3f54db31
.long 0x3f800000, 0x00000000, 0x3f54db31, 0xbf0e39da, 0x3ec3ef15, 0xbf6c835e, 0xbe47c5c2, 0xbf7b14be
.long 0xbf3504f3, 0xbf3504f3, 0xbf7b14be, 0xbe47c5c2, 0xbf6c835e, 0x3ec3ef15, 0xbf0e39da, 0x3f54db31
.long 0x3f800000, 0x00000000, 0x3f54db31, 0xbf0e39da, 0x3ec3ef15, 0xbf6c835e, 0xbe47c5c2, 0xbf7b14be
.long 0xbf3504f3, 0xbf3504f3, 0xbf7b14be, 0xbe47c5c2, 0xbf6c835e, 0x3ec3ef15, 0xbf0e39da, 0x3f54db31
.long 0x3f800000, 0x00000000, 0x3f54db31, 0xbf0e39da, 0x3ec3ef15, 0xbf6c835e, 0xbe47c5c2, 0xbf7b14be
.long 0xbf3504f3, 0xbf3504f3, 0xbf7b14be, 0xbe47c5c2, 0xbf6c835e, 0x3ec3ef15, 0xbf0e39da, 0x3f54db31
.long 0x3f800000, 0x00000000, 0x3f54db31, 0xbf0e39da, 0x3ec3ef15, 0xbf6c835e, 0xbe47c5c2, 0xbf7b14be
.long 0xbf3504f3, 0xbf3504f3, 0xbf7b14be, 0xbe47c5c2, 0xbf6c835e, 0x3ec3ef15, 0xbf0e39da, 0x3f54db31
.long 0x3f800000, 0x00000000, 0x3f54db31, 0xbf0e39da, 0x3ec3ef15, 0xbf6c835e, 0xbe47c5c2, 0xbf7b14be
.long 0xbf3504f3, 0xbf3504f3, 0xbf7b14be, 0xbe47c5c2, 0xbf6c835e, 0x3ec3ef15, 0xbf0e39da, 0x3f54db31
.long 0x3f800000, 0x00000000, 0x3f54db31, 0xbf0e39da, 0x3ec3ef15, 0xbf6c835e, 0xbe47c5c2, 0xbf7b14be
.long 0xbf3504f3, 0xbf3504f3, 0xbf7b14be, 0xbe47c5c2, 0xbf6c835e, 0x3ec3ef15, 0xbf0e39da, 0x3f54db31
.long 0x3f800000, 0x00000000, 0x3f54db31, 0xbf0e39da, 0x3ec3ef15, 0xbf6c835e, 0xbe47c5c2, 0xbf7b14be
.long 0xbf3504f3, 0xbf3504f3, 0xbf7b14be, 0xbe47c5c2, 0xbf6c835e, 0x3ec3ef15, 0xbf0e39da, 0x3f54db31
.long 0x3f800000, 0x00000000, 0x3f54db31, 0xbf0e39da, 0x3ec3ef15, 0xbf6c835e, 0xbe47c5c2, 0xbf7b14be
.long 0xbf3504f3, 0xbf3504f3, 0xbf7b14be, 0xbe47c5c2, 0xbf6c835e, 0x3ec3ef15, 0xbf0e39da, 0x3f54db31
.long 0x3f800000, 0x00000000, 0x3f54db31, 0xbf0e39da, 0x3ec3ef15, 0xbf6c835e, 0xbe47c5c2, 0xbf7b14be
.long 0xbf3504f3, 0xbf3504f3, 0xbf7b14be, 0xbe47c5c2, 0xbf6c835e, 0x3ec3ef15, 0xbf0e39da, 0x3f54db31
.long 0x3f800000, 0x00000000, 0x3f54db31, 0xbf0e39da, 0x3ec3ef15, 0xbf6c835e, 0xbe47c5c2, 0xbf7b14be
.long 0xbf3504f3, 0xbf3504f3, 0xbf7b14be, 0xbe47c5c2, 0xbf6c835e, 0x3ec3ef15, 0xbf0e39da, 0x3f54db31
.long 0x3f800000, 0x00000000, 0x3f54db31, 0xbf0e39da, 0x3ec3ef15, 0xbf6c835e, 0xbe47c5c2, 0xbf7b14be
.long 0xbf3504f3, 0xbf3504f3, 0xbf7b14be, 0xbe47c5c2, 0xbf6c835e, 0x3ec3ef15, 0xbf0e39da, 0x3f54db31
.long 0x3f800000, 0x00000000, 0x3f54db31, 0xbf0e39da, 0x3ec3ef15, 0xbf6c835e, 0xbe47c5c2, 0xbf7b14be
.long 0xbf3504f3, 0xbf3504f3, 0xbf7b14be, 0xbe47c5c2, 0xbf6c835e, 0x3ec3ef15, 0xbf0e39da, 0x3f54db31
.long 0x3f800000, 0x00000000, 0x3f54db31, 0xbf0e39da, 0x3ec3ef15, 0xbf6c835e, 0xbe47c5c2, 0xbf7b14be
.long 0xbf3504f3, 0xbf3504f3, 0xbf7b14be, 0xbe47c5c2, 0xbf6c835e, 0x3ec3ef15, 0xbf0e39da, 0x3f54db31
.long 0x3f800000, 0x00000000, 0x3f54db31, 0xbf0e39da, 0x3ec3ef15, 0xbf6c835e, 0xbe47c5c2, 0xbf7b14be
.long 0xbf3504f3, 0xbf3504f3, 0xbf7b14be, 0xbe47c5c2, 0xbf6c835e, 0x3ec3ef15, 0xbf0e39da, 0x3f54db31
.long 0x3f800000, 0x00000000, 0x3f54db31, 0xbf0e39da, 0x3ec3ef15, 0xbf6c835e, 0xbe47c5c2, 0xbf7b14be
.long 0xbf3504f3, 0xbf3504f3, 0xbf7b14be, 0xbe47c5c2, 0xbf6c835e, 0x3ec3ef15, 0xbf0e39da, 0x3f54db31
.long 0x3f800000, 0x00000000, 0x3f4d9f02, 0xbf187fc0, 0x3e94a031, 0xbf74fa0b, 0xbeac7cd4, 0xbf710908
.long 0xbf54db31, 0xbf0e39da, 0xbf7fb10f, 0x3d48fb30, 0xbf45e403, 0x3f226799, 0xbe78cfcc, 0x3f7853f8
.long 0x3f800000, 0x00000000, 0x3f4d9f02, 0xbf187fc0, 0x3e94a031, 0xbf74fa0b, 0xbeac7cd4, 0xbf710908
.long 0xbf54db31, 0xbf0e39da, 0xbf7fb10f, 0x3d48fb30, 0xbf45e403, 0x3f226799, 0xbe78cfcc, 0x3f7853f8
.long 0x3f800000, 0x00000000, 0x3f4d9f02, 0xbf187fc0, 0x3e94a031, 0xbf74fa0b, 0xbeac7cd4, 0xbf710908
.long 0xbf54db31, 0xbf0e39da, 0xbf7fb10f, 0x3d48fb30, 0xbf45e403, 0x3f226799, 0xbe78cfcc, 0x3f7853f8
.long 0x3f800000, 0x00000000, 0x3f4d9f02, 0xbf187fc0, 0x3e94a031, 0xbf74fa0b, 0xbeac7cd4, 0xbf710908
.long 0xbf54db31, 0xbf0e39da, 0xbf7fb10f, 0x3d48fb30, 0xbf45e403, 0x3f226799, 0xbe78cfcc, 0x3f7853f8
.long 0x3f800000, 0x00000000, 0x3f4d9f02, 0xbf187fc0, 0x3e94a031, 0xbf74fa0b, 0xbeac7cd4, 0xbf710908
.long 0xbf54db31, 0xbf0e39da, 0xbf7fb10f, 0x3d48fb30, 0xbf45e403, 0x3f226799, 0xbe78cfcc, 0x3f7853f8
.long 0x3f800000, 0x00000000, 0x3f4d9f02, 0xbf187fc0, 0x3e94a031, 0xbf74fa0b, 0xbeac7cd4, 0xbf710908
.long 0xbf54db31, 0xbf0e39da, 0xbf7fb10f, 0x3d48fb30, 0xbf45e403, 0x3f226799, 0xbe78cfcc, 0x3f7853f8
.long 0x3f800000, 0x00000000, 0x3f4d9f02, 0xbf187fc0, 0x3e94a031, 0xbf74fa0b, 0xbeac7cd4, 0xbf710908
.long 0xbf54db31, 0xbf0e39da, 0xbf7fb10f, 0x3d48fb30, 0xbf45e403, 0x3f226799, 0xbe78cfcc, 0x3f7853f8
.long 0x3f800000, 0x00000000, 0x3f4d9f02, 0xbf187fc0, 0x3e94a031, 0xbf74fa0b, 0xbeac7cd4, 0xbf710908
.long 0xbf54db31, 0xbf0e39da, 0xbf7fb10f, 0x3d48fb30, 0xbf45e403, 0x3f226799, 0xbe78cfcc, 0x3f7853f8
.long 0x3f800000, 0x00000000, 0x3f4d9f02, 0xbf187fc0, 0x3e94a031, 0xbf74fa0b, 0xbeac7cd4, 0xbf710908
.long 0xbf54db31, 0xbf0e39da, 0xbf7fb10f, 0x3d48fb30, 0xbf45e403, 0x3f226799, 0xbe78cfcc, 0x3f7853f8
.long 0x3f800000, 0x00000000, 0x3f4d9f02, 0xbf187fc0, 0x3e94a031, 0xbf74fa0b, 0xbeac7cd4, 0xbf710908
.long 0xbf54db31, 0xbf0e39da, 0xbf7fb10f, 0x3d48fb30, 0xbf45e403, 0x3f226799, 0xbe78cfcc, 0x3f7853f8
.long 0x3f800000, 0x00000000, 0x3f4d9f02, 0xbf187fc0, 0x3e94a031, 0xbf74fa0b, 0xbeac7cd4, 0xbf710908
.long 0xbf54db31, 0xbf0e39da, 0xbf7fb10f, 0x3d48fb30, 0xbf45e403, 0x3f226799, 0xbe78cfcc, 0x3f7853f8
.long 0x3f800000, 0x00000000, 0x3f4d9f02, 0xbf187fc0, 0x3e94a031, 0xbf74fa0b, 0xbeac7cd4, 0xbf710908
.long 0xbf54db31, 0xbf0e39da, 0xbf7fb10f, 0x3d48fb30, 0xbf45e403, 0x3f226799, 0xbe78cfcc, 0x3f7853f8
.long 0x3f800000, 0x00000000, 0x3f4d9f02, 0xbf187fc0, 0x3e94a031, 0xbf74fa0b, 0xbeac7cd4, 0xbf710908
.long 0xbf54db31, 0xbf0e39da, 0xbf7fb10f, 0x3d48fb30, 0xbf45e403, 0x3f226799, 0xbe78cfcc, 0x3f7853f8
.long 0x3f800000, 0x00000000, 0x3f4d9f02, 0xbf187fc0, 0x3e94a031, 0xbf74fa0b, 0xbeac7cd4, 0xbf710908
.long 0xbf54db31, 0xbf0e39da, 0xbf7fb10f, 0x3d48fb30, 0xbf45e403, 0x3f226799, 0xbe78cfcc, 0x3f7853f8
.long 0x3f800000, 0x00000000, 0x3f4d9f02, 0xbf187fc0, 0x3e94a031, 0xbf74fa0b, 0xbeac7cd4, 0xbf710908
.long 0xbf54db31, 0xbf0e39da, 0xbf7fb10f, 0x3d48fb30, 0xbf45e403, 0x3f226799, 0xbe78cfcc, 0x3f7853f8
.long 0x3f800000, 0x00000000, 0x3f4d9f02, 0xbf187fc0, 0x3e94a031, 0xbf74fa0b, 0xbeac7cd4, 0xbf710908
.long 0xbf54db31, 0xbf0e39da, 0xbf7fb10f, 0x3d48fb30, 0xbf45e403, 0x3f226799, 0xbe78cfcc, 0x3f7853f8
.long 0x3f800000, 0x00000000, 0x3f45e403, 0xbf226799, 0x3e47c5c2, 0xbf7b14be, 0xbef15aea, 0xbf61c598
.long 0xbf6c835e, 0xbec3ef15, 0xbf74fa0b, 0x3e94a031, 0xbf0e39da, 0x3f54db31, 0x3dc8bd36, 0x3f7ec46d
.long 0x3f800000, 0x00000000, 0x3f45e403, 0xbf226799, 0x3e47c5c2, 0xbf7b14be, 0xbef15aea, 0xbf61c598
.long 0xbf6c835e, 0xbec3ef15, 0xbf74fa0b, 0x3e94a031, 0xbf0e39da, 0x3f54db31, 0x3dc8bd36, 0x3f7ec46d
.long 0x3f800000, 0x00000000, 0x3f45e403, 0xbf226799, 0x3e47c5c2, 0xbf7b14be, 0xbef15aea, 0xbf61c598
.long 0xbf6c835e, 0xbec3ef15, 0xbf74fa0b, 0x3e94a031, 0xbf0e39da, 0x3f54db31, 0x3dc8bd36, 0x3f7ec46d
.long 0x3f800000, 0x00000000, 0x3f45e403, 0xbf226799, 0x3e47c5c2, 0xbf7b14be, 0xbef15aea, 0xbf61c598
.long 0xbf6c835e, 0xbec3ef15, 0xbf74fa0b, 0x3e94a031, 0xbf0e39da, 0x3f54db31, 0x3dc8bd36, 0x3f7ec46d
.long 0x3f800000, 0x00000000, 0x3f45e403, 0xbf226799, 0x3e47c5c2, 0xbf7b14be, 0xbef15aea, 0xbf61c598
.long 0xbf6c835e, 0xbec3ef15, 0xbf74fa0b, 0x3e94a031, 0xbf0e39da, 0x3f54db31, 0x3dc8bd36, 0x3f7ec46d
.long 0x3f800000, 0x00000000, 0x3f45e403, 0xbf226799, 0x3e47c5c2, 0xbf7b14be, 0xbef15aea, 0xbf61c598
.long 0xbf6c835e, 0xbec3ef15, 0xbf74fa0b, 0x3e94a031, 0xbf0e39da, 0x3f54db31, 0x3dc8bd36, 0x3f7ec46d
.long 0x3f800000, 0x00000000, 0x3f45e403, 0xbf226799, 0x3e47c5c2, 0xbf7b14be, 0xbef15aea, 0xbf61c598
.long 0xbf6c835e, 0xbec3ef15, 0xbf74fa0b, 0x3e94a031, 0xbf0e39da, 0x3f54db31, 0x3dc8bd36, 0x3f7ec46d
.long 0x3f800000, 0x00000000, 0x3f45e403, 0xbf226799, 0x3e47c5c2, 0xbf7b14be, 0xbef15aea, 0xbf61c598
.long 0xbf6c835e, 0xbec3ef15, 0xbf74fa0b, 0x3e94a031, 0xbf0e39da, 0x3f54db31, 0x3dc8bd36, 0x3f7ec46d
.long 0x3f800000, 0x00000000, 0x3f45e403, 0xbf226799, 0x3e47c5c2, 0xbf7b14be, 0xbef15aea, 0xbf61c598
.long 0xbf6c835e, 0xbec3ef15, 0xbf74fa0b, 0x3e94a031, 0xbf0e39da, 0x3f54db31, 0x3dc8bd36, 0x3f7ec46d
.long 0x3f800000, 0x00000000, 0x3f45e403, 0xbf226799, 0x3e47c5c2, 0xbf7b14be, 0xbef15aea, 0xbf61c598
.long 0xbf6c835e, 0xbec3ef15, 0xbf74fa0b, 0x3e94a031, 0xbf0e39da, 0x3f54db31, 0x3dc8bd36, 0x3f7ec46d
.long 0x3f800000, 0x00000000, 0x3f45e403, 0xbf226799, 0x3e47c5c2, 0xbf7b14be, 0xbef15aea, 0xbf61c598
.long 0xbf6c835e, 0xbec3ef15, 0xbf74fa0b, 0x3e94a031, 0xbf0e39da, 0x3f54db31, 0x3dc8bd36, 0x3f7ec46d
.long 0x3f800000, 0x00000000, 0x3f45e403, 0xbf226799, 0x3e47c5c2, 0xbf7b14be, 0xbef15aea, 0xbf61c598
.long 0xbf6c835e, 0xbec3ef15, 0xbf74fa0b, 0x3e94a031, 0xbf0e39da, 0x3f54db31, 0x3dc8bd36, 0x3f7ec46d
.long 0x3f800000, 0x00000000, 0x3f45e403, 0xbf226799, 0x3e47c5c2, 0xbf7b14be, 0xbef15aea, 0xbf61c598
.long 0xbf6c835e, 0xbec3ef15, 0xbf74fa0b, 0x3e94a031, 0xbf0e39da, 0x3f54db31, 0x3dc8bd36, 0x3f7ec46d
.long 0x3f800000, 0x00000000, 0x3f45e403, 0xbf226799, 0x3e47c5c2, 0xbf7b14be, 0xbef15aea, 0xbf61c598
.long 0xbf6c835e, 0xbec3ef15, 0xbf74fa0b, 0x3e94a031, 0xbf0e39da, 0x3f54db31, 0x3dc8bd36, 0x3f7ec46d
.long 0x3f800000, 0x00000000, 0x3f45e403, 0xbf226799, 0x3e47c5c2, 0xbf7b14be, 0xbef15aea, 0xbf61c598
.long 0xbf6c835e, 0xbec3ef15, 0xbf74fa0b, 0x3e94a031, 0xbf0e39da, 0x3f54db31, 0x3dc8bd36, 0x3f7ec46d
.long 0x3f800000, 0x00000000, 0x3f45e403, 0xbf226799, 0x3e47c5c2, 0xbf7b14be, 0xbef15aea, 0xbf61c598
.long 0xbf6c835e, 0xbec3ef15, 0xbf74fa0b, 0x3e94a031, 0xbf0e39da, 0x3f54db31, 0x3dc8bd36, 0x3f7ec46d
.long 0x3f800000, 0x00000000, 0x3f3daef9, 0xbf2beb4a, 0x3dc8bd36, 0xbf7ec46d, 0xbf187fc0, 0xbf4d9f02
.long 0xbf7b14be, 0xbe47c5c2, 0xbf5b941a, 0x3f039c3d, 0xbe94a031, 0x3f74fa0b, 0x3edae880, 0x3f676bd8
.long 0x3f800000, 0x00000000, 0x3f3daef9, 0xbf2beb4a, 0x3dc8bd36, 0xbf7ec46d, 0xbf187fc0, 0xbf4d9f02
.long 0xbf7b14be, 0xbe47c5c2, 0xbf5b941a, 0x3f039c3d, 0xbe94a031, 0x3f74fa0b, 0x3edae880, 0x3f676bd8
.long 0x3f800000, 0x00000000, 0x3f3daef9, 0xbf2beb4a, 0x3dc8bd36, 0xbf7ec46d, 0xbf187fc0, 0xbf4d9f02
.long 0xbf7b14be, 0xbe47c5c2, 0xbf5b941a, 0x3f039c3d, 0xbe94a031, 0x3f74fa0b, 0x3edae880, 0x3f676bd8
.long 0x3f800000, 0x00000000, 0x3f3daef9, 0xbf2beb4a, 0x3dc8bd36, 0xbf7ec46d, 0xbf187fc0, 0xbf4d9f02
.long 0xbf7b14be, 0xbe47c5c2, 0xbf5b941a, 0x3f039c3d, 0xbe94a031, 0x3f74fa0b, 0x3edae880, 0x3f676bd8
.long 0x3f800000, 0x00000000, 0x3f3daef9, 0xbf2beb4a, 0x3dc8bd36, 0xbf7ec46d, 0xbf187fc0, 0xbf4d9f02
.long 0xbf7b14be, 0xbe47c5c2, 0xbf5b941a, 0x3f039c3d, 0xbe94a031, 0x3f74fa0b, 0x3edae880, 0x3f676bd8
.long 0x3f800000, 0x00000000, 0x3f3daef9, 0xbf2beb4a, 0x3dc8bd36, 0xbf7ec46d, 0xbf187fc0, 0xbf4d9f02
.long 0xbf7b14be, 0xbe47c5c2, 0xbf5b941a, 0x3f039c3d, 0xbe94a031, 0x3f74fa0b, 0x3edae880, 0x3f676bd8
.long 0x3f800000, 0x00000000, 0x3f3daef9, 0xbf2beb4a, 0x3dc8bd36, 0xbf7ec46d, 0xbf187fc0, 0xbf4d9f02
.long 0xbf7b14be, 0xbe47c5c2, 0xbf5b941a, 0x3f039c3d, 0xbe94a031, 0x3f74fa0b, 0x3edae880, 0x3f676bd8
.long 0x3f800000, 0x00000000, 0x3f3daef9, 0xbf2beb4a, 0x3dc8bd36, 0xbf7ec46d, 0xbf187fc0, 0xbf4d9f02
.long 0xbf7b14be, 0xbe47c5c2, 0xbf5b941a, 0x3f039c3d, 0xbe94a031, 0x3f74fa0b, 0x3edae880, 0x3f676bd8
.long 0x3f800000, 0x00000000, 0x3f3daef9, 0xbf2beb4a, 0x3dc8bd36, 0xbf7ec46d, 0xbf187fc0, 0xbf4d9f02
.long 0xbf7b14be, 0xbe47c5c2, 0xbf5b941a, 0x3f039c3d, 0xbe94a031, 0x3f74fa0b, 0x3edae880, 0x3f676bd8
.long 0x3f800000, 0x00000000, 0x3f3daef9, 0xbf2beb4a, 0x3dc8bd36, 0xbf7ec46d, 0xbf187fc0, 0xbf4d9f02
.long 0xbf7b14be, 0xbe47c5c2, 0xbf5b941a, 0x3f039c3d, 0xbe94a031, 0x3f74fa0b, 0x3edae880, 0x3f676bd8
.long 0x3f800000, 0x00000000, 0x3f3daef9, 0xbf2beb4a, 0x3dc8bd36, 0xbf7ec46d, 0xbf187fc0, 0xbf4d9f02
.long 0xbf7b14be, 0xbe47c5c2, 0xbf5b941a, 0x3f039c3d, 0xbe94a031, 0x3f74fa0b, 0x3edae880, 0x3f676bd8
.long 0x3f800000, 0x00000000, 0x3f3daef9, 0xbf2beb4a, 0x3dc8bd36, 0xbf7ec46d, 0xbf187fc0, 0xbf4d9f02
.long 0xbf7b14be, 0xbe47c5c2, 0xbf5b941a, 0x3f039c3d, 0xbe94a031, 0x3f74fa0b, 0x3edae880, 0x3f676bd8
.long 0x3f800000, 0x00000000, 0x3f3daef9, 0xbf2beb4a, 0x3dc8bd36, 0xbf7ec46d, 0xbf187fc0, 0xbf4d9f02
.long 0xbf7b14be, 0xbe47c5c2, 0xbf5b941a, 0x3f039c3d, 0xbe94a031, 0x3f74fa0b, 0x3edae880, 0x3f676bd8
.long 0x3f800000, 0x00000000, 0x3f3daef9, 0xbf2beb4a, 0x3dc8bd36, 0xbf7ec46d, 0xbf187fc0, 0xbf4d9f02
.long 0xbf7b14be, 0xbe47c5c2, 0xbf5b941a, 0x3f039c3d, 0xbe94a031, 0x3f74fa0b, 0x3edae880, 0x3f676bd8
.long 0x3f800000, 0x00000000, 0x3f3daef9, 0xbf2beb4a, 0x3dc8bd36, 0xbf7ec46d, 0xbf187fc0, 0xbf4d9f02
.long 0xbf7b14be, 0xbe47c5c2, 0xbf5b941a, 0x3f039c3d, 0xbe94a031, 0x3f74fa0b, 0x3edae880, 0x3f676bd8
.long 0x3f800000, 0x00000000, 0x3f3daef9, 0xbf2beb4a, 0x3dc8bd36, 0xbf7ec46d, 0xbf187fc0, 0xbf4d9f02
.long 0xbf7b14be, 0xbe47c5c2, 0xbf5b941a, 0x3f039c3d, 0xbe94a031, 0x3f74fa0b, 0x3edae880, 0x3f676bd8
T2048_tw2B:
.long 0x3f800000, 0x00000000, 0x3f800000, 0x00000000, 0x3f800000, 0x00000000, 0x3f800000, 0x00000000
.long 0x3f800000, 0x00000000, 0x3f800000, 0x00000000, 0x3f800000, 0x00000000, 0x3f800000, 0x00000000
.long 0x3f800000, 0x00000000, 0x3f800000, 0x00000000, 0x3f800000, 0x00000000, 0x3f800000, 0x00000000
.long 0x3f800000, 0x00000000, 0x3f800000, 0x00000000, 0x3f800000, 0x00000000, 0x3f800000, 0x00000000
.long 0x3f800000, 0x00000000, 0x3f800000, 0x00000000, 0x3f800000, 0x00000000, 0x3f800000, 0x00000000
.long 0x3f800000, 0x00000000, 0x3f800000, 0x00000000, 0x3f800000, 0x00000000, 0x3f800000, 0x00000000
.long 0x3f800000, 0x00000000, 0x3f800000, 0x00000000, 0x3f800000, 0x00000000, 0x3f800000, 0x00000000
.long 0x3f800000, 0x00000000, 0x3f800000, 0x00000000, 0x3f800000, 0x00000000, 0x3f800000, 0x00000000
.long 0x3f800000, 0x00000000, 0x3f800000, 0x00000000, 0x3f800000, 0x00000000, 0x3f800000, 0x00000000
.long 0x3f800000, 0x00000000, 0x3f800000, 0x00000000, 0x3f800000, 0x00000000, 0x3f800000, 0x00000000
.long 0x3f800000, 0x00000000, 0x3f800000, 0x00000000, 0x3f800000, 0x00000000, 0x3f800000, 0x00000000
.long 0x3f800000, 0x00000000, 0x3f800000, 0x00000000, 0x3f800000, 0x00000000, 0x3f800000, 0x00000000
.long 0x3f800000, 0x00000000, 0x3f800000, 0x00000000, 0x3f800000, 0x00000000, 0x3f800000, 0x00000000
.long 0x3f800000, 0x00000000, 0x3f800000, 0x00000000, 0x3f800000, 0x00000000, 0x3f800000, 0x00000000
.long 0x3f800000, 0x00000000, 0x3f800000, 0x00000000, 0x3f800000, 0x00000000, 0x3f800000, 0x00000000
.long 0x3f800000, 0x00000000, 0x3f800000, 0x00000000, 0x3f800000, 0x00000000, 0x3f800000, 0x00000000
.long 0x3f800000, 0x00000000, 0x3f800000, 0x00000000, 0x3f800000, 0x00000000, 0x3f800000, 0x00000000
.long 0x3f800000, 0x00000000, 0x3f800000, 0x00000000, 0x3f800000, 0x00000000, 0x3f800000, 0x00000000
.long 0x3f800000, 0x00000000, 0x3f800000, 0x00000000, 0x3f800000, 0x00000000, 0x3f800000, 0x00000000
.long 0x3f800000, 0x00000000, 0x3f800000, 0x00000000, 0x3f800000, 0x00000000, 0x3f800000, 0x00000000
.long 0x3f800000, 0x00000000, 0x3f800000, 0x00000000, 0x3f800000, 0x00000000, 0x3f800000, 0x00000000
.long 0x3f800000, 0x00000000, 0x3f800000, 0x00000000, 0x3f800000, 0x00000000, 0x3f800000, 0x00000000
.long 0x3f800000, 0x00000000, 0x3f800000, 0x00000000, 0x3f800000, 0x00000000, 0x3f800000, 0x00000000
.long 0x3f800000, 0x00000000, 0x3f800000, 0x00000000, 0x3f800000, 0x00000000, 0x3f800000, 0x00000000
.long 0x3f800000, 0x00000000, 0x3f800000, 0x00000000, 0x3f800000, 0x00000000, 0x3f800000, 0x00000000
.long 0x3f800000, 0x00000000, 0x3f800000, 0x00000000, 0x3f800000, 0x00000000, 0x3f800000, 0x00000000
.long 0x3f800000, 0x00000000, 0x3f800000, 0x00000000, 0x3f800000, 0x00000000, 0x3f800000, 0x00000000
.long 0x3f800000, 0x00000000, 0x3f800000, 0x00000000, 0x3f800000, 0x00000000, 0x3f800000, 0x00000000
.long 0x3f800000, 0x00000000, 0x3f800000, 0x00000000, 0x3f800000, 0x00000000, 0x3f800000, 0x00000000
.long 0x3f800000, 0x00000000, 0x3f800000, 0x00000000, 0x3f800000, 0x00000000, 0x3f800000, 0x00000000
.long 0x3f800000, 0x00000000, 0x3f800000, 0x00000000, 0x3f800000, 0x00000000, 0x3f800000, 0x00000000
.long 0x3f800000, 0x00000000, 0x3f800000, 0x00000000, 0x3f800000, 0x00000000, 0x3f800000, 0x00000000
.long 0x3f800000, 0x00000000, 0x3f800000, 0x00000000, 0x3f800000, 0x00000000, 0x3f800000, 0x00000000
.long 0x3f800000, 0x00000000, 0x3f800000, 0x00000000, 0x3f800000, 0x00000000, 0x3f800000, 0x00000000
.long 0x3f7fb10f, 0xbd48fb30, 0x3f7fb10f, 0xbd48fb30, 0x3f7fb10f, 0xbd48fb30, 0x3f7fb10f, 0xbd48fb30
.long 0x3f7fb10f, 0xbd48fb30, 0x3f7fb10f, 0xbd48fb30, 0x3f7fb10f, 0xbd48fb30, 0x3f7fb10f, 0xbd48fb30
.long 0x3f7ec46d, 0xbdc8bd36, 0x3f7ec46d, 0xbdc8bd36, 0x3f7ec46d, 0xbdc8bd36, 0x3f7ec46d, 0xbdc8bd36
.long 0x3f7ec46d, 0xbdc8bd36, 0x3f7ec46d, 0xbdc8bd36, 0x3f7ec46d, 0xbdc8bd36, 0x3f7ec46d, 0xbdc8bd36
.long 0x3f7d3aac, 0xbe164083, 0x3f7d3aac, 0xbe164083, 0x3f7d3aac, 0xbe164083, 0x3f7d3aac, 0xbe164083
.long 0x3f7d3aac, 0xbe164083, 0x3f7d3aac, 0xbe164083, 0x3f7d3aac, 0xbe164083, 0x3f7d3aac, 0xbe164083
.long 0x3f7b14be, 0xbe47c5c2, 0x3f7b14be, 0xbe47c5c2, 0x3f7b14be, 0xbe47c5c2, 0x3f7b14be, 0xbe47c5c2
.long 0x3f7b14be, 0xbe47c5c2, 0x3f7b14be, 0xbe47c5c2, 0x3f7b14be, 0xbe47c5c2, 0x3f7b14be, 0xbe47c5c2
.long 0x3f7853f8, 0xbe78cfcc, 0x3f7853f8, 0xbe78cfcc, 0x3f7853f8, 0xbe78cfcc, 0x3f7853f8, 0xbe78cfcc
.long 0x3f7853f8, 0xbe78cfcc, 0x3f7853f8, 0xbe78cfcc, 0x3f7853f8, 0xbe78cfcc, 0x3f7853f8, 0xbe78cfcc
.long 0x3f74fa0b, 0xbe94a031, 0x3f74fa0b, 0xbe94a031, 0x3f74fa0b, 0xbe94a031, 0x3f74fa0b, 0xbe94a031
.long 0x3f74fa0b, 0xbe94a031, 0x3f74fa0b, 0xbe94a031, 0x3f74fa0b, 0xbe94a031, 0x3f74fa0b, 0xbe94a031
.long 0x3f710908, 0xbeac7cd4, 0x3f710908, 0xbeac7cd4, 0x3f710908, 0xbeac7cd4, 0x3f710908, 0xbeac7cd4
.long 0x3f710908, 0xbeac7cd4, 0x3f710908, 0xbeac7cd4, 0x3f710908, 0xbeac7cd4, 0x3f710908, 0xbeac7cd4
.long 0x3f6c835e, 0xbec3ef15, 0x3f6c835e, 0xbec3ef15, 0x3f6c835e, 0xbec3ef15, 0x3f6c835e, 0xbec3ef15
.long 0x3f6c835e, 0xbec3ef15, 0x3f6c835e, 0xbec3ef15, 0x3f6c835e, 0xbec3ef15, 0x3f6c835e, 0xbec3ef15
.long 0x3f676bd8, 0xbedae880, 0x3f676bd8, 0xbedae880, 0x3f676bd8, 0xbedae880, 0x3f676bd8, 0xbedae880
.long 0x3f676bd8, 0xbedae880, 0x3f676bd8, 0xbedae880, 0x3f676bd8, 0xbedae880, 0x3f676bd8, 0xbedae880
.long 0x3f61c598, 0xbef15aea, 0x3f61c598, 0xbef15aea, 0x3f61c598, 0xbef15aea, 0x3f61c598, 0xbef15aea
.long 0x3f61c598, 0xbef15aea, 0x3f61c598, 0xbef15aea, 0x3f61c598, 0xbef15aea, 0x3f61c598, 0xbef15aea
.long 0x3f5b941a, 0xbf039c3d, 0x3f5b941a, 0xbf039c3d, 0x3f5b941a, 0xbf039c3d, 0x3f5b941a, 0xbf039c3d
.long 0x3f5b941a, 0xbf039c3d, 0x3f5b941a, 0xbf039c3d, 0x3f5b941a, 0xbf039c3d, 0x3f5b941a, 0xbf039c3d
.long 0x3f54db31, 0xbf0e39da, 0x3f54db31, 0xbf0e39da, 0x3f54db31, 0xbf0e39da, 0x3f54db31, 0xbf0e39da
.long 0x3f54db31, 0xbf0e39da, 0x3f54db31, 0xbf0e39da, 0x3f54db31, 0xbf0e39da, 0x3f54db31, 0xbf0e39da
.long 0x3f4d9f02, 0xbf187fc0, 0x3f4d9f02, 0xbf187fc0, 0x3f4d9f02, 0xbf187fc0, 0x3f4d9f02, 0xbf187fc0
.long 0x3f4d9f02, 0xbf187fc0, 0x3f4d9f02, 0xbf187fc0, 0x3f4d9f02, 0xbf187fc0, 0x3f4d9f02, 0xbf187fc0
.long 0x3f45e403, 0xbf226799, 0x3f45e403, 0xbf226799, 0x3f45e403, 0xbf226799, 0x3f45e403, 0xbf226799
.long 0x3f45e403, 0xbf226799, 0x3f45e403, 0xbf226799, 0x3f45e403, 0xbf226799, 0x3f45e403, 0xbf226799
.long 0x3f3daef9, 0xbf2beb4a, 0x3f3daef9, 0xbf2beb4a, 0x3f3daef9, 0xbf2beb4a, 0x3f3daef9, 0xbf2beb4a
.long 0x3f3daef9, 0xbf2beb4a, 0x3f3daef9, 0xbf2beb4a, 0x3f3daef9, 0xbf2beb4a, 0x3f3daef9, 0xbf2beb4a
.long 0x3f800000, 0x00000000, 0x3f800000, 0x00000000, 0x3f800000, 0x00000000, 0x3f800000, 0x00000000
.long 0x3f800000, 0x00000000, 0x3f800000, 0x00000000, 0x3f800000, 0x00000000, 0x3f800000, 0x00000000
.long 0x3f7ec46d, 0xbdc8bd36, 0x3f7ec46d, 0xbdc8bd36, 0x3f7ec46d, 0xbdc8bd36, 0x3f7ec46d, 0xbdc8bd36
.long 0x3f7ec46d, 0xbdc8bd36, 0x3f7ec46d, 0xbdc8bd36, 0x3f7ec46d, 0xbdc8bd36, 0x3f7ec46d, 0xbdc8bd36
.long 0x3f7b14be, 0xbe47c5c2, 0x3f7b14be, 0xbe47c5c2, 0x3f7b14be, 0xbe47c5c2, 0x3f7b14be, 0xbe47c5c2
.long 0x3f7b14be, 0xbe47c5c2, 0x3f7b14be, 0xbe47c5c2, 0x3f7b14be, 0xbe47c5c2, 0x3f7b14be, 0xbe47c5c2
.long 0x3f74fa0b, 0xbe94a031, 0x3f74fa0b, 0xbe94a031, 0x3f74fa0b, 0xbe94a031, 0x3f74fa0b, 0xbe94a031
.long 0x3f74fa0b, 0xbe94a031, 0x3f74fa0b, 0xbe94a031, 0x3f74fa0b, 0xbe94a031, 0x3f74fa0b, 0xbe94a031
.long 0x3f6c835e, 0xbec3ef15, 0x3f6c835e, 0xbec3ef15, 0x3f6c835e, 0xbec3ef15, 0x3f6c835e, 0xbec3ef15
.long 0x3f6c835e, 0xbec3ef15, 0x3f6c835e, 0xbec3ef15, 0x3f6c835e, 0xbec3ef15, 0x3f6c835e, 0xbec3ef15
.long 0x3f61c598, 0xbef15aea, 0x3f61c598, 0xbef15aea, 0x3f61c598, 0xbef15aea, 0x3f61c598, 0xbef15aea
.long 0x3f61c598, 0xbef15aea, 0x3f61c598, 0xbef15aea, 0x3f61c598, 0xbef15aea, 0x3f61c598, 0xbef15aea
.long 0x3f54db31, 0xbf0e39da, 0x3f54db31, 0xbf0e39da, 0x3f54db31, 0xbf0e39da, 0x3f54db31, 0xbf0e39da
.long 0x3f54db31, 0xbf0e39da, 0x3f54db31, 0xbf0e39da, 0x3f54db31, 0xbf0e39da, 0x3f54db31, 0xbf0e39da
.long 0x3f45e403, 0xbf226799, 0x3f45e403, 0xbf226799, 0x3f45e403, 0xbf226799, 0x3f45e403, 0xbf226799
.long 0x3f45e403, 0xbf226799, 0x3f45e403, 0xbf226799, 0x3f45e403, 0xbf226799, 0x3f45e403, 0xbf226799
.long 0x3f3504f3, 0xbf3504f3, 0x3f3504f3, 0xbf3504f3, 0x3f3504f3, 0xbf3504f3, 0x3f3504f3, 0xbf3504f3
.long 0x3f3504f3, 0xbf3504f3, 0x3f3504f3, 0xbf3504f3, 0x3f3504f3, 0xbf3504f3, 0x3f3504f3, 0xbf3504f3
.long 0x3f226799, 0xbf45e403, 0x3f226799, 0xbf45e403, 0x3f226799, 0xbf45e403, 0x3f226799, 0xbf45e403
.long 0x3f226799, 0xbf45e403, 0x3f226799, 0xbf45e403, 0x3f226799, 0xbf45e403, 0x3f226799, 0xbf45e403
.long 0x3f0e39da, 0xbf54db31, 0x3f0e39da, 0xbf54db31, 0x3f0e39da, 0xbf54db31, 0x3f0e39da, 0xbf54db31
.long 0x3f0e39da, 0xbf54db31, 0x3f0e39da, 0xbf54db31, 0x3f0e39da, 0xbf54db31, 0x3f0e39da, 0xbf54db31
.long 0x3ef15aea, 0xbf61c598, 0x3ef15aea, 0xbf61c598, 0x3ef15aea, 0xbf61c598, 0x3ef15aea, 0xbf61c598
.long 0x3ef15aea, 0xbf61c598, 0x3ef15aea, 0xbf61c598, 0x3ef15aea, 0xbf61c598, 0x3ef15aea, 0xbf61c598
.long 0x3ec3ef15, 0xbf6c835e, 0x3ec3ef15, 0xbf6c835e, 0x3ec3ef15, 0xbf6c835e, 0x3ec3ef15, 0xbf6c835e
.long 0x3ec3ef15, 0xbf6c835e, 0x3ec3ef15, 0xbf6c835e, 0x3ec3ef15, 0xbf6c835e, 0x3ec3ef15, 0xbf6c835e
.long 0x3e94a031, 0xbf74fa0b, 0x3e94a031, 0xbf74fa0b, 0x3e94a031, 0xbf74fa0b, 0x3e94a031, 0xbf74fa0b
.long 0x3e94a031, 0xbf74fa0b, 0x3e94a031, 0xbf74fa0b, 0x3e94a031, 0xbf74fa0b, 0x3e94a031, 0xbf74fa0b
.long 0x3e47c5c2, 0xbf7b14be, 0x3e47c5c2, 0xbf7b14be, 0x3e47c5c2, 0xbf7b14be, 0x3e47c5c2, 0xbf7b14be
.long 0x3e47c5c2, 0xbf7b14be, 0x3e47c5c2, 0xbf7b14be, 0x3e47c5c2, 0xbf7b14be, 0x3e47c5c2, 0xbf7b14be
.long 0x3dc8bd36, 0xbf7ec46d, 0x3dc8bd36, 0xbf7ec46d, 0x3dc8bd36, 0xbf7ec46d, 0x3dc8bd36, 0xbf7ec46d
.long 0x3dc8bd36, 0xbf7ec46d, 0x3dc8bd36, 0xbf7ec46d, 0x3dc8bd36, 0xbf7ec46d, 0x3dc8bd36, 0xbf7ec46d
.long 0x3f800000, 0x00000000, 0x3f800000, 0x00000000, 0x3f800000, 0x00000000, 0x3f800000, 0x00000000
.long 0x3f800000, 0x00000000, 0x3f800000, 0x00000000, 0x3f800000, 0x00000000, 0x3f800000, 0x00000000
.long 0x3f7d3aac, 0xbe164083, 0x3f7d3aac, 0xbe164083, 0x3f7d3aac, 0xbe164083, 0x3f7d3aac, 0xbe164083
.long 0x3f7d3aac, 0xbe164083, 0x3f7d3aac, 0xbe164083, 0x3f7d3aac, 0xbe164083, 0x3f7d3aac, 0xbe164083
.long 0x3f74fa0b, 0xbe94a031, 0x3f74fa0b, 0xbe94a031, 0x3f74fa0b, 0xbe94a031, 0x3f74fa0b, 0xbe94a031
.long 0x3f74fa0b, 0xbe94a031, 0x3f74fa0b, 0xbe94a031, 0x3f74fa0b, 0xbe94a031, 0x3f74fa0b, 0xbe94a031
.long 0x3f676bd8, 0xbedae880, 0x3f676bd8, 0xbedae880, 0x3f676bd8, 0xbedae880, 0x3f676bd8, 0xbedae880
.long 0x3f676bd8, 0xbedae880, 0x3f676bd8, 0xbedae880, 0x3f676bd8, 0xbedae880, 0x3f676bd8, 0xbedae880
.long 0x3f54db31, 0xbf0e39da, 0x3f54db31, 0xbf0e39da, 0x3f54db31, 0xbf0e39da, 0x3f54db31, 0xbf0e39da
.long 0x3f54db31, 0xbf0e39da, 0x3f54db31, 0xbf0e39da, 0x3f54db31, 0xbf0e39da, 0x3f54db31, 0xbf0e39da
.long 0x3f3daef9, 0xbf2beb4a, 0x3f3daef9, 0xbf2beb4a, 0x3f3daef9, 0xbf2beb4a, 0x3f3daef9, 0xbf2beb4a
.long 0x3f3daef9, 0xbf2beb4a, 0x3f3daef9, 0xbf2beb4a, 0x3f3daef9, 0xbf2beb4a, 0x3f3daef9, 0xbf2beb4a
.long 0x3f226799, 0xbf45e403, 0x3f226799, 0xbf45e403, 0x3f226799, 0xbf45e403, 0x3f226799, 0xbf45e403
.long 0x3f226799, 0xbf45e403, 0x3f226799, 0xbf45e403, 0x3f226799, 0xbf45e403, 0x3f226799, 0xbf45e403
.long 0x3f039c3d, 0xbf5b941a, 0x3f039c3d, 0xbf5b941a, 0x3f039c3d, 0xbf5b941a, 0x3f039c3d, 0xbf5b941a
.long 0x3f039c3d, 0xbf5b941a, 0x3f039c3d, 0xbf5b941a, 0x3f039c3d, 0xbf5b941a, 0x3f039c3d, 0xbf5b941a
.long 0x3ec3ef15, 0xbf6c835e, 0x3ec3ef15, 0xbf6c835e, 0x3ec3ef15, 0xbf6c835e, 0x3ec3ef15, 0xbf6c835e
.long 0x3ec3ef15, 0xbf6c835e, 0x3ec3ef15, 0xbf6c835e, 0x3ec3ef15, 0xbf6c835e, 0x3ec3ef15, 0xbf6c835e
.long 0x3e78cfcc, 0xbf7853f8, 0x3e78cfcc, 0xbf7853f8, 0x3e78cfcc, 0xbf7853f8, 0x3e78cfcc, 0xbf7853f8
.long 0x3e78cfcc, 0xbf7853f8, 0x3e78cfcc, 0xbf7853f8, 0x3e78cfcc, 0xbf7853f8, 0x3e78cfcc, 0xbf7853f8
.long 0x3dc8bd36, 0xbf7ec46d, 0x3dc8bd36, 0xbf7ec46d, 0x3dc8bd36, 0xbf7ec46d, 0x3dc8bd36, 0xbf7ec46d
.long 0x3dc8bd36, 0xbf7ec46d, 0x3dc8bd36, 0xbf7ec46d, 0x3dc8bd36, 0xbf7ec46d, 0x3dc8bd36, 0xbf7ec46d
.long 0xbd48fb30, 0xbf7fb10f, 0xbd48fb30, 0xbf7fb10f, 0xbd48fb30, 0xbf7fb10f, 0xbd48fb30, 0xbf7fb10f
.long 0xbd48fb30, 0xbf7fb10f, 0xbd48fb30, 0xbf7fb10f, 0xbd48fb30, 0xbf7fb10f, 0xbd48fb30, 0xbf7fb10f
.long 0xbe47c5c2, 0xbf7b14be, 0xbe47c5c2, 0xbf7b14be, 0xbe47c5c2, 0xbf7b14be, 0xbe47c5c2, 0xbf7b14be
.long 0xbe47c5c2, 0xbf7b14be, 0xbe47c5c2, 0xbf7b14be, 0xbe47c5c2, 0xbf7b14be, 0xbe47c5c2, 0xbf7b14be
.long 0xbeac7cd4, 0xbf710908, 0xbeac7cd4, 0xbf710908, 0xbeac7cd4, 0xbf710908, 0xbeac7cd4, 0xbf710908
.long 0xbeac7cd4, 0xbf710908, 0xbeac7cd4, 0xbf710908, 0xbeac7cd4, 0xbf710908, 0xbeac7cd4, 0xbf710908
.long 0xbef15aea, 0xbf61c598, 0xbef15aea, 0xbf61c598, 0xbef15aea, 0xbf61c598, 0xbef15aea, 0xbf61c598
.long 0xbef15aea, 0xbf61c598, 0xbef15aea, 0xbf61c598, 0xbef15aea, 0xbf61c598, 0xbef15aea, 0xbf61c598
.long 0xbf187fc0, 0xbf4d9f02, 0xbf187fc0, 0xbf4d9f02, 0xbf187fc0, 0xbf4d9f02, 0xbf187fc0, 0xbf4d9f02
.long 0xbf187fc0, 0xbf4d9f02, 0xbf187fc0, 0xbf4d9f02, 0xbf187fc0, 0xbf4d9f02, 0xbf187fc0, 0xbf4d9f02
.long 0x3f800000, 0x00000000, 0x3f800000, 0x00000000, 0x3f800000, 0x00000000, 0x3f800000, 0x00000000
.long 0x3f800000, 0x00000000, 0x3f800000, 0x00000000, 0x3f800000, 0x00000000, 0x3f800000, 0x00000000
.long 0x3f7b14be, 0xbe47c5c2, 0x3f7b14be, 0xbe47c5c2, 0x3f7b14be, 0xbe47c5c2, 0x3f7b14be, 0xbe47c5c2
.long 0x3f7b14be, 0xbe47c5c2, 0x3f7b14be, 0xbe47c5c2, 0x3f7b14be, 0xbe47c5c2, 0x3f7b14be, 0xbe47c5c2
.long 0x3f6c835e, 0xbec3ef15, 0x3f6c835e, 0xbec3ef15, 0x3f6c835e, 0xbec3ef15, 0x3f6c835e, 0xbec3ef15
.long 0x3f6c835e, 0xbec3ef15, 0x3f6c835e, 0xbec3ef15, 0x3f6c835e, 0xbec3ef15, 0x3f6c835e, 0xbec3ef15
.long 0x3f54db31, 0xbf0e39da, 0x3f54db31, 0xbf0e39da, 0x3f54db31, 0xbf0e39da, 0x3f54db31, 0xbf0e39da
.long 0x3f54db31, 0xbf0e39da, 0x3f54db31, 0xbf0e39da, 0x3f54db31, 0xbf0e39da, 0x3f54db31, 0xbf0e39da
.long 0x3f3504f3, 0xbf3504f3, 0x3f3504f3, 0xbf3504f3, 0x3f3504f3, 0xbf3504f3, 0x3f3504f3, 0xbf3504f3
.long 0x3f3504f3, 0xbf3504f3, 0x3f3504f3, 0xbf3504f3, 0x3f3504f3, 0xbf3504f3, 0x3f3504f3, 0xbf3504f3
.long 0x3f0e39da, 0xbf54db31, 0x3f0e39da, 0xbf54db31, 0x3f0e39da, 0xbf54db31, 0x3f0e39da, 0xbf54db31
.long 0x3f0e39da, 0xbf54db31, 0x3f0e39da, 0xbf54db31, 0x3f0e39da, 0xbf54db31, 0x3f0e39da, 0xbf54db31
.long 0x3ec3ef15, 0xbf6c835e, 0x3ec3ef15, 0xbf6c835e, 0x3ec3ef15, 0xbf6c835e, 0x3ec3ef15, 0xbf6c835e
.long 0x3ec3ef15, 0xbf6c835e, 0x3ec3ef15, 0xbf6c835e, 0x3ec3ef15, 0xbf6c835e, 0x3ec3ef15, 0xbf6c835e
.long 0x3e47c5c2, 0xbf7b14be, 0x3e47c5c2, 0xbf7b14be, 0x3e47c5c2, 0xbf7b14be, 0x3e47c5c2, 0xbf7b14be
.long 0x3e47c5c2, 0xbf7b14be, 0x3e47c5c2, 0xbf7b14be, 0x3e47c5c2, 0xbf7b14be, 0x3e47c5c2, 0xbf7b14be
.long 0x248d3132, 0xbf800000, 0x248d3132, 0xbf800000, 0x248d3132, 0xbf800000, 0x248d3132, 0xbf800000
.long 0x248d3132, 0xbf800000, 0x248d3132, 0xbf800000, 0x248d3132, 0xbf800000, 0x248d3132, 0xbf800000
.long 0xbe47c5c2, 0xbf7b14be, 0xbe47c5c2, 0xbf7b14be, 0xbe47c5c2, 0xbf7b14be, 0xbe47c5c2, 0xbf7b14be
.long 0xbe47c5c2, 0xbf7b14be, 0xbe47c5c2, 0xbf7b14be, 0xbe47c5c2, 0xbf7b14be, 0xbe47c5c2, 0xbf7b14be
.long 0xbec3ef15, 0xbf6c835e, 0xbec3ef15, 0xbf6c835e, 0xbec3ef15, 0xbf6c835e, 0xbec3ef15, 0xbf6c835e
.long 0xbec3ef15, 0xbf6c835e, 0xbec3ef15, 0xbf6c835e, 0xbec3ef15, 0xbf6c835e, 0xbec3ef15, 0xbf6c835e
.long 0xbf0e39da, 0xbf54db31, 0xbf0e39da, 0xbf54db31, 0xbf0e39da, 0xbf54db31, 0xbf0e39da, 0xbf54db31
.long 0xbf0e39da, 0xbf54db31, 0xbf0e39da, 0xbf54db31, 0xbf0e39da, 0xbf54db31, 0xbf0e39da, 0xbf54db31
.long 0xbf3504f3, 0xbf3504f3, 0xbf3504f3, 0xbf3504f3, 0xbf3504f3, 0xbf3504f3, 0xbf3504f3, 0xbf3504f3
.long 0xbf3504f3, 0xbf3504f3, 0xbf3504f3, 0xbf3504f3, 0xbf3504f3, 0xbf3504f3, 0xbf3504f3, 0xbf3504f3
.long 0xbf54db31, 0xbf0e39da, 0xbf54db31, 0xbf0e39da, 0xbf54db31, 0xbf0e39da, 0xbf54db31, 0xbf0e39da
.long 0xbf54db31, 0xbf0e39da, 0xbf54db31, 0xbf0e39da, 0xbf54db31, 0xbf0e39da, 0xbf54db31, 0xbf0e39da
.long 0xbf6c835e, 0xbec3ef15, 0xbf6c835e, 0xbec3ef15, 0xbf6c835e, 0xbec3ef15, 0xbf6c835e, 0xbec3ef15
.long 0xbf6c835e, 0xbec3ef15, 0xbf6c835e, 0xbec3ef15, 0xbf6c835e, 0xbec3ef15, 0xbf6c835e, 0xbec3ef15
.long 0xbf7b14be, 0xbe47c5c2, 0xbf7b14be, 0xbe47c5c2, 0xbf7b14be, 0xbe47c5c2, 0xbf7b14be, 0xbe47c5c2
.long 0xbf7b14be, 0xbe47c5c2, 0xbf7b14be, 0xbe47c5c2, 0xbf7b14be, 0xbe47c5c2, 0xbf7b14be, 0xbe47c5c2
.long 0x3f800000, 0x00000000, 0x3f800000, 0x00000000, 0x3f800000, 0x00000000, 0x3f800000, 0x00000000
.long 0x3f800000, 0x00000000, 0x3f800000, 0x00000000, 0x3f800000, 0x00000000, 0x3f800000, 0x00000000
.long 0x3f7853f8, 0xbe78cfcc, 0x3f7853f8, 0xbe78cfcc, 0x3f7853f8, 0xbe78cfcc, 0x3f7853f8, 0xbe78cfcc
.long 0x3f7853f8, 0xbe78cfcc, 0x3f7853f8, 0xbe78cfcc, 0x3f7853f8, 0xbe78cfcc, 0x3f7853f8, 0xbe78cfcc
.long 0x3f61c598, 0xbef15aea, 0x3f61c598, 0xbef15aea, 0x3f61c598, 0xbef15aea, 0x3f61c598, 0xbef15aea
.long 0x3f61c598, 0xbef15aea, 0x3f61c598, 0xbef15aea, 0x3f61c598, 0xbef15aea, 0x3f61c598, 0xbef15aea
.long 0x3f3daef9, 0xbf2beb4a, 0x3f3daef9, 0xbf2beb4a, 0x3f3daef9, 0xbf2beb4a, 0x3f3daef9, 0xbf2beb4a
.long 0x3f3daef9, 0xbf2beb4a, 0x3f3daef9, 0xbf2beb4a, 0x3f3daef9, 0xbf2beb4a, 0x3f3daef9, 0xbf2beb4a
.long 0x3f0e39da, 0xbf54db31, 0x3f0e39da, 0xbf54db31, 0x3f0e39da, 0xbf54db31, 0x3f0e39da, 0xbf54db31
.long 0x3f0e39da, 0xbf54db31, 0x3f0e39da, 0xbf54db31, 0x3f0e39da, 0xbf54db31, 0x3f0e39da, 0xbf54db31
.long 0x3eac7cd4, 0xbf710908, 0x3eac7cd4, 0xbf710908, 0x3eac7cd4, 0xbf710908, 0x3eac7cd4, 0xbf710908
.long 0x3eac7cd4, 0xbf710908, 0x3eac7cd4, 0xbf710908, 0x3eac7cd4, 0xbf710908, 0x3eac7cd4, 0xbf710908
.long 0x3dc8bd36, 0xbf7ec46d, 0x3dc8bd36, 0xbf7ec46d, 0x3dc8bd36, 0xbf7ec46d, 0x3dc8bd36, 0xbf7ec46d
.long 0x3dc8bd36, 0xbf7ec46d, 0x3dc8bd36, 0xbf7ec46d, 0x3dc8bd36, 0xbf7ec46d, 0x3dc8bd36, 0xbf7ec46d
.long 0xbe164083, 0xbf7d3aac, 0xbe164083, 0xbf7d3aac, 0xbe164083, 0xbf7d3aac, 0xbe164083, 0xbf7d3aac
.long 0xbe164083, 0xbf7d3aac, 0xbe164083, 0xbf7d3aac, 0xbe164083, 0xbf7d3aac, 0xbe164083, 0xbf7d3aac
.long 0xbec3ef15, 0xbf6c835e, 0xbec3ef15, 0xbf6c835e, 0xbec3ef15, 0xbf6c835e, 0xbec3ef15, 0xbf6c835e
.long 0xbec3ef15, 0xbf6c835e, 0xbec3ef15, 0xbf6c835e, 0xbec3ef15, 0xbf6c835e, 0xbec3ef15, 0xbf6c835e
.long 0xbf187fc0, 0xbf4d9f02, 0xbf187fc0, 0xbf4d9f02, 0xbf187fc0, 0xbf4d9f02, 0xbf187fc0, 0xbf4d9f02
.long 0xbf187fc0, 0xbf4d9f02, 0xbf187fc0, 0xbf4d9f02, 0xbf187fc0, 0xbf4d9f02, 0xbf187fc0, 0xbf4d9f02
.long 0xbf45e403, 0xbf226799, 0xbf45e403, 0xbf226799, 0xbf45e403, 0xbf226799, 0xbf45e403, 0xbf226799
.long 0xbf45e403, 0xbf226799, 0xbf45e403, 0xbf226799, 0xbf45e403, 0xbf226799, 0xbf45e403, 0xbf226799
.long 0xbf676bd8, 0xbedae880, 0xbf676bd8, 0xbedae880, 0xbf676bd8, 0xbedae880, 0xbf676bd8, 0xbedae880
.long 0xbf676bd8, 0xbedae880, 0xbf676bd8, 0xbedae880, 0xbf676bd8, 0xbedae880, 0xbf676bd8, 0xbedae880
.long 0xbf7b14be, 0xbe47c5c2, 0xbf7b14be, 0xbe47c5c2, 0xbf7b14be, 0xbe47c5c2, 0xbf7b14be, 0xbe47c5c2
.long 0xbf7b14be, 0xbe47c5c2, 0xbf7b14be, 0xbe47c5c2, 0xbf7b14be, 0xbe47c5c2, 0xbf7b14be, 0xbe47c5c2
.long 0xbf7fb10f, 0x3d48fb30, 0xbf7fb10f, 0x3d48fb30, 0xbf7fb10f, 0x3d48fb30, 0xbf7fb10f, 0x3d48fb30
.long 0xbf7fb10f, 0x3d48fb30, 0xbf7fb10f, 0x3d48fb30, 0xbf7fb10f, 0x3d48fb30, 0xbf7fb10f, 0x3d48fb30
.long 0xbf74fa0b, 0x3e94a031, 0xbf74fa0b, 0x3e94a031, 0xbf74fa0b, 0x3e94a031, 0xbf74fa0b, 0x3e94a031
.long 0xbf74fa0b, 0x3e94a031, 0xbf74fa0b, 0x3e94a031, 0xbf74fa0b, 0x3e94a031, 0xbf74fa0b, 0x3e94a031
.long 0xbf5b941a, 0x3f039c3d, 0xbf5b941a, 0x3f039c3d, 0xbf5b941a, 0x3f039c3d, 0xbf5b941a, 0x3f039c3d
.long 0xbf5b941a, 0x3f039c3d, 0xbf5b941a, 0x3f039c3d, 0xbf5b941a, 0x3f039c3d, 0xbf5b941a, 0x3f039c3d
.long 0x3f800000, 0x00000000, 0x3f800000, 0x00000000, 0x3f800000, 0x00000000, 0x3f800000, 0x00000000
.long 0x3f800000, 0x00000000, 0x3f800000, 0x00000000, 0x3f800000, 0x00000000, 0x3f800000, 0x00000000
.long 0x3f74fa0b, 0xbe94a031, 0x3f74fa0b, 0xbe94a031, 0x3f74fa0b, 0xbe94a031, 0x3f74fa0b, 0xbe94a031
.long 0x3f74fa0b, 0xbe94a031, 0x3f74fa0b, 0xbe94a031, 0x3f74fa0b, 0xbe94a031, 0x3f74fa0b, 0xbe94a031
.long 0x3f54db31, 0xbf0e39da, 0x3f54db31, 0xbf0e39da, 0x3f54db31, 0xbf0e39da, 0x3f54db31, 0xbf0e39da
.long 0x3f54db31, 0xbf0e39da, 0x3f54db31, 0xbf0e39da, 0x3f54db31, 0xbf0e39da, 0x3f54db31, 0xbf0e39da
.long 0x3f226799, 0xbf45e403, 0x3f226799, 0xbf45e403, 0x3f226799, 0xbf45e403, 0x3f226799, 0xbf45e403
.long 0x3f226799, 0xbf45e403, 0x3f226799, 0xbf45e403, 0x3f226799, 0xbf45e403, 0x3f226799, 0xbf45e403
.long 0x3ec3ef15, 0xbf6c835e, 0x3ec3ef15, 0xbf6c835e, 0x3ec3ef15, 0xbf6c835e, 0x3ec3ef15, 0xbf6c835e
.long 0x3ec3ef15, 0xbf6c835e, 0x3ec3ef15, 0xbf6c835e, 0x3ec3ef15, 0xbf6c835e, 0x3ec3ef15, 0xbf6c835e
.long 0x3dc8bd36, 0xbf7ec46d, 0x3dc8bd36, 0xbf7ec46d, 0x3dc8bd36, 0xbf7ec46d, 0x3dc8bd36, 0xbf7ec46d
.long 0x3dc8bd36, 0xbf7ec46d, 0x3dc8bd36, 0xbf7ec46d, 0x3dc8bd36, 0xbf7ec46d, 0x3dc8bd36, 0xbf7ec46d
.long 0xbe47c5c2, 0xbf7b14be, 0xbe47c5c2, 0xbf7b14be, 0xbe47c5c2, 0xbf7b14be, 0xbe47c5c2, 0xbf7b14be
.long 0xbe47c5c2, 0xbf7b14be, 0xbe47c5c2, 0xbf7b14be, 0xbe47c5c2, 0xbf7b14be, 0xbe47c5c2, 0xbf7b14be
.long 0xbef15aea, 0xbf61c598, 0xbef15aea, 0xbf61c598, 0xbef15aea, 0xbf61c598, 0xbef15aea, 0xbf61c598
.long 0xbef15aea, 0xbf61c598, 0xbef15aea, 0xbf61c598, 0xbef15aea, 0xbf61c598, 0xbef15aea, 0xbf61c598
.long 0xbf3504f3, 0xbf3504f3, 0xbf3504f3, 0xbf3504f3, 0xbf3504f3, 0xbf3504f3, 0xbf3504f3, 0xbf3504f3
.long 0xbf3504f3, 0xbf3504f3, 0xbf3504f3, 0xbf3504f3, 0xbf3504f3, 0xbf3504f3, 0xbf3504f3, 0xbf3504f3
.long 0xbf61c598, 0xbef15aea, 0xbf61c598, 0xbef15aea, 0xbf61c598, 0xbef15aea, 0xbf61c598, 0xbef15aea
.long 0xbf61c598, 0xbef15aea, 0xbf61c598, 0xbef15aea, 0xbf61c598, 0xbef15aea, 0xbf61c598, 0xbef15aea
.long 0xbf7b14be, 0xbe47c5c2, 0xbf7b14be, 0xbe47c5c2, 0xbf7b14be, 0xbe47c5c2, 0xbf7b14be, 0xbe47c5c2
.long 0xbf7b14be, 0xbe47c5c2, 0xbf7b14be, 0xbe47c5c2, 0xbf7b14be, 0xbe47c5c2, 0xbf7b14be, 0xbe47c5c2
.long 0xbf7ec46d, 0x3dc8bd36, 0xbf7ec46d, 0x3dc8bd36, 0xbf7ec46d, 0x3dc8bd36, 0xbf7ec46d, 0x3dc8bd36
.long 0xbf7ec46d, 0x3dc8bd36, 0xbf7ec46d, 0x3dc8bd36, 0xbf7ec46d, 0x3dc8bd36, 0xbf7ec46d, 0x3dc8bd36
.long 0xbf6c835e, 0x3ec3ef15, 0xbf6c835e, 0x3ec3ef15, 0xbf6c835e, 0x3ec3ef15, 0xbf6c835e, 0x3ec3ef15
.long 0xbf6c835e, 0x3ec3ef15, 0xbf6c835e, 0x3ec3ef15, 0xbf6c835e, 0x3ec3ef15, 0xbf6c835e, 0x3ec3ef15
.long 0xbf45e403, 0x3f226799, 0xbf45e403, 0x3f226799, 0xbf45e403, 0x3f226799, 0xbf45e403, 0x3f226799
.long 0xbf45e403, 0x3f226799, 0xbf45e403, 0x3f226799, 0xbf45e403, 0x3f226799, 0xbf45e403, 0x3f226799
.long 0xbf0e39da, 0x3f54db31, 0xbf0e39da, 0x3f54db31, 0xbf0e39da, 0x3f54db31, 0xbf0e39da, 0x3f54db31
.long 0xbf0e39da, 0x3f54db31, 0xbf0e39da, 0x3f54db31, 0xbf0e39da, 0x3f54db31, 0xbf0e39da, 0x3f54db31
.long 0xbe94a031, 0x3f74fa0b, 0xbe94a031, 0x3f74fa0b, 0xbe94a031, 0x3f74fa0b, 0xbe94a031, 0x3f74fa0b
.long 0xbe94a031, 0x3f74fa0b, 0xbe94a031, 0x3f74fa0b, 0xbe94a031, 0x3f74fa0b, 0xbe94a031, 0x3f74fa0b
.long 0x3f800000, 0x00000000, 0x3f800000, 0x00000000, 0x3f800000, 0x00000000, 0x3f800000, 0x00000000
.long 0x3f800000, 0x00000000, 0x3f800000, 0x00000000, 0x3f800000, 0x00000000, 0x3f800000, 0x00000000
.long 0x3f710908, 0xbeac7cd4, 0x3f710908, 0xbeac7cd4, 0x3f710908, 0xbeac7cd4, 0x3f710908, 0xbeac7cd4
.long 0x3f710908, 0xbeac7cd4, 0x3f710908, 0xbeac7cd4, 0x3f710908, 0xbeac7cd4, 0x3f710908, 0xbeac7cd4
.long 0x3f45e403, 0xbf226799, 0x3f45e403, 0xbf226799, 0x3f45e403, 0xbf226799, 0x3f45e403, 0xbf226799
.long 0x3f45e403, 0xbf226799, 0x3f45e403, 0xbf226799, 0x3f45e403, 0xbf226799, 0x3f45e403, 0xbf226799
.long 0x3f039c3d, 0xbf5b941a, 0x3f039c3d, 0xbf5b941a, 0x3f039c3d, 0xbf5b941a, 0x3f039c3d, 0xbf5b941a
.long 0x3f039c3d, 0xbf5b941a, 0x3f039c3d, 0xbf5b941a, 0x3f039c3d, 0xbf5b941a, 0x3f039c3d, 0xbf5b941a
.long 0x3e47c5c2, 0xbf7b14be, 0x3e47c5c2, 0xbf7b14be, 0x3e47c5c2, 0xbf7b14be, 0x3e47c5c2, 0xbf7b14be
.long 0x3e47c5c2, 0xbf7b14be, 0x3e47c5c2, 0xbf7b14be, 0x3e47c5c2, 0xbf7b14be, 0x3e47c5c2, 0xbf7b14be
.long 0xbe164083, 0xbf7d3aac, 0xbe164083, 0xbf7d3aac, 0xbe164083, 0xbf7d3aac, 0xbe164083, 0xbf7d3aac
.long 0xbe164083, 0xbf7d3aac, 0xbe164083, 0xbf7d3aac, 0xbe164083, 0xbf7d3aac, 0xbe164083, 0xbf7d3aac
.long 0xbef15aea, 0xbf61c598, 0xbef15aea, 0xbf61c598, 0xbef15aea, 0xbf61c598, 0xbef15aea, 0xbf61c598
.long 0xbef15aea, 0xbf61c598, 0xbef15aea, 0xbf61c598, 0xbef15aea, 0xbf61c598, 0xbef15aea, 0xbf61c598
.long 0xbf3daef9, 0xbf2beb4a, 0xbf3daef9, 0xbf2beb4a, 0xbf3daef9, 0xbf2beb4a, 0xbf3daef9, 0xbf2beb4a
.long 0xbf3daef9, 0xbf2beb4a, 0xbf3daef9, 0xbf2beb4a, 0xbf3daef9, 0xbf2beb4a, 0xbf3daef9, 0xbf2beb4a
.long 0xbf6c835e, 0xbec3ef15, 0xbf6c835e, 0xbec3ef15, 0xbf6c835e, 0xbec3ef15, 0xbf6c835e, 0xbec3ef15
.long 0xbf6c835e, 0xbec3ef15, 0xbf6c835e, 0xbec3ef15, 0xbf6c835e, 0xbec3ef15, 0xbf6c835e, 0xbec3ef15
.long 0xbf7fb10f, 0xbd48fb30, 0xbf7fb10f, 0xbd48fb30, 0xbf7fb10f, 0xbd48fb30, 0xbf7fb10f, 0xbd48fb30
.long 0xbf7fb10f, 0xbd48fb30, 0xbf7fb10f, 0xbd48fb30, 0xbf7fb10f, 0xbd48fb30, 0xbf7fb10f, 0xbd48fb30
.long 0xbf74fa0b, 0x3e94a031, 0xbf74fa0b, 0x3e94a031, 0xbf74fa0b, 0x3e94a031, 0xbf74fa0b, 0x3e94a031
.long 0xbf74fa0b, 0x3e94a031, 0xbf74fa0b, 0x3e94a031, 0xbf74fa0b, 0x3e94a031, 0xbf74fa0b, 0x3e94a031
.long 0xbf4d9f02, 0x3f187fc0, 0xbf4d9f02, 0x3f187fc0, 0xbf4d9f02, 0x3f187fc0, 0xbf4d9f02, 0x3f187fc0
.long 0xbf4d9f02, 0x3f187fc0, 0xbf4d9f02, 0x3f187fc0, 0xbf4d9f02, 0x3f187fc0, 0xbf4d9f02, 0x3f187fc0
.long 0xbf0e39da, 0x3f54db31, 0xbf0e39da, 0x3f54db31, 0xbf0e39da, 0x3f54db31, 0xbf0e39da, 0x3f54db31
.long 0xbf0e39da, 0x3f54db31, 0xbf0e39da, 0x3f54db31, 0xbf0e39da, 0x3f54db31, 0xbf0e39da, 0x3f54db31
.long 0xbe78cfcc, 0x3f7853f8, 0xbe78cfcc, 0x3f7853f8, 0xbe78cfcc, 0x3f7853f8, 0xbe78cfcc, 0x3f7853f8
.long 0xbe78cfcc, 0x3f7853f8, 0xbe78cfcc, 0x3f7853f8, 0xbe78cfcc, 0x3f7853f8, 0xbe78cfcc, 0x3f7853f8
.long 0x3dc8bd36, 0x3f7ec46d, 0x3dc8bd36, 0x3f7ec46d, 0x3dc8bd36, 0x3f7ec46d, 0x3dc8bd36, 0x3f7ec46d
.long 0x3dc8bd36, 0x3f7ec46d, 0x3dc8bd36, 0x3f7ec46d, 0x3dc8bd36, 0x3f7ec46d, 0x3dc8bd36, 0x3f7ec46d
.long 0x3edae880, 0x3f676bd8, 0x3edae880, 0x3f676bd8, 0x3edae880, 0x3f676bd8, 0x3edae880, 0x3f676bd8
.long 0x3edae880, 0x3f676bd8, 0x3edae880, 0x3f676bd8, 0x3edae880, 0x3f676bd8, 0x3edae880, 0x3f676bd8
T2048_tw1B:
.long 0x3f800000, 0x00000000, 0x3f800000, 0x00000000, 0x3f800000, 0x00000000, 0x3f800000, 0x00000000
.long 0x3f800000, 0x00000000, 0x3f800000, 0x00000000, 0x3f800000, 0x00000000, 0x3f800000, 0x00000000
.long 0x3f800000, 0x00000000, 0x3f7fffb1, 0xbb490fc6, 0x3f7ffec4, 0xbbc90f88, 0x3f7ffd39, 0xbc16cb58
.long 0x3f7ffb11, 0xbc490e90, 0x3f7ff84a, 0xbc7b514b, 0x3f7ff4e6, 0xbc96c9b6, 0x3f7ff0e3, 0xbcafea69
.long 0x3f800000, 0x00000000, 0x3f7ffec4, 0xbbc90f88, 0x3f7ffb11, 0xbc490e90, 0x3f7ff4e6, 0xbc96c9b6
.long 0x3f7fec43, 0xbcc90ab0, 0x3f7fe129, 0xbcfb49ba, 0x3f7fd397, 0xbd16c32c, 0x3f7fc38f, 0xbd2fe007
.long 0x3f800000, 0x00000000, 0x3f7ffd39, 0xbc16cb58, 0x3f7ff4e6, 0xbc96c9b6, 0x3f7fe705, 0xbce22a7a
.long 0x3f7fd397, 0xbd16c32c, 0x3f7fba9e, 0xbd3c6dd5, 0x3f7f9c18, 0xbd621469, 0x3f7f7808, 0xbd83db0a
.long 0x3f800000, 0x00000000, 0x3f7ffb11, 0xbc490e90, 0x3f7fec43, 0xbcc90ab0, 0x3f7fd397, 0xbd16c32c
.long 0x3f7fb10f, 0xbd48fb30, 0x3f7f84ab, 0xbd7b2b74, 0x3f7f4e6d, 0xbd96a905, 0x3f7f0e58, 0xbdafb680
.long 0x3f800000, 0x00000000, 0x3f7ff84a, 0xbc7b514b, 0x3f7fe129, 0xbcfb49ba, 0x3f7fba9e, 0xbd3c6dd5
.long 0x3f7f84ab, 0xbd7b2b74, 0x3f7f3f54, 0xbd9cecf9, 0x3f7eea9d, 0xbdbc3ac3, 0x3f7e868b, 0xbddb7d37
.long 0x3f800000, 0x00000000, 0x3f7ff4e6, 0xbc96c9b6, 0x3f7fd397, 0xbd16c32c, 0x3f7f9c18, 0xbd621469
.long 0x3f7f4e6d, 0xbd96a905, 0x3f7eea9d, 0xbdbc3ac3, 0x3f7e70b0, 0xbde1bc2e, 0x3f7de0b1, 0xbe039502
.long 0x3f800000, 0x00000000, 0x3f7ff0e3, 0xbcafea69, 0x3f7fc38f, 0xbd2fe007, 0x3f7f7808, 0xbd83db0a
.long 0x3f7f0e58, 0xbdafb680, 0x3f7e868b, 0xbddb7d37, 0x3f7de0b1, 0xbe039502, 0x3f7d1cdd, 0xbe195be0
.long 0x3f800000, 0x00000000, 0x3f7fec43, 0xbcc90ab0, 0x3f7fb10f, 0xbd48fb30, 0x3f7f4e6d, 0xbd96a905
.long 0x3f7ec46d, 0xbdc8bd36, 0x3f7e1324, 0xbdfab273, 0x3f7d3aac, 0xbe164083, 0x3f7c3b28, 0xbe2f10a2
.long 0x3f800000, 0x00000000, 0x3f7fe705, 0xbce22a7a, 0x3f7f9c18, 0xbd621469, 0x3f7f1f49, 0xbda973ba
.long 0x3f7e70b0, 0xbde1bc2e, 0x3f7d906e, 0xbe0cec4a, 0x3f7c7eb0, 0xbe28defc, 0x3f7b3bab, 0xbe44b0b9
.long 0x3f800000, 0x00000000, 0x3f7fe129, 0xbcfb49ba, 0x3f7f84ab, 0xbd7b2b74, 0x3f7eea9d, 0xbdbc3ac3
.long 0x3f7e1324, 0xbdfab273, 0x3f7cfe73, 0xbe1c76de, 0x3f7baccd, 0xbe3b6ecf, 0x3f7a1e84, 0xbe5a3997
.long 0x3f800000, 0x00000000, 0x3f7fdaaf, 0xbd0a342f, 0x3f7f6ac7, 0xbd8a200a, 0x3f7eb069, 0xbdcefdb7
.long 0x3f7dabcc, 0xbe09cf86, 0x3f7c5d3a, 0xbe2bf804, 0x3f7ac516, 0xbe4dee60, 0x3f78e3d6, 0xbe6fa8b2
.long 0x3f800000, 0x00000000, 0x3f7fd397, 0xbd16c32c, 0x3f7f4e6d, 0xbd96a905, 0x3f7e70b0, 0xbde1bc2e
.long 0x3f7d3aac, 0xbe164083, 0x3f7baccd, 0xbe3b6ecf, 0x3f79c79d, 0xbe605c13, 0x3f778bc5, 0xbe827dc0
.long 0x3f800000, 0x00000000, 0x3f7fcbe2, 0xbd2351cb, 0x3f7f2f9d, 0xbda3308c, 0x3f7e2b72, 0xbdf475c0
.long 0x3f7cbfc9, 0xbe22abb6, 0x3f7aed37, 0xbe4ada4f, 0x3f78b47b, 0xbe72b651, 0x3f76167a, 0xbe8d17c0
.long 0x3f800000, 0x00000000, 0x3f7fc38f, 0xbd2fe007, 0x3f7f0e58, 0xbdafb680, 0x3f7de0b1, 0xbe039502
.long 0x3f7c3b28, 0xbe2f10a2, 0x3f7a1e84, 0xbe5a3997, 0x3f778bc5, 0xbe827dc0, 0x3f748422, 0xbe97a117
.long 0x3f800000, 0x00000000, 0x3f7fba9e, 0xbd3c6dd5, 0x3f7eea9d, 0xbdbc3ac3, 0x3f7d906e, 0xbe0cec4a
.long 0x3f7baccd, 0xbe3b6ecf, 0x3f7940c0, 0xbe698bba, 0x3f764d97, 0xbe8b9507, 0x3f72d4eb, 0xbea21887
.long 0x3f800000, 0x00000000, 0x3f800000, 0x00000000, 0x3f800000, 0x00000000, 0x3f800000, 0x00000000
.long 0x3f800000, 0x00000000, 0x3f800000, 0x00000000, 0x3f800000, 0x00000000, 0x3f800000, 0x00000000
.long 0x3f7fec43, 0xbcc90ab0, 0x3f7fe705, 0xbce22a7a, 0x3f7fe129, 0xbcfb49ba, 0x3f7fdaaf, 0xbd0a342f
.long 0x3f7fd397, 0xbd16c32c, 0x3f7fcbe2, 0xbd2351cb, 0x3f7fc38f, 0xbd2fe007, 0x3f7fba9e, 0xbd3c6dd5
.long 0x3f7fb10f, 0xbd48fb30, 0x3f7f9c18, 0xbd621469, 0x3f7f84ab, 0xbd7b2b74, 0x3f7f6ac7, 0xbd8a200a
.long 0x3f7f4e6d, 0xbd96a905, 0x3f7f2f9d, 0xbda3308c, 0x3f7f0e58, 0xbdafb680, 0x3f7eea9d, 0xbdbc3ac3
.long 0x3f7f4e6d, 0xbd96a905, 0x3f7f1f49, 0xbda973ba, 0x3f7eea9d, 0xbdbc3ac3, 0x3f7eb069, 0xbdcefdb7
.long 0x3f7e70b0, 0xbde1bc2e, 0x3f7e2b72, 0xbdf475c0, 0x3f7de0b1, 0xbe039502, 0x3f7d906e, 0xbe0cec4a
.long 0x3f7ec46d, 0xbdc8bd36, 0x3f7e70b0, 0xbde1bc2e, 0x3f7e1324, 0xbdfab273, 0x3f7dabcc, 0xbe09cf86
.long 0x3f7d3aac, 0xbe164083, 0x3f7cbfc9, 0xbe22abb6, 0x3f7c3b28, 0xbe2f10a2, 0x3f7baccd, 0xbe3b6ecf
.long 0x3f7e1324, 0xbdfab273, 0x3f7d906e, 0xbe0cec4a, 0x3f7cfe73, 0xbe1c76de, 0x3f7c5d3a, 0xbe2bf804
.long 0x3f7baccd, 0xbe3b6ecf, 0x3f7aed37, 0xbe4ada4f, 0x3f7a1e84, 0xbe5a3997, 0x3f7940c0, 0xbe698bba
.long 0x3f7d3aac, 0xbe164083, 0x3f7c7eb0, 0xbe28defc, 0x3f7baccd, 0xbe3b6ecf, 0x3f7ac516, 0xbe4dee60
.long 0x3f79c79d, 0xbe605c13, 0x3f78b47b, 0xbe72b651, 0x3f778bc5, 0xbe827dc0, 0x3f764d97, 0xbe8b9507
.long 0x3f7c3b28, 0xbe2f10a2, 0x3f7b3bab, 0xbe44b0b9, 0x3f7a1e84, 0xbe5a3997, 0x3f78e3d6, 0xbe6fa8b2
.long 0x3f778bc5, 0xbe827dc0, 0x3f76167a, 0xbe8d17c0, 0x3f748422, 0xbe97a117, 0x3f72d4eb, 0xbea21887
.long 0x3f7b14be, 0xbe47c5c2, 0x3f79c79d, 0xbe605c13, 0x3f7853f8, 0xbe78cfcc, 0x3f76ba07, 0xbe888e93
.long 0x3f74fa0b, 0xbe94a031, 0x3f731447, 0xbea09ae5, 0x3f710908, 0xbeac7cd4, 0x3f6ed89e, 0xbeb8442a
.long 0x3f79c79d, 0xbe605c13, 0x3f7822d1, 0xbe7bdba4, 0x3f764d97, 0xbe8b9507, 0x3f74484b, 0xbe9920fe
.long 0x3f721352, 0xbea68f12, 0x3f6faf1b, 0xbeb3dca5, 0x3f6d1c1d, 0xbec1071e, 0x3f6a5ad9, 0xbece0bea
.long 0x3f7853f8, 0xbe78cfcc, 0x3f764d97, 0xbe8b9507, 0x3f740bdd, 0xbe9aa086, 0x3f718f57, 0xbea986c4
.long 0x3f6ed89e, 0xbeb8442a, 0x3f6be858, 0xbec6d529, 0x3f68bf3c, 0xbed53641, 0x3f655e0b, 0xbee363fa
.long 0x3f76ba07, 0xbe888e93, 0x3f74484b, 0xbe9920fe, 0x3f718f57, 0xbea986c4, 0x3f6e8ff8, 0xbeb9bb1e
.long 0x3f6b4b0c, 0xbec9b953, 0x3f67c187, 0xbed97cb9, 0x3f63f473, 0xbee900b7, 0x3f5fe4e9, 0xbef840c8
.long 0x3f74fa0b, 0xbe94a031, 0x3f721352, 0xbea68f12, 0x3f6ed89e, 0xbeb8442a, 0x3f6b4b0c, 0xbec9b953
.long 0x3f676bd8, 0xbedae880, 0x3f633c5a, 0xbeebcbbb, 0x3f5ebe05, 0xbefc5d27, 0x3f59f26a, 0xbf064b82
.long 0x3f731447, 0xbea09ae5, 0x3f6faf1b, 0xbeb3dca5, 0x3f6be858, 0xbec6d529, 0x3f67c187, 0xbed97cb9
.long 0x3f633c5a, 0xbeebcbbb, 0x3f5e5aa6, 0xbefdbabb, 0x3f591e6a, 0xbf07a136, 0x3f5389c7, 0xbf102dd5
.long 0x3f710908, 0xbeac7cd4, 0x3f6d1c1d, 0xbec1071e, 0x3f68bf3c, 0xbed53641, 0x3f63f473, 0xbee900b7
.long 0x3f5ebe05, 0xbefc5d27, 0x3f591e6a, 0xbf07a136, 0x3f531849, 0xbf10d3cd, 0x3f4cae79, 0xbf19c200
.long 0x3f6ed89e, 0xbeb8442a, 0x3f6a5ad9, 0xbece0bea, 0x3f655e0b, 0xbee363fa, 0x3f5fe4e9, 0xbef840c8
.long 0x3f59f26a, 0xbf064b82, 0x3f5389c7, 0xbf102dd5, 0x3f4cae79, 0xbf19c200, 0x3f456439, 0xbf2302d3
.long 0x3f800000, 0x00000000, 0x3f800000, 0x00000000, 0x3f800000, 0x00000000, 0x3f800000, 0x00000000
.long 0x3f800000, 0x00000000, 0x3f800000, 0x00000000, 0x3f800000, 0x00000000, 0x3f800000, 0x00000000
.long 0x3f7fb10f, 0xbd48fb30, 0x3f7fa6e3, 0xbd55880e, 0x3f7f9c18, 0xbd621469, 0x3f7f90b1, 0xbd6ea038
.long 0x3f7f84ab, 0xbd7b2b74, 0x3f7f7808, 0xbd83db0a, 0x3f7f6ac7, 0xbd8a200a, 0x3f7f5ce9, 0xbd9064b4
.long 0x3f7ec46d, 0xbdc8bd36, 0x3f7e9bc9, 0xbdd53db9, 0x3f7e70b0, 0xbde1bc2e, 0x3f7e4323, 0xbdee3876
.long 0x3f7e1324, 0xbdfab273, 0x3f7de0b1, 0xbe039502, 0x3f7dabcc, 0xbe09cf86, 0x3f7d7474, 0xbe1008b7
.long 0x3f7d3aac, 0xbe164083, 0x3f7cdf6c, 0xbe1f917b, 0x3f7c7eb0, 0xbe28defc, 0x3f7c187a, 0xbe3228d4
.long 0x3f7baccd, 0xbe3b6ecf, 0x3f7b3bab, 0xbe44b0b9, 0x3f7ac516, 0xbe4dee60, 0x3f7a4910, 0xbe57278f
.long 0x3f7b14be, 0xbe47c5c2, 0x3f7a7302, 0xbe541501, 0x3f79c79d, 0xbe605c13, 0x3f791298, 0xbe6c9a7f
.long 0x3f7853f8, 0xbe78cfcc, 0x3f778bc5, 0xbe827dc0, 0x3f76ba07, 0xbe888e93, 0x3f75dec6, 0xbe8e9a22
.long 0x3f7853f8, 0xbe78cfcc, 0x3f77583a, 0xbe840270, 0x3f764d97, 0xbe8b9507, 0x3f75341d, 0xbe931f35
.long 0x3f740bdd, 0xbe9aa086, 0x3f72d4eb, 0xbea21887, 0x3f718f57, 0xbea986c4, 0x3f703b37, 0xbeb0eacb
.long 0x3f74fa0b, 0xbe94a031, 0x3f73913f, 0xbe9d9e78, 0x3f721352, 0xbea68f12, 0x3f708066, 0xbeaf713a
.long 0x3f6ed89e, 0xbeb8442a, 0x3f6d1c1d, 0xbec1071e, 0x3f6b4b0c, 0xbec9b953, 0x3f696591, 0xbed25a09
.long 0x3f710908, 0xbeac7cd4, 0x3f6f20b0, 0xbeb6ccc3, 0x3f6d1c1d, 0xbec1071e, 0x3f6afb8c, 0xbecb2aae
.long 0x3f68bf3c, 0xbed53641, 0x3f666771, 0xbedf28a9, 0x3f63f473, 0xbee900b7, 0x3f61668a, 0xbef2bd43
.long 0x3f6c835e, 0xbec3ef15, 0x3f6a09a7, 0xbecf7bca, 0x3f676bd8, 0xbedae880, 0x3f64aa59, 0xbee63375
.long 0x3f61c598, 0xbef15aea, 0x3f5ebe05, 0xbefc5d27, 0x3f5b941a, 0xbf039c3d, 0x3f584853, 0xbf08f59b
.long 0x3f676bd8, 0xbedae880, 0x3f644fac, 0xbee79a5d, 0x3f6106f2, 0xbef41f07, 0x3f5d924d, 0xbf003a06
.long 0x3f59f26a, 0xbf064b82, 0x3f5627fe, 0xbf0c42c9, 0x3f5233c6, 0xbf121eb0, 0x3f4e1689, 0xbf17de12
.long 0x3f61c598, 0xbef15aea, 0x3f5df6be, 0xbeff17b2, 0x3f59f26a, 0xbf064b82, 0x3f55b993, 0xbf0cead0
.long 0x3f514d3d, 0xbf13682a, 0x3f4cae79, 0xbf19c200, 0x3f47de65, 0xbf1ff6cb, 0x3f42de29, 0xbf26050a
.long 0x3f5b941a, 0xbf039c3d, 0x3f570348, 0xbf0af1b7, 0x3f5233c6, 0xbf121eb0, 0x3f4d26fd, 0xbf19210f
.long 0x3f47de65, 0xbf1ff6cb, 0x3f425b89, 0xbf269de3, 0x3f3ca003, 0xbf2d1469, 0x3f36ad7f, 0xbf33587a
.long 0x3f54db31, 0xbf0e39da, 0x3f4f7a1f, 0xbf15f6d9, 0x3f49d112, 0xbf1d7fd1, 0x3f43e200, 0xbf24d225
.long 0x3f3daef9, 0xbf2beb4a, 0x3f373a23, 0xbf32c8c9, 0x3f3085bb, 0xbf396842, 0x3f299415, 0xbf3fc767
.long 0x3f4d9f02, 0xbf187fc0, 0x3f476085, 0xbf209393, 0x3f40d0da, 0xbf286605, 0x3f39f2ac, 0xbf2ff3e6
.long 0x3f32c8c9, 0xbf373a23, 0x3f2b561b, 0xbf3e35c5, 0x3f239da9, 0xbf44e3f5, 0x3f1ba299, 0xbf4b41fa
.long 0x3f45e403, 0xbf226799, 0x3f3ebc1b, 0xbf2ac082, 0x3f373a23, 0xbf32c8c9, 0x3f2f61a5, 0xbf3a7ca4
.long 0x3f273656, 0xbf41d870, 0x3f1ebc12, 0xbf48d8b3, 0x3f15f6d9, 0xbf4f7a1f, 0x3f0cead0, 0xbf55b993
.long 0x3f3daef9, 0xbf2beb4a, 0x3f3592e7, 0xbf34768f, 0x3f2d1469, 0xbf3ca003, 0x3f24381a, 0xbf446337
.long 0x3f1b02c6, 0xbf4bbbf8, 0x3f11796b, 0xbf52a649, 0x3f07a136, 0xbf591e6a, 0x3efafef7, 0xbf5f20db
.long 0x3f800000, 0x00000000, 0x3f800000, 0x00000000, 0x3f800000, 0x00000000, 0x3f800000, 0x00000000
.long 0x3f800000, 0x00000000, 0x3f800000, 0x00000000, 0x3f800000, 0x00000000, 0x3f800000, 0x00000000
.long 0x3f7f4e6d, 0xbd96a905, 0x3f7f3f54, 0xbd9cecf9, 0x3f7f2f9d, 0xbda3308c, 0x3f7f1f49, 0xbda973ba
.long 0x3f7f0e58, 0xbdafb680, 0x3f7efcc9, 0xbdb5f8da, 0x3f7eea9d, 0xbdbc3ac3, 0x3f7ed7d4, 0xbdc27c39
.long 0x3f7d3aac, 0xbe164083, 0x3f7cfe73, 0xbe1c76de, 0x3f7cbfc9, 0xbe22abb6, 0x3f7c7eb0, 0xbe28defc
.long 0x3f7c3b28, 0xbe2f10a2, 0x3f7bf531, 0xbe354098, 0x3f7baccd, 0xbe3b6ecf, 0x3f7b61fc, 0xbe419b37
.long 0x3f79c79d, 0xbe605c13, 0x3f7940c0, 0xbe698bba, 0x3f78b47b, 0xbe72b651, 0x3f7822d1, 0xbe7bdba4
.long 0x3f778bc5, 0xbe827dc0, 0x3f76ef5b, 0xbe870ada, 0x3f764d97, 0xbe8b9507, 0x3f75a67b, 0xbe901c2c
.long 0x3f74fa0b, 0xbe94a031, 0x3f740bdd, 0xbe9aa086, 0x3f731447, 0xbea09ae5, 0x3f721352, 0xbea68f12
.long 0x3f710908, 0xbeac7cd4, 0x3f6ff573, 0xbeb263ef, 0x3f6ed89e, 0xbeb8442a, 0x3f6db293, 0xbebe1d4a
.long 0x3f6ed89e, 0xbeb8442a, 0x3f6d67a1, 0xbebf926f, 0x3f6be858, 0xbec6d529, 0x3f6a5ad9, 0xbece0bea
.long 0x3f68bf3c, 0xbed53641, 0x3f671599, 0xbedc53c1, 0x3f655e0b, 0xbee363fa, 0x3f6398ac, 0xbeea6681
.long 0x3f676bd8, 0xbedae880, 0x3f655e0b, 0xbee363fa, 0x3f633c5a, 0xbeebcbbb, 0x3f6106f2, 0xbef41f07
.long 0x3f5ebe05, 0xbefc5d27, 0x3f5c61c7, 0xbf0242b1, 0x3f59f26a, 0xbf064b82, 0x3f577026, 0xbf0a48ad
.long 0x3f5ebe05, 0xbefc5d27, 0x3f5bfb34, 0xbf02ef9f, 0x3f591e6a, 0xbf07a136, 0x3f5627fe, 0xbf0c42c9
.long 0x3f531849, 0xbf10d3cd, 0x3f4fefa8, 0xbf1553b7, 0x3f4cae79, 0xbf19c200, 0x3f495521, 0xbf1e1e22
.long 0x3f54db31, 0xbf0e39da, 0x3f514d3d, 0xbf13682a, 0x3f4d9f02, 0xbf187fc0, 0x3f49d112, 0xbf1d7fd1
.long 0x3f45e403, 0xbf226799, 0x3f41d870, 0xbf273656, 0x3f3daef9, 0xbf2beb4a, 0x3f396842, 0xbf3085bb
.long 0x3f49d112, 0xbf1d7fd1, 0x3f456439, 0xbf2302d3, 0x3f40d0da, 0xbf286605, 0x3f3c17d9, 0xbf2da859
.long 0x3f373a23, 0xbf32c8c9, 0x3f3238aa, 0xbf37c655, 0x3f2d1469, 0xbf3ca003, 0x3f27ce61, 0xbf4154e1
.long 0x3f3daef9, 0xbf2beb4a, 0x3f385216, 0xbf31a81d, 0x3f32c8c9, 0xbf373a23, 0x3f2d1469, 0xbf3ca003
.long 0x3f273656, 0xbf41d870, 0x3f212ff9, 0xbf46e22a, 0x3f1b02c6, 0xbf4bbbf8, 0x3f14b039, 0xbf5064af
.long 0x3f3085bb, 0xbf396842, 0x3f2a2a80, 0xbf3f41fc, 0x3f239da9, 0xbf44e3f5, 0x3f1ce11f, 0xbf4a4c87
.long 0x3f15f6d9, 0xbf4f7a1f, 0x3f0ee0db, 0xbf546b3b, 0x3f07a136, 0xbf591e6a, 0x3f003a06, 0xbf5d924d
.long 0x3f226799, 0xbf45e403, 0x3f1b02c6, 0xbf4bbbf8, 0x3f13682a, 0xbf514d3d, 0x3f0b9a6b, 0xbf5695e5
.long 0x3f039c3d, 0xbf5b941a, 0x3ef6e0cb, 0xbf604621, 0x3ee63375, 0xbf64aa59, 0x3ed53641, 0xbf68bf3c
.long 0x3f13682a, 0xbf514d3d, 0x3f0af1b7, 0xbf570348, 0x3f0242b1, 0xbf5c61c7, 0x3ef2bd43, 0xbf61668a
.long 0x3ee0924f, 0xbf660f88, 0x3ece0bea, 0xbf6a5ad9, 0x3ebb31a0, 0xbf6e46be, 0x3ea80b1f, 0xbf71d19f
.long 0x3f039c3d, 0xbf5b941a, 0x3ef41f07, 0xbf6106f2, 0x3ee0924f, 0xbf660f88, 0x3ecc9b8b, 0xbf6aab7b
.long 0x3eb8442a, 0xbf6ed89e, 0x3ea395c5, 0xbf7294f8, 0x3e8e9a22, 0xbf75dec6, 0x3e72b651, 0xbf78b47b
.long 0x3ee63375, 0xbf64aa59, 0x3ed0eb2a, 0xbf69b7e4, 0x3ebb31a0, 0xbf6e46be, 0x3ea5129f, 0xbf725470
.long 0x3e8e9a22, 0xbf75dec6, 0x3e6fa8b2, 0xbf78e3d6, 0x3e419b37, 0xbf7b61fc, 0x3e1324ca, 0xbf7d57de
.long 0x3f800000, 0x00000000, 0x3f800000, 0x00000000, 0x3f800000, 0x00000000, 0x3f800000, 0x00000000
.long 0x3f800000, 0x00000000, 0x3f800000, 0x00000000, 0x3f800000, 0x00000000, 0x3f800000, 0x00000000
.long 0x3f7ec46d, 0xbdc8bd36, 0x3f7eb069, 0xbdcefdb7, 0x3f7e9bc9, 0xbdd53db9, 0x3f7e868b, 0xbddb7d37
.long 0x3f7e70b0, 0xbde1bc2e, 0x3f7e5a38, 0xbde7fa9a, 0x3f7e4323, 0xbdee3876, 0x3f7e2b72, 0xbdf475c0
.long 0x3f7b14be, 0xbe47c5c2, 0x3f7ac516, 0xbe4dee60, 0x3f7a7302, 0xbe541501, 0x3f7a1e84, 0xbe5a3997
.long 0x3f79c79d, 0xbe605c13, 0x3f796e4e, 0xbe667c66, 0x3f791298, 0xbe6c9a7f, 0x3f78b47b, 0xbe72b651
.long 0x3f74fa0b, 0xbe94a031, 0x3f74484b, 0xbe9920fe, 0x3f73913f, 0xbe9d9e78, 0x3f72d4eb, 0xbea21887
.long 0x3f721352, 0xbea68f12, 0x3f714c7a, 0xbeab0201, 0x3f708066, 0xbeaf713a, 0x3f6faf1b, 0xbeb3dca5
.long 0x3f6c835e, 0xbec3ef15, 0x3f6b4b0c, 0xbec9b953, 0x3f6a09a7, 0xbecf7bca, 0x3f68bf3c, 0xbed53641
.long 0x3f676bd8, 0xbedae880, 0x3f660f88, 0xbee0924f, 0x3f64aa59, 0xbee63375, 0x3f633c5a, 0xbeebcbbb
.long 0x3f61c598, 0xbef15aea, 0x3f5fe4e9, 0xbef840c8, 0x3f5df6be, 0xbeff17b2, 0x3f5bfb34, 0xbf02ef9f
.long 0x3f59f26a, 0xbf064b82, 0x3f57dc7f, 0xbf099f4e, 0x3f55b993, 0xbf0cead0, 0x3f5389c7, 0xbf102dd5
.long 0x3f54db31, 0xbf0e39da, 0x3f5233c6, 0xbf121eb0, 0x3f4f7a1f, 0xbf15f6d9, 0x3f4cae79, 0xbf19c200
.long 0x3f49d112, 0xbf1d7fd1, 0x3f46e22a, 0xbf212ff9, 0x3f43e200, 0xbf24d225, 0x3f40d0da, 0xbf286605
.long 0x3f45e403, 0xbf226799, 0x3f425b89, 0xbf269de3, 0x3f3ebc1b, 0xbf2ac082, 0x3f3b0629, 0xbf2ecef7
.long 0x3f373a23, 0xbf32c8c9, 0x3f33587a, 0xbf36ad7f, 0x3f2f61a5, 0xbf3a7ca4, 0x3f2b561b, 0xbf3e35c5
.long 0x3f3504f3, 0xbf3504f3, 0x3f3085bb, 0xbf396842, 0x3f2beb4a, 0xbf3daef9, 0x3f273656, 0xbf41d870
.long 0x3f226799, 0xbf45e403, 0x3f1d7fd1, 0xbf49d112, 0x3f187fc0, 0xbf4d9f02, 0x3f13682a, 0xbf514d3d
.long 0x3f226799, 0xbf45e403, 0x3f1ce11f, 0xbf4a4c87, 0x3f173c07, 0xbf4e8d90, 0x3f11796b, 0xbf52a649
.long 0x3f0b9a6b, 0xbf5695e5, 0x3f05a02c, 0xbf5a5ba0, 0x3eff17b2, 0xbf5df6be, 0x3ef2bd43, 0xbf61668a
.long 0x3f0e39da, 0xbf54db31, 0x3f07a136, 0xbf591e6a, 0x3f00e7e4, 0xbf5d2d53, 0x3ef41f07, 0xbf6106f2
.long 0x3ee63375, 0xbf64aa59, 0x3ed8106b, 0xbf6816a8, 0x3ec9b953, 0xbf6b4b0c, 0x3ebb31a0, 0xbf6e46be
.long 0x3ef15aea, 0xbf61c598, 0x3ee1fb6a, 0xbf65b710, 0x3ed25a09, 0xbf696591, 0x3ec27b55, 0xbf6cd007
.long 0x3eb263ef, 0xbf6ff573, 0x3ea21887, 0xbf72d4eb, 0x3e919ddd, 0xbf756d97, 0x3e80f8c0, 0xbf77beb7
.long 0x3ec3ef15, 0xbf6c835e, 0x3eb263ef, 0xbf6ff573, 0x3ea09ae5, 0xbf731447, 0x3e8e9a22, 0xbf75dec6
.long 0x3e78cfcc, 0xbf7853f8, 0x3e541501, 0xbf7a7302, 0x3e2f10a2, 0xbf7c3b28, 0x3e09cf86, 0xbf7dabcc
.long 0x3e94a031, 0xbf74fa0b, 0x3e80f8c0, 0xbf77beb7, 0x3e5a3997, 0xbf7a1e84, 0x3e3228d4, 0xbf7c187a
.long 0x3e09cf86, 0xbf7dabcc, 0x3dc27c39, 0xbf7ed7d4, 0x3d621469, 0xbf7f9c18, 0x3c7b514b, 0xbf7ff84a
.long 0x3e47c5c2, 0xbf7b14be, 0x3e1c76de, 0xbf7cfe73, 0x3de1bc2e, 0xbf7e70b0, 0x3d8a200a, 0xbf7f6ac7
.long 0x3cc90ab0, 0xbf7fec43, 0xbc96c9b6, 0xbf7ff4e6, 0xbd7b2b74, 0xbf7f84ab, 0xbdd53db9, 0xbf7e9bc9
.long 0x3dc8bd36, 0xbf7ec46d, 0x3d55880e, 0xbf7fa6e3, 0x3bc90f88, 0xbf7ffec4, 0xbd2351cb, 0xbf7fcbe2
.long 0xbdafb680, 0xbf7f0e58, 0xbe06b26e, 0xbf7dc68c, 0xbe354098, 0xbf7bf531, 0xbe636c83, 0xbf799b43
.long 0x3f800000, 0x00000000, 0x3f800000, 0x00000000, 0x3f800000, 0x00000000, 0x3f800000, 0x00000000
.long 0x3f800000, 0x00000000, 0x3f800000, 0x00000000, 0x3f800000, 0x00000000, 0x3f800000, 0x00000000
.long 0x3f7e1324, 0xbdfab273, 0x3f7dfa38, 0xbe007745, 0x3f7de0b1, 0xbe039502, 0x3f7dc68c, 0xbe06b26e
.long 0x3f7dabcc, 0xbe09cf86, 0x3f7d906e, 0xbe0cec4a, 0x3f7d7474, 0xbe1008b7, 0x3f7d57de, 0xbe1324ca
.long 0x3f7853f8, 0xbe78cfcc, 0x3f77f110, 0xbe7ee6e1, 0x3f778bc5, 0xbe827dc0, 0x3f772417, 0xbe8586ce
.long 0x3f76ba07, 0xbe888e93, 0x3f764d97, 0xbe8b9507, 0x3f75dec6, 0xbe8e9a22, 0x3f756d97, 0xbe919ddd
.long 0x3f6ed89e, 0xbeb8442a, 0x3f6dfcf2, 0xbebca7af, 0x3f6d1c1d, 0xbec1071e, 0x3f6c3624, 0xbec5625c
.long 0x3f6b4b0c, 0xbec9b953, 0x3f6a5ad9, 0xbece0bea, 0x3f696591, 0xbed25a09, 0x3f686b39, 0xbed6a399
.long 0x3f61c598, 0xbef15aea, 0x3f604621, 0xbef6e0cb, 0x3f5ebe05, 0xbefc5d27, 0x3f5d2d53, 0xbf00e7e4
.long 0x3f5b941a, 0xbf039c3d, 0x3f59f26a, 0xbf064b82, 0x3f584853, 0xbf08f59b, 0x3f5695e5, 0xbf0b9a6b
.long 0x3f514d3d, 0xbf13682a, 0x3f4f0417, 0xbf16999f, 0x3f4cae79, 0xbf19c200, 0x3f4a4c87, 0xbf1ce11f
.long 0x3f47de65, 0xbf1ff6cb, 0x3f456439, 0xbf2302d3, 0x3f42de29, 0xbf26050a, 0x3f404c5c, 0xbf28fd41
.long 0x3f3daef9, 0xbf2beb4a, 0x3f3a7ca4, 0xbf2f61a5, 0x3f373a23, 0xbf32c8c9, 0x3f33e7bc, 0xbf36206c
.long 0x3f3085bb, 0xbf396842, 0x3f2d1469, 0xbf3ca003, 0x3f299415, 0xbf3fc767, 0x3f26050a, 0xbf42de29
.long 0x3f273656, 0xbf41d870, 0x3f2302d3, 0xbf456439, 0x3f1ebc12, 0xbf48d8b3, 0x3f1a6293, 0xbf4c3578
.long 0x3f15f6d9, 0xbf4f7a1f, 0x3f11796b, 0xbf52a649, 0x3f0cead0, 0xbf55b993, 0x3f084b92, 0xbf58b3a1
.long 0x3f0e39da, 0xbf54db31, 0x3f08f59b, 0xbf584853, 0x3f039c3d, 0xbf5b941a, 0x3efc5d27, 0xbf5ebe05
.long 0x3ef15aea, 0xbf61c598, 0x3ee63375, 0xbf64aa59, 0x3edae880, 0xbf676bd8, 0x3ecf7bca, 0xbf6a09a7
.long 0x3ee63375, 0xbf64aa59, 0x3ed97cb9, 0xbf67c187, 0x3ecc9b8b, 0xbf6aab7b, 0x3ebf926f, 0xbf6d67a1
.long 0x3eb263ef, 0xbf6ff573, 0x3ea5129f, 0xbf725470, 0x3e97a117, 0xbf748422, 0x3e8a11f7, 0xbf76841b
.long 0x3eac7cd4, 0xbf710908, 0x3e9d9e78, 0xbf73913f, 0x3e8e9a22, 0xbf75dec6, 0x3e7ee6e1, 0xbf77f110
.long 0x3e605c13, 0xbf79c79d, 0x3e419b37, 0xbf7b61fc, 0x3e22abb6, 0xbf7cbfc9, 0x3e039502, 0xbf7de0b1
.long 0x3e605c13, 0xbf79c79d, 0x3e3e853e, 0xbf7b87b2, 0x3e1c76de, 0xbf7cfe73, 0x3df475c0, 0xbf7e2b72
.long 0x3dafb680, 0xbf7f0e58, 0x3d55880e, 0xbf7fa6e3, 0x3c96c9b6, 0xbf7ff4e6, 0xbc7b514b, 0xbf7ff84a
.long 0x3dc8bd36, 0xbf7ec46d, 0x3d7b2b74, 0xbf7f84ab, 0x3cc90ab0, 0xbf7fec43, 0xbc490e90, 0xbf7ffb11
.long 0xbd48fb30, 0xbf7fb10f, 0xbdafb680, 0xbf7f0e58, 0xbdfab273, 0xbf7e1324, 0xbe22abb6, 0xbf7cbfc9
.long 0xbcc90ab0, 0xbf7fec43, 0xbd83db0a, 0xbf7f7808, 0xbdd53db9, 0xbf7e9bc9, 0xbe1324ca, 0xbf7d57de
.long 0xbe3b6ecf, 0xbf7baccd, 0xbe636c83, 0xbf799b43, 0xbe8586ce, 0xbf772417, 0xbe9920fe, 0xbf74484b
.long 0xbe164083, 0xbf7d3aac, 0xbe419b37, 0xbf7b61fc, 0xbe6c9a7f, 0xbf791298, 0xbe8b9507, 0xbf764d97
.long 0xbea09ae5, 0xbf731447, 0xbeb554ec, 0xbf6f6830, 0xbec9b953, 0xbf6b4b0c, 0xbeddbe79, 0xbf66becc
.long 0xbe888e93, 0xbf76ba07, 0xbe9f1cdf, 0xbf73530e, 0xbeb554ec, 0xbf6f6830, 0xbecb2aae, 0xbf6afb8c
.long 0xbee0924f, 0xbf660f88, 0xbef58035, 0xbf60a6cf, 0xbf04f484, 0xbf5ac450, 0xbf0ee0db, 0xbf546b3b
.long 0x3f800000, 0x00000000, 0x3f800000, 0x00000000, 0x3f800000, 0x00000000, 0x3f800000, 0x00000000
.long 0x3f800000, 0x00000000, 0x3f800000, 0x00000000, 0x3f800000, 0x00000000, 0x3f800000, 0x00000000
.long 0x3f7d3aac, 0xbe164083, 0x3f7d1cdd, 0xbe195be0, 0x3f7cfe73, 0xbe1c76de, 0x3f7cdf6c, 0xbe1f917b
.long 0x3f7cbfc9, 0xbe22abb6, 0x3f7c9f8a, 0xbe25c58c, 0x3f7c7eb0, 0xbe28defc, 0x3f7c5d3a, 0xbe2bf804
.long 0x3f74fa0b, 0xbe94a031, 0x3f748422, 0xbe97a117, 0x3f740bdd, 0xbe9aa086, 0x3f73913f, 0xbe9d9e78
.long 0x3f731447, 0xbea09ae5, 0x3f7294f8, 0xbea395c5, 0x3f721352, 0xbea68f12, 0x3f718f57, 0xbea986c4
.long 0x3f676bd8, 0xbedae880, 0x3f666771, 0xbedf28a9, 0x3f655e0b, 0xbee363fa, 0x3f644fac, 0xbee79a5d
.long 0x3f633c5a, 0xbeebcbbb, 0x3f62241a, 0xbeeff7fb, 0x3f6106f2, 0xbef41f07, 0x3f5fe4e9, 0xbef840c8
.long 0x3f54db31, 0xbf0e39da, 0x3f531849, 0xbf10d3cd, 0x3f514d3d, 0xbf13682a, 0x3f4f7a1f, 0xbf15f6d9
.long 0x3f4d9f02, 0xbf187fc0, 0x3f4bbbf8, 0xbf1b02c6, 0x3f49d112, 0xbf1d7fd1, 0x3f47de65, 0xbf1ff6cb
.long 0x3f3daef9, 0xbf2beb4a, 0x3f3b0629, 0xbf2ecef7, 0x3f385216, 0xbf31a81d, 0x3f3592e7, 0xbf34768f
.long 0x3f32c8c9, 0xbf373a23, 0x3f2ff3e6, 0xbf39f2ac, 0x3f2d1469, 0xbf3ca003, 0x3f2a2a80, 0xbf3f41fc
.long 0x3f226799, 0xbf45e403, 0x3f1ebc12, 0xbf48d8b3, 0x3f1b02c6, 0xbf4bbbf8, 0x3f173c07, 0xbf4e8d90
.long 0x3f13682a, 0xbf514d3d, 0x3f0f8784, 0xbf53fac3, 0x3f0b9a6b, 0xbf5695e5, 0x3f07a136, 0xbf591e6a
.long 0x3f039c3d, 0xbf5b941a, 0x3efdbabb, 0xbf5e5aa6, 0x3ef41f07, 0xbf6106f2, 0x3eea6681, 0xbf6398ac
.long 0x3ee0924f, 0xbf660f88, 0x3ed6a399, 0xbf686b39, 0x3ecc9b8b, 0xbf6aab7b, 0x3ec27b55, 0xbf6cd007
.long 0x3ec3ef15, 0xbf6c835e, 0x3eb8442a, 0xbf6ed89e, 0x3eac7cd4, 0xbf710908, 0x3ea09ae5, 0xbf731447
.long 0x3e94a031, 0xbf74fa0b, 0x3e888e93, 0xbf76ba07, 0x3e78cfcc, 0xbf7853f8, 0x3e605c13, 0xbf79c79d
.long 0x3e78cfcc, 0xbf7853f8, 0x3e5d4b1a, 0xbf79f35e, 0x3e419b37, 0xbf7b61fc, 0x3e25c58c, 0xbf7c9f8a
.long 0x3e09cf86, 0xbf7dabcc, 0x3ddb7d37, 0xbf7e868b, 0x3da3308c, 0xbf7f2f9d, 0x3d55880e, 0xbf7fa6e3
.long 0x3dc8bd36, 0xbf7ec46d, 0x3d8a200a, 0xbf7f6ac7, 0x3d16c32c, 0xbf7fd397, 0x3bc90f88, 0xbf7ffec4
.long 0xbcc90ab0, 0xbf7fec43, 0xbd621469, 0xbf7f9c18, 0xbdafb680, 0xbf7f0e58, 0xbdee3876, 0xbf7e4323
.long 0xbd48fb30, 0xbf7fb10f, 0xbda973ba, 0xbf7f1f49, 0xbdee3876, 0xbf7e4323, 0xbe195be0, 0xbf7d1cdd
.long 0xbe3b6ecf, 0xbf7baccd, 0xbe5d4b1a, 0xbf79f35e, 0xbe7ee6e1, 0xbf77f110, 0xbe901c2c, 0xbf75a67b
.long 0xbe47c5c2, 0xbf7b14be, 0xbe6c9a7f, 0xbf791298, 0xbe888e93, 0xbf76ba07, 0xbe9aa086, 0xbf740bdd
.long 0xbeac7cd4, 0xbf710908, 0xbebe1d4a, 0xbf6db293, 0xbecf7bca, 0xbf6a09a7, 0xbee0924f, 0xbf660f88
.long 0xbeac7cd4, 0xbf710908, 0xbebf926f, 0xbf6d67a1, 0xbed25a09, 0xbf696591, 0xbee4cbfe, 0xbf650479
.long 0xbef6e0cb, 0xbf604621, 0xbf044889, 0xbf5b2c79, 0xbf0cead0, 0xbf55b993, 0xbf1553b7, 0xbf4fefa8
.long 0xbef15aea, 0xbf61c598, 0xbf0242b1, 0xbf5c61c7, 0xbf0b9a6b, 0xbf5695e5, 0xbf14b039, 0xbf5064af
.long 0xbf1d7fd1, 0xbf49d112, 0xbf26050a, 0xbf42de29, 0xbf2e3bde, 0xbf3b8f3b, 0xbf36206c, 0xbf33e7bc
.long 0xbf187fc0, 0xbf4d9f02, 0xbf21cbfb, 0xbf466354, 0xbf2ac082, 0xbf3ebc1b, 0xbf33587a, 0xbf36ad7f
.long 0xbf3b8f3b, 0xbf2e3bde, 0xbf436051, 0xbf256bcb, 0xbf4ac77f, 0xbf1c420c, 0xbf51c0c2, 0xbf12c39a
.long 0x3f800000, 0x00000000, 0x3f800000, 0x00000000, 0x3f800000, 0x00000000, 0x3f800000, 0x00000000
.long 0x3f800000, 0x00000000, 0x3f800000, 0x00000000, 0x3f800000, 0x00000000, 0x3f800000, 0x00000000
.long 0x3f7c3b28, 0xbe2f10a2, 0x3f7c187a, 0xbe3228d4, 0x3f7bf531, 0xbe354098, 0x3f7bd14d, 0xbe3857ec
.long 0x3f7baccd, 0xbe3b6ecf, 0x3f7b87b2, 0xbe3e853e, 0x3f7b61fc, 0xbe419b37, 0x3f7b3bab, 0xbe44b0b9
.long 0x3f710908, 0xbeac7cd4, 0x3f708066, 0xbeaf713a, 0x3f6ff573, 0xbeb263ef, 0x3f6f6830, 0xbeb554ec
.long 0x3f6ed89e, 0xbeb8442a, 0x3f6e46be, 0xbebb31a0, 0x3f6db293, 0xbebe1d4a, 0x3f6d1c1d, 0xbec1071e
.long 0x3f5ebe05, 0xbefc5d27, 0x3f5d924d, 0xbf003a06, 0x3f5c61c7, 0xbf0242b1, 0x3f5b2c79, 0xbf044889
.long 0x3f59f26a, 0xbf064b82, 0x3f58b3a1, 0xbf084b92, 0x3f577026, 0xbf0a48ad, 0x3f5627fe, 0xbf0c42c9
.long 0x3f45e403, 0xbf226799, 0x3f43e200, 0xbf24d225, 0x3f41d870, 0xbf273656, 0x3f3fc767, 0xbf299415
.long 0x3f3daef9, 0xbf2beb4a, 0x3f3b8f3b, 0xbf2e3bde, 0x3f396842, 0xbf3085bb, 0x3f373a23, 0xbf32c8c9
.long 0x3f273656, 0xbf41d870, 0x3f24381a, 0xbf446337, 0x3f212ff9, 0xbf46e22a, 0x3f1e1e22, 0xbf495521
.long 0x3f1b02c6, 0xbf4bbbf8, 0x3f17de12, 0xbf4e1689, 0x3f14b039, 0xbf5064af, 0x3f11796b, 0xbf52a649
.long 0x3f039c3d, 0xbf5b941a, 0x3eff17b2, 0xbf5df6be, 0x3ef6e0cb, 0xbf604621, 0x3eee9479, 0xbf628210
.long 0x3ee63375, 0xbf64aa59, 0x3eddbe79, 0xbf66becc, 0x3ed53641, 0xbf68bf3c, 0x3ecc9b8b, 0xbf6aab7b
.long 0x3eb8442a, 0xbf6ed89e, 0x3eadf73c, 0xbf70c501, 0x3ea395c5, 0xbf7294f8, 0x3e9920fe, 0xbf74484b
.long 0x3e8e9a22, 0xbf75dec6, 0x3e840270, 0xbf77583a, 0x3e72b651, 0xbf78b47b, 0x3e5d4b1a, 0xbf79f35e
.long 0x3e47c5c2, 0xbf7b14be, 0x3e2f10a2, 0xbf7c3b28, 0x3e164083, 0xbf7d3aac, 0x3dfab273, 0xbf7e1324
.long 0x3dc8bd36, 0xbf7ec46d, 0x3d96a905, 0xbf7f4e6d, 0x3d48fb30, 0xbf7fb10f, 0x3cc90ab0, 0xbf7fec43
.long 0x3cc90ab0, 0xbf7fec43, 0xbb490fc6, 0xbf7fffb1, 0xbcfb49ba, 0xbf7fe129, 0xbd6ea038, 0xbf7f90b1
.long 0xbdafb680, 0xbf7f0e58, 0xbde7fa9a, 0xbf7e5a38, 0xbe1008b7, 0xbf7d7474, 0xbe2bf804, 0xbf7c5d3a
.long 0xbe164083, 0xbf7d3aac, 0xbe354098, 0xbf7bf531, 0xbe541501, 0xbf7a7302, 0xbe72b651, 0xbf78b47b
.long 0xbe888e93, 0xbf76ba07, 0xbe97a117, 0xbf748422, 0xbea68f12, 0xbf721352, 0xbeb554ec, 0xbf6f6830
.long 0xbea09ae5, 0xbf731447, 0xbeb0eacb, 0xbf703b37, 0xbec1071e, 0xbf6d1c1d, 0xbed0eb2a, 0xbf69b7e4
.long 0xbee0924f, 0xbf660f88, 0xbeeff7fb, 0xbf62241a, 0xbeff17b2, 0xbf5df6be, 0xbf06f686, 0xbf5988ad
.long 0xbef15aea, 0xbf61c598, 0xbf00e7e4, 0xbf5d2d53, 0xbf08f59b, 0xbf584853, 0xbf10d3cd, 0xbf531849
.long 0xbf187fc0, 0xbf4d9f02, 0xbf1ff6cb, 0xbf47de65, 0xbf273656, 0xbf41d870, 0xbf2e3bde, 0xbf3b8f3b
.long 0xbf1d7fd1, 0xbf49d112, 0xbf256bcb, 0xbf436051, 0xbf2d1469, 0xbf3ca003, 0xbf34768f, 0xbf3592e7
.long 0xbf3b8f3b, 0xbf2e3bde, 0xbf425b89, 0xbf269de3, 0xbf48d8b3, 0xbf1ebc12, 0xbf4f0417, 0xbf16999f
.long 0xbf3daef9, 0xbf2beb4a, 0xbf44e3f5, 0xbf239da9, 0xbf4bbbf8, 0xbf1b02c6, 0xbf5233c6, 0xbf121eb0
.long 0xbf584853, 0xbf08f59b, 0xbf5df6be, 0xbeff17b2, 0xbf633c5a, 0xbeebcbbb, 0xbf6816a8, 0xbed8106b
.long 0xbf584853, 0xbf08f59b, 0xbf5e5aa6, 0xbefdbabb, 0xbf63f473, 0xbee900b7, 0xbf6912ae, 0xbed3c867
.long 0xbf6db293, 0xbebe1d4a, 0xbf71d19f, 0xbea80b1f, 0xbf756d97, 0xbe919ddd, 0xbf788486, 0xbe75c35a
.long 0x3f800000, 0x00000000, 0x3f800000, 0x00000000, 0x3f800000, 0x00000000, 0x3f800000, 0x00000000
.long 0x3f800000, 0x00000000, 0x3f800000, 0x00000000, 0x3f800000, 0x00000000, 0x3f800000, 0x00000000
.long 0x3f7b14be, 0xbe47c5c2, 0x3f7aed37, 0xbe4ada4f, 0x3f7ac516, 0xbe4dee60, 0x3f7a9c59, 0xbe5101f1
.long 0x3f7a7302, 0xbe541501, 0x3f7a4910, 0xbe57278f, 0x3f7a1e84, 0xbe5a3997, 0x3f79f35e, 0xbe5d4b1a
.long 0x3f6c835e, 0xbec3ef15, 0x3f6be858, 0xbec6d529, 0x3f6b4b0c, 0xbec9b953, 0x3f6aab7b, 0xbecc9b8b
.long 0x3f6a09a7, 0xbecf7bca, 0x3f696591, 0xbed25a09, 0x3f68bf3c, 0xbed53641, 0x3f6816a8, 0xbed8106b
.long 0x3f54db31, 0xbf0e39da, 0x3f5389c7, 0xbf102dd5, 0x3f5233c6, 0xbf121eb0, 0x3f50d937, 0xbf140c5f
.long 0x3f4f7a1f, 0xbf15f6d9, 0x3f4e1689, 0xbf17de12, 0x3f4cae79, 0xbf19c200, 0x3f4b41fa, 0xbf1ba299
.long 0x3f3504f3, 0xbf3504f3, 0x3f32c8c9, 0xbf373a23, 0x3f3085bb, 0xbf396842, 0x3f2e3bde, 0xbf3b8f3b
.long 0x3f2beb4a, 0xbf3daef9, 0x3f299415, 0xbf3fc767, 0x3f273656, 0xbf41d870, 0x3f24d225, 0xbf43e200
.long 0x3f0e39da, 0xbf54db31, 0x3f0af1b7, 0xbf570348, 0x3f07a136, 0xbf591e6a, 0x3f044889, 0xbf5b2c79
.long 0x3f00e7e4, 0xbf5d2d53, 0x3efafef7, 0xbf5f20db, 0x3ef41f07, 0xbf6106f2, 0x3eed3063, 0xbf62df7b
.long 0x3ec3ef15, 0xbf6c835e, 0x3ebb31a0, 0xbf6e46be, 0x3eb263ef, 0xbf6ff573, 0x3ea986c4, 0xbf718f57
.long 0x3ea09ae5, 0xbf731447, 0x3e97a117, 0xbf748422, 0x3e8e9a22, 0xbf75dec6, 0x3e8586ce, 0xbf772417
.long 0x3e47c5c2, 0xbf7b14be, 0x3e3228d4, 0xbf7c187a, 0x3e1c76de, 0xbf7cfe73, 0x3e06b26e, 0xbf7dc68c
.long 0x3de1bc2e, 0xbf7e70b0, 0x3db5f8da, 0xbf7efcc9, 0x3d8a200a, 0xbf7f6ac7, 0x3d3c6dd5, 0xbf7fba9e
.long 0x248d3132, 0xbf800000, 0xbcc90ab0, 0xbf7fec43, 0xbd48fb30, 0xbf7fb10f, 0xbd96a905, 0xbf7f4e6d
.long 0xbdc8bd36, 0xbf7ec46d, 0xbdfab273, 0xbf7e1324, 0xbe164083, 0xbf7d3aac, 0xbe2f10a2, 0xbf7c3b28
.long 0xbe47c5c2, 0xbf7b14be, 0xbe636c83, 0xbf799b43, 0xbe7ee6e1, 0xbf77f110, 0xbe8d17c0, 0xbf76167a
.long 0xbe9aa086, 0xbf740bdd, 0xbea80b1f, 0xbf71d19f, 0xbeb554ec, 0xbf6f6830, 0xbec27b55, 0xbf6cd007
.long 0xbec3ef15, 0xbf6c835e, 0xbed25a09, 0xbf696591, 0xbee0924f, 0xbf660f88, 0xbeee9479, 0xbf628210
.long 0xbefc5d27, 0xbf5ebe05, 0xbf04f484, 0xbf5ac450, 0xbf0b9a6b, 0xbf5695e5, 0xbf121eb0, 0xbf5233c6
.long 0xbf0e39da, 0xbf54db31, 0xbf1553b7, 0xbf4fefa8, 0xbf1c420c, 0xbf4ac77f, 0xbf2302d3, 0xbf456439
.long 0xbf299415, 0xbf3fc767, 0xbf2ff3e6, 0xbf39f2ac, 0xbf36206c, 0xbf33e7bc, 0xbf3c17d9, 0xbf2da859
.long 0xbf3504f3, 0xbf3504f3, 0xbf3b8f3b, 0xbf2e3bde, 0xbf41d870, 0xbf273656, 0xbf47de65, 0xbf1ff6cb
.long 0xbf4d9f02, 0xbf187fc0, 0xbf531849, 0xbf10d3cd, 0xbf584853, 0xbf08f59b, 0xbf5d2d53, 0xbf00e7e4
.long 0xbf54db31, 0xbf0e39da, 0xbf5a5ba0, 0xbf05a02c, 0xbf5f8327, 0xbef9a02d, 0xbf644fac, 0xbee79a5d
.long 0xbf68bf3c, 0xbed53641, 0xbf6cd007, 0xbec27b55, 0xbf708066, 0xbeaf713a, 0xbf73ced9, 0xbe9c1faf
.long 0xbf6c835e, 0xbec3ef15, 0xbf708066, 0xbeaf713a, 0xbf740bdd, 0xbe9aa086, 0xbf772417, 0xbe8586ce
.long 0xbf79c79d, 0xbe605c13, 0xbf7bf531, 0xbe354098, 0xbf7dabcc, 0xbe09cf86, 0xbf7eea9d, 0xbdbc3ac3
.long 0xbf7b14be, 0xbe47c5c2, 0xbf7d1cdd, 0xbe195be0, 0xbf7e9bc9, 0xbdd53db9, 0xbf7f90b1, 0xbd6ea038
.long 0xbf7ffb11, 0xbc490e90, 0xbf7fdaaf, 0x3d0a342f, 0xbf7f2f9d, 0x3da3308c, 0xbf7dfa38, 0x3e007745
.long 0x3f800000, 0x00000000, 0x3f800000, 0x00000000, 0x3f800000, 0x00000000, 0x3f800000, 0x00000000
.long 0x3f800000, 0x00000000, 0x3f800000, 0x00000000, 0x3f800000, 0x00000000, 0x3f800000, 0x00000000
.long 0x3f79c79d, 0xbe605c13, 0x3f799b43, 0xbe636c83, 0x3f796e4e, 0xbe667c66, 0x3f7940c0, 0xbe698bba
.long 0x3f791298, 0xbe6c9a7f, 0x3f78e3d6, 0xbe6fa8b2, 0x3f78b47b, 0xbe72b651, 0x3f788486, 0xbe75c35a
.long 0x3f676bd8, 0xbedae880, 0x3f66becc, 0xbeddbe79, 0x3f660f88, 0xbee0924f, 0x3f655e0b, 0xbee363fa
.long 0x3f64aa59, 0xbee63375, 0x3f63f473, 0xbee900b7, 0x3f633c5a, 0xbeebcbbb, 0x3f628210, 0xbeee9479
.long 0x3f49d112, 0xbf1d7fd1, 0x3f485bca, 0xbf1f599f, 0x3f46e22a, 0xbf212ff9, 0x3f456439, 0xbf2302d3
.long 0x3f43e200, 0xbf24d225, 0x3f425b89, 0xbf269de3, 0x3f40d0da, 0xbf286605, 0x3f3f41fc, 0xbf2a2a80
.long 0x3f226799, 0xbf45e403, 0x3f1ff6cb, 0xbf47de65, 0x3f1d7fd1, 0xbf49d112, 0x3f1b02c6, 0xbf4bbbf8
.long 0x3f187fc0, 0xbf4d9f02, 0x3f15f6d9, 0xbf4f7a1f, 0x3f13682a, 0xbf514d3d, 0x3f10d3cd, 0xbf531849
.long 0x3ee63375, 0xbf64aa59, 0x3edf28a9, 0xbf666771, 0x3ed8106b, 0xbf6816a8, 0x3ed0eb2a, 0xbf69b7e4
.long 0x3ec9b953, 0xbf6b4b0c, 0x3ec27b55, 0xbf6cd007, 0x3ebb31a0, 0xbf6e46be, 0x3eb3dca5, 0xbf6faf1b
.long 0x3e78cfcc, 0xbf7853f8, 0x3e667c66, 0xbf796e4e, 0x3e541501, 0xbf7a7302, 0x3e419b37, 0xbf7b61fc
.long 0x3e2f10a2, 0xbf7c3b28, 0x3e1c76de, 0xbf7cfe73, 0x3e09cf86, 0xbf7dabcc, 0x3dee3876, 0xbf7e4323
.long 0x3cc90ab0, 0xbf7fec43, 0x3b490fc6, 0xbf7fffb1, 0xbc96c9b6, 0xbf7ff4e6, 0xbd2351cb, 0xbf7fcbe2
.long 0xbd7b2b74, 0xbf7f84ab, 0xbda973ba, 0xbf7f1f49, 0xbdd53db9, 0xbf7e9bc9, 0xbe007745, 0xbf7dfa38
.long 0xbe47c5c2, 0xbf7b14be, 0xbe605c13, 0xbf79c79d, 0xbe78cfcc, 0xbf7853f8, 0xbe888e93, 0xbf76ba07
.long 0xbe94a031, 0xbf74fa0b, 0xbea09ae5, 0xbf731447, 0xbeac7cd4, 0xbf710908, 0xbeb8442a, 0xbf6ed89e
.long 0xbecf7bca, 0xbf6a09a7, 0xbedc53c1, 0xbf671599, 0xbee900b7, 0xbf63f473, 0xbef58035, 0xbf60a6cf
.long 0xbf00e7e4, 0xbf5d2d53, 0xbf06f686, 0xbf5988ad, 0xbf0cead0, 0xbf55b993, 0xbf12c39a, 0xbf51c0c2
.long 0xbf187fc0, 0xbf4d9f02, 0xbf1ebc12, 0xbf48d8b3, 0xbf24d225, 0xbf43e200, 0xbf2ac082, 0xbf3ebc1b
.long 0xbf3085bb, 0xbf396842, 0xbf36206c, 0xbf33e7bc, 0xbf3b8f3b, 0xbf2e3bde, 0xbf40d0da, 0xbf286605
.long 0xbf41d870, 0xbf273656, 0xbf476085, 0xbf209393, 0xbf4cae79, 0xbf19c200, 0xbf51c0c2, 0xbf12c39a
.long 0xbf5695e5, 0xbf0b9a6b, 0xbf5b2c79, 0xbf044889, 0xbf5f8327, 0xbef9a02d, 0xbf6398ac, 0xbeea6681
.long 0xbf61c598, 0xbef15aea, 0xbf660f88, 0xbee0924f, 0xbf6a09a7, 0xbecf7bca, 0xbf6db293, 0xbebe1d4a
.long 0xbf710908, 0xbeac7cd4, 0xbf740bdd, 0xbe9aa086, 0xbf76ba07, 0xbe888e93, 0xbf791298, 0xbe6c9a7f
.long 0xbf76ba07, 0xbe888e93, 0xbf7940c0, 0xbe698bba, 0xbf7b61fc, 0xbe419b37, 0xbf7d1cdd, 0xbe195be0
.long 0xbf7e70b0, 0xbde1bc2e, 0xbf7f5ce9, 0xbd9064b4, 0xbf7fe129, 0xbcfb49ba, 0xbf7ffd39, 0x3c16cb58
.long 0xbf7fb10f, 0xbd48fb30, 0xbf7ffec4, 0xbbc90f88, 0xbf7fd397, 0x3d16c32c, 0xbf7f2f9d, 0x3da3308c
.long 0xbf7e1324, 0x3dfab273, 0xbf7c7eb0, 0x3e28defc, 0xbf7a7302, 0x3e541501, 0xbf77f110, 0x3e7ee6e1
.long 0xbf7c3b28, 0x3e2f10a2, 0xbf79f35e, 0x3e5d4b1a, 0xbf772417, 0x3e8586ce, 0xbf73ced9, 0x3e9c1faf
.long 0xbf6ff573, 0x3eb263ef, 0xbf6b99fb, 0x3ec8477c, 0xbf66becc, 0x3eddbe79, 0xbf61668a, 0x3ef2bd43
.long 0x3f800000, 0x00000000, 0x3f800000, 0x00000000, 0x3f800000, 0x00000000, 0x3f800000, 0x00000000
.long 0x3f800000, 0x00000000, 0x3f800000, 0x00000000, 0x3f800000, 0x00000000, 0x3f800000, 0x00000000
.long 0x3f7853f8, 0xbe78cfcc, 0x3f7822d1, 0xbe7bdba4, 0x3f77f110, 0xbe7ee6e1, 0x3f77beb7, 0xbe80f8c0
.long 0x3f778bc5, 0xbe827dc0, 0x3f77583a, 0xbe840270, 0x3f772417, 0xbe8586ce, 0x3f76ef5b, 0xbe870ada
.long 0x3f61c598, 0xbef15aea, 0x3f6106f2, 0xbef41f07, 0x3f604621, 0xbef6e0cb, 0x3f5f8327, 0xbef9a02d
.long 0x3f5ebe05, 0xbefc5d27, 0x3f5df6be, 0xbeff17b2, 0x3f5d2d53, 0xbf00e7e4, 0x3f5c61c7, 0xbf0242b1
.long 0x3f3daef9, 0xbf2beb4a, 0x3f3c17d9, 0xbf2da859, 0x3f3a7ca4, 0xbf2f61a5, 0x3f38dd65, 0xbf311722
.long 0x3f373a23, 0xbf32c8c9, 0x3f3592e7, 0xbf34768f, 0x3f33e7bc, 0xbf36206c, 0x3f3238aa, 0xbf37c655
.long 0x3f0e39da, 0xbf54db31, 0x3f0b9a6b, 0xbf5695e5, 0x3f08f59b, 0xbf584853, 0x3f064b82, 0xbf59f26a
.long 0x3f039c3d, 0xbf5b941a, 0x3f00e7e4, 0xbf5d2d53, 0x3efc5d27, 0xbf5ebe05, 0x3ef6e0cb, 0xbf604621
.long 0x3eac7cd4, 0xbf710908, 0x3ea5129f, 0xbf725470, 0x3e9d9e78, 0xbf73913f, 0x3e9620d2, 0xbf74bf62
.long 0x3e8e9a22, 0xbf75dec6, 0x3e870ada, 0xbf76ef5b, 0x3e7ee6e1, 0xbf77f110, 0x3e6fa8b2, 0xbf78e3d6
.long 0x3dc8bd36, 0xbf7ec46d, 0x3da3308c, 0xbf7f2f9d, 0x3d7b2b74, 0xbf7f84ab, 0x3d2fe007, 0xbf7fc38f
.long 0x3cc90ab0, 0xbf7fec43, 0x3bc90f88, 0xbf7ffec4, 0xbc490e90, 0xbf7ffb11, 0xbcfb49ba, 0xbf7fe129
.long 0xbe164083, 0xbf7d3aac, 0xbe2bf804, 0xbf7c5d3a, 0xbe419b37, 0xbf7b61fc, 0xbe57278f, 0xbf7a4910
.long 0xbe6c9a7f, 0xbf791298, 0xbe80f8c0, 0xbf77beb7, 0xbe8b9507, 0xbf764d97, 0xbe9620d2, 0xbf74bf62
.long 0xbec3ef15, 0xbf6c835e, 0xbecf7bca, 0xbf6a09a7, 0xbedae880, 0xbf676bd8, 0xbee63375, 0xbf64aa59
.long 0xbef15aea, 0xbf61c598, 0xbefc5d27, 0xbf5ebe05, 0xbf039c3d, 0xbf5b941a, 0xbf08f59b, 0xbf584853
.long 0xbf187fc0, 0xbf4d9f02, 0xbf1e1e22, 0xbf495521, 0xbf239da9, 0xbf44e3f5, 0xbf28fd41, 0xbf404c5c
.long 0xbf2e3bde, 0xbf3b8f3b, 0xbf33587a, 0xbf36ad7f, 0xbf385216, 0xbf31a81d, 0xbf3d27b8, 0xbf2c800f
.long 0xbf45e403, 0xbf226799, 0xbf4ac77f, 0xbf1c420c, 0xbf4f7a1f, 0xbf15f6d9, 0xbf53fac3, 0xbf0f8784
.long 0xbf584853, 0xbf08f59b, 0xbf5c61c7, 0xbf0242b1, 0xbf604621, 0xbef6e0cb, 0xbf63f473, 0xbee900b7
.long 0xbf676bd8, 0xbedae880, 0xbf6afb8c, 0xbecb2aae, 0xbf6e46be, 0xbebb31a0, 0xbf714c7a, 0xbeab0201
.long 0xbf740bdd, 0xbe9aa086, 0xbf76841b, 0xbe8a11f7, 0xbf78b47b, 0xbe72b651, 0xbf7a9c59, 0xbe5101f1
.long 0xbf7b14be, 0xbe47c5c2, 0xbf7cbfc9, 0xbe22abb6, 0xbf7e1324, 0xbdfab273, 0xbf7f0e58, 0xbdafb680
.long 0xbf7fb10f, 0xbd48fb30, 0xbf7ffb11, 0xbc490e90, 0xbf7fec43, 0x3cc90ab0, 0xbf7f84ab, 0x3d7b2b74
.long 0xbf7fb10f, 0x3d48fb30, 0xbf7efcc9, 0x3db5f8da, 0xbf7de0b1, 0x3e039502, 0xbf7c5d3a, 0x3e2bf804
.long 0xbf7a7302, 0x3e541501, 0xbf7822d1, 0x3e7bdba4, 0xbf756d97, 0x3e919ddd, 0xbf725470, 0x3ea5129f
.long 0xbf74fa0b, 0x3e94a031, 0xbf718f57, 0x3ea986c4, 0xbf6db293, 0x3ebe1d4a, 0xbf696591, 0x3ed25a09
.long 0xbf64aa59, 0x3ee63375, 0xbf5f8327, 0x3ef9a02d, 0xbf59f26a, 0x3f064b82, 0xbf53fac3, 0x3f0f8784
.long 0xbf5b941a, 0x3f039c3d, 0xbf554aa4, 0x3f0d9281, 0xbf4e8d90, 0x3f173c07, 0xbf476085, 0x3f209393
.long 0xbf3fc767, 0x3f299415, 0xbf37c655, 0x3f3238aa, 0xbf2f61a5, 0x3f3a7ca4, 0xbf269de3, 0x3f425b89
.long 0x3f800000, 0x00000000, 0x3f800000, 0x00000000, 0x3f800000, 0x00000000, 0x3f800000, 0x00000000
.long 0x3f800000, 0x00000000, 0x3f800000, 0x00000000, 0x3f800000, 0x00000000, 0x3f800000, 0x00000000
.long 0x3f76ba07, 0xbe888e93, 0x3f76841b, 0xbe8a11f7, 0x3f764d97, 0xbe8b9507, 0x3f76167a, 0xbe8d17c0
.long 0x3f75dec6, 0xbe8e9a22, 0x3f75a67b, 0xbe901c2c, 0x3f756d97, 0xbe919ddd, 0x3f75341d, 0xbe931f35
.long 0x3f5b941a, 0xbf039c3d, 0x3f5ac450, 0xbf04f484, 0x3f59f26a, 0xbf064b82, 0x3f591e6a, 0xbf07a136
.long 0x3f584853, 0xbf08f59b, 0x3f577026, 0xbf0a48ad, 0x3f5695e5, 0xbf0b9a6b, 0x3f55b993, 0xbf0cead0
.long 0x3f3085bb, 0xbf396842, 0x3f2ecef7, 0xbf3b0629, 0x3f2d1469, 0xbf3ca003, 0x3f2b561b, 0xbf3e35c5
.long 0x3f299415, 0xbf3fc767, 0x3f27ce61, 0xbf4154e1, 0x3f26050a, 0xbf42de29, 0x3f24381a, 0xbf446337
.long 0x3ef15aea, 0xbf61c598, 0x3eebcbbb, 0xbf633c5a, 0x3ee63375, 0xbf64aa59, 0x3ee0924f, 0xbf660f88
.long 0x3edae880, 0xbf676bd8, 0x3ed53641, 0xbf68bf3c, 0x3ecf7bca, 0xbf6a09a7, 0x3ec9b953, 0xbf6b4b0c
.long 0x3e605c13, 0xbf79c79d, 0x3e5101f1, 0xbf7a9c59, 0x3e419b37, 0xbf7b61fc, 0x3e3228d4, 0xbf7c187a
.long 0x3e22abb6, 0xbf7cbfc9, 0x3e1324ca, 0xbf7d57de, 0x3e039502, 0xbf7de0b1, 0x3de7fa9a, 0xbf7e5a38
.long 0xbd48fb30, 0xbf7fb10f, 0xbd8a200a, 0xbf7f6ac7, 0xbdafb680, 0xbf7f0e58, 0xbdd53db9, 0xbf7e9bc9
.long 0xbdfab273, 0xbf7e1324, 0xbe1008b7, 0xbf7d7474, 0xbe22abb6, 0xbf7cbfc9, 0xbe354098, 0xbf7bf531
.long 0xbea09ae5, 0xbf731447, 0xbeab0201, 0xbf714c7a, 0xbeb554ec, 0xbf6f6830, 0xbebf926f, 0xbf6d67a1
.long 0xbec9b953, 0xbf6b4b0c, 0xbed3c867, 0xbf6912ae, 0xbeddbe79, 0xbf66becc, 0xbee79a5d, 0xbf644fac
.long 0xbf0e39da, 0xbf54db31, 0xbf13682a, 0xbf514d3d, 0xbf187fc0, 0xbf4d9f02, 0xbf1d7fd1, 0xbf49d112
.long 0xbf226799, 0xbf45e403, 0xbf273656, 0xbf41d870, 0xbf2beb4a, 0xbf3daef9, 0xbf3085bb, 0xbf396842
.long 0xbf41d870, 0xbf273656, 0xbf466354, 0xbf21cbfb, 0xbf4ac77f, 0xbf1c420c, 0xbf4f0417, 0xbf16999f
.long 0xbf531849, 0xbf10d3cd, 0xbf570348, 0xbf0af1b7, 0xbf5ac450, 0xbf04f484, 0xbf5e5aa6, 0xbefdbabb
.long 0xbf676bd8, 0xbedae880, 0xbf6aab7b, 0xbecc9b8b, 0xbf6db293, 0xbebe1d4a, 0xbf708066, 0xbeaf713a
.long 0xbf731447, 0xbea09ae5, 0xbf756d97, 0xbe919ddd, 0xbf778bc5, 0xbe827dc0, 0xbf796e4e, 0xbe667c66
.long 0xbf7c3b28, 0xbe2f10a2, 0xbf7d906e, 0xbe0cec4a, 0xbf7e9bc9, 0xbdd53db9, 0xbf7f5ce9, 0xbd9064b4
.long 0xbf7fd397, 0xbd16c32c, 0xbf7fffb1, 0xbb490fc6, 0xbf7fe129, 0x3cfb49ba, 0xbf7f7808, 0x3d83db0a
.long 0xbf7ec46d, 0x3dc8bd36, 0xbf7dabcc, 0x3e09cf86, 0xbf7c3b28, 0x3e2f10a2, 0xbf7a7302, 0x3e541501
.long 0xbf7853f8, 0x3e78cfcc, 0xbf75dec6, 0x3e8e9a22, 0xbf731447, 0x3ea09ae5, 0xbf6ff573, 0x3eb263ef
.long 0xbf6ed89e, 0x3eb8442a, 0xbf6afb8c, 0x3ecb2aae, 0xbf66becc, 0x3eddbe79, 0xbf62241a, 0x3eeff7fb
.long 0xbf5d2d53, 0x3f00e7e4, 0xbf57dc7f, 0x3f099f4e, 0xbf5233c6, 0x3f121eb0, 0xbf4c3578, 0x3f1a6293
.long 0xbf4d9f02, 0x3f187fc0, 0xbf46e22a, 0x3f212ff9, 0xbf3fc767, 0x3f299415, 0xbf385216, 0x3f31a81d
.long 0xbf3085bb, 0x3f396842, 0xbf286605, 0x3f40d0da, 0xbf1ff6cb, 0x3f47de65, 0xbf173c07, 0x3f4e8d90
.long 0xbf1d7fd1, 0x3f49d112, 0xbf140c5f, 0x3f50d937, 0xbf0a48ad, 0x3f577026, 0xbf003a06, 0x3f5d924d
.long 0xbeebcbbb, 0x3f633c5a, 0xbed6a399, 0x3f686b39, 0xbec1071e, 0x3f6d1c1d, 0xbeab0201, 0x3f714c7a
.long 0x3f800000, 0x00000000, 0x3f800000, 0x00000000, 0x3f800000, 0x00000000, 0x3f800000, 0x00000000
.long 0x3f800000, 0x00000000, 0x3f800000, 0x00000000, 0x3f800000, 0x00000000, 0x3f800000, 0x00000000
.long 0x3f74fa0b, 0xbe94a031, 0x3f74bf62, 0xbe9620d2, 0x3f748422, 0xbe97a117, 0x3f74484b, 0xbe9920fe
.long 0x3f740bdd, 0xbe9aa086, 0x3f73ced9, 0xbe9c1faf, 0x3f73913f, 0xbe9d9e78, 0x3f73530e, 0xbe9f1cdf
.long 0x3f54db31, 0xbf0e39da, 0x3f53fac3, 0xbf0f8784, 0x3f531849, 0xbf10d3cd, 0x3f5233c6, 0xbf121eb0
.long 0x3f514d3d, 0xbf13682a, 0x3f5064af, 0xbf14b039, 0x3f4f7a1f, 0xbf15f6d9, 0x3f4e8d90, 0xbf173c07
.long 0x3f226799, 0xbf45e403, 0x3f209393, 0xbf476085, 0x3f1ebc12, 0xbf48d8b3, 0x3f1ce11f, 0xbf4a4c87
.long 0x3f1b02c6, 0xbf4bbbf8, 0x3f19210f, 0xbf4d26fd, 0x3f173c07, 0xbf4e8d90, 0x3f1553b7, 0xbf4fefa8
.long 0x3ec3ef15, 0xbf6c835e, 0x3ebe1d4a, 0xbf6db293, 0x3eb8442a, 0xbf6ed89e, 0x3eb263ef, 0xbf6ff573
.long 0x3eac7cd4, 0xbf710908, 0x3ea68f12, 0xbf721352, 0x3ea09ae5, 0xbf731447, 0x3e9aa086, 0xbf740bdd
.long 0x3dc8bd36, 0xbf7ec46d, 0x3da973ba, 0xbf7f1f49, 0x3d8a200a, 0xbf7f6ac7, 0x3d55880e, 0xbf7fa6e3
.long 0x3d16c32c, 0xbf7fd397, 0x3cafea69, 0xbf7ff0e3, 0x3bc90f88, 0xbf7ffec4, 0xbc16cb58, 0xbf7ffd39
.long 0xbe47c5c2, 0xbf7b14be, 0xbe5a3997, 0xbf7a1e84, 0xbe6c9a7f, 0xbf791298, 0xbe7ee6e1, 0xbf77f110
.long 0xbe888e93, 0xbf76ba07, 0xbe919ddd, 0xbf756d97, 0xbe9aa086, 0xbf740bdd, 0xbea395c5, 0xbf7294f8
.long 0xbef15aea, 0xbf61c598, 0xbefafef7, 0xbf5f20db, 0xbf0242b1, 0xbf5c61c7, 0xbf06f686, 0xbf5988ad
.long 0xbf0b9a6b, 0xbf5695e5, 0xbf102dd5, 0xbf5389c7, 0xbf14b039, 0xbf5064af, 0xbf19210f, 0xbf4d26fd
.long 0xbf3504f3, 0xbf3504f3, 0xbf396842, 0xbf3085bb, 0xbf3daef9, 0xbf2beb4a, 0xbf41d870, 0xbf273656
.long 0xbf45e403, 0xbf226799, 0xbf49d112, 0xbf1d7fd1, 0xbf4d9f02, 0xbf187fc0, 0xbf514d3d, 0xbf13682a
.long 0xbf61c598, 0xbef15aea, 0xbf650479, 0xbee4cbfe, 0xbf6816a8, 0xbed8106b, 0xbf6afb8c, 0xbecb2aae
.long 0xbf6db293, 0xbebe1d4a, 0xbf703b37, 0xbeb0eacb, 0xbf7294f8, 0xbea395c5, 0xbf74bf62, 0xbe9620d2
.long 0xbf7b14be, 0xbe47c5c2, 0xbf7c7eb0, 0xbe28defc, 0xbf7dabcc, 0xbe09cf86, 0xbf7e9bc9, 0xbdd53db9
.long 0xbf7f4e6d, 0xbd96a905, 0xbf7fc38f, 0xbd2fe007, 0xbf7ffb11, 0xbc490e90, 0xbf7ff4e6, 0x3c96c9b6
.long 0xbf7ec46d, 0x3dc8bd36, 0xbf7dc68c, 0x3e06b26e, 0xbf7c7eb0, 0x3e28defc, 0xbf7aed37, 0x3e4ada4f
.long 0xbf791298, 0x3e6c9a7f, 0xbf76ef5b, 0x3e870ada, 0xbf748422, 0x3e97a117, 0xbf71d19f, 0x3ea80b1f
.long 0xbf6c835e, 0x3ec3ef15, 0xbf68bf3c, 0x3ed53641, 0xbf64aa59, 0x3ee63375, 0xbf604621, 0x3ef6e0cb
.long 0xbf5b941a, 0x3f039c3d, 0xbf5695e5, 0x3f0b9a6b, 0xbf514d3d, 0x3f13682a, 0xbf4bbbf8, 0x3f1b02c6
.long 0xbf45e403, 0x3f226799, 0xbf3f41fc, 0x3f2a2a80, 0xbf385216, 0x3f31a81d, 0xbf311722, 0x3f38dd65
.long 0xbf299415, 0x3f3fc767, 0xbf21cbfb, 0x3f466354, 0xbf19c200, 0x3f4cae79, 0xbf11796b, 0x3f52a649
.long 0xbf0e39da, 0x3f54db31, 0xbf04f484, 0x3f5ac450, 0xbef6e0cb, 0x3f604621, 0xbee363fa, 0x3f655e0b
.long 0xbecf7bca, 0x3f6a09a7, 0xbebb31a0, 0x3f6e46be, 0xbea68f12, 0x3f721352, 0xbe919ddd, 0x3f756d97
.long 0xbe94a031, 0x3f74fa0b, 0xbe7bdba4, 0x3f7822d1, 0xbe4dee60, 0x3f7ac516, 0xbe1f917b, 0x3f7cdf6c
.long 0xbde1bc2e, 0x3f7e70b0, 0xbd83db0a, 0x3f7f7808, 0xbc96c9b6, 0x3f7ff4e6, 0x3ce22a7a, 0x3f7fe705
.long 0x3f800000, 0x00000000, 0x3f800000, 0x00000000, 0x3f800000, 0x00000000, 0x3f800000, 0x00000000
.long 0x3f800000, 0x00000000, 0x3f800000, 0x00000000, 0x3f800000, 0x00000000, 0x3f800000, 0x00000000
.long 0x3f731447, 0xbea09ae5, 0x3f72d4eb, 0xbea21887, 0x3f7294f8, 0xbea395c5, 0x3f725470, 0xbea5129f
.long 0x3f721352, 0xbea68f12, 0x3f71d19f, 0xbea80b1f, 0x3f718f57, 0xbea986c4, 0x3f714c7a, 0xbeab0201
.long 0x3f4d9f02, 0xbf187fc0, 0x3f4cae79, 0xbf19c200, 0x3f4bbbf8, 0xbf1b02c6, 0x3f4ac77f, 0xbf1c420c
.long 0x3f49d112, 0xbf1d7fd1, 0x3f48d8b3, 0xbf1ebc12, 0x3f47de65, 0xbf1ff6cb, 0x3f46e22a, 0xbf212ff9
.long 0x3f13682a, 0xbf514d3d, 0x3f11796b, 0xbf52a649, 0x3f0f8784, 0xbf53fac3, 0x3f0d9281, 0xbf554aa4
.long 0x3f0b9a6b, 0xbf5695e5, 0x3f099f4e, 0xbf57dc7f, 0x3f07a136, 0xbf591e6a, 0x3f05a02c, 0xbf5a5ba0
.long 0x3e94a031, 0xbf74fa0b, 0x3e8e9a22, 0xbf75dec6, 0x3e888e93, 0xbf76ba07, 0x3e827dc0, 0xbf778bc5
.long 0x3e78cfcc, 0xbf7853f8, 0x3e6c9a7f, 0xbf791298, 0x3e605c13, 0xbf79c79d, 0x3e541501, 0xbf7a7302
.long 0xbcc90ab0, 0xbf7fec43, 0xbd2351cb, 0xbf7fcbe2, 0xbd621469, 0xbf7f9c18, 0xbd9064b4, 0xbf7f5ce9
.long 0xbdafb680, 0xbf7f0e58, 0xbdcefdb7, 0xbf7eb069, 0xbdee3876, 0xbf7e4323, 0xbe06b26e, 0xbf7dc68c
.long 0xbeac7cd4, 0xbf710908, 0xbeb554ec, 0xbf6f6830, 0xbebe1d4a, 0xbf6db293, 0xbec6d529, 0xbf6be858
.long 0xbecf7bca, 0xbf6a09a7, 0xbed8106b, 0xbf6816a8, 0xbee0924f, 0xbf660f88, 0xbee900b7, 0xbf63f473
.long 0xbf1d7fd1, 0xbf49d112, 0xbf21cbfb, 0xbf466354, 0xbf26050a, 0xbf42de29, 0xbf2a2a80, 0xbf3f41fc
.long 0xbf2e3bde, 0xbf3b8f3b, 0xbf3238aa, 0xbf37c655, 0xbf36206c, 0xbf33e7bc, 0xbf39f2ac, 0xbf2ff3e6
.long 0xbf54db31, 0xbf0e39da, 0xbf584853, 0xbf08f59b, 0xbf5b941a, 0xbf039c3d, 0xbf5ebe05, 0xbefc5d27
.long 0xbf61c598, 0xbef15aea, 0xbf64aa59, 0xbee63375, 0xbf676bd8, 0xbedae880, 0xbf6a09a7, 0xbecf7bca
.long 0xbf76ba07, 0xbe888e93, 0xbf788486, 0xbe75c35a, 0xbf7a1e84, 0xbe5a3997, 0xbf7b87b2, 0xbe3e853e
.long 0xbf7cbfc9, 0xbe22abb6, 0xbf7dc68c, 0xbe06b26e, 0xbf7e9bc9, 0xbdd53db9, 0xbf7f3f54, 0xbd9cecf9
.long 0xbf7fb10f, 0x3d48fb30, 0xbf7f2f9d, 0x3da3308c, 0xbf7e70b0, 0x3de1bc2e, 0xbf7d7474, 0x3e1008b7
.long 0xbf7c3b28, 0x3e2f10a2, 0xbf7ac516, 0x3e4dee60, 0xbf791298, 0x3e6c9a7f, 0xbf772417, 0x3e8586ce
.long 0xbf6ed89e, 0x3eb8442a, 0xbf6b99fb, 0x3ec8477c, 0xbf6816a8, 0x3ed8106b, 0xbf644fac, 0x3ee79a5d
.long 0xbf604621, 0x3ef6e0cb, 0xbf5bfb34, 0x3f02ef9f, 0xbf577026, 0x3f0a48ad, 0xbf52a649, 0x3f11796b
.long 0xbf45e403, 0x3f226799, 0xbf3fc767, 0x3f299415, 0xbf396842, 0x3f3085bb, 0xbf32c8c9, 0x3f373a23
.long 0xbf2beb4a, 0x3f3daef9, 0xbf24d225, 0x3f43e200, 0xbf1d7fd1, 0x3f49d112, 0xbf15f6d9, 0x3f4f7a1f
.long 0xbf08f59b, 0x3f584853, 0xbf003a06, 0x3f5d924d, 0xbeee9479, 0x3f628210, 0xbedc53c1, 0x3f671599
.long 0xbec9b953, 0x3f6b4b0c, 0xbeb6ccc3, 0x3f6f20b0, 0xbea395c5, 0x3f7294f8, 0xbe901c2c, 0x3f75a67b
.long 0xbe78cfcc, 0x3f7853f8, 0xbe4dee60, 0x3f7ac516, 0xbe22abb6, 0x3f7cbfc9, 0xbdee3876, 0x3f7e4323
.long 0xbd96a905, 0x3f7f4e6d, 0xbcfb49ba, 0x3f7fe129, 0x3c490e90, 0x3f7ffb11, 0x3d621469, 0x3f7f9c18
.long 0x3d96a905, 0x3f7f4e6d, 0x3df475c0, 0x3f7e2b72, 0x3e28defc, 0x3f7c7eb0, 0x3e57278f, 0x3f7a4910
.long 0x3e827dc0, 0x3f778bc5, 0x3e9920fe, 0x3f74484b, 0x3eaf713a, 0x3f708066, 0x3ec5625c, 0x3f6c3624
.long 0x3f800000, 0x00000000, 0x3f800000, 0x00000000, 0x3f800000, 0x00000000, 0x3f800000, 0x00000000
.long 0x3f800000, 0x00000000, 0x3f800000, 0x00000000, 0x3f800000, 0x00000000, 0x3f800000, 0x00000000
.long 0x3f710908, 0xbeac7cd4, 0x3f70c501, 0xbeadf73c, 0x3f708066, 0xbeaf713a, 0x3f703b37, 0xbeb0eacb
.long 0x3f6ff573, 0xbeb263ef, 0x3f6faf1b, 0xbeb3dca5, 0x3f6f6830, 0xbeb554ec, 0x3f6f20b0, 0xbeb6ccc3
.long 0x3f45e403, 0xbf226799, 0x3f44e3f5, 0xbf239da9, 0x3f43e200, 0xbf24d225, 0x3f42de29, 0xbf26050a
.long 0x3f41d870, 0xbf273656, 0x3f40d0da, 0xbf286605, 0x3f3fc767, 0xbf299415, 0x3f3ebc1b, 0xbf2ac082
.long 0x3f039c3d, 0xbf5b941a, 0x3f019573, 0xbf5cc7d1, 0x3eff17b2, 0xbf5df6be, 0x3efafef7, 0xbf5f20db
.long 0x3ef6e0cb, 0xbf604621, 0x3ef2bd43, 0xbf61668a, 0x3eee9479, 0xbf628210, 0x3eea6681, 0xbf6398ac
.long 0x3e47c5c2, 0xbf7b14be, 0x3e3b6ecf, 0xbf7baccd, 0x3e2f10a2, 0xbf7c3b28, 0x3e22abb6, 0xbf7cbfc9
.long 0x3e164083, 0xbf7d3aac, 0x3e09cf86, 0xbf7dabcc, 0x3dfab273, 0xbf7e1324, 0x3de1bc2e, 0xbf7e70b0
.long 0xbe164083, 0xbf7d3aac, 0xbe25c58c, 0xbf7c9f8a, 0xbe354098, 0xbf7bf531, 0xbe44b0b9, 0xbf7b3bab
.long 0xbe541501, 0xbf7a7302, 0xbe636c83, 0xbf799b43, 0xbe72b651, 0xbf78b47b, 0xbe80f8c0, 0xbf77beb7
.long 0xbef15aea, 0xbf61c598, 0xbef9a02d, 0xbf5f8327, 0xbf00e7e4, 0xbf5d2d53, 0xbf04f484, 0xbf5ac450
.long 0xbf08f59b, 0xbf584853, 0xbf0cead0, 0xbf55b993, 0xbf10d3cd, 0xbf531849, 0xbf14b039, 0xbf5064af
.long 0xbf3daef9, 0xbf2beb4a, 0xbf4154e1, 0xbf27ce61, 0xbf44e3f5, 0xbf239da9, 0xbf485bca, 0xbf1f599f
.long 0xbf4bbbf8, 0xbf1b02c6, 0xbf4f0417, 0xbf16999f, 0xbf5233c6, 0xbf121eb0, 0xbf554aa4, 0xbf0d9281
.long 0xbf6c835e, 0xbec3ef15, 0xbf6ed89e, 0xbeb8442a, 0xbf710908, 0xbeac7cd4, 0xbf731447, 0xbea09ae5
.long 0xbf74fa0b, 0xbe94a031, 0xbf76ba07, 0xbe888e93, 0xbf7853f8, 0xbe78cfcc, 0xbf79c79d, 0xbe605c13
.long 0xbf7fb10f, 0xbd48fb30, 0xbf7ff0e3, 0xbcafea69, 0xbf7ffec4, 0x3bc90f88, 0xbf7fdaaf, 0x3d0a342f
.long 0xbf7f84ab, 0x3d7b2b74, 0xbf7efcc9, 0x3db5f8da, 0xbf7e4323, 0x3dee3876, 0xbf7d57de, 0x3e1324ca
.long 0xbf74fa0b, 0x3e94a031, 0xbf7294f8, 0x3ea395c5, 0xbf6ff573, 0x3eb263ef, 0xbf6d1c1d, 0x3ec1071e
.long 0xbf6a09a7, 0x3ecf7bca, 0xbf66becc, 0x3eddbe79, 0xbf633c5a, 0x3eebcbbb, 0xbf5f8327, 0x3ef9a02d
.long 0xbf4d9f02, 0x3f187fc0, 0xbf485bca, 0x3f1f599f, 0xbf42de29, 0x3f26050a, 0xbf3d27b8, 0x3f2c800f
.long 0xbf373a23, 0x3f32c8c9, 0xbf311722, 0x3f38dd65, 0xbf2ac082, 0x3f3ebc1b, 0xbf24381a, 0x3f446337
.long 0xbf0e39da, 0x3f54db31, 0xbf064b82, 0x3f59f26a, 0xbefc5d27, 0x3f5ebe05, 0xbeebcbbb, 0x3f633c5a
.long 0xbedae880, 0x3f676bd8, 0xbec9b953, 0x3f6b4b0c, 0xbeb8442a, 0x3f6ed89e, 0xbea68f12, 0x3f721352
.long 0xbe78cfcc, 0x3f7853f8, 0xbe5101f1, 0x3f7a9c59, 0xbe28defc, 0x3f7c7eb0, 0xbe007745, 0x3f7dfa38
.long 0xbdafb680, 0x3f7f0e58, 0xbd3c6dd5, 0x3f7fba9e, 0xbbc90f88, 0x3f7ffec4, 0x3d0a342f, 0x3f7fdaaf
.long 0x3dc8bd36, 0x3f7ec46d, 0x3e1008b7, 0x3f7d7474, 0x3e3b6ecf, 0x3f7baccd, 0x3e667c66, 0x3f796e4e
.long 0x3e888e93, 0x3f76ba07, 0x3e9d9e78, 0x3f73913f, 0x3eb263ef, 0x3f6ff573, 0x3ec6d529, 0x3f6be858
.long 0x3edae880, 0x3f676bd8, 0x3eeff7fb, 0x3f62241a, 0x3f0242b1, 0x3f5c61c7, 0x3f0c42c9, 0x3f5627fe
.long 0x3f15f6d9, 0x3f4f7a1f, 0x3f1f599f, 0x3f485bca, 0x3f286605, 0x3f40d0da, 0x3f311722, 0x3f38dd65
.long 0x3f800000, 0x00000000, 0x3f800000, 0x00000000, 0x3f800000, 0x00000000, 0x3f800000, 0x00000000
.long 0x3f800000, 0x00000000, 0x3f800000, 0x00000000, 0x3f800000, 0x00000000, 0x3f800000, 0x00000000
.long 0x3f6ed89e, 0xbeb8442a, 0x3f6e8ff8, 0xbeb9bb1e, 0x3f6e46be, 0xbebb31a0, 0x3f6dfcf2, 0xbebca7af
.long 0x3f6db293, 0xbebe1d4a, 0x3f6d67a1, 0xbebf926f, 0x3f6d1c1d, 0xbec1071e, 0x3f6cd007, 0xbec27b55
.long 0x3f3daef9, 0xbf2beb4a, 0x3f3ca003, 0xbf2d1469, 0x3f3b8f3b, 0xbf2e3bde, 0x3f3a7ca4, 0xbf2f61a5
.long 0x3f396842, 0xbf3085bb, 0x3f385216, 0xbf31a81d, 0x3f373a23, 0xbf32c8c9, 0x3f36206c, 0xbf33e7bc
.long 0x3ee63375, 0xbf64aa59, 0x3ee1fb6a, 0xbf65b710, 0x3eddbe79, 0xbf66becc, 0x3ed97cb9, 0xbf67c187
.long 0x3ed53641, 0xbf68bf3c, 0x3ed0eb2a, 0xbf69b7e4, 0x3ecc9b8b, 0xbf6aab7b, 0x3ec8477c, 0xbf6b99fb
.long 0x3dc8bd36, 0xbf7ec46d, 0x3dafb680, 0xbf7f0e58, 0x3d96a905, 0xbf7f4e6d, 0x3d7b2b74, 0xbf7f84ab
.long 0x3d48fb30, 0xbf7fb10f, 0x3d16c32c, 0xbf7fd397, 0x3cc90ab0, 0xbf7fec43, 0x3c490e90, 0xbf7ffb11
.long 0xbe888e93, 0xbf76ba07, 0xbe901c2c, 0xbf75a67b, 0xbe97a117, 0xbf748422, 0xbe9f1cdf, 0xbf73530e
.long 0xbea68f12, 0xbf721352, 0xbeadf73c, 0xbf70c501, 0xbeb554ec, 0xbf6f6830, 0xbebca7af, 0xbf6dfcf2
.long 0xbf187fc0, 0xbf4d9f02, 0xbf1c420c, 0xbf4ac77f, 0xbf1ff6cb, 0xbf47de65, 0xbf239da9, 0xbf44e3f5
.long 0xbf273656, 0xbf41d870, 0xbf2ac082, 0xbf3ebc1b, 0xbf2e3bde, 0xbf3b8f3b, 0xbf31a81d, 0xbf385216
.long 0xbf584853, 0xbf08f59b, 0xbf5b2c79, 0xbf044889, 0xbf5df6be, 0xbeff17b2, 0xbf60a6cf, 0xbef58035
.long 0xbf633c5a, 0xbeebcbbb, 0xbf65b710, 0xbee1fb6a, 0xbf6816a8, 0xbed8106b, 0xbf6a5ad9, 0xbece0bea
.long 0xbf7b14be, 0xbe47c5c2, 0xbf7c3b28, 0xbe2f10a2, 0xbf7d3aac, 0xbe164083, 0xbf7e1324, 0xbdfab273
.long 0xbf7ec46d, 0xbdc8bd36, 0xbf7f4e6d, 0xbd96a905, 0xbf7fb10f, 0xbd48fb30, 0xbf7fec43, 0xbcc90ab0
.long 0xbf7c3b28, 0x3e2f10a2, 0xbf7aed37, 0x3e4ada4f, 0xbf796e4e, 0x3e667c66, 0xbf77beb7, 0x3e80f8c0
.long 0xbf75dec6, 0x3e8e9a22, 0xbf73ced9, 0x3e9c1faf, 0xbf718f57, 0x3ea986c4, 0xbf6f20b0, 0x3eb6ccc3
.long 0xbf5b941a, 0x3f039c3d, 0xbf577026, 0x3f0a48ad, 0xbf531849, 0x3f10d3cd, 0xbf4e8d90, 0x3f173c07
.long 0xbf49d112, 0x3f1d7fd1, 0xbf44e3f5, 0x3f239da9, 0xbf3fc767, 0x3f299415, 0xbf3a7ca4, 0x3f2f61a5
.long 0xbf1d7fd1, 0x3f49d112, 0xbf16999f, 0x3f4f0417, 0xbf0f8784, 0x3f53fac3, 0xbf084b92, 0x3f58b3a1
.long 0xbf00e7e4, 0x3f5d2d53, 0xbef2bd43, 0x3f61668a, 0xbee363fa, 0x3f655e0b, 0xbed3c867, 0x3f6912ae
.long 0xbe94a031, 0x3f74fa0b, 0xbe827dc0, 0x3f778bc5, 0xbe605c13, 0x3f79c79d, 0xbe3b6ecf, 0x3f7baccd
.long 0xbe164083, 0x3f7d3aac, 0xbde1bc2e, 0x3f7e70b0, 0xbd96a905, 0x3f7f4e6d, 0xbd16c32c, 0x3f7fd397
.long 0x3d96a905, 0x3f7f4e6d, 0x3de7fa9a, 0x3f7e5a38, 0x3e1c76de, 0x3f7cfe73, 0x3e44b0b9, 0x3f7b3bab
.long 0x3e6c9a7f, 0x3f791298, 0x3e8a11f7, 0x3f76841b, 0x3e9d9e78, 0x3f73913f, 0x3eb0eacb, 0x3f703b37
.long 0x3edae880, 0x3f676bd8, 0x3eee9479, 0x3f628210, 0x3f00e7e4, 0x3f5d2d53, 0x3f0a48ad, 0x3f577026
.long 0x3f13682a, 0x3f514d3d, 0x3f1c420c, 0x3f4ac77f, 0x3f24d225, 0x3f43e200, 0x3f2d1469, 0x3f3ca003
.long 0x3f396842, 0x3f3085bb, 0x3f4154e1, 0x3f27ce61, 0x3f48d8b3, 0x3f1ebc12, 0x3f4fefa8, 0x3f1553b7
.long 0x3f5695e5, 0x3f0b9a6b, 0x3f5cc7d1, 0x3f019573, 0x3f628210, 0x3eee9479, 0x3f67c187, 0x3ed97cb9
```
